```python
import torch

def _softmax(x, axis=-1):
    return torch.softmax(x, dim=axis)

def _gelu(x):
    return torch.nn.functional.gelu(x, approximate='tanh')

def _silu(x):
    return torch.nn.functional.silu(x)

def _sigmoid(x):
    return torch.sigmoid(x)

def _layernorm(x, axis=-1, eps=1e-05):
    m = x.mean(dim=axis, keepdim=True)
    v = x.var(dim=axis, keepdim=True, unbiased=False)
    return (x - m) / torch.sqrt(v + eps)

def _scatter_add(tgt, idx, src, axis=0):
    return tgt.clone().index_add_(axis, idx, src)

def _segment_sum(src, seg, n):
    out = torch.zeros((n,) + src.shape[1:], dtype=src.dtype)
    return out.index_add_(0, seg, src)

def _pad(x, pw):
    flat = tuple((v for pair in reversed(pw) for v in pair))
    return torch.nn.functional.pad(x, flat)
kernel_name = 'adaLN_cond__grouped_kv_mqa__glu_gated_reglu__prompt'

def setup_inputs():

    _w = lambda a: (lambda t: t.to(torch.bfloat16) if t.is_floating_point() else t)(torch.as_tensor(a))

    def _A_setup():
        B, S, D, H = (1, 2048, 1024, 32)
        Dh = D // H
        return {'x': _w((lambda *s: torch.randn(*s, dtype=torch.bfloat16) * 0.05)(B, S, D)), 'wq': _w((lambda *s: torch.randn(*s, dtype=torch.bfloat16) * 0.05)(D, H * Dh)), 'wk': _w((lambda *s: torch.randn(*s, dtype=torch.bfloat16) * 0.05)(D, Dh)), 'wv': _w((lambda *s: torch.randn(*s, dtype=torch.bfloat16) * 0.05)(D, Dh)), 'wo': _w((lambda *s: torch.randn(*s, dtype=torch.bfloat16) * 0.05)(H * Dh, D))}
    _A_in = _A_setup()

    def _B_setup():
        B, S, D, F = (1, 2048, 1024, 3584)
        return {'x': _w((lambda *s: torch.randn(*s, dtype=torch.bfloat16) * 0.05)(B, S, D)), 'W_gate': _w((lambda *s: torch.randn(*s, dtype=torch.bfloat16) * 0.8)(D, F) * (2.0 / D) ** 0.5), 'W_up': _w((lambda *s: torch.randn(*s, dtype=torch.bfloat16) * 0.8)(D, F) * (2.0 / D) ** 0.5), 'W_down': _w((lambda *s: torch.randn(*s, dtype=torch.bfloat16) * 0.8)(F, D) * (1.0 / F) ** 0.5)}
    _B_in = _B_setup()
    return {'A_x': _A_in['x'], 'A_wq': _A_in['wq'], 'A_wk': _A_in['wk'], 'A_wv': _A_in['wv'], 'A_wo': _A_in['wo'], 'B_x': _B_in['x'], 'B_W_gate': _B_in['W_gate'], 'B_W_up': _B_in['W_up'], 'B_W_down': _B_in['W_down'], 'c': _w((lambda *s: torch.randn(*s, dtype=torch.bfloat16) * 0.1)(1, 1024) * 8.0), 'w_mod': _w((lambda *s: torch.randn(*s, dtype=torch.bfloat16) * 0.1)(1024, 6 * 1024) * 1024 ** (-0.5) * 8.0)}

def reference(A_x, A_wq, A_wk, A_wv, A_wo, B_x, B_W_gate, B_W_up, B_W_down, c, w_mod):

    def _A_ref(x, wq, wk, wv, wo):
        B, S, D = x.shape
        H = 32
        Dh = D // H
        q = (lambda x, *d: x.permute(*d))((x @ wq).reshape(B, S, H, Dh), 0, 2, 1, 3)
        k = x @ wk
        v = x @ wv
        scores = torch.einsum('bhqd,bkd->bhqk', q, k) * Dh ** (-0.5)
        p = _softmax(scores, axis=-1)
        o = torch.einsum('bhqk,bkd->bhqd', p, v)
        return (lambda x, *d: x.permute(*d))(o, 0, 2, 1, 3).reshape(B, S, H * Dh) @ wo

    def _B_ref(x, W_gate, W_up, W_down):
        gate = torch.einsum('bsd,df->bsf', x, W_gate)
        up = torch.einsum('bsd,df->bsf', x, W_up)
        gate = gate * (lambda x, dt: x.to(dt))(gate > 0, gate.dtype)
        h = gate * up
        return torch.einsum('bsf,fd->bsd', h, W_down)
    x = A_x
    mod = (_silu(c) @ w_mod).reshape(c.shape[0], 6, 1, -1)
    sa, ca, ga, sb, cb, gb = (mod[:, 0].clone(), mod[:, 1].clone(), mod[:, 2].clone(), mod[:, 3].clone(), mod[:, 4].clone(), mod[:, 5].clone())
    h = _layernorm(x, axis=-1) * (1 + ca) + sa
    x = x + ga * _A_ref(h, A_wq, A_wk, A_wv, A_wo)
    h = _layernorm(x, axis=-1) * (1 + cb) + sb
    x = x + gb * _B_ref(h, B_W_gate, B_W_up, B_W_down)
    return x
```

```asm
; @launch kernel=k1_kernel grid=(516,1,1) block=(256,1,1) lds=32768
; @launch kernel=k2_kernel grid=(256,1,1) block=(256,1,1) lds=157696
; @launch kernel=k3_kernel grid=(256,1,1) block=(512,1,1) lds=163840
; @launch kernel=k4_kernel grid=(256,1,1) block=(512,1,1) lds=101376
; @launch kernel=k5_kernel grid=(256,1,1) block=(256,1,1) lds=144640
; @launch kernel=k6_kernel grid=(256,1,1) block=(256,1,1) lds=101376
.amdgcn_target "amdgcn-amd-amdhsa--gfx950"
.text
.globl k1_kernel
.p2align 8
.type k1_kernel,@function
k1_kernel:
  s_cmp_ge_u32 s2, 516
  s_cbranch_scc1 k1_end
  s_load_dwordx2 s[4:5], s[0:1], 104
  v_and_b32 v1, 63, v0
  v_lshrrev_b32 v2, 6, v0
  s_nop 0
  v_readfirstlane_b32 s3, v2
  s_cmp_ge_u32 s2, 260
  s_cbranch_scc1 k1_ln
  s_cmp_ge_u32 s2, 192
  s_cbranch_scc1 k1_rt
  s_load_dwordx2 s[6:7], s[0:1], 80
  s_load_dwordx2 s[8:9], s[0:1], 72
  s_lshr_b32 s12, s2, 1
  s_and_b32 s10, s2, 1
  v_lshrrev_b32 v3, 3, v1
  v_lshlrev_b32 v3, 4, v3
  s_lshl_b32 s13, s3, 7
  s_lshl_b32 s11, s10, 9
  s_add_u32 s13, s13, s11
  v_add_u32 v3, s13, v3
  s_mov_b32 s14, 12288
  v_mul_lo_u32 v4, v3, s14
  v_and_b32 v5, 7, v1
  v_lshlrev_b32 v5, 4, v5
  s_lshl_b32 s15, s12, 7
  v_add3_u32 v4, v4, v5, s15
  v_lshlrev_b32 v6, 1, v3
  s_waitcnt lgkmcnt(0)
  s_mov_b32 s16, s6
  s_and_b32 s17, s7, 0xffff
  s_mov_b32 s18, 12582912
  s_mov_b32 s19, 0x00020000
  s_mov_b32 s20, s8
  s_and_b32 s21, s9, 0xffff
  s_mov_b32 s22, 2048
  s_mov_b32 s23, 0x00020000
  s_add_u32 s24, s4, 196608
  s_addc_u32 s25, s5, 0
  s_and_b32 s25, s25, 0xffff
  s_mov_b32 s26, 49152
  s_mov_b32 s27, 0x00020000
  buffer_load_dwordx4 v[8:11], v6, s[20:23], 0 offen
  buffer_load_dwordx4 v[12:15], v6, s[20:23], 0 offen offset:16
  s_mov_b32 s28, 0
  buffer_load_dwordx4 v[32:35], v4, s[16:19], s28 offen nt
  s_add_u32 s28, s28, 12288
  buffer_load_dwordx4 v[36:39], v4, s[16:19], s28 offen nt
  s_add_u32 s28, s28, 12288
  buffer_load_dwordx4 v[40:43], v4, s[16:19], s28 offen nt
  s_add_u32 s28, s28, 12288
  buffer_load_dwordx4 v[44:47], v4, s[16:19], s28 offen nt
  s_add_u32 s28, s28, 12288
  buffer_load_dwordx4 v[48:51], v4, s[16:19], s28 offen nt
  s_add_u32 s28, s28, 12288
  buffer_load_dwordx4 v[52:55], v4, s[16:19], s28 offen nt
  s_add_u32 s28, s28, 12288
  buffer_load_dwordx4 v[56:59], v4, s[16:19], s28 offen nt
  s_add_u32 s28, s28, 12288
  buffer_load_dwordx4 v[60:63], v4, s[16:19], s28 offen nt
  s_add_u32 s28, s28, 12288
  buffer_load_dwordx4 v[64:67], v4, s[16:19], s28 offen nt
  s_add_u32 s28, s28, 12288
  buffer_load_dwordx4 v[68:71], v4, s[16:19], s28 offen nt
  s_add_u32 s28, s28, 12288
  buffer_load_dwordx4 v[72:75], v4, s[16:19], s28 offen nt
  s_add_u32 s28, s28, 12288
  buffer_load_dwordx4 v[76:79], v4, s[16:19], s28 offen nt
  s_add_u32 s28, s28, 12288
  buffer_load_dwordx4 v[80:83], v4, s[16:19], s28 offen nt
  s_add_u32 s28, s28, 12288
  buffer_load_dwordx4 v[84:87], v4, s[16:19], s28 offen nt
  s_add_u32 s28, s28, 12288
  buffer_load_dwordx4 v[88:91], v4, s[16:19], s28 offen nt
  s_add_u32 s28, s28, 12288
  buffer_load_dwordx4 v[92:95], v4, s[16:19], s28 offen nt
  s_waitcnt vmcnt(16)
  v_lshlrev_b32 v28, 16, v8
  v_mul_f32 v29, 0xbfb8aa3b, v28
  v_exp_f32 v29, v29
  s_nop 0
  v_add_f32 v29, 1.0, v29
  v_rcp_f32 v29, v29
  s_nop 0
  v_mul_f32 v29, v28, v29
  v_cvt_pk_bf16_f32 v29, v29, v29
  v_and_b32 v96, 0xffff, v29
  v_and_b32 v112, 0xffff0000, v29
  v_and_b32 v28, 0xffff0000, v8
  v_mul_f32 v29, 0xbfb8aa3b, v28
  v_exp_f32 v29, v29
  s_nop 0
  v_add_f32 v29, 1.0, v29
  v_rcp_f32 v29, v29
  s_nop 0
  v_mul_f32 v29, v28, v29
  v_cvt_pk_bf16_f32 v29, v29, v29
  v_and_b32 v97, 0xffff, v29
  v_and_b32 v113, 0xffff0000, v29
  v_lshlrev_b32 v28, 16, v9
  v_mul_f32 v29, 0xbfb8aa3b, v28
  v_exp_f32 v29, v29
  s_nop 0
  v_add_f32 v29, 1.0, v29
  v_rcp_f32 v29, v29
  s_nop 0
  v_mul_f32 v29, v28, v29
  v_cvt_pk_bf16_f32 v29, v29, v29
  v_and_b32 v98, 0xffff, v29
  v_and_b32 v114, 0xffff0000, v29
  v_and_b32 v28, 0xffff0000, v9
  v_mul_f32 v29, 0xbfb8aa3b, v28
  v_exp_f32 v29, v29
  s_nop 0
  v_add_f32 v29, 1.0, v29
  v_rcp_f32 v29, v29
  s_nop 0
  v_mul_f32 v29, v28, v29
  v_cvt_pk_bf16_f32 v29, v29, v29
  v_and_b32 v99, 0xffff, v29
  v_and_b32 v115, 0xffff0000, v29
  v_lshlrev_b32 v28, 16, v10
  v_mul_f32 v29, 0xbfb8aa3b, v28
  v_exp_f32 v29, v29
  s_nop 0
  v_add_f32 v29, 1.0, v29
  v_rcp_f32 v29, v29
  s_nop 0
  v_mul_f32 v29, v28, v29
  v_cvt_pk_bf16_f32 v29, v29, v29
  v_and_b32 v100, 0xffff, v29
  v_and_b32 v116, 0xffff0000, v29
  v_and_b32 v28, 0xffff0000, v10
  v_mul_f32 v29, 0xbfb8aa3b, v28
  v_exp_f32 v29, v29
  s_nop 0
  v_add_f32 v29, 1.0, v29
  v_rcp_f32 v29, v29
  s_nop 0
  v_mul_f32 v29, v28, v29
  v_cvt_pk_bf16_f32 v29, v29, v29
  v_and_b32 v101, 0xffff, v29
  v_and_b32 v117, 0xffff0000, v29
  v_lshlrev_b32 v28, 16, v11
  v_mul_f32 v29, 0xbfb8aa3b, v28
  v_exp_f32 v29, v29
  s_nop 0
  v_add_f32 v29, 1.0, v29
  v_rcp_f32 v29, v29
  s_nop 0
  v_mul_f32 v29, v28, v29
  v_cvt_pk_bf16_f32 v29, v29, v29
  v_and_b32 v102, 0xffff, v29
  v_and_b32 v118, 0xffff0000, v29
  v_and_b32 v28, 0xffff0000, v11
  v_mul_f32 v29, 0xbfb8aa3b, v28
  v_exp_f32 v29, v29
  s_nop 0
  v_add_f32 v29, 1.0, v29
  v_rcp_f32 v29, v29
  s_nop 0
  v_mul_f32 v29, v28, v29
  v_cvt_pk_bf16_f32 v29, v29, v29
  v_and_b32 v103, 0xffff, v29
  v_and_b32 v119, 0xffff0000, v29
  v_lshlrev_b32 v28, 16, v12
  v_mul_f32 v29, 0xbfb8aa3b, v28
  v_exp_f32 v29, v29
  s_nop 0
  v_add_f32 v29, 1.0, v29
  v_rcp_f32 v29, v29
  s_nop 0
  v_mul_f32 v29, v28, v29
  v_cvt_pk_bf16_f32 v29, v29, v29
  v_and_b32 v104, 0xffff, v29
  v_and_b32 v120, 0xffff0000, v29
  v_and_b32 v28, 0xffff0000, v12
  v_mul_f32 v29, 0xbfb8aa3b, v28
  v_exp_f32 v29, v29
  s_nop 0
  v_add_f32 v29, 1.0, v29
  v_rcp_f32 v29, v29
  s_nop 0
  v_mul_f32 v29, v28, v29
  v_cvt_pk_bf16_f32 v29, v29, v29
  v_and_b32 v105, 0xffff, v29
  v_and_b32 v121, 0xffff0000, v29
  v_lshlrev_b32 v28, 16, v13
  v_mul_f32 v29, 0xbfb8aa3b, v28
  v_exp_f32 v29, v29
  s_nop 0
  v_add_f32 v29, 1.0, v29
  v_rcp_f32 v29, v29
  s_nop 0
  v_mul_f32 v29, v28, v29
  v_cvt_pk_bf16_f32 v29, v29, v29
  v_and_b32 v106, 0xffff, v29
  v_and_b32 v122, 0xffff0000, v29
  v_and_b32 v28, 0xffff0000, v13
  v_mul_f32 v29, 0xbfb8aa3b, v28
  v_exp_f32 v29, v29
  s_nop 0
  v_add_f32 v29, 1.0, v29
  v_rcp_f32 v29, v29
  s_nop 0
  v_mul_f32 v29, v28, v29
  v_cvt_pk_bf16_f32 v29, v29, v29
  v_and_b32 v107, 0xffff, v29
  v_and_b32 v123, 0xffff0000, v29
  v_lshlrev_b32 v28, 16, v14
  v_mul_f32 v29, 0xbfb8aa3b, v28
  v_exp_f32 v29, v29
  s_nop 0
  v_add_f32 v29, 1.0, v29
  v_rcp_f32 v29, v29
  s_nop 0
  v_mul_f32 v29, v28, v29
  v_cvt_pk_bf16_f32 v29, v29, v29
  v_and_b32 v108, 0xffff, v29
  v_and_b32 v124, 0xffff0000, v29
  v_and_b32 v28, 0xffff0000, v14
  v_mul_f32 v29, 0xbfb8aa3b, v28
  v_exp_f32 v29, v29
  s_nop 0
  v_add_f32 v29, 1.0, v29
  v_rcp_f32 v29, v29
  s_nop 0
  v_mul_f32 v29, v28, v29
  v_cvt_pk_bf16_f32 v29, v29, v29
  v_and_b32 v109, 0xffff, v29
  v_and_b32 v125, 0xffff0000, v29
  v_lshlrev_b32 v28, 16, v15
  v_mul_f32 v29, 0xbfb8aa3b, v28
  v_exp_f32 v29, v29
  s_nop 0
  v_add_f32 v29, 1.0, v29
  v_rcp_f32 v29, v29
  s_nop 0
  v_mul_f32 v29, v28, v29
  v_cvt_pk_bf16_f32 v29, v29, v29
  v_and_b32 v110, 0xffff, v29
  v_and_b32 v126, 0xffff0000, v29
  v_and_b32 v28, 0xffff0000, v15
  v_mul_f32 v29, 0xbfb8aa3b, v28
  v_exp_f32 v29, v29
  s_nop 0
  v_add_f32 v29, 1.0, v29
  v_rcp_f32 v29, v29
  s_nop 0
  v_mul_f32 v29, v28, v29
  v_cvt_pk_bf16_f32 v29, v29, v29
  v_and_b32 v111, 0xffff, v29
  v_and_b32 v127, 0xffff0000, v29
  v_mov_b32 v16, 0
  v_mov_b32 v17, 0
  v_mov_b32 v18, 0
  v_mov_b32 v19, 0
  v_mov_b32 v20, 0
  v_mov_b32 v21, 0
  v_mov_b32 v22, 0
  v_mov_b32 v23, 0
  s_waitcnt vmcnt(15)
  v_dot2_f32_bf16 v16, v32, v96, v16
  v_dot2_f32_bf16 v17, v32, v112, v17
  v_dot2_f32_bf16 v18, v33, v96, v18
  v_dot2_f32_bf16 v19, v33, v112, v19
  v_dot2_f32_bf16 v20, v34, v96, v20
  v_dot2_f32_bf16 v21, v34, v112, v21
  v_dot2_f32_bf16 v22, v35, v96, v22
  v_dot2_f32_bf16 v23, v35, v112, v23
  s_waitcnt vmcnt(14)
  v_dot2_f32_bf16 v16, v36, v97, v16
  v_dot2_f32_bf16 v17, v36, v113, v17
  v_dot2_f32_bf16 v18, v37, v97, v18
  v_dot2_f32_bf16 v19, v37, v113, v19
  v_dot2_f32_bf16 v20, v38, v97, v20
  v_dot2_f32_bf16 v21, v38, v113, v21
  v_dot2_f32_bf16 v22, v39, v97, v22
  v_dot2_f32_bf16 v23, v39, v113, v23
  s_waitcnt vmcnt(13)
  v_dot2_f32_bf16 v16, v40, v98, v16
  v_dot2_f32_bf16 v17, v40, v114, v17
  v_dot2_f32_bf16 v18, v41, v98, v18
  v_dot2_f32_bf16 v19, v41, v114, v19
  v_dot2_f32_bf16 v20, v42, v98, v20
  v_dot2_f32_bf16 v21, v42, v114, v21
  v_dot2_f32_bf16 v22, v43, v98, v22
  v_dot2_f32_bf16 v23, v43, v114, v23
  s_waitcnt vmcnt(12)
  v_dot2_f32_bf16 v16, v44, v99, v16
  v_dot2_f32_bf16 v17, v44, v115, v17
  v_dot2_f32_bf16 v18, v45, v99, v18
  v_dot2_f32_bf16 v19, v45, v115, v19
  v_dot2_f32_bf16 v20, v46, v99, v20
  v_dot2_f32_bf16 v21, v46, v115, v21
  v_dot2_f32_bf16 v22, v47, v99, v22
  v_dot2_f32_bf16 v23, v47, v115, v23
  s_waitcnt vmcnt(11)
  v_dot2_f32_bf16 v16, v48, v100, v16
  v_dot2_f32_bf16 v17, v48, v116, v17
  v_dot2_f32_bf16 v18, v49, v100, v18
  v_dot2_f32_bf16 v19, v49, v116, v19
  v_dot2_f32_bf16 v20, v50, v100, v20
  v_dot2_f32_bf16 v21, v50, v116, v21
  v_dot2_f32_bf16 v22, v51, v100, v22
  v_dot2_f32_bf16 v23, v51, v116, v23
  s_waitcnt vmcnt(10)
  v_dot2_f32_bf16 v16, v52, v101, v16
  v_dot2_f32_bf16 v17, v52, v117, v17
  v_dot2_f32_bf16 v18, v53, v101, v18
  v_dot2_f32_bf16 v19, v53, v117, v19
  v_dot2_f32_bf16 v20, v54, v101, v20
  v_dot2_f32_bf16 v21, v54, v117, v21
  v_dot2_f32_bf16 v22, v55, v101, v22
  v_dot2_f32_bf16 v23, v55, v117, v23
  s_waitcnt vmcnt(9)
  v_dot2_f32_bf16 v16, v56, v102, v16
  v_dot2_f32_bf16 v17, v56, v118, v17
  v_dot2_f32_bf16 v18, v57, v102, v18
  v_dot2_f32_bf16 v19, v57, v118, v19
  v_dot2_f32_bf16 v20, v58, v102, v20
  v_dot2_f32_bf16 v21, v58, v118, v21
  v_dot2_f32_bf16 v22, v59, v102, v22
  v_dot2_f32_bf16 v23, v59, v118, v23
  s_waitcnt vmcnt(8)
  v_dot2_f32_bf16 v16, v60, v103, v16
  v_dot2_f32_bf16 v17, v60, v119, v17
  v_dot2_f32_bf16 v18, v61, v103, v18
  v_dot2_f32_bf16 v19, v61, v119, v19
  v_dot2_f32_bf16 v20, v62, v103, v20
  v_dot2_f32_bf16 v21, v62, v119, v21
  v_dot2_f32_bf16 v22, v63, v103, v22
  v_dot2_f32_bf16 v23, v63, v119, v23
  s_waitcnt vmcnt(7)
  v_dot2_f32_bf16 v16, v64, v104, v16
  v_dot2_f32_bf16 v17, v64, v120, v17
  v_dot2_f32_bf16 v18, v65, v104, v18
  v_dot2_f32_bf16 v19, v65, v120, v19
  v_dot2_f32_bf16 v20, v66, v104, v20
  v_dot2_f32_bf16 v21, v66, v120, v21
  v_dot2_f32_bf16 v22, v67, v104, v22
  v_dot2_f32_bf16 v23, v67, v120, v23
  s_waitcnt vmcnt(6)
  v_dot2_f32_bf16 v16, v68, v105, v16
  v_dot2_f32_bf16 v17, v68, v121, v17
  v_dot2_f32_bf16 v18, v69, v105, v18
  v_dot2_f32_bf16 v19, v69, v121, v19
  v_dot2_f32_bf16 v20, v70, v105, v20
  v_dot2_f32_bf16 v21, v70, v121, v21
  v_dot2_f32_bf16 v22, v71, v105, v22
  v_dot2_f32_bf16 v23, v71, v121, v23
  s_waitcnt vmcnt(5)
  v_dot2_f32_bf16 v16, v72, v106, v16
  v_dot2_f32_bf16 v17, v72, v122, v17
  v_dot2_f32_bf16 v18, v73, v106, v18
  v_dot2_f32_bf16 v19, v73, v122, v19
  v_dot2_f32_bf16 v20, v74, v106, v20
  v_dot2_f32_bf16 v21, v74, v122, v21
  v_dot2_f32_bf16 v22, v75, v106, v22
  v_dot2_f32_bf16 v23, v75, v122, v23
  s_waitcnt vmcnt(4)
  v_dot2_f32_bf16 v16, v76, v107, v16
  v_dot2_f32_bf16 v17, v76, v123, v17
  v_dot2_f32_bf16 v18, v77, v107, v18
  v_dot2_f32_bf16 v19, v77, v123, v19
  v_dot2_f32_bf16 v20, v78, v107, v20
  v_dot2_f32_bf16 v21, v78, v123, v21
  v_dot2_f32_bf16 v22, v79, v107, v22
  v_dot2_f32_bf16 v23, v79, v123, v23
  s_waitcnt vmcnt(3)
  v_dot2_f32_bf16 v16, v80, v108, v16
  v_dot2_f32_bf16 v17, v80, v124, v17
  v_dot2_f32_bf16 v18, v81, v108, v18
  v_dot2_f32_bf16 v19, v81, v124, v19
  v_dot2_f32_bf16 v20, v82, v108, v20
  v_dot2_f32_bf16 v21, v82, v124, v21
  v_dot2_f32_bf16 v22, v83, v108, v22
  v_dot2_f32_bf16 v23, v83, v124, v23
  s_waitcnt vmcnt(2)
  v_dot2_f32_bf16 v16, v84, v109, v16
  v_dot2_f32_bf16 v17, v84, v125, v17
  v_dot2_f32_bf16 v18, v85, v109, v18
  v_dot2_f32_bf16 v19, v85, v125, v19
  v_dot2_f32_bf16 v20, v86, v109, v20
  v_dot2_f32_bf16 v21, v86, v125, v21
  v_dot2_f32_bf16 v22, v87, v109, v22
  v_dot2_f32_bf16 v23, v87, v125, v23
  s_waitcnt vmcnt(1)
  v_dot2_f32_bf16 v16, v88, v110, v16
  v_dot2_f32_bf16 v17, v88, v126, v17
  v_dot2_f32_bf16 v18, v89, v110, v18
  v_dot2_f32_bf16 v19, v89, v126, v19
  v_dot2_f32_bf16 v20, v90, v110, v20
  v_dot2_f32_bf16 v21, v90, v126, v21
  v_dot2_f32_bf16 v22, v91, v110, v22
  v_dot2_f32_bf16 v23, v91, v126, v23
  s_waitcnt vmcnt(0)
  v_dot2_f32_bf16 v16, v92, v111, v16
  v_dot2_f32_bf16 v17, v92, v127, v17
  v_dot2_f32_bf16 v18, v93, v111, v18
  v_dot2_f32_bf16 v19, v93, v127, v19
  v_dot2_f32_bf16 v20, v94, v111, v20
  v_dot2_f32_bf16 v21, v94, v127, v21
  v_dot2_f32_bf16 v22, v95, v111, v22
  v_dot2_f32_bf16 v23, v95, v127, v23
  v_add_f32_dpp v16, v16, v16 row_ror:8 row_mask:0xf bank_mask:0xf
  v_add_f32_dpp v17, v17, v17 row_ror:8 row_mask:0xf bank_mask:0xf
  v_add_f32_dpp v18, v18, v18 row_ror:8 row_mask:0xf bank_mask:0xf
  v_add_f32_dpp v19, v19, v19 row_ror:8 row_mask:0xf bank_mask:0xf
  v_add_f32_dpp v20, v20, v20 row_ror:8 row_mask:0xf bank_mask:0xf
  v_add_f32_dpp v21, v21, v21 row_ror:8 row_mask:0xf bank_mask:0xf
  v_add_f32_dpp v22, v22, v22 row_ror:8 row_mask:0xf bank_mask:0xf
  v_add_f32_dpp v23, v23, v23 row_ror:8 row_mask:0xf bank_mask:0xf
  v_mov_b32 v24, v16
  v_mov_b32 v25, v17
  v_mov_b32 v26, v18
  v_mov_b32 v27, v19
  v_mov_b32 v28, v20
  v_mov_b32 v29, v21
  v_mov_b32 v30, v22
  v_mov_b32 v31, v23
  v_permlane16_swap_b32 v16, v24
  v_permlane16_swap_b32 v17, v25
  v_permlane16_swap_b32 v18, v26
  v_permlane16_swap_b32 v19, v27
  v_permlane16_swap_b32 v20, v28
  v_permlane16_swap_b32 v21, v29
  v_permlane16_swap_b32 v22, v30
  v_permlane16_swap_b32 v23, v31
  v_add_f32 v16, v16, v24
  v_add_f32 v17, v17, v25
  v_add_f32 v18, v18, v26
  v_add_f32 v19, v19, v27
  v_add_f32 v20, v20, v28
  v_add_f32 v21, v21, v29
  v_add_f32 v22, v22, v30
  v_add_f32 v23, v23, v31
  v_mov_b32 v24, v16
  v_mov_b32 v25, v17
  v_mov_b32 v26, v18
  v_mov_b32 v27, v19
  v_mov_b32 v28, v20
  v_mov_b32 v29, v21
  v_mov_b32 v30, v22
  v_mov_b32 v31, v23
  v_permlane32_swap_b32 v16, v24
  v_permlane32_swap_b32 v17, v25
  v_permlane32_swap_b32 v18, v26
  v_permlane32_swap_b32 v19, v27
  v_permlane32_swap_b32 v20, v28
  v_permlane32_swap_b32 v21, v29
  v_permlane32_swap_b32 v22, v30
  v_permlane32_swap_b32 v23, v31
  v_add_f32 v16, v16, v24
  v_add_f32 v17, v17, v25
  v_add_f32 v18, v18, v26
  v_add_f32 v19, v19, v27
  v_add_f32 v20, v20, v28
  v_add_f32 v21, v21, v29
  v_add_f32 v22, v22, v30
  v_add_f32 v23, v23, v31
  s_lshl_b32 s13, s3, 8
  v_lshlrev_b32 v7, 1, v5
  v_add_u32 v7, s13, v7
  v_cmp_gt_u32 vcc, 8, v1
  s_nop 2
  s_and_saveexec_b64 s[30:31], vcc
  ds_write_b128 v7, v[16:19]
  ds_write_b128 v7, v[20:23] offset:16
  s_mov_b64 exec, s[30:31]
  s_waitcnt lgkmcnt(0)
  s_barrier
  v_cmp_gt_u32 vcc, 64, v0
  s_nop 2
  s_and_saveexec_b64 s[30:31], vcc
  s_cbranch_execz k1_end
  v_lshlrev_b32 v7, 2, v0
  ds_read_b32 v16, v7 offset:0
  ds_read_b32 v17, v7 offset:256
  ds_read_b32 v18, v7 offset:512
  ds_read_b32 v19, v7 offset:768
  s_waitcnt lgkmcnt(0)
  v_add_f32 v16, v16, v17
  v_add_f32 v16, v16, v18
  v_add_f32 v16, v16, v19
  s_lshl_b32 s15, s12, 8
  s_mul_i32 s16, s10, 24576
  s_add_u32 s15, s15, s16
  buffer_store_dword v16, v7, s[24:27], s15 offen
  s_endpgm
k1_ln:
  s_load_dwordx2 s[6:7], s[0:1], 0
  s_sub_u32 s10, s2, 260
  v_and_b32 v3, 7, v1
  v_lshrrev_b32 v4, 3, v1
  s_lshl_b32 s11, s10, 14
  v_lshlrev_b32 v5, 11, v3
  v_lshl_add_u32 v5, v4, 4, v5
  s_lshl_b32 s12, s3, 9
  s_add_u32 s11, s11, s12
  s_waitcnt lgkmcnt(0)
  s_mov_b32 s16, s6
  s_and_b32 s17, s7, 0xffff
  s_mov_b32 s18, 4194304
  s_mov_b32 s19, 0x00020000
  s_add_u32 s24, s4, 2097152
  s_addc_u32 s25, s5, 0
  s_and_b32 s25, s25, 0xffff
  s_mov_b32 s26, 4194304
  s_mov_b32 s27, 0x00020000
  buffer_load_dwordx4 v[32:35], v5, s[16:19], s11 offen offset:0
  buffer_load_dwordx4 v[36:39], v5, s[16:19], s11 offen offset:128
  buffer_load_dwordx4 v[40:43], v5, s[16:19], s11 offen offset:256
  buffer_load_dwordx4 v[44:47], v5, s[16:19], s11 offen offset:384
  v_lshrrev_b32 v6, 1, v4
  v_lshlrev_b32 v6, 10, v6
  v_and_b32 v7, 1, v4
  v_lshl_add_u32 v6, v7, 9, v6
  s_and_b32 s13, s10, 3
  s_lshl_b32 s13, s13, 7
  v_lshl_add_u32 v6, v3, 4, v6
  v_add_u32 v6, s13, v6
  s_lshr_b32 s14, s10, 2
  s_lshl_b32 s14, s14, 16
  s_lshl_b32 s15, s3, 14
  s_add_u32 s14, s14, s15
  v_lshlrev_b32 v7, 4, v3
  s_lshl_b32 s13, s3, 2
  v_add_u32 v12, s13, v7
  s_waitcnt vmcnt(3)
  v_lshlrev_b32 v64, 16, v32
  v_and_b32 v65, 0xffff0000, v32
  v_lshlrev_b32 v66, 16, v33
  v_and_b32 v67, 0xffff0000, v33
  v_lshlrev_b32 v68, 16, v34
  v_and_b32 v69, 0xffff0000, v34
  v_lshlrev_b32 v70, 16, v35
  v_and_b32 v71, 0xffff0000, v35
  s_waitcnt vmcnt(2)
  v_lshlrev_b32 v72, 16, v36
  v_and_b32 v73, 0xffff0000, v36
  v_lshlrev_b32 v74, 16, v37
  v_and_b32 v75, 0xffff0000, v37
  v_lshlrev_b32 v76, 16, v38
  v_and_b32 v77, 0xffff0000, v38
  v_lshlrev_b32 v78, 16, v39
  v_and_b32 v79, 0xffff0000, v39
  s_waitcnt vmcnt(1)
  v_lshlrev_b32 v80, 16, v40
  v_and_b32 v81, 0xffff0000, v40
  v_lshlrev_b32 v82, 16, v41
  v_and_b32 v83, 0xffff0000, v41
  v_lshlrev_b32 v84, 16, v42
  v_and_b32 v85, 0xffff0000, v42
  v_lshlrev_b32 v86, 16, v43
  v_and_b32 v87, 0xffff0000, v43
  s_waitcnt vmcnt(0)
  v_lshlrev_b32 v88, 16, v44
  v_and_b32 v89, 0xffff0000, v44
  v_lshlrev_b32 v90, 16, v45
  v_and_b32 v91, 0xffff0000, v45
  v_lshlrev_b32 v92, 16, v46
  v_and_b32 v93, 0xffff0000, v46
  v_lshlrev_b32 v94, 16, v47
  v_and_b32 v95, 0xffff0000, v47
  v_add_f32 v8, v64, v68
  v_add_f32 v9, v65, v69
  v_add_f32 v10, v66, v70
  v_add_f32 v11, v67, v71
  v_add_f32 v8, v8, v72
  v_add_f32 v9, v9, v73
  v_add_f32 v10, v10, v74
  v_add_f32 v11, v11, v75
  v_add_f32 v8, v8, v76
  v_add_f32 v9, v9, v77
  v_add_f32 v10, v10, v78
  v_add_f32 v11, v11, v79
  v_add_f32 v8, v8, v80
  v_add_f32 v9, v9, v81
  v_add_f32 v10, v10, v82
  v_add_f32 v11, v11, v83
  v_add_f32 v8, v8, v84
  v_add_f32 v9, v9, v85
  v_add_f32 v10, v10, v86
  v_add_f32 v11, v11, v87
  v_add_f32 v8, v8, v88
  v_add_f32 v9, v9, v89
  v_add_f32 v10, v10, v90
  v_add_f32 v11, v11, v91
  v_add_f32 v8, v8, v92
  v_add_f32 v9, v9, v93
  v_add_f32 v10, v10, v94
  v_add_f32 v11, v11, v95
  v_add_f32 v8, v8, v9
  v_add_f32 v10, v10, v11
  v_add_f32 v8, v8, v10
  s_nop 1
  v_add_f32_dpp v8, v8, v8 row_ror:8 row_mask:0xf bank_mask:0xf
  v_mov_b32 v9, v8
  s_nop 1
  v_permlane16_swap_b32 v8, v9
  v_add_f32 v8, v8, v9
  v_mov_b32 v9, v8
  s_nop 1
  v_permlane32_swap_b32 v8, v9
  v_add_f32 v8, v8, v9
  ds_write_b32 v12, v8
  s_waitcnt lgkmcnt(0)
  s_barrier
  ds_read_b128 v[16:19], v7
  s_waitcnt lgkmcnt(0)
  v_add_f32 v16, v16, v17
  v_add_f32 v16, v16, v18
  v_add_f32 v16, v16, v19
  v_mul_f32 v16, 0x3a800000, v16
  v_sub_f32 v64, v64, v16
  v_sub_f32 v65, v65, v16
  v_sub_f32 v66, v66, v16
  v_sub_f32 v67, v67, v16
  v_sub_f32 v68, v68, v16
  v_sub_f32 v69, v69, v16
  v_sub_f32 v70, v70, v16
  v_sub_f32 v71, v71, v16
  v_sub_f32 v72, v72, v16
  v_sub_f32 v73, v73, v16
  v_sub_f32 v74, v74, v16
  v_sub_f32 v75, v75, v16
  v_sub_f32 v76, v76, v16
  v_sub_f32 v77, v77, v16
  v_sub_f32 v78, v78, v16
  v_sub_f32 v79, v79, v16
  v_sub_f32 v80, v80, v16
  v_sub_f32 v81, v81, v16
  v_sub_f32 v82, v82, v16
  v_sub_f32 v83, v83, v16
  v_sub_f32 v84, v84, v16
  v_sub_f32 v85, v85, v16
  v_sub_f32 v86, v86, v16
  v_sub_f32 v87, v87, v16
  v_sub_f32 v88, v88, v16
  v_sub_f32 v89, v89, v16
  v_sub_f32 v90, v90, v16
  v_sub_f32 v91, v91, v16
  v_sub_f32 v92, v92, v16
  v_sub_f32 v93, v93, v16
  v_sub_f32 v94, v94, v16
  v_sub_f32 v95, v95, v16
  v_mul_f32 v8, v64, v64
  v_mul_f32 v9, v65, v65
  v_mul_f32 v10, v66, v66
  v_mul_f32 v11, v67, v67
  v_fmac_f32 v8, v68, v68
  v_fmac_f32 v9, v69, v69
  v_fmac_f32 v10, v70, v70
  v_fmac_f32 v11, v71, v71
  v_fmac_f32 v8, v72, v72
  v_fmac_f32 v9, v73, v73
  v_fmac_f32 v10, v74, v74
  v_fmac_f32 v11, v75, v75
  v_fmac_f32 v8, v76, v76
  v_fmac_f32 v9, v77, v77
  v_fmac_f32 v10, v78, v78
  v_fmac_f32 v11, v79, v79
  v_fmac_f32 v8, v80, v80
  v_fmac_f32 v9, v81, v81
  v_fmac_f32 v10, v82, v82
  v_fmac_f32 v11, v83, v83
  v_fmac_f32 v8, v84, v84
  v_fmac_f32 v9, v85, v85
  v_fmac_f32 v10, v86, v86
  v_fmac_f32 v11, v87, v87
  v_fmac_f32 v8, v88, v88
  v_fmac_f32 v9, v89, v89
  v_fmac_f32 v10, v90, v90
  v_fmac_f32 v11, v91, v91
  v_fmac_f32 v8, v92, v92
  v_fmac_f32 v9, v93, v93
  v_fmac_f32 v10, v94, v94
  v_fmac_f32 v11, v95, v95
  v_add_f32 v8, v8, v9
  v_add_f32 v10, v10, v11
  v_add_f32 v8, v8, v10
  s_nop 1
  v_add_f32_dpp v8, v8, v8 row_ror:8 row_mask:0xf bank_mask:0xf
  v_mov_b32 v9, v8
  s_nop 1
  v_permlane16_swap_b32 v8, v9
  v_add_f32 v8, v8, v9
  v_mov_b32 v9, v8
  s_nop 1
  v_permlane32_swap_b32 v8, v9
  v_add_f32 v8, v8, v9
  ds_write_b32 v12, v8 offset:128
  s_waitcnt lgkmcnt(0)
  s_barrier
  ds_read_b128 v[16:19], v7 offset:128
  s_waitcnt lgkmcnt(0)
  v_add_f32 v16, v16, v17
  v_add_f32 v16, v16, v18
  v_add_f32 v16, v16, v19
  v_mov_b32 v17, 0x3727c5ac
  v_fmac_f32 v17, 0x3a800000, v16
  v_rsq_f32 v17, v17
  s_nop 0
  v_mul_f32 v64, v64, v17
  v_mul_f32 v65, v65, v17
  v_mul_f32 v66, v66, v17
  v_mul_f32 v67, v67, v17
  v_mul_f32 v68, v68, v17
  v_mul_f32 v69, v69, v17
  v_mul_f32 v70, v70, v17
  v_mul_f32 v71, v71, v17
  v_mul_f32 v72, v72, v17
  v_mul_f32 v73, v73, v17
  v_mul_f32 v74, v74, v17
  v_mul_f32 v75, v75, v17
  v_mul_f32 v76, v76, v17
  v_mul_f32 v77, v77, v17
  v_mul_f32 v78, v78, v17
  v_mul_f32 v79, v79, v17
  v_mul_f32 v80, v80, v17
  v_mul_f32 v81, v81, v17
  v_mul_f32 v82, v82, v17
  v_mul_f32 v83, v83, v17
  v_mul_f32 v84, v84, v17
  v_mul_f32 v85, v85, v17
  v_mul_f32 v86, v86, v17
  v_mul_f32 v87, v87, v17
  v_mul_f32 v88, v88, v17
  v_mul_f32 v89, v89, v17
  v_mul_f32 v90, v90, v17
  v_mul_f32 v91, v91, v17
  v_mul_f32 v92, v92, v17
  v_mul_f32 v93, v93, v17
  v_mul_f32 v94, v94, v17
  v_mul_f32 v95, v95, v17
  v_cvt_pk_bf16_f32 v32, v64, v65
  v_cvt_pk_bf16_f32 v33, v66, v67
  v_cvt_pk_bf16_f32 v34, v68, v69
  v_cvt_pk_bf16_f32 v35, v70, v71
  buffer_store_dwordx4 v[32:35], v6, s[24:27], s14 offen sc1
  s_add_u32 s14, s14, 4096
  v_cvt_pk_bf16_f32 v36, v72, v73
  v_cvt_pk_bf16_f32 v37, v74, v75
  v_cvt_pk_bf16_f32 v38, v76, v77
  v_cvt_pk_bf16_f32 v39, v78, v79
  buffer_store_dwordx4 v[36:39], v6, s[24:27], s14 offen sc1
  s_add_u32 s14, s14, 4096
  v_cvt_pk_bf16_f32 v40, v80, v81
  v_cvt_pk_bf16_f32 v41, v82, v83
  v_cvt_pk_bf16_f32 v42, v84, v85
  v_cvt_pk_bf16_f32 v43, v86, v87
  buffer_store_dwordx4 v[40:43], v6, s[24:27], s14 offen sc1
  s_add_u32 s14, s14, 4096
  v_cvt_pk_bf16_f32 v44, v88, v89
  v_cvt_pk_bf16_f32 v45, v90, v91
  v_cvt_pk_bf16_f32 v46, v92, v93
  v_cvt_pk_bf16_f32 v47, v94, v95
  buffer_store_dwordx4 v[44:47], v6, s[24:27], s14 offen sc1
  s_endpgm
k1_rt:
  s_sub_u32 s10, s2, 192
  s_lshl_b32 s10, s10, 2
  s_add_u32 s10, s10, s3
  s_lshl_b32 s20, s3, 13
  v_bfe_u32 v3, v1, 2, 2
  v_lshrrev_b32 v4, 5, v1
  v_lshl_add_u32 v3, v4, 3, v3
  v_and_b32 v4, 3, v1
  v_bfe_u32 v5, v1, 4, 1
  v_lshlrev_b32 v6, 4, v1
  s_cmp_ge_u32 s10, 256
  s_cbranch_scc1 k1_rtkv
  s_load_dwordx2 s[6:7], s[0:1], 8
  s_lshr_b32 s11, s10, 4
  s_and_b32 s12, s10, 15
  v_lshlrev_b32 v7, 7, v3
  v_lshl_add_u32 v7, v4, 3, v7
  v_lshl_add_u32 v7, v5, 5, v7
  v_add_u32 v7, s20, v7
  v_lshrrev_b32 v8, 3, v1
  v_lshlrev_b32 v8, 11, v8
  v_and_b32 v9, 7, v1
  v_lshl_add_u32 v8, v9, 4, v8
  s_lshl_b32 s13, s11, 17
  s_lshl_b32 s14, s12, 7
  s_add_u32 s13, s13, s14
  s_waitcnt lgkmcnt(0)
  s_mov_b32 s16, s6
  s_and_b32 s17, s7, 0xffff
  s_mov_b32 s18, 2097152
  s_mov_b32 s19, 0x00020000
  s_add_u32 s24, s4, 6291456
  s_addc_u32 s25, s5, 0
  s_and_b32 s25, s25, 0xffff
  s_mov_b32 s26, 2097152
  s_mov_b32 s27, 0x00020000
  s_add_u32 m0, s20, 0
  s_nop 0
  buffer_load_dwordx4 v8, s[16:19], s13 offen lds
  s_add_u32 s13, s13, 16384
  s_add_u32 m0, s20, 1024
  s_nop 0
  buffer_load_dwordx4 v8, s[16:19], s13 offen lds
  s_add_u32 s13, s13, 16384
  s_add_u32 m0, s20, 2048
  s_nop 0
  buffer_load_dwordx4 v8, s[16:19], s13 offen lds
  s_add_u32 s13, s13, 16384
  s_add_u32 m0, s20, 3072
  s_nop 0
  buffer_load_dwordx4 v8, s[16:19], s13 offen lds
  s_add_u32 s13, s13, 16384
  s_add_u32 m0, s20, 4096
  s_nop 0
  buffer_load_dwordx4 v8, s[16:19], s13 offen lds
  s_add_u32 s13, s13, 16384
  s_add_u32 m0, s20, 5120
  s_nop 0
  buffer_load_dwordx4 v8, s[16:19], s13 offen lds
  s_add_u32 s13, s13, 16384
  s_add_u32 m0, s20, 6144
  s_nop 0
  buffer_load_dwordx4 v8, s[16:19], s13 offen lds
  s_add_u32 s13, s13, 16384
  s_add_u32 m0, s20, 7168
  s_nop 0
  buffer_load_dwordx4 v8, s[16:19], s13 offen lds
  s_add_u32 s13, s13, 16384
  s_lshl_b32 s13, s12, 17
  s_lshl_b32 s14, s11, 12
  s_add_u32 s13, s13, s14
  s_add_u32 s14, s13, 0x10000
  s_waitcnt vmcnt(6)
  ds_read_b64_tr_b16 v[32:33], v7 offset:0
  ds_read_b64_tr_b16 v[34:35], v7 offset:512
  ds_read_b64_tr_b16 v[36:37], v7 offset:64
  ds_read_b64_tr_b16 v[38:39], v7 offset:576
  s_waitcnt vmcnt(4)
  ds_read_b64_tr_b16 v[40:41], v7 offset:2048
  ds_read_b64_tr_b16 v[42:43], v7 offset:2560
  ds_read_b64_tr_b16 v[44:45], v7 offset:2112
  ds_read_b64_tr_b16 v[46:47], v7 offset:2624
  s_waitcnt vmcnt(2)
  ds_read_b64_tr_b16 v[48:49], v7 offset:4096
  ds_read_b64_tr_b16 v[50:51], v7 offset:4608
  ds_read_b64_tr_b16 v[52:53], v7 offset:4160
  ds_read_b64_tr_b16 v[54:55], v7 offset:4672
  s_waitcnt vmcnt(0)
  ds_read_b64_tr_b16 v[56:57], v7 offset:6144
  ds_read_b64_tr_b16 v[58:59], v7 offset:6656
  ds_read_b64_tr_b16 v[60:61], v7 offset:6208
  ds_read_b64_tr_b16 v[62:63], v7 offset:6720
  s_waitcnt lgkmcnt(12)
  buffer_store_dwordx4 v[32:35], v6, s[24:27], s13 offen offset:0 sc1
  buffer_store_dwordx4 v[36:39], v6, s[24:27], s14 offen offset:0 sc1
  s_waitcnt lgkmcnt(8)
  buffer_store_dwordx4 v[40:43], v6, s[24:27], s13 offen offset:1024 sc1
  buffer_store_dwordx4 v[44:47], v6, s[24:27], s14 offen offset:1024 sc1
  s_waitcnt lgkmcnt(4)
  buffer_store_dwordx4 v[48:51], v6, s[24:27], s13 offen offset:2048 sc1
  buffer_store_dwordx4 v[52:55], v6, s[24:27], s14 offen offset:2048 sc1
  s_waitcnt lgkmcnt(0)
  buffer_store_dwordx4 v[56:59], v6, s[24:27], s13 offen offset:3072 sc1
  buffer_store_dwordx4 v[60:63], v6, s[24:27], s14 offen offset:3072 sc1
  s_endpgm
k1_rtkv:
  s_sub_u32 s10, s10, 256
  s_lshr_b32 s11, s10, 3
  s_and_b32 s12, s10, 7
  s_load_dwordx2 s[6:7], s[0:1], 16
  s_load_dwordx2 s[8:9], s[0:1], 24
  v_lshlrev_b32 v7, 6, v3
  v_lshl_add_u32 v7, v4, 3, v7
  v_lshl_add_u32 v7, v5, 5, v7
  v_add_u32 v7, s20, v7
  s_lshl_b32 s13, s12, 13
  s_waitcnt lgkmcnt(0)
  s_cmp_eq_u32 s11, 0
  s_cselect_b32 s6, s6, s8
  s_cselect_b32 s7, s7, s9
  s_mov_b32 s16, s6
  s_and_b32 s17, s7, 0xffff
  s_mov_b32 s18, 65536
  s_mov_b32 s19, 0x00020000
  s_add_u32 s24, s4, 8388608
  s_addc_u32 s25, s5, 0
  s_and_b32 s25, s25, 0xffff
  s_mov_b32 s26, 131072
  s_mov_b32 s27, 0x00020000
  s_add_u32 m0, s20, 0
  s_nop 0
  buffer_load_dwordx4 v6, s[16:19], s13 offen lds
  s_add_u32 s13, s13, 1024
  s_add_u32 m0, s20, 1024
  s_nop 0
  buffer_load_dwordx4 v6, s[16:19], s13 offen lds
  s_add_u32 s13, s13, 1024
  s_add_u32 m0, s20, 2048
  s_nop 0
  buffer_load_dwordx4 v6, s[16:19], s13 offen lds
  s_add_u32 s13, s13, 1024
  s_add_u32 m0, s20, 3072
  s_nop 0
  buffer_load_dwordx4 v6, s[16:19], s13 offen lds
  s_add_u32 s13, s13, 1024
  s_add_u32 m0, s20, 4096
  s_nop 0
  buffer_load_dwordx4 v6, s[16:19], s13 offen lds
  s_add_u32 s13, s13, 1024
  s_add_u32 m0, s20, 5120
  s_nop 0
  buffer_load_dwordx4 v6, s[16:19], s13 offen lds
  s_add_u32 s13, s13, 1024
  s_add_u32 m0, s20, 6144
  s_nop 0
  buffer_load_dwordx4 v6, s[16:19], s13 offen lds
  s_add_u32 s13, s13, 1024
  s_add_u32 m0, s20, 7168
  s_nop 0
  buffer_load_dwordx4 v6, s[16:19], s13 offen lds
  s_add_u32 s13, s13, 1024
  s_lshl_b32 s13, s11, 16
  s_lshl_b32 s14, s12, 13
  s_add_u32 s13, s13, s14
  s_add_u32 s14, s13, 4096
  s_waitcnt vmcnt(7)
  ds_read_b64_tr_b16 v[32:33], v7 offset:0
  ds_read_b64_tr_b16 v[34:35], v7 offset:256
  s_waitcnt vmcnt(6)
  ds_read_b64_tr_b16 v[36:37], v7 offset:1024
  ds_read_b64_tr_b16 v[38:39], v7 offset:1280
  s_waitcnt vmcnt(5)
  ds_read_b64_tr_b16 v[40:41], v7 offset:2048
  ds_read_b64_tr_b16 v[42:43], v7 offset:2304
  s_waitcnt vmcnt(4)
  ds_read_b64_tr_b16 v[44:45], v7 offset:3072
  ds_read_b64_tr_b16 v[46:47], v7 offset:3328
  s_waitcnt vmcnt(3)
  ds_read_b64_tr_b16 v[48:49], v7 offset:4096
  ds_read_b64_tr_b16 v[50:51], v7 offset:4352
  s_waitcnt vmcnt(2)
  ds_read_b64_tr_b16 v[52:53], v7 offset:5120
  ds_read_b64_tr_b16 v[54:55], v7 offset:5376
  s_waitcnt vmcnt(1)
  ds_read_b64_tr_b16 v[56:57], v7 offset:6144
  ds_read_b64_tr_b16 v[58:59], v7 offset:6400
  s_waitcnt vmcnt(0)
  ds_read_b64_tr_b16 v[60:61], v7 offset:7168
  ds_read_b64_tr_b16 v[62:63], v7 offset:7424
  s_waitcnt lgkmcnt(14)
  buffer_store_dwordx4 v[32:35], v6, s[24:27], s13 offen offset:0 sc1
  s_waitcnt lgkmcnt(12)
  buffer_store_dwordx4 v[36:39], v6, s[24:27], s13 offen offset:1024 sc1
  s_waitcnt lgkmcnt(10)
  buffer_store_dwordx4 v[40:43], v6, s[24:27], s13 offen offset:2048 sc1
  s_waitcnt lgkmcnt(8)
  buffer_store_dwordx4 v[44:47], v6, s[24:27], s13 offen offset:3072 sc1
  s_waitcnt lgkmcnt(6)
  buffer_store_dwordx4 v[48:51], v6, s[24:27], s14 offen offset:0 sc1
  s_waitcnt lgkmcnt(4)
  buffer_store_dwordx4 v[52:55], v6, s[24:27], s14 offen offset:1024 sc1
  s_waitcnt lgkmcnt(2)
  buffer_store_dwordx4 v[56:59], v6, s[24:27], s14 offen offset:2048 sc1
  s_waitcnt lgkmcnt(0)
  buffer_store_dwordx4 v[60:63], v6, s[24:27], s14 offen offset:3072 sc1
k1_end:
  s_endpgm
.globl k2_kernel
.p2align 8
.type k2_kernel,@function
k2_kernel:
  s_cmp_ge_u32 s2, 256
  s_cbranch_scc1 k2_end
  s_load_dwordx2 s[4:5], s[0:1], 104
  v_and_b32 v1, 63, v0
  v_lshrrev_b32 v10, 6, v0
  v_lshlrev_b32 v2, 4, v1
  v_readfirstlane_b32 s3, v10
  s_and_b32 s6, s2, 7
  s_lshr_b32 s7, s2, 3
  s_lshr_b32 s8, s6, 1
  s_lshl_b32 s8, s8, 3
  s_lshr_b32 s9, s7, 2
  s_add_u32 s8, s8, s9
  s_and_b32 s9, s6, 1
  s_lshl_b32 s9, s9, 2
  s_and_b32 s10, s7, 3
  s_add_u32 s9, s9, s10
  v_lshlrev_b32 v11, 4, v0
  s_waitcnt lgkmcnt(0)
  s_add_u32 s12, s4, 196608
  s_addc_u32 s13, s5, 0
  s_and_b32 s13, s13, 0xffff
  s_mov_b32 s14, 49152
  s_mov_b32 s15, 0x00020000
  s_add_u32 s16, s4, 2097152
  s_addc_u32 s17, s5, 0
  s_and_b32 s17, s17, 0xffff
  s_mov_b32 s18, 4194304
  s_mov_b32 s19, 0x00020000
  s_add_u32 s20, s4, 6291456
  s_addc_u32 s21, s5, 0
  s_and_b32 s21, s21, 0xffff
  s_mov_b32 s22, 2097152
  s_mov_b32 s23, 0x00020000
  s_add_u32 s24, s4, 8388608
  s_addc_u32 s25, s5, 0
  s_and_b32 s25, s25, 0xffff
  s_mov_b32 s26, 131072
  s_mov_b32 s27, 0x00020000
  buffer_load_dwordx4 v[192:195], v11, s[12:15], 0 offen
  s_movk_i32 s28, 0x1000
  buffer_load_dwordx4 v[196:199], v11, s[12:15], s28 offen
  s_movk_i32 s28, 24576
  buffer_load_dwordx4 v[200:203], v11, s[12:15], s28 offen
  s_mov_b32 s28, 28672
  buffer_load_dwordx4 v[204:207], v11, s[12:15], s28 offen
  v_lshlrev_b32 v234, 2, v0
  s_lshl_b32 s50, s2, 10
  s_cmp_ge_u32 s2, 24
  s_cselect_b32 s50, 0x7ff00000, s50
  buffer_load_dword v232, v234, s[12:15], s50 offen
  s_add_u32 s38, s50, 24576
  buffer_load_dword v233, v234, s[12:15], s38 offen
  s_lshl_b32 s29, s8, 17
  s_lshl_b32 s30, s3, 12
  s_add_u32 s29, s29, s30
  s_add_u32 s30, s29, 0x10000
  s_lshl_b32 s31, s9, 2
  s_add_u32 s31, s31, s3
  s_lshl_b32 s31, s31, 16
  s_and_b32 s32, s9, 2
  s_lshr_b32 s33, s9, 2
  s_and_b32 s34, s9, 1
  s_lshl_b32 s35, s33, 16
  s_lshl_b32 s36, s3, 10
  s_add_u32 s35, s35, s36
  buffer_load_dwordx4 v[64:67], v2, s[16:19], s29 offen offset:0
  buffer_load_dwordx4 v[68:71], v2, s[16:19], s29 offen offset:1024
  buffer_load_dwordx4 v[72:75], v2, s[16:19], s29 offen offset:2048
  buffer_load_dwordx4 v[76:79], v2, s[16:19], s29 offen offset:3072
  buffer_load_dwordx4 v[80:83], v2, s[16:19], s30 offen offset:0
  buffer_load_dwordx4 v[84:87], v2, s[16:19], s30 offen offset:1024
  buffer_load_dwordx4 v[88:91], v2, s[16:19], s30 offen offset:2048
  buffer_load_dwordx4 v[92:95], v2, s[16:19], s30 offen offset:3072
  s_add_u32 s29, s29, 16384
  s_add_u32 s30, s30, 16384
  buffer_load_dwordx4 a[0:3], v2, s[20:23], s31 offen offset:0
  buffer_load_dwordx4 a[4:7], v2, s[20:23], s31 offen offset:1024
  buffer_load_dwordx4 a[8:11], v2, s[20:23], s31 offen offset:2048
  buffer_load_dwordx4 a[12:15], v2, s[20:23], s31 offen offset:3072
  s_add_u32 s31, s31, 4096
  buffer_load_dwordx4 v[96:99], v2, s[16:19], s29 offen offset:0
  buffer_load_dwordx4 v[100:103], v2, s[16:19], s29 offen offset:1024
  buffer_load_dwordx4 v[104:107], v2, s[16:19], s29 offen offset:2048
  buffer_load_dwordx4 v[108:111], v2, s[16:19], s29 offen offset:3072
  buffer_load_dwordx4 v[112:115], v2, s[16:19], s30 offen offset:0
  buffer_load_dwordx4 v[116:119], v2, s[16:19], s30 offen offset:1024
  buffer_load_dwordx4 v[120:123], v2, s[16:19], s30 offen offset:2048
  buffer_load_dwordx4 v[124:127], v2, s[16:19], s30 offen offset:3072
  s_add_u32 s29, s29, 16384
  s_add_u32 s30, s30, 16384
  buffer_load_dwordx4 a[16:19], v2, s[20:23], s31 offen offset:0
  buffer_load_dwordx4 a[20:23], v2, s[20:23], s31 offen offset:1024
  buffer_load_dwordx4 a[24:27], v2, s[20:23], s31 offen offset:2048
  buffer_load_dwordx4 a[28:31], v2, s[20:23], s31 offen offset:3072
  s_add_u32 s31, s31, 4096
  v_add_u32 v4, 0x10000, v2
  v_lshrrev_b32 v10, 5, v1
  v_lshlrev_b32 v8, 6, v10
  v_add_u32 v8, 131072, v8
  s_lshl_b32 s36, s3, 12
  v_add_u32 v12, s36, v2
  v_add_u32 v13, 0x10000, v12
  s_lshl_b32 s36, s34, 16
  s_lshl_b32 s37, s3, 10
  s_add_u32 s36, s36, s37
  v_add_u32 v7, s36, v2
  v_lshrrev_b32 v14, 1, v0
  v_lshlrev_b32 v14, 6, v14
  v_and_b32 v15, 1, v0
  v_lshl_add_u32 v14, v15, 4, v14
  v_add_u32 v14, 131072, v14
  s_waitcnt vmcnt(24)
  v_add_f32 v192, v192, v200
  v_add_f32 v196, v196, v204
  v_cvt_pk_bf16_f32 v192, v192, v192
  v_and_b32 v192, 0xffff0000, v192
  v_cvt_pk_bf16_f32 v196, v196, v196
  v_and_b32 v196, 0xffff0000, v196
  v_add_f32 v193, v193, v201
  v_add_f32 v197, v197, v205
  v_cvt_pk_bf16_f32 v193, v193, v193
  v_and_b32 v193, 0xffff0000, v193
  v_cvt_pk_bf16_f32 v197, v197, v197
  v_and_b32 v197, 0xffff0000, v197
  v_add_f32 v194, v194, v202
  v_add_f32 v198, v198, v206
  v_cvt_pk_bf16_f32 v194, v194, v194
  v_and_b32 v194, 0xffff0000, v194
  v_cvt_pk_bf16_f32 v198, v198, v198
  v_and_b32 v198, 0xffff0000, v198
  v_add_f32 v195, v195, v203
  v_add_f32 v199, v199, v207
  v_cvt_pk_bf16_f32 v195, v195, v195
  v_and_b32 v195, 0xffff0000, v195
  v_cvt_pk_bf16_f32 v199, v199, v199
  v_and_b32 v199, 0xffff0000, v199
  v_add_f32 v224, 1.0, v196
  v_cvt_pk_bf16_f32 v224, v224, v224
  v_and_b32 v224, 0xffff0000, v224
  v_add_f32 v225, 1.0, v197
  v_cvt_pk_bf16_f32 v225, v225, v225
  v_and_b32 v225, 0xffff0000, v225
  v_add_f32 v226, 1.0, v198
  v_cvt_pk_bf16_f32 v226, v226, v226
  v_and_b32 v226, 0xffff0000, v226
  v_add_f32 v227, 1.0, v199
  v_cvt_pk_bf16_f32 v227, v227, v227
  v_and_b32 v227, 0xffff0000, v227
  s_mov_b32 s40, s4
  s_and_b32 s41, s5, 0xffff
  s_mov_b32 s42, 24576
  s_mov_b32 s43, 0x00020000
  s_add_u32 s44, s4, 32768
  s_addc_u32 s45, s5, 0
  s_and_b32 s45, s45, 0xffff
  s_mov_b32 s46, 12288
  s_mov_b32 s47, 0x00020000
  v_add_f32 v232, v232, v233
  v_cvt_pk_bf16_f32 v232, v232, v232
  v_and_b32 v232, 0xffff0000, v232
  s_lshr_b32 s38, s2, 2
  s_cmp_eq_u32 s38, 1
  s_cselect_b32 s39, 1.0, 0
  s_cmp_eq_u32 s38, 4
  s_cselect_b32 s39, 1.0, s39
  v_add_f32 v233, s39, v232
  v_cvt_pk_bf16_f32 v233, v233, v233
  v_and_b32 v232, 0xffff0000, v233
  buffer_store_dword v232, v234, s[40:43], s50 offen
  v_lshlrev_b32 v234, 1, v0
  s_lshr_b32 s38, s50, 1
  buffer_store_short v233, v234, s[44:47], s38 offen
  ds_write_b128 v14, v[224:227]
  ds_write_b128 v14, v[192:195] offset:32
  v_mov_b32 v16, 0
  v_mov_b32 v17, 0
  v_mov_b32 v18, 0
  v_mov_b32 v19, 0
  v_mov_b32 v20, 0
  v_mov_b32 v21, 0
  v_mov_b32 v22, 0
  v_mov_b32 v23, 0
  v_mov_b32 v24, 0
  v_mov_b32 v25, 0
  v_mov_b32 v26, 0
  v_mov_b32 v27, 0
  v_mov_b32 v28, 0
  v_mov_b32 v29, 0
  v_mov_b32 v30, 0
  v_mov_b32 v31, 0
  v_mov_b32 v32, 0
  v_mov_b32 v33, 0
  v_mov_b32 v34, 0
  v_mov_b32 v35, 0
  v_mov_b32 v36, 0
  v_mov_b32 v37, 0
  v_mov_b32 v38, 0
  v_mov_b32 v39, 0
  v_mov_b32 v40, 0
  v_mov_b32 v41, 0
  v_mov_b32 v42, 0
  v_mov_b32 v43, 0
  v_mov_b32 v44, 0
  v_mov_b32 v45, 0
  v_mov_b32 v46, 0
  v_mov_b32 v47, 0
  v_mov_b32 v48, 0
  v_mov_b32 v49, 0
  v_mov_b32 v50, 0
  v_mov_b32 v51, 0
  v_mov_b32 v52, 0
  v_mov_b32 v53, 0
  v_mov_b32 v54, 0
  v_mov_b32 v55, 0
  v_mov_b32 v56, 0
  v_mov_b32 v57, 0
  v_mov_b32 v58, 0
  v_mov_b32 v59, 0
  v_mov_b32 v60, 0
  v_mov_b32 v61, 0
  v_mov_b32 v62, 0
  v_mov_b32 v63, 0
  s_waitcnt lgkmcnt(0)
  s_barrier
  s_lshl_b32 s36, s3, 9
  v_add_u32 v8, s36, v8
  s_cmp_lg_u32 s32, 0
  s_cbranch_scc1 k2_nokv2
  ds_read_b128 v[192:195], v8 offset:0
  ds_read_b128 v[196:199], v8 offset:16
  ds_read_b128 v[200:203], v8 offset:32
  ds_read_b128 v[204:207], v8 offset:48
  s_waitcnt vmcnt(18)
  ds_read_b128 v[208:211], v8 offset:128
  ds_read_b128 v[212:215], v8 offset:144
  ds_read_b128 v[216:219], v8 offset:160
  ds_read_b128 v[220:223], v8 offset:176
  s_waitcnt lgkmcnt(4)
  v_lshlrev_b32 v224, 16, v64
  buffer_load_dwordx4 v[128:131], v2, s[16:19], s29 offen offset:0
  v_and_b32 v225, 0xffff0000, v64
  v_lshlrev_b32 v226, 16, v65
  v_and_b32 v227, 0xffff0000, v65
  v_lshlrev_b32 v228, 16, v66
  v_and_b32 v229, 0xffff0000, v66
  buffer_load_dwordx4 v[132:135], v2, s[16:19], s29 offen offset:1024
  v_lshlrev_b32 v230, 16, v67
  v_and_b32 v231, 0xffff0000, v67
  v_fma_f32 v224, v224, v192, v200
  v_fma_f32 v225, v225, v193, v201
  v_fma_f32 v226, v226, v194, v202
  buffer_load_dwordx4 v[136:139], v2, s[16:19], s29 offen offset:2048
  v_fma_f32 v227, v227, v195, v203
  v_fma_f32 v228, v228, v196, v204
  v_fma_f32 v229, v229, v197, v205
  v_fma_f32 v230, v230, v198, v206
  v_fma_f32 v231, v231, v199, v207
  buffer_load_dwordx4 v[140:143], v2, s[16:19], s29 offen offset:3072
  v_cvt_pk_bf16_f32 v64, v224, v225
  v_cvt_pk_bf16_f32 v65, v226, v227
  v_cvt_pk_bf16_f32 v66, v228, v229
  v_cvt_pk_bf16_f32 v67, v230, v231
  ds_write_b128 v12, v[64:67] offset:0
  buffer_load_dwordx4 v[144:147], v2, s[16:19], s30 offen offset:0
  v_lshlrev_b32 v224, 16, v80
  v_and_b32 v225, 0xffff0000, v80
  v_lshlrev_b32 v226, 16, v81
  v_and_b32 v227, 0xffff0000, v81
  v_lshlrev_b32 v228, 16, v82
  buffer_load_dwordx4 v[148:151], v2, s[16:19], s30 offen offset:1024
  v_and_b32 v229, 0xffff0000, v82
  v_lshlrev_b32 v230, 16, v83
  v_and_b32 v231, 0xffff0000, v83
  v_fma_f32 v224, v224, v192, v200
  v_fma_f32 v225, v225, v193, v201
  buffer_load_dwordx4 v[152:155], v2, s[16:19], s30 offen offset:2048
  v_fma_f32 v226, v226, v194, v202
  v_fma_f32 v227, v227, v195, v203
  v_fma_f32 v228, v228, v196, v204
  v_fma_f32 v229, v229, v197, v205
  v_fma_f32 v230, v230, v198, v206
  buffer_load_dwordx4 v[156:159], v2, s[16:19], s30 offen offset:3072
  s_add_u32 s29, s29, 16384
  s_add_u32 s30, s30, 16384
  v_fma_f32 v231, v231, v199, v207
  v_cvt_pk_bf16_f32 v80, v224, v225
  v_cvt_pk_bf16_f32 v81, v226, v227
  v_cvt_pk_bf16_f32 v82, v228, v229
  v_cvt_pk_bf16_f32 v83, v230, v231
  buffer_load_dwordx4 a[32:35], v2, s[20:23], s31 offen offset:0
  ds_write_b128 v13, v[80:83] offset:0
  ds_read_b128 v[192:195], v8 offset:256
  ds_read_b128 v[196:199], v8 offset:272
  ds_read_b128 v[200:203], v8 offset:288
  ds_read_b128 v[204:207], v8 offset:304
  s_waitcnt lgkmcnt(6)
  v_lshlrev_b32 v224, 16, v68
  v_and_b32 v225, 0xffff0000, v68
  buffer_load_dwordx4 a[36:39], v2, s[20:23], s31 offen offset:1024
  v_lshlrev_b32 v226, 16, v69
  v_and_b32 v227, 0xffff0000, v69
  v_lshlrev_b32 v228, 16, v70
  v_and_b32 v229, 0xffff0000, v70
  v_lshlrev_b32 v230, 16, v71
  buffer_load_dwordx4 a[40:43], v2, s[20:23], s31 offen offset:2048
  v_and_b32 v231, 0xffff0000, v71
  v_fma_f32 v224, v224, v208, v216
  v_fma_f32 v225, v225, v209, v217
  v_fma_f32 v226, v226, v210, v218
  v_fma_f32 v227, v227, v211, v219
  buffer_load_dwordx4 a[44:47], v2, s[20:23], s31 offen offset:3072
  s_add_u32 s31, s31, 4096
  v_fma_f32 v228, v228, v212, v220
  v_fma_f32 v229, v229, v213, v221
  v_fma_f32 v230, v230, v214, v222
  v_fma_f32 v231, v231, v215, v223
  v_cvt_pk_bf16_f32 v68, v224, v225
  buffer_load_dwordx4 a[128:131], v2, s[24:27], s35 offen
  s_add_u32 s35, s35, 4096
  v_cvt_pk_bf16_f32 v69, v226, v227
  v_cvt_pk_bf16_f32 v70, v228, v229
  v_cvt_pk_bf16_f32 v71, v230, v231
  ds_write_b128 v12, v[68:71] offset:1024
  v_lshlrev_b32 v224, 16, v84
  buffer_load_dwordx4 a[132:135], v2, s[24:27], s35 offen
  s_add_u32 s35, s35, 4096
  v_and_b32 v225, 0xffff0000, v84
  v_lshlrev_b32 v226, 16, v85
  v_and_b32 v227, 0xffff0000, v85
  v_lshlrev_b32 v228, 16, v86
  v_and_b32 v229, 0xffff0000, v86
  buffer_load_dwordx4 v[160:163], v2, s[16:19], s29 offen offset:0
  v_lshlrev_b32 v230, 16, v87
  v_and_b32 v231, 0xffff0000, v87
  v_fma_f32 v224, v224, v208, v216
  v_fma_f32 v225, v225, v209, v217
  v_fma_f32 v226, v226, v210, v218
  buffer_load_dwordx4 v[164:167], v2, s[16:19], s29 offen offset:1024
  v_fma_f32 v227, v227, v211, v219
  v_fma_f32 v228, v228, v212, v220
  v_fma_f32 v229, v229, v213, v221
  v_fma_f32 v230, v230, v214, v222
  v_fma_f32 v231, v231, v215, v223
  buffer_load_dwordx4 v[168:171], v2, s[16:19], s29 offen offset:2048
  v_cvt_pk_bf16_f32 v84, v224, v225
  v_cvt_pk_bf16_f32 v85, v226, v227
  v_cvt_pk_bf16_f32 v86, v228, v229
  v_cvt_pk_bf16_f32 v87, v230, v231
  ds_write_b128 v13, v[84:87] offset:1024
  buffer_load_dwordx4 v[172:175], v2, s[16:19], s29 offen offset:3072
  ds_read_b128 v[208:211], v8 offset:384
  ds_read_b128 v[212:215], v8 offset:400
  ds_read_b128 v[216:219], v8 offset:416
  ds_read_b128 v[220:223], v8 offset:432
  s_waitcnt lgkmcnt(6)
  v_lshlrev_b32 v224, 16, v72
  v_and_b32 v225, 0xffff0000, v72
  v_lshlrev_b32 v226, 16, v73
  buffer_load_dwordx4 v[176:179], v2, s[16:19], s30 offen offset:0
  v_and_b32 v227, 0xffff0000, v73
  v_lshlrev_b32 v228, 16, v74
  v_and_b32 v229, 0xffff0000, v74
  v_lshlrev_b32 v230, 16, v75
  v_and_b32 v231, 0xffff0000, v75
  buffer_load_dwordx4 v[180:183], v2, s[16:19], s30 offen offset:1024
  v_fma_f32 v224, v224, v192, v200
  v_fma_f32 v225, v225, v193, v201
  v_fma_f32 v226, v226, v194, v202
  v_fma_f32 v227, v227, v195, v203
  v_fma_f32 v228, v228, v196, v204
  buffer_load_dwordx4 v[184:187], v2, s[16:19], s30 offen offset:2048
  v_fma_f32 v229, v229, v197, v205
  v_fma_f32 v230, v230, v198, v206
  v_fma_f32 v231, v231, v199, v207
  v_cvt_pk_bf16_f32 v72, v224, v225
  v_cvt_pk_bf16_f32 v73, v226, v227
  buffer_load_dwordx4 v[188:191], v2, s[16:19], s30 offen offset:3072
  s_add_u32 s29, s29, 16384
  s_add_u32 s30, s30, 16384
  v_cvt_pk_bf16_f32 v74, v228, v229
  v_cvt_pk_bf16_f32 v75, v230, v231
  ds_write_b128 v12, v[72:75] offset:2048
  v_lshlrev_b32 v224, 16, v88
  v_and_b32 v225, 0xffff0000, v88
  buffer_load_dwordx4 a[48:51], v2, s[20:23], s31 offen offset:0
  v_lshlrev_b32 v226, 16, v89
  v_and_b32 v227, 0xffff0000, v89
  v_lshlrev_b32 v228, 16, v90
  v_and_b32 v229, 0xffff0000, v90
  v_lshlrev_b32 v230, 16, v91
  buffer_load_dwordx4 a[52:55], v2, s[20:23], s31 offen offset:1024
  v_and_b32 v231, 0xffff0000, v91
  v_fma_f32 v224, v224, v192, v200
  v_fma_f32 v225, v225, v193, v201
  v_fma_f32 v226, v226, v194, v202
  v_fma_f32 v227, v227, v195, v203
  buffer_load_dwordx4 a[56:59], v2, s[20:23], s31 offen offset:2048
  v_fma_f32 v228, v228, v196, v204
  v_fma_f32 v229, v229, v197, v205
  v_fma_f32 v230, v230, v198, v206
  v_fma_f32 v231, v231, v199, v207
  v_cvt_pk_bf16_f32 v88, v224, v225
  buffer_load_dwordx4 a[60:63], v2, s[20:23], s31 offen offset:3072
  s_add_u32 s31, s31, 4096
  v_cvt_pk_bf16_f32 v89, v226, v227
  v_cvt_pk_bf16_f32 v90, v228, v229
  v_cvt_pk_bf16_f32 v91, v230, v231
  ds_write_b128 v13, v[88:91] offset:2048
  buffer_load_dwordx4 a[136:139], v2, s[24:27], s35 offen
  s_add_u32 s35, s35, 4096
  s_waitcnt lgkmcnt(2)
  v_lshlrev_b32 v224, 16, v76
  v_and_b32 v225, 0xffff0000, v76
  v_lshlrev_b32 v226, 16, v77
  v_and_b32 v227, 0xffff0000, v77
  buffer_load_dwordx4 a[140:143], v2, s[24:27], s35 offen
  s_add_u32 s35, s35, 4096
  v_lshlrev_b32 v228, 16, v78
  v_and_b32 v229, 0xffff0000, v78
  v_lshlrev_b32 v230, 16, v79
  v_and_b32 v231, 0xffff0000, v79
  v_fma_f32 v224, v224, v208, v216
  buffer_load_dwordx4 a[64:67], v2, s[20:23], s31 offen offset:0
  v_fma_f32 v225, v225, v209, v217
  v_fma_f32 v226, v226, v210, v218
  v_fma_f32 v227, v227, v211, v219
  v_fma_f32 v228, v228, v212, v220
  v_fma_f32 v229, v229, v213, v221
  buffer_load_dwordx4 a[68:71], v2, s[20:23], s31 offen offset:1024
  v_fma_f32 v230, v230, v214, v222
  v_fma_f32 v231, v231, v215, v223
  v_cvt_pk_bf16_f32 v76, v224, v225
  v_cvt_pk_bf16_f32 v77, v226, v227
  v_cvt_pk_bf16_f32 v78, v228, v229
  buffer_load_dwordx4 a[72:75], v2, s[20:23], s31 offen offset:2048
  v_cvt_pk_bf16_f32 v79, v230, v231
  ds_write_b128 v12, v[76:79] offset:3072
  v_lshlrev_b32 v224, 16, v92
  v_and_b32 v225, 0xffff0000, v92
  v_lshlrev_b32 v226, 16, v93
  buffer_load_dwordx4 a[76:79], v2, s[20:23], s31 offen offset:3072
  s_add_u32 s31, s31, 4096
  v_and_b32 v227, 0xffff0000, v93
  v_lshlrev_b32 v228, 16, v94
  v_and_b32 v229, 0xffff0000, v94
  v_lshlrev_b32 v230, 16, v95
  v_and_b32 v231, 0xffff0000, v95
  v_fma_f32 v224, v224, v208, v216
  v_fma_f32 v225, v225, v209, v217
  v_fma_f32 v226, v226, v210, v218
  v_fma_f32 v227, v227, v211, v219
  v_fma_f32 v228, v228, v212, v220
  v_fma_f32 v229, v229, v213, v221
  v_fma_f32 v230, v230, v214, v222
  v_fma_f32 v231, v231, v215, v223
  v_cvt_pk_bf16_f32 v92, v224, v225
  v_cvt_pk_bf16_f32 v93, v226, v227
  v_cvt_pk_bf16_f32 v94, v228, v229
  v_cvt_pk_bf16_f32 v95, v230, v231
  ds_write_b128 v13, v[92:95] offset:3072
  s_waitcnt lgkmcnt(0)
  s_barrier
  ds_read_b128 v[232:235], v2 offset:0
  ds_read_b128 v[236:239], v4 offset:0
  ds_read_b128 a[240:243], v7 offset:0
  ds_read_b128 v[240:243], v2 offset:1024
  ds_read_b128 v[244:247], v4 offset:1024
  ds_read_b128 v[192:195], v8 offset:2048
  ds_read_b128 v[196:199], v8 offset:2064
  ds_read_b128 v[200:203], v8 offset:2080
  ds_read_b128 v[204:207], v8 offset:2096
  s_waitcnt vmcnt(38)
  ds_read_b128 v[208:211], v8 offset:2176
  ds_read_b128 v[212:215], v8 offset:2192
  ds_read_b128 v[216:219], v8 offset:2208
  ds_read_b128 v[220:223], v8 offset:2224
  s_waitcnt lgkmcnt(4)
  v_mfma_f32_32x32x16_bf16 v[16:31], a[0:3], v[232:235], v[16:31]
  v_lshlrev_b32 v224, 16, v96
  v_and_b32 v225, 0xffff0000, v96
  v_lshlrev_b32 v226, 16, v97
  v_and_b32 v227, 0xffff0000, v97
  v_lshlrev_b32 v228, 16, v98
  buffer_load_dwordx4 a[80:83], v2, s[20:23], s31 offen offset:0
  v_mfma_f32_32x32x16_bf16 v[32:47], a[0:3], v[236:239], v[32:47]
  v_and_b32 v229, 0xffff0000, v98
  v_lshlrev_b32 v230, 16, v99
  v_and_b32 v231, 0xffff0000, v99
  v_fma_f32 v224, v224, v192, v200
  buffer_load_dwordx4 a[84:87], v2, s[20:23], s31 offen offset:1024
  ds_read_b128 v[248:251], v2 offset:2048
  ds_read_b128 v[252:255], v4 offset:2048
  v_mfma_f32_32x32x16_bf16 v[16:31], a[4:7], v[240:243], v[16:31]
  v_fma_f32 v225, v225, v193, v201
  v_fma_f32 v226, v226, v194, v202
  v_fma_f32 v227, v227, v195, v203
  v_fma_f32 v228, v228, v196, v204
  v_fma_f32 v229, v229, v197, v205
  buffer_load_dwordx4 a[88:91], v2, s[20:23], s31 offen offset:2048
  v_mfma_f32_32x32x16_bf16 v[32:47], a[4:7], v[244:247], v[32:47]
  v_fma_f32 v230, v230, v198, v206
  v_fma_f32 v231, v231, v199, v207
  v_cvt_pk_bf16_f32 v96, v224, v225
  v_cvt_pk_bf16_f32 v97, v226, v227
  buffer_load_dwordx4 a[92:95], v2, s[20:23], s31 offen offset:3072
  s_add_u32 s31, s31, 4096
  s_waitcnt vmcnt(23)
  v_mfma_f32_32x32x16_bf16 v[48:63], a[128:131], a[240:243], v[48:63]
  v_cvt_pk_bf16_f32 v98, v228, v229
  v_cvt_pk_bf16_f32 v99, v230, v231
  ds_write_b128 v12, v[96:99] offset:16384
  v_lshlrev_b32 v224, 16, v112
  v_and_b32 v225, 0xffff0000, v112
  buffer_load_dwordx4 a[96:99], v2, s[20:23], s31 offen offset:0
  ds_read_b128 v[232:235], v2 offset:3072
  ds_read_b128 v[236:239], v4 offset:3072
  s_waitcnt lgkmcnt(3)
  v_mfma_f32_32x32x16_bf16 v[16:31], a[8:11], v[248:251], v[16:31]
  v_lshlrev_b32 v226, 16, v113
  v_and_b32 v227, 0xffff0000, v113
  v_lshlrev_b32 v228, 16, v114
  v_and_b32 v229, 0xffff0000, v114
  v_lshlrev_b32 v230, 16, v115
  buffer_load_dwordx4 a[100:103], v2, s[20:23], s31 offen offset:1024
  v_mfma_f32_32x32x16_bf16 v[32:47], a[8:11], v[252:255], v[32:47]
  v_and_b32 v231, 0xffff0000, v115
  v_fma_f32 v224, v224, v192, v200
  v_fma_f32 v225, v225, v193, v201
  v_fma_f32 v226, v226, v194, v202
  buffer_load_dwordx4 a[104:107], v2, s[20:23], s31 offen offset:2048
  ds_read_b128 v[240:243], v2 offset:4096
  ds_read_b128 v[244:247], v4 offset:4096
  ds_read_b128 a[244:247], v7 offset:4096
  s_waitcnt lgkmcnt(3)
  v_mfma_f32_32x32x16_bf16 v[16:31], a[12:15], v[232:235], v[16:31]
  v_fma_f32 v227, v227, v195, v203
  v_fma_f32 v228, v228, v196, v204
  v_fma_f32 v229, v229, v197, v205
  v_fma_f32 v230, v230, v198, v206
  v_fma_f32 v231, v231, v199, v207
  buffer_load_dwordx4 a[108:111], v2, s[20:23], s31 offen offset:3072
  s_add_u32 s31, s31, 4096
  v_mfma_f32_32x32x16_bf16 v[32:47], a[12:15], v[236:239], v[32:47]
  v_cvt_pk_bf16_f32 v112, v224, v225
  v_cvt_pk_bf16_f32 v113, v226, v227
  v_cvt_pk_bf16_f32 v114, v228, v229
  v_cvt_pk_bf16_f32 v115, v230, v231
  ds_read_b128 v[248:251], v2 offset:5120
  ds_read_b128 v[252:255], v4 offset:5120
  s_waitcnt lgkmcnt(3)
  v_mfma_f32_32x32x16_bf16 v[16:31], a[16:19], v[240:243], v[16:31]
  ds_write_b128 v13, v[112:115] offset:16384
  ds_read_b128 v[192:195], v8 offset:2304
  ds_read_b128 v[196:199], v8 offset:2320
  ds_read_b128 v[200:203], v8 offset:2336
  ds_read_b128 v[204:207], v8 offset:2352
  v_lshlrev_b32 v224, 16, v100
  v_and_b32 v225, 0xffff0000, v100
  buffer_load_dwordx4 a[112:115], v2, s[20:23], s31 offen offset:0
  v_mfma_f32_32x32x16_bf16 v[32:47], a[16:19], v[244:247], v[32:47]
  v_lshlrev_b32 v226, 16, v101
  v_and_b32 v227, 0xffff0000, v101
  v_lshlrev_b32 v228, 16, v102
  v_and_b32 v229, 0xffff0000, v102
  v_lshlrev_b32 v230, 16, v103
  buffer_load_dwordx4 a[116:119], v2, s[20:23], s31 offen offset:1024
  ds_read_b128 v[232:235], v2 offset:6144
  ds_read_b128 v[236:239], v4 offset:6144
  s_waitcnt lgkmcnt(7)
  v_mfma_f32_32x32x16_bf16 v[16:31], a[20:23], v[248:251], v[16:31]
  v_and_b32 v231, 0xffff0000, v103
  v_fma_f32 v224, v224, v208, v216
  v_fma_f32 v225, v225, v209, v217
  v_fma_f32 v226, v226, v210, v218
  buffer_load_dwordx4 a[120:123], v2, s[20:23], s31 offen offset:2048
  v_mfma_f32_32x32x16_bf16 v[32:47], a[20:23], v[252:255], v[32:47]
  v_fma_f32 v227, v227, v211, v219
  v_fma_f32 v228, v228, v212, v220
  v_fma_f32 v229, v229, v213, v221
  v_fma_f32 v230, v230, v214, v222
  v_fma_f32 v231, v231, v215, v223
  buffer_load_dwordx4 a[124:127], v2, s[20:23], s31 offen offset:3072
  s_add_u32 s31, s31, 4096
  s_waitcnt vmcnt(30)
  v_mfma_f32_32x32x16_bf16 v[48:63], a[132:135], a[244:247], v[48:63]
  v_cvt_pk_bf16_f32 v100, v224, v225
  v_cvt_pk_bf16_f32 v101, v226, v227
  v_cvt_pk_bf16_f32 v102, v228, v229
  v_cvt_pk_bf16_f32 v103, v230, v231
  buffer_load_dwordx4 a[144:147], v2, s[24:27], s35 offen
  s_add_u32 s35, s35, 4096
  ds_read_b128 v[240:243], v2 offset:7168
  ds_read_b128 v[244:247], v4 offset:7168
  s_waitcnt lgkmcnt(2)
  v_mfma_f32_32x32x16_bf16 v[16:31], a[24:27], v[232:235], v[16:31]
  ds_write_b128 v12, v[100:103] offset:17408
  v_lshlrev_b32 v224, 16, v116
  v_and_b32 v225, 0xffff0000, v116
  v_lshlrev_b32 v226, 16, v117
  v_and_b32 v227, 0xffff0000, v117
  buffer_load_dwordx4 a[148:151], v2, s[24:27], s35 offen
  s_add_u32 s35, s35, 4096
  v_mfma_f32_32x32x16_bf16 v[32:47], a[24:27], v[236:239], v[32:47]
  v_lshlrev_b32 v228, 16, v118
  v_and_b32 v229, 0xffff0000, v118
  v_lshlrev_b32 v230, 16, v119
  v_and_b32 v231, 0xffff0000, v119
  v_fma_f32 v224, v224, v208, v216
  buffer_load_dwordx4 a[152:155], v2, s[24:27], s35 offen
  s_add_u32 s35, s35, 4096
  ds_read_b128 v[248:251], v2 offset:8192
  ds_read_b128 v[252:255], v4 offset:8192
  ds_read_b128 a[240:243], v7 offset:8192
  s_waitcnt lgkmcnt(4)
  v_mfma_f32_32x32x16_bf16 v[16:31], a[28:31], v[240:243], v[16:31]
  v_fma_f32 v225, v225, v209, v217
  v_fma_f32 v226, v226, v210, v218
  v_fma_f32 v227, v227, v211, v219
  v_fma_f32 v228, v228, v212, v220
  buffer_load_dwordx4 a[156:159], v2, s[24:27], s35 offen
  s_add_u32 s35, s35, 4096
  v_mfma_f32_32x32x16_bf16 v[32:47], a[28:31], v[244:247], v[32:47]
  v_fma_f32 v229, v229, v213, v221
  v_fma_f32 v230, v230, v214, v222
  v_fma_f32 v231, v231, v215, v223
  v_cvt_pk_bf16_f32 v116, v224, v225
  v_cvt_pk_bf16_f32 v117, v226, v227
  buffer_load_dwordx4 a[0:3], v2, s[20:23], s31 offen offset:0
  ds_read_b128 v[232:235], v2 offset:9216
  ds_read_b128 v[236:239], v4 offset:9216
  s_waitcnt lgkmcnt(3)
  v_mfma_f32_32x32x16_bf16 v[16:31], a[32:35], v[248:251], v[16:31]
  v_cvt_pk_bf16_f32 v118, v228, v229
  v_cvt_pk_bf16_f32 v119, v230, v231
  ds_write_b128 v13, v[116:119] offset:17408
  ds_read_b128 v[208:211], v8 offset:2432
  ds_read_b128 v[212:215], v8 offset:2448
  ds_read_b128 v[216:219], v8 offset:2464
  ds_read_b128 v[220:223], v8 offset:2480
  v_mfma_f32_32x32x16_bf16 v[32:47], a[32:35], v[252:255], v[32:47]
  v_lshlrev_b32 v224, 16, v104
  v_and_b32 v225, 0xffff0000, v104
  v_lshlrev_b32 v226, 16, v105
  v_and_b32 v227, 0xffff0000, v105
  buffer_load_dwordx4 a[4:7], v2, s[20:23], s31 offen offset:1024
  ds_read_b128 v[240:243], v2 offset:10240
  ds_read_b128 v[244:247], v4 offset:10240
  s_waitcnt lgkmcnt(7)
  v_mfma_f32_32x32x16_bf16 v[16:31], a[36:39], v[232:235], v[16:31]
  v_lshlrev_b32 v228, 16, v106
  v_and_b32 v229, 0xffff0000, v106
  v_lshlrev_b32 v230, 16, v107
  v_and_b32 v231, 0xffff0000, v107
  v_fma_f32 v224, v224, v192, v200
  buffer_load_dwordx4 a[8:11], v2, s[20:23], s31 offen offset:2048
  v_mfma_f32_32x32x16_bf16 v[32:47], a[36:39], v[236:239], v[32:47]
  v_fma_f32 v225, v225, v193, v201
  v_fma_f32 v226, v226, v194, v202
  v_fma_f32 v227, v227, v195, v203
  v_fma_f32 v228, v228, v196, v204
  buffer_load_dwordx4 a[12:15], v2, s[20:23], s31 offen offset:3072
  s_add_u32 s31, s31, 4096
  s_waitcnt vmcnt(25)
  v_mfma_f32_32x32x16_bf16 v[48:63], a[136:139], a[240:243], v[48:63]
  v_fma_f32 v229, v229, v197, v205
  v_fma_f32 v230, v230, v198, v206
  v_fma_f32 v231, v231, v199, v207
  v_cvt_pk_bf16_f32 v104, v224, v225
  v_cvt_pk_bf16_f32 v105, v226, v227
  buffer_load_dwordx4 a[16:19], v2, s[20:23], s31 offen offset:0
  ds_read_b128 v[248:251], v2 offset:11264
  ds_read_b128 v[252:255], v4 offset:11264
  s_waitcnt lgkmcnt(2)
  v_mfma_f32_32x32x16_bf16 v[16:31], a[40:43], v[240:243], v[16:31]
  v_cvt_pk_bf16_f32 v106, v228, v229
  v_cvt_pk_bf16_f32 v107, v230, v231
  ds_write_b128 v12, v[104:107] offset:18432
  v_lshlrev_b32 v224, 16, v120
  buffer_load_dwordx4 a[20:23], v2, s[20:23], s31 offen offset:1024
  v_mfma_f32_32x32x16_bf16 v[32:47], a[40:43], v[244:247], v[32:47]
  v_and_b32 v225, 0xffff0000, v120
  v_lshlrev_b32 v226, 16, v121
  v_and_b32 v227, 0xffff0000, v121
  v_lshlrev_b32 v228, 16, v122
  v_and_b32 v229, 0xffff0000, v122
  buffer_load_dwordx4 a[24:27], v2, s[20:23], s31 offen offset:2048
  ds_read_b128 v[232:235], v2 offset:12288
  ds_read_b128 v[236:239], v4 offset:12288
  ds_read_b128 a[244:247], v7 offset:12288
  s_waitcnt lgkmcnt(4)
  v_mfma_f32_32x32x16_bf16 v[16:31], a[44:47], v[248:251], v[16:31]
  v_lshlrev_b32 v230, 16, v123
  v_and_b32 v231, 0xffff0000, v123
  v_fma_f32 v224, v224, v192, v200
  v_fma_f32 v225, v225, v193, v201
  v_fma_f32 v226, v226, v194, v202
  buffer_load_dwordx4 a[28:31], v2, s[20:23], s31 offen offset:3072
  s_add_u32 s31, s31, 4096
  v_mfma_f32_32x32x16_bf16 v[32:47], a[44:47], v[252:255], v[32:47]
  v_fma_f32 v227, v227, v195, v203
  v_fma_f32 v228, v228, v196, v204
  v_fma_f32 v229, v229, v197, v205
  v_fma_f32 v230, v230, v198, v206
  buffer_load_dwordx4 a[32:35], v2, s[20:23], s31 offen offset:0
  ds_read_b128 v[240:243], v2 offset:13312
  ds_read_b128 v[244:247], v4 offset:13312
  s_waitcnt lgkmcnt(3)
  v_mfma_f32_32x32x16_bf16 v[16:31], a[48:51], v[232:235], v[16:31]
  v_fma_f32 v231, v231, v199, v207
  v_cvt_pk_bf16_f32 v120, v224, v225
  v_cvt_pk_bf16_f32 v121, v226, v227
  v_cvt_pk_bf16_f32 v122, v228, v229
  v_cvt_pk_bf16_f32 v123, v230, v231
  buffer_load_dwordx4 a[36:39], v2, s[20:23], s31 offen offset:1024
  v_mfma_f32_32x32x16_bf16 v[32:47], a[48:51], v[236:239], v[32:47]
  ds_write_b128 v13, v[120:123] offset:18432
  v_lshlrev_b32 v224, 16, v108
  ds_read_b128 v[248:251], v2 offset:14336
  ds_read_b128 v[252:255], v4 offset:14336
  s_waitcnt lgkmcnt(3)
  v_mfma_f32_32x32x16_bf16 v[16:31], a[52:55], v[240:243], v[16:31]
  v_and_b32 v225, 0xffff0000, v108
  v_lshlrev_b32 v226, 16, v109
  v_and_b32 v227, 0xffff0000, v109
  v_lshlrev_b32 v228, 16, v110
  v_and_b32 v229, 0xffff0000, v110
  buffer_load_dwordx4 a[40:43], v2, s[20:23], s31 offen offset:2048
  v_mfma_f32_32x32x16_bf16 v[32:47], a[52:55], v[244:247], v[32:47]
  v_lshlrev_b32 v230, 16, v111
  v_and_b32 v231, 0xffff0000, v111
  v_fma_f32 v224, v224, v208, v216
  v_fma_f32 v225, v225, v209, v217
  v_fma_f32 v226, v226, v210, v218
  buffer_load_dwordx4 a[44:47], v2, s[20:23], s31 offen offset:3072
  s_add_u32 s31, s31, 4096
  s_waitcnt vmcnt(32)
  v_mfma_f32_32x32x16_bf16 v[48:63], a[140:143], a[244:247], v[48:63]
  v_fma_f32 v227, v227, v211, v219
  v_fma_f32 v228, v228, v212, v220
  v_fma_f32 v229, v229, v213, v221
  v_fma_f32 v230, v230, v214, v222
  ds_read_b128 v[232:235], v2 offset:15360
  ds_read_b128 v[236:239], v4 offset:15360
  s_waitcnt lgkmcnt(2)
  v_mfma_f32_32x32x16_bf16 v[16:31], a[56:59], v[248:251], v[16:31]
  v_fma_f32 v231, v231, v215, v223
  v_cvt_pk_bf16_f32 v108, v224, v225
  v_cvt_pk_bf16_f32 v109, v226, v227
  v_cvt_pk_bf16_f32 v110, v228, v229
  v_cvt_pk_bf16_f32 v111, v230, v231
  v_mfma_f32_32x32x16_bf16 v[32:47], a[56:59], v[252:255], v[32:47]
  ds_write_b128 v12, v[108:111] offset:19456
  v_lshlrev_b32 v224, 16, v124
  v_and_b32 v225, 0xffff0000, v124
  v_lshlrev_b32 v226, 16, v125
  s_waitcnt lgkmcnt(1)
  v_mfma_f32_32x32x16_bf16 v[16:31], a[60:63], v[232:235], v[16:31]
  v_and_b32 v227, 0xffff0000, v125
  v_lshlrev_b32 v228, 16, v126
  v_and_b32 v229, 0xffff0000, v126
  v_lshlrev_b32 v230, 16, v127
  v_and_b32 v231, 0xffff0000, v127
  v_mfma_f32_32x32x16_bf16 v[32:47], a[60:63], v[236:239], v[32:47]
  v_fma_f32 v224, v224, v208, v216
  v_fma_f32 v225, v225, v209, v217
  v_fma_f32 v226, v226, v210, v218
  v_fma_f32 v227, v227, v211, v219
  v_fma_f32 v228, v228, v212, v220
  v_fma_f32 v229, v229, v213, v221
  v_fma_f32 v230, v230, v214, v222
  v_fma_f32 v231, v231, v215, v223
  v_cvt_pk_bf16_f32 v124, v224, v225
  v_cvt_pk_bf16_f32 v125, v226, v227
  v_cvt_pk_bf16_f32 v126, v228, v229
  v_cvt_pk_bf16_f32 v127, v230, v231
  ds_write_b128 v13, v[124:127] offset:19456
  s_waitcnt lgkmcnt(0)
  s_barrier
  ds_read_b128 v[240:243], v2 offset:16384
  ds_read_b128 v[244:247], v4 offset:16384
  ds_read_b128 a[240:243], v7 offset:16384
  ds_read_b128 v[248:251], v2 offset:17408
  ds_read_b128 v[252:255], v4 offset:17408
  ds_read_b128 v[192:195], v8 offset:4096
  ds_read_b128 v[196:199], v8 offset:4112
  ds_read_b128 v[200:203], v8 offset:4128
  ds_read_b128 v[204:207], v8 offset:4144
  ds_read_b128 v[208:211], v8 offset:4224
  ds_read_b128 v[212:215], v8 offset:4240
  ds_read_b128 v[216:219], v8 offset:4256
  ds_read_b128 v[220:223], v8 offset:4272
  s_waitcnt lgkmcnt(4)
  s_waitcnt vmcnt(31)
  v_mfma_f32_32x32x16_bf16 v[16:31], a[64:67], v[240:243], v[16:31]
  v_lshlrev_b32 v224, 16, v128
  v_and_b32 v225, 0xffff0000, v128
  v_lshlrev_b32 v226, 16, v129
  v_and_b32 v227, 0xffff0000, v129
  v_lshlrev_b32 v228, 16, v130
  buffer_load_dwordx4 a[160:163], v2, s[24:27], s35 offen
  s_add_u32 s35, s35, 4096
  v_mfma_f32_32x32x16_bf16 v[32:47], a[64:67], v[244:247], v[32:47]
  v_and_b32 v229, 0xffff0000, v130
  v_lshlrev_b32 v230, 16, v131
  v_and_b32 v231, 0xffff0000, v131
  v_fma_f32 v224, v224, v192, v200
  buffer_load_dwordx4 a[164:167], v2, s[24:27], s35 offen
  s_add_u32 s35, s35, 4096
  ds_read_b128 v[232:235], v2 offset:18432
  ds_read_b128 v[236:239], v4 offset:18432
  s_waitcnt vmcnt(32)
  v_mfma_f32_32x32x16_bf16 v[16:31], a[68:71], v[248:251], v[16:31]
  v_fma_f32 v225, v225, v193, v201
  v_fma_f32 v226, v226, v194, v202
  v_fma_f32 v227, v227, v195, v203
  v_fma_f32 v228, v228, v196, v204
  v_fma_f32 v229, v229, v197, v205
  buffer_load_dwordx4 a[168:171], v2, s[24:27], s35 offen
  s_add_u32 s35, s35, 4096
  v_mfma_f32_32x32x16_bf16 v[32:47], a[68:71], v[252:255], v[32:47]
  v_fma_f32 v230, v230, v198, v206
  v_fma_f32 v231, v231, v199, v207
  v_cvt_pk_bf16_f32 v128, v224, v225
  v_cvt_pk_bf16_f32 v129, v226, v227
  buffer_load_dwordx4 a[172:175], v2, s[24:27], s35 offen
  s_add_u32 s35, s35, 4096
  s_waitcnt vmcnt(19)
  v_mfma_f32_32x32x16_bf16 v[48:63], a[144:147], a[240:243], v[48:63]
  v_cvt_pk_bf16_f32 v130, v228, v229
  v_cvt_pk_bf16_f32 v131, v230, v231
  ds_write_b128 v12, v[128:131] offset:32768
  v_lshlrev_b32 v224, 16, v144
  v_and_b32 v225, 0xffff0000, v144
  buffer_load_dwordx4 a[48:51], v2, s[20:23], s31 offen offset:0
  ds_read_b128 v[240:243], v2 offset:19456
  ds_read_b128 v[244:247], v4 offset:19456
  s_waitcnt lgkmcnt(3)
  v_mfma_f32_32x32x16_bf16 v[16:31], a[72:75], v[232:235], v[16:31]
  v_lshlrev_b32 v226, 16, v145
  v_and_b32 v227, 0xffff0000, v145
  v_lshlrev_b32 v228, 16, v146
  v_and_b32 v229, 0xffff0000, v146
  v_lshlrev_b32 v230, 16, v147
  buffer_load_dwordx4 a[52:55], v2, s[20:23], s31 offen offset:1024
  v_mfma_f32_32x32x16_bf16 v[32:47], a[72:75], v[236:239], v[32:47]
  v_and_b32 v231, 0xffff0000, v147
  v_fma_f32 v224, v224, v192, v200
  v_fma_f32 v225, v225, v193, v201
  v_fma_f32 v226, v226, v194, v202
  buffer_load_dwordx4 a[56:59], v2, s[20:23], s31 offen offset:2048
  ds_read_b128 v[248:251], v2 offset:20480
  ds_read_b128 v[252:255], v4 offset:20480
  ds_read_b128 a[244:247], v7 offset:20480
  s_waitcnt lgkmcnt(3)
  v_mfma_f32_32x32x16_bf16 v[16:31], a[76:79], v[240:243], v[16:31]
  v_fma_f32 v227, v227, v195, v203
  v_fma_f32 v228, v228, v196, v204
  v_fma_f32 v229, v229, v197, v205
  v_fma_f32 v230, v230, v198, v206
  v_fma_f32 v231, v231, v199, v207
  buffer_load_dwordx4 a[60:63], v2, s[20:23], s31 offen offset:3072
  s_add_u32 s31, s31, 4096
  v_mfma_f32_32x32x16_bf16 v[32:47], a[76:79], v[244:247], v[32:47]
  v_cvt_pk_bf16_f32 v144, v224, v225
  v_cvt_pk_bf16_f32 v145, v226, v227
  v_cvt_pk_bf16_f32 v146, v228, v229
  v_cvt_pk_bf16_f32 v147, v230, v231
  ds_read_b128 v[232:235], v2 offset:21504
  ds_read_b128 v[236:239], v4 offset:21504
  s_waitcnt lgkmcnt(3)
  v_mfma_f32_32x32x16_bf16 v[16:31], a[80:83], v[248:251], v[16:31]
  ds_write_b128 v13, v[144:147] offset:32768
  ds_read_b128 v[192:195], v8 offset:4352
  ds_read_b128 v[196:199], v8 offset:4368
  ds_read_b128 v[200:203], v8 offset:4384
  ds_read_b128 v[204:207], v8 offset:4400
  v_lshlrev_b32 v224, 16, v132
  v_and_b32 v225, 0xffff0000, v132
  buffer_load_dwordx4 a[64:67], v2, s[20:23], s31 offen offset:0
  v_mfma_f32_32x32x16_bf16 v[32:47], a[80:83], v[252:255], v[32:47]
  v_lshlrev_b32 v226, 16, v133
  v_and_b32 v227, 0xffff0000, v133
  v_lshlrev_b32 v228, 16, v134
  v_and_b32 v229, 0xffff0000, v134
  v_lshlrev_b32 v230, 16, v135
  buffer_load_dwordx4 a[68:71], v2, s[20:23], s31 offen offset:1024
  ds_read_b128 v[240:243], v2 offset:22528
  ds_read_b128 v[244:247], v4 offset:22528
  s_waitcnt lgkmcnt(7)
  v_mfma_f32_32x32x16_bf16 v[16:31], a[84:87], v[232:235], v[16:31]
  v_and_b32 v231, 0xffff0000, v135
  v_fma_f32 v224, v224, v208, v216
  v_fma_f32 v225, v225, v209, v217
  v_fma_f32 v226, v226, v210, v218
  buffer_load_dwordx4 a[72:75], v2, s[20:23], s31 offen offset:2048
  v_mfma_f32_32x32x16_bf16 v[32:47], a[84:87], v[236:239], v[32:47]
  v_fma_f32 v227, v227, v211, v219
  v_fma_f32 v228, v228, v212, v220
  v_fma_f32 v229, v229, v213, v221
  v_fma_f32 v230, v230, v214, v222
  v_fma_f32 v231, v231, v215, v223
  buffer_load_dwordx4 a[76:79], v2, s[20:23], s31 offen offset:3072
  s_add_u32 s31, s31, 4096
  s_waitcnt vmcnt(26)
  v_mfma_f32_32x32x16_bf16 v[48:63], a[148:151], a[244:247], v[48:63]
  v_cvt_pk_bf16_f32 v132, v224, v225
  v_cvt_pk_bf16_f32 v133, v226, v227
  v_cvt_pk_bf16_f32 v134, v228, v229
  v_cvt_pk_bf16_f32 v135, v230, v231
  buffer_load_dwordx4 a[80:83], v2, s[20:23], s31 offen offset:0
  ds_read_b128 v[248:251], v2 offset:23552
  ds_read_b128 v[252:255], v4 offset:23552
  s_waitcnt lgkmcnt(2)
  v_mfma_f32_32x32x16_bf16 v[16:31], a[88:91], v[240:243], v[16:31]
  ds_write_b128 v12, v[132:135] offset:33792
  v_lshlrev_b32 v224, 16, v148
  v_and_b32 v225, 0xffff0000, v148
  v_lshlrev_b32 v226, 16, v149
  v_and_b32 v227, 0xffff0000, v149
  buffer_load_dwordx4 a[84:87], v2, s[20:23], s31 offen offset:1024
  v_mfma_f32_32x32x16_bf16 v[32:47], a[88:91], v[244:247], v[32:47]
  v_lshlrev_b32 v228, 16, v150
  v_and_b32 v229, 0xffff0000, v150
  v_lshlrev_b32 v230, 16, v151
  v_and_b32 v231, 0xffff0000, v151
  v_fma_f32 v224, v224, v208, v216
  buffer_load_dwordx4 a[88:91], v2, s[20:23], s31 offen offset:2048
  ds_read_b128 v[232:235], v2 offset:24576
  ds_read_b128 v[236:239], v4 offset:24576
  ds_read_b128 a[240:243], v7 offset:24576
  s_waitcnt lgkmcnt(4)
  v_mfma_f32_32x32x16_bf16 v[16:31], a[92:95], v[248:251], v[16:31]
  v_fma_f32 v225, v225, v209, v217
  v_fma_f32 v226, v226, v210, v218
  v_fma_f32 v227, v227, v211, v219
  v_fma_f32 v228, v228, v212, v220
  v_mfma_f32_32x32x16_bf16 v[32:47], a[92:95], v[252:255], v[32:47]
  v_fma_f32 v229, v229, v213, v221
  v_fma_f32 v230, v230, v214, v222
  v_fma_f32 v231, v231, v215, v223
  v_cvt_pk_bf16_f32 v148, v224, v225
  v_cvt_pk_bf16_f32 v149, v226, v227
  buffer_load_dwordx4 a[92:95], v2, s[20:23], s31 offen offset:3072
  s_add_u32 s31, s31, 4096
  ds_read_b128 v[240:243], v2 offset:25600
  ds_read_b128 v[244:247], v4 offset:25600
  s_waitcnt lgkmcnt(3)
  v_mfma_f32_32x32x16_bf16 v[16:31], a[96:99], v[232:235], v[16:31]
  v_cvt_pk_bf16_f32 v150, v228, v229
  v_cvt_pk_bf16_f32 v151, v230, v231
  ds_write_b128 v13, v[148:151] offset:33792
  ds_read_b128 v[208:211], v8 offset:4480
  ds_read_b128 v[212:215], v8 offset:4496
  ds_read_b128 v[216:219], v8 offset:4512
  ds_read_b128 v[220:223], v8 offset:4528
  v_mfma_f32_32x32x16_bf16 v[32:47], a[96:99], v[236:239], v[32:47]
  v_lshlrev_b32 v224, 16, v136
  v_and_b32 v225, 0xffff0000, v136
  v_lshlrev_b32 v226, 16, v137
  v_and_b32 v227, 0xffff0000, v137
  buffer_load_dwordx4 a[96:99], v2, s[20:23], s31 offen offset:0
  ds_read_b128 v[248:251], v2 offset:26624
  ds_read_b128 v[252:255], v4 offset:26624
  s_waitcnt lgkmcnt(7)
  v_mfma_f32_32x32x16_bf16 v[16:31], a[100:103], v[240:243], v[16:31]
  v_lshlrev_b32 v228, 16, v138
  v_and_b32 v229, 0xffff0000, v138
  v_lshlrev_b32 v230, 16, v139
  v_and_b32 v231, 0xffff0000, v139
  v_fma_f32 v224, v224, v192, v200
  v_mfma_f32_32x32x16_bf16 v[32:47], a[100:103], v[244:247], v[32:47]
  v_fma_f32 v225, v225, v193, v201
  v_fma_f32 v226, v226, v194, v202
  v_fma_f32 v227, v227, v195, v203
  v_fma_f32 v228, v228, v196, v204
  buffer_load_dwordx4 a[100:103], v2, s[20:23], s31 offen offset:1024
  s_waitcnt vmcnt(31)
  v_mfma_f32_32x32x16_bf16 v[48:63], a[152:155], a[240:243], v[48:63]
  v_fma_f32 v229, v229, v197, v205
  v_fma_f32 v230, v230, v198, v206
  v_fma_f32 v231, v231, v199, v207
  v_cvt_pk_bf16_f32 v136, v224, v225
  v_cvt_pk_bf16_f32 v137, v226, v227
  ds_read_b128 v[232:235], v2 offset:27648
  ds_read_b128 v[236:239], v4 offset:27648
  s_waitcnt lgkmcnt(2)
  v_mfma_f32_32x32x16_bf16 v[16:31], a[104:107], v[248:251], v[16:31]
  v_cvt_pk_bf16_f32 v138, v228, v229
  v_cvt_pk_bf16_f32 v139, v230, v231
  ds_write_b128 v12, v[136:139] offset:34816
  v_lshlrev_b32 v224, 16, v152
  v_mfma_f32_32x32x16_bf16 v[32:47], a[104:107], v[252:255], v[32:47]
  v_and_b32 v225, 0xffff0000, v152
  v_lshlrev_b32 v226, 16, v153
  v_and_b32 v227, 0xffff0000, v153
  v_lshlrev_b32 v228, 16, v154
  v_and_b32 v229, 0xffff0000, v154
  buffer_load_dwordx4 a[104:107], v2, s[20:23], s31 offen offset:2048
  ds_read_b128 v[240:243], v2 offset:28672
  ds_read_b128 v[244:247], v4 offset:28672
  ds_read_b128 a[244:247], v7 offset:28672
  s_waitcnt lgkmcnt(4)
  v_mfma_f32_32x32x16_bf16 v[16:31], a[108:111], v[232:235], v[16:31]
  v_lshlrev_b32 v230, 16, v155
  v_and_b32 v231, 0xffff0000, v155
  v_fma_f32 v224, v224, v192, v200
  v_fma_f32 v225, v225, v193, v201
  v_fma_f32 v226, v226, v194, v202
  v_mfma_f32_32x32x16_bf16 v[32:47], a[108:111], v[236:239], v[32:47]
  v_fma_f32 v227, v227, v195, v203
  v_fma_f32 v228, v228, v196, v204
  v_fma_f32 v229, v229, v197, v205
  v_fma_f32 v230, v230, v198, v206
  buffer_load_dwordx4 a[108:111], v2, s[20:23], s31 offen offset:3072
  s_add_u32 s31, s31, 4096
  ds_read_b128 v[248:251], v2 offset:29696
  ds_read_b128 v[252:255], v4 offset:29696
  s_waitcnt lgkmcnt(3)
  v_mfma_f32_32x32x16_bf16 v[16:31], a[112:115], v[240:243], v[16:31]
  v_fma_f32 v231, v231, v199, v207
  v_cvt_pk_bf16_f32 v152, v224, v225
  v_cvt_pk_bf16_f32 v153, v226, v227
  v_cvt_pk_bf16_f32 v154, v228, v229
  v_cvt_pk_bf16_f32 v155, v230, v231
  v_mfma_f32_32x32x16_bf16 v[32:47], a[112:115], v[244:247], v[32:47]
  ds_write_b128 v13, v[152:155] offset:34816
  v_lshlrev_b32 v224, 16, v140
  ds_read_b128 v[232:235], v2 offset:30720
  ds_read_b128 v[236:239], v4 offset:30720
  s_waitcnt lgkmcnt(3)
  v_mfma_f32_32x32x16_bf16 v[16:31], a[116:119], v[248:251], v[16:31]
  v_and_b32 v225, 0xffff0000, v140
  v_lshlrev_b32 v226, 16, v141
  v_and_b32 v227, 0xffff0000, v141
  v_lshlrev_b32 v228, 16, v142
  v_and_b32 v229, 0xffff0000, v142
  v_mfma_f32_32x32x16_bf16 v[32:47], a[116:119], v[252:255], v[32:47]
  v_lshlrev_b32 v230, 16, v143
  v_and_b32 v231, 0xffff0000, v143
  v_fma_f32 v224, v224, v208, v216
  v_fma_f32 v225, v225, v209, v217
  v_fma_f32 v226, v226, v210, v218
  s_waitcnt vmcnt(32)
  v_mfma_f32_32x32x16_bf16 v[48:63], a[156:159], a[244:247], v[48:63]
  v_fma_f32 v227, v227, v211, v219
  v_fma_f32 v228, v228, v212, v220
  v_fma_f32 v229, v229, v213, v221
  v_fma_f32 v230, v230, v214, v222
  ds_read_b128 v[240:243], v2 offset:31744
  ds_read_b128 v[244:247], v4 offset:31744
  s_waitcnt lgkmcnt(2)
  v_mfma_f32_32x32x16_bf16 v[16:31], a[120:123], v[232:235], v[16:31]
  v_fma_f32 v231, v231, v215, v223
  v_cvt_pk_bf16_f32 v140, v224, v225
  v_cvt_pk_bf16_f32 v141, v226, v227
  v_cvt_pk_bf16_f32 v142, v228, v229
  v_cvt_pk_bf16_f32 v143, v230, v231
  v_mfma_f32_32x32x16_bf16 v[32:47], a[120:123], v[236:239], v[32:47]
  ds_write_b128 v12, v[140:143] offset:35840
  v_lshlrev_b32 v224, 16, v156
  v_and_b32 v225, 0xffff0000, v156
  v_lshlrev_b32 v226, 16, v157
  s_waitcnt lgkmcnt(1)
  v_mfma_f32_32x32x16_bf16 v[16:31], a[124:127], v[240:243], v[16:31]
  v_and_b32 v227, 0xffff0000, v157
  v_lshlrev_b32 v228, 16, v158
  v_and_b32 v229, 0xffff0000, v158
  v_lshlrev_b32 v230, 16, v159
  v_and_b32 v231, 0xffff0000, v159
  v_mfma_f32_32x32x16_bf16 v[32:47], a[124:127], v[244:247], v[32:47]
  v_fma_f32 v224, v224, v208, v216
  v_fma_f32 v225, v225, v209, v217
  v_fma_f32 v226, v226, v210, v218
  v_fma_f32 v227, v227, v211, v219
  v_fma_f32 v228, v228, v212, v220
  v_fma_f32 v229, v229, v213, v221
  v_fma_f32 v230, v230, v214, v222
  v_fma_f32 v231, v231, v215, v223
  v_cvt_pk_bf16_f32 v156, v224, v225
  v_cvt_pk_bf16_f32 v157, v226, v227
  v_cvt_pk_bf16_f32 v158, v228, v229
  v_cvt_pk_bf16_f32 v159, v230, v231
  ds_write_b128 v13, v[156:159] offset:35840
  s_waitcnt lgkmcnt(0)
  s_barrier
  ds_read_b128 v[248:251], v2 offset:32768
  ds_read_b128 v[252:255], v4 offset:32768
  ds_read_b128 a[240:243], v7 offset:32768
  ds_read_b128 v[232:235], v2 offset:33792
  ds_read_b128 v[236:239], v4 offset:33792
  ds_read_b128 v[192:195], v8 offset:6144
  ds_read_b128 v[196:199], v8 offset:6160
  ds_read_b128 v[200:203], v8 offset:6176
  ds_read_b128 v[204:207], v8 offset:6192
  ds_read_b128 v[208:211], v8 offset:6272
  ds_read_b128 v[212:215], v8 offset:6288
  ds_read_b128 v[216:219], v8 offset:6304
  ds_read_b128 v[220:223], v8 offset:6320
  s_waitcnt lgkmcnt(4)
  s_waitcnt vmcnt(31)
  v_mfma_f32_32x32x16_bf16 v[16:31], a[0:3], v[248:251], v[16:31]
  v_lshlrev_b32 v224, 16, v160
  v_and_b32 v225, 0xffff0000, v160
  v_lshlrev_b32 v226, 16, v161
  v_and_b32 v227, 0xffff0000, v161
  v_lshlrev_b32 v228, 16, v162
  buffer_load_dwordx4 a[176:179], v2, s[24:27], s35 offen
  s_add_u32 s35, s35, 4096
  v_mfma_f32_32x32x16_bf16 v[32:47], a[0:3], v[252:255], v[32:47]
  v_and_b32 v229, 0xffff0000, v162
  v_lshlrev_b32 v230, 16, v163
  v_and_b32 v231, 0xffff0000, v163
  v_fma_f32 v224, v224, v192, v200
  buffer_load_dwordx4 a[180:183], v2, s[24:27], s35 offen
  s_add_u32 s35, s35, 4096
  ds_read_b128 v[240:243], v2 offset:34816
  ds_read_b128 v[244:247], v4 offset:34816
  s_waitcnt vmcnt(32)
  v_mfma_f32_32x32x16_bf16 v[16:31], a[4:7], v[232:235], v[16:31]
  v_fma_f32 v225, v225, v193, v201
  v_fma_f32 v226, v226, v194, v202
  v_fma_f32 v227, v227, v195, v203
  v_fma_f32 v228, v228, v196, v204
  v_fma_f32 v229, v229, v197, v205
  buffer_load_dwordx4 a[184:187], v2, s[24:27], s35 offen
  s_add_u32 s35, s35, 4096
  v_mfma_f32_32x32x16_bf16 v[32:47], a[4:7], v[236:239], v[32:47]
  v_fma_f32 v230, v230, v198, v206
  v_fma_f32 v231, v231, v199, v207
  v_cvt_pk_bf16_f32 v160, v224, v225
  v_cvt_pk_bf16_f32 v161, v226, v227
  buffer_load_dwordx4 a[188:191], v2, s[24:27], s35 offen
  s_add_u32 s35, s35, 4096
  s_waitcnt vmcnt(23)
  v_mfma_f32_32x32x16_bf16 v[48:63], a[160:163], a[240:243], v[48:63]
  v_cvt_pk_bf16_f32 v162, v228, v229
  v_cvt_pk_bf16_f32 v163, v230, v231
  ds_write_b128 v12, v[160:163] offset:49152
  v_lshlrev_b32 v224, 16, v176
  v_and_b32 v225, 0xffff0000, v176
  buffer_load_dwordx4 a[112:115], v2, s[20:23], s31 offen offset:0
  ds_read_b128 v[248:251], v2 offset:35840
  ds_read_b128 v[252:255], v4 offset:35840
  s_waitcnt lgkmcnt(3)
  v_mfma_f32_32x32x16_bf16 v[16:31], a[8:11], v[240:243], v[16:31]
  v_lshlrev_b32 v226, 16, v177
  v_and_b32 v227, 0xffff0000, v177
  v_lshlrev_b32 v228, 16, v178
  v_and_b32 v229, 0xffff0000, v178
  v_lshlrev_b32 v230, 16, v179
  buffer_load_dwordx4 a[116:119], v2, s[20:23], s31 offen offset:1024
  v_mfma_f32_32x32x16_bf16 v[32:47], a[8:11], v[244:247], v[32:47]
  v_and_b32 v231, 0xffff0000, v179
  v_fma_f32 v224, v224, v192, v200
  v_fma_f32 v225, v225, v193, v201
  v_fma_f32 v226, v226, v194, v202
  buffer_load_dwordx4 a[120:123], v2, s[20:23], s31 offen offset:2048
  ds_read_b128 v[232:235], v2 offset:36864
  ds_read_b128 v[236:239], v4 offset:36864
  ds_read_b128 a[244:247], v7 offset:36864
  s_waitcnt lgkmcnt(3)
  v_mfma_f32_32x32x16_bf16 v[16:31], a[12:15], v[248:251], v[16:31]
  v_fma_f32 v227, v227, v195, v203
  v_fma_f32 v228, v228, v196, v204
  v_fma_f32 v229, v229, v197, v205
  v_fma_f32 v230, v230, v198, v206
  v_fma_f32 v231, v231, v199, v207
  buffer_load_dwordx4 a[124:127], v2, s[20:23], s31 offen offset:3072
  s_add_u32 s31, s31, 4096
  v_mfma_f32_32x32x16_bf16 v[32:47], a[12:15], v[252:255], v[32:47]
  v_cvt_pk_bf16_f32 v176, v224, v225
  v_cvt_pk_bf16_f32 v177, v226, v227
  v_cvt_pk_bf16_f32 v178, v228, v229
  v_cvt_pk_bf16_f32 v179, v230, v231
  ds_read_b128 v[240:243], v2 offset:37888
  ds_read_b128 v[244:247], v4 offset:37888
  s_waitcnt lgkmcnt(3)
  v_mfma_f32_32x32x16_bf16 v[16:31], a[16:19], v[232:235], v[16:31]
  ds_write_b128 v13, v[176:179] offset:49152
  ds_read_b128 v[192:195], v8 offset:6400
  ds_read_b128 v[196:199], v8 offset:6416
  ds_read_b128 v[200:203], v8 offset:6432
  ds_read_b128 v[204:207], v8 offset:6448
  v_lshlrev_b32 v224, 16, v164
  v_and_b32 v225, 0xffff0000, v164
  v_mfma_f32_32x32x16_bf16 v[32:47], a[16:19], v[236:239], v[32:47]
  v_lshlrev_b32 v226, 16, v165
  v_and_b32 v227, 0xffff0000, v165
  v_lshlrev_b32 v228, 16, v166
  v_and_b32 v229, 0xffff0000, v166
  v_lshlrev_b32 v230, 16, v167
  ds_read_b128 v[248:251], v2 offset:38912
  ds_read_b128 v[252:255], v4 offset:38912
  s_waitcnt lgkmcnt(7)
  v_mfma_f32_32x32x16_bf16 v[16:31], a[20:23], v[240:243], v[16:31]
  v_and_b32 v231, 0xffff0000, v167
  v_fma_f32 v224, v224, v208, v216
  v_fma_f32 v225, v225, v209, v217
  v_fma_f32 v226, v226, v210, v218
  v_mfma_f32_32x32x16_bf16 v[32:47], a[20:23], v[244:247], v[32:47]
  v_fma_f32 v227, v227, v211, v219
  v_fma_f32 v228, v228, v212, v220
  v_fma_f32 v229, v229, v213, v221
  v_fma_f32 v230, v230, v214, v222
  v_fma_f32 v231, v231, v215, v223
  s_waitcnt vmcnt(26)
  v_mfma_f32_32x32x16_bf16 v[48:63], a[164:167], a[244:247], v[48:63]
  v_cvt_pk_bf16_f32 v164, v224, v225
  v_cvt_pk_bf16_f32 v165, v226, v227
  v_cvt_pk_bf16_f32 v166, v228, v229
  v_cvt_pk_bf16_f32 v167, v230, v231
  ds_read_b128 v[232:235], v2 offset:39936
  ds_read_b128 v[236:239], v4 offset:39936
  s_waitcnt lgkmcnt(2)
  v_mfma_f32_32x32x16_bf16 v[16:31], a[24:27], v[248:251], v[16:31]
  ds_write_b128 v12, v[164:167] offset:50176
  v_lshlrev_b32 v224, 16, v180
  v_and_b32 v225, 0xffff0000, v180
  v_lshlrev_b32 v226, 16, v181
  v_and_b32 v227, 0xffff0000, v181
  v_mfma_f32_32x32x16_bf16 v[32:47], a[24:27], v[252:255], v[32:47]
  v_lshlrev_b32 v228, 16, v182
  v_and_b32 v229, 0xffff0000, v182
  v_lshlrev_b32 v230, 16, v183
  v_and_b32 v231, 0xffff0000, v183
  v_fma_f32 v224, v224, v208, v216
  ds_read_b128 v[240:243], v2 offset:40960
  ds_read_b128 v[244:247], v4 offset:40960
  ds_read_b128 a[240:243], v7 offset:40960
  s_waitcnt lgkmcnt(4)
  v_mfma_f32_32x32x16_bf16 v[16:31], a[28:31], v[232:235], v[16:31]
  v_fma_f32 v225, v225, v209, v217
  v_fma_f32 v226, v226, v210, v218
  v_fma_f32 v227, v227, v211, v219
  v_fma_f32 v228, v228, v212, v220
  v_mfma_f32_32x32x16_bf16 v[32:47], a[28:31], v[236:239], v[32:47]
  v_fma_f32 v229, v229, v213, v221
  v_fma_f32 v230, v230, v214, v222
  v_fma_f32 v231, v231, v215, v223
  v_cvt_pk_bf16_f32 v180, v224, v225
  v_cvt_pk_bf16_f32 v181, v226, v227
  ds_read_b128 v[248:251], v2 offset:41984
  ds_read_b128 v[252:255], v4 offset:41984
  s_waitcnt lgkmcnt(3)
  v_mfma_f32_32x32x16_bf16 v[16:31], a[32:35], v[240:243], v[16:31]
  v_cvt_pk_bf16_f32 v182, v228, v229
  v_cvt_pk_bf16_f32 v183, v230, v231
  ds_write_b128 v13, v[180:183] offset:50176
  ds_read_b128 v[208:211], v8 offset:6528
  ds_read_b128 v[212:215], v8 offset:6544
  ds_read_b128 v[216:219], v8 offset:6560
  ds_read_b128 v[220:223], v8 offset:6576
  v_mfma_f32_32x32x16_bf16 v[32:47], a[32:35], v[244:247], v[32:47]
  v_lshlrev_b32 v224, 16, v168
  v_and_b32 v225, 0xffff0000, v168
  v_lshlrev_b32 v226, 16, v169
  v_and_b32 v227, 0xffff0000, v169
  ds_read_b128 v[232:235], v2 offset:43008
  ds_read_b128 v[236:239], v4 offset:43008
  s_waitcnt lgkmcnt(7)
  v_mfma_f32_32x32x16_bf16 v[16:31], a[36:39], v[248:251], v[16:31]
  v_lshlrev_b32 v228, 16, v170
  v_and_b32 v229, 0xffff0000, v170
  v_lshlrev_b32 v230, 16, v171
  v_and_b32 v231, 0xffff0000, v171
  v_fma_f32 v224, v224, v192, v200
  v_mfma_f32_32x32x16_bf16 v[32:47], a[36:39], v[252:255], v[32:47]
  v_fma_f32 v225, v225, v193, v201
  v_fma_f32 v226, v226, v194, v202
  v_fma_f32 v227, v227, v195, v203
  v_fma_f32 v228, v228, v196, v204
  s_waitcnt vmcnt(25)
  v_mfma_f32_32x32x16_bf16 v[48:63], a[168:171], a[240:243], v[48:63]
  v_fma_f32 v229, v229, v197, v205
  v_fma_f32 v230, v230, v198, v206
  v_fma_f32 v231, v231, v199, v207
  v_cvt_pk_bf16_f32 v168, v224, v225
  v_cvt_pk_bf16_f32 v169, v226, v227
  ds_read_b128 v[240:243], v2 offset:44032
  ds_read_b128 v[244:247], v4 offset:44032
  s_waitcnt lgkmcnt(2)
  v_mfma_f32_32x32x16_bf16 v[16:31], a[40:43], v[232:235], v[16:31]
  v_cvt_pk_bf16_f32 v170, v228, v229
  v_cvt_pk_bf16_f32 v171, v230, v231
  ds_write_b128 v12, v[168:171] offset:51200
  v_lshlrev_b32 v224, 16, v184
  v_mfma_f32_32x32x16_bf16 v[32:47], a[40:43], v[236:239], v[32:47]
  v_and_b32 v225, 0xffff0000, v184
  v_lshlrev_b32 v226, 16, v185
  v_and_b32 v227, 0xffff0000, v185
  v_lshlrev_b32 v228, 16, v186
  v_and_b32 v229, 0xffff0000, v186
  ds_read_b128 v[248:251], v2 offset:45056
  ds_read_b128 v[252:255], v4 offset:45056
  ds_read_b128 a[244:247], v7 offset:45056
  s_waitcnt lgkmcnt(4)
  v_mfma_f32_32x32x16_bf16 v[16:31], a[44:47], v[240:243], v[16:31]
  v_lshlrev_b32 v230, 16, v187
  v_and_b32 v231, 0xffff0000, v187
  v_fma_f32 v224, v224, v192, v200
  v_fma_f32 v225, v225, v193, v201
  v_fma_f32 v226, v226, v194, v202
  v_mfma_f32_32x32x16_bf16 v[32:47], a[44:47], v[244:247], v[32:47]
  v_fma_f32 v227, v227, v195, v203
  v_fma_f32 v228, v228, v196, v204
  v_fma_f32 v229, v229, v197, v205
  v_fma_f32 v230, v230, v198, v206
  ds_read_b128 v[232:235], v2 offset:46080
  ds_read_b128 v[236:239], v4 offset:46080
  s_waitcnt vmcnt(23)
  s_waitcnt lgkmcnt(3)
  v_mfma_f32_32x32x16_bf16 v[16:31], a[48:51], v[248:251], v[16:31]
  v_fma_f32 v231, v231, v199, v207
  v_cvt_pk_bf16_f32 v184, v224, v225
  v_cvt_pk_bf16_f32 v185, v226, v227
  v_cvt_pk_bf16_f32 v186, v228, v229
  v_cvt_pk_bf16_f32 v187, v230, v231
  v_mfma_f32_32x32x16_bf16 v[32:47], a[48:51], v[252:255], v[32:47]
  ds_write_b128 v13, v[184:187] offset:51200
  v_lshlrev_b32 v224, 16, v172
  ds_read_b128 v[240:243], v2 offset:47104
  ds_read_b128 v[244:247], v4 offset:47104
  s_waitcnt vmcnt(22)
  s_waitcnt lgkmcnt(3)
  v_mfma_f32_32x32x16_bf16 v[16:31], a[52:55], v[232:235], v[16:31]
  v_and_b32 v225, 0xffff0000, v172
  v_lshlrev_b32 v226, 16, v173
  v_and_b32 v227, 0xffff0000, v173
  v_lshlrev_b32 v228, 16, v174
  v_and_b32 v229, 0xffff0000, v174
  v_mfma_f32_32x32x16_bf16 v[32:47], a[52:55], v[236:239], v[32:47]
  v_lshlrev_b32 v230, 16, v175
  v_and_b32 v231, 0xffff0000, v175
  v_fma_f32 v224, v224, v208, v216
  v_fma_f32 v225, v225, v209, v217
  v_fma_f32 v226, v226, v210, v218
  v_mfma_f32_32x32x16_bf16 v[48:63], a[172:175], a[244:247], v[48:63]
  v_fma_f32 v227, v227, v211, v219
  v_fma_f32 v228, v228, v212, v220
  v_fma_f32 v229, v229, v213, v221
  v_fma_f32 v230, v230, v214, v222
  ds_read_b128 v[248:251], v2 offset:48128
  ds_read_b128 v[252:255], v4 offset:48128
  s_waitcnt vmcnt(21)
  s_waitcnt lgkmcnt(2)
  v_mfma_f32_32x32x16_bf16 v[16:31], a[56:59], v[240:243], v[16:31]
  v_fma_f32 v231, v231, v215, v223
  v_cvt_pk_bf16_f32 v172, v224, v225
  v_cvt_pk_bf16_f32 v173, v226, v227
  v_cvt_pk_bf16_f32 v174, v228, v229
  v_cvt_pk_bf16_f32 v175, v230, v231
  v_mfma_f32_32x32x16_bf16 v[32:47], a[56:59], v[244:247], v[32:47]
  ds_write_b128 v12, v[172:175] offset:52224
  v_lshlrev_b32 v224, 16, v188
  v_and_b32 v225, 0xffff0000, v188
  v_lshlrev_b32 v226, 16, v189
  s_waitcnt vmcnt(20)
  s_waitcnt lgkmcnt(1)
  v_mfma_f32_32x32x16_bf16 v[16:31], a[60:63], v[248:251], v[16:31]
  v_and_b32 v227, 0xffff0000, v189
  v_lshlrev_b32 v228, 16, v190
  v_and_b32 v229, 0xffff0000, v190
  v_lshlrev_b32 v230, 16, v191
  v_and_b32 v231, 0xffff0000, v191
  v_mfma_f32_32x32x16_bf16 v[32:47], a[60:63], v[252:255], v[32:47]
  v_fma_f32 v224, v224, v208, v216
  v_fma_f32 v225, v225, v209, v217
  v_fma_f32 v226, v226, v210, v218
  v_fma_f32 v227, v227, v211, v219
  v_fma_f32 v228, v228, v212, v220
  v_fma_f32 v229, v229, v213, v221
  v_fma_f32 v230, v230, v214, v222
  v_fma_f32 v231, v231, v215, v223
  v_cvt_pk_bf16_f32 v188, v224, v225
  v_cvt_pk_bf16_f32 v189, v226, v227
  v_cvt_pk_bf16_f32 v190, v228, v229
  v_cvt_pk_bf16_f32 v191, v230, v231
  ds_write_b128 v13, v[188:191] offset:52224
  s_waitcnt lgkmcnt(0)
  s_barrier
  ds_read_b128 v[232:235], v2 offset:49152
  ds_read_b128 v[236:239], v4 offset:49152
  ds_read_b128 a[240:243], v7 offset:49152
  ds_read_b128 v[240:243], v2 offset:50176
  ds_read_b128 v[244:247], v4 offset:50176
  s_waitcnt vmcnt(19)
  s_waitcnt lgkmcnt(3)
  v_mfma_f32_32x32x16_bf16 v[16:31], a[64:67], v[232:235], v[16:31]
  v_mfma_f32_32x32x16_bf16 v[32:47], a[64:67], v[236:239], v[32:47]
  ds_read_b128 v[248:251], v2 offset:51200
  ds_read_b128 v[252:255], v4 offset:51200
  s_waitcnt vmcnt(18)
  s_waitcnt lgkmcnt(2)
  v_mfma_f32_32x32x16_bf16 v[16:31], a[68:71], v[240:243], v[16:31]
  v_mfma_f32_32x32x16_bf16 v[32:47], a[68:71], v[244:247], v[32:47]
  s_waitcnt vmcnt(7)
  v_mfma_f32_32x32x16_bf16 v[48:63], a[176:179], a[240:243], v[48:63]
  ds_read_b128 v[232:235], v2 offset:52224
  ds_read_b128 v[236:239], v4 offset:52224
  s_waitcnt lgkmcnt(2)
  v_mfma_f32_32x32x16_bf16 v[16:31], a[72:75], v[248:251], v[16:31]
  v_mfma_f32_32x32x16_bf16 v[32:47], a[72:75], v[252:255], v[32:47]
  ds_read_b128 v[240:243], v2 offset:53248
  ds_read_b128 v[244:247], v4 offset:53248
  ds_read_b128 a[244:247], v7 offset:53248
  s_waitcnt lgkmcnt(3)
  v_mfma_f32_32x32x16_bf16 v[16:31], a[76:79], v[232:235], v[16:31]
  v_mfma_f32_32x32x16_bf16 v[32:47], a[76:79], v[236:239], v[32:47]
  ds_read_b128 v[248:251], v2 offset:54272
  ds_read_b128 v[252:255], v4 offset:54272
  s_waitcnt lgkmcnt(3)
  v_mfma_f32_32x32x16_bf16 v[16:31], a[80:83], v[240:243], v[16:31]
  v_mfma_f32_32x32x16_bf16 v[32:47], a[80:83], v[244:247], v[32:47]
  ds_read_b128 v[232:235], v2 offset:55296
  ds_read_b128 v[236:239], v4 offset:55296
  s_waitcnt lgkmcnt(2)
  v_mfma_f32_32x32x16_bf16 v[16:31], a[84:87], v[248:251], v[16:31]
  v_mfma_f32_32x32x16_bf16 v[32:47], a[84:87], v[252:255], v[32:47]
  s_waitcnt vmcnt(6)
  v_mfma_f32_32x32x16_bf16 v[48:63], a[180:183], a[244:247], v[48:63]
  ds_read_b128 v[240:243], v2 offset:56320
  ds_read_b128 v[244:247], v4 offset:56320
  s_waitcnt lgkmcnt(2)
  v_mfma_f32_32x32x16_bf16 v[16:31], a[88:91], v[232:235], v[16:31]
  v_mfma_f32_32x32x16_bf16 v[32:47], a[88:91], v[236:239], v[32:47]
  ds_read_b128 v[248:251], v2 offset:57344
  ds_read_b128 v[252:255], v4 offset:57344
  ds_read_b128 a[240:243], v7 offset:57344
  s_waitcnt lgkmcnt(3)
  v_mfma_f32_32x32x16_bf16 v[16:31], a[92:95], v[240:243], v[16:31]
  v_mfma_f32_32x32x16_bf16 v[32:47], a[92:95], v[244:247], v[32:47]
  ds_read_b128 v[232:235], v2 offset:58368
  ds_read_b128 v[236:239], v4 offset:58368
  s_waitcnt lgkmcnt(3)
  v_mfma_f32_32x32x16_bf16 v[16:31], a[96:99], v[248:251], v[16:31]
  v_mfma_f32_32x32x16_bf16 v[32:47], a[96:99], v[252:255], v[32:47]
  ds_read_b128 v[240:243], v2 offset:59392
  ds_read_b128 v[244:247], v4 offset:59392
  s_waitcnt lgkmcnt(2)
  v_mfma_f32_32x32x16_bf16 v[16:31], a[100:103], v[232:235], v[16:31]
  v_mfma_f32_32x32x16_bf16 v[32:47], a[100:103], v[236:239], v[32:47]
  s_waitcnt vmcnt(5)
  v_mfma_f32_32x32x16_bf16 v[48:63], a[184:187], a[240:243], v[48:63]
  ds_read_b128 v[248:251], v2 offset:60416
  ds_read_b128 v[252:255], v4 offset:60416
  s_waitcnt lgkmcnt(2)
  v_mfma_f32_32x32x16_bf16 v[16:31], a[104:107], v[240:243], v[16:31]
  v_mfma_f32_32x32x16_bf16 v[32:47], a[104:107], v[244:247], v[32:47]
  ds_read_b128 v[232:235], v2 offset:61440
  ds_read_b128 v[236:239], v4 offset:61440
  ds_read_b128 a[244:247], v7 offset:61440
  s_waitcnt lgkmcnt(3)
  v_mfma_f32_32x32x16_bf16 v[16:31], a[108:111], v[248:251], v[16:31]
  v_mfma_f32_32x32x16_bf16 v[32:47], a[108:111], v[252:255], v[32:47]
  ds_read_b128 v[240:243], v2 offset:62464
  ds_read_b128 v[244:247], v4 offset:62464
  s_waitcnt vmcnt(3)
  s_waitcnt lgkmcnt(3)
  v_mfma_f32_32x32x16_bf16 v[16:31], a[112:115], v[232:235], v[16:31]
  v_mfma_f32_32x32x16_bf16 v[32:47], a[112:115], v[236:239], v[32:47]
  ds_read_b128 v[248:251], v2 offset:63488
  ds_read_b128 v[252:255], v4 offset:63488
  s_waitcnt vmcnt(2)
  s_waitcnt lgkmcnt(2)
  v_mfma_f32_32x32x16_bf16 v[16:31], a[116:119], v[240:243], v[16:31]
  v_mfma_f32_32x32x16_bf16 v[32:47], a[116:119], v[244:247], v[32:47]
  v_mfma_f32_32x32x16_bf16 v[48:63], a[188:191], a[244:247], v[48:63]
  ds_read_b128 v[232:235], v2 offset:64512
  ds_read_b128 v[236:239], v4 offset:64512
  s_waitcnt vmcnt(1)
  s_waitcnt lgkmcnt(2)
  v_mfma_f32_32x32x16_bf16 v[16:31], a[120:123], v[248:251], v[16:31]
  v_mfma_f32_32x32x16_bf16 v[32:47], a[120:123], v[252:255], v[32:47]
  s_waitcnt vmcnt(0)
  s_waitcnt lgkmcnt(0)
  v_mfma_f32_32x32x16_bf16 v[16:31], a[124:127], v[232:235], v[16:31]
  v_mfma_f32_32x32x16_bf16 v[32:47], a[124:127], v[236:239], v[32:47]
  s_add_u32 s40, s4, 8650752
  s_addc_u32 s41, s5, 0
  s_and_b32 s41, s41, 0xffff
  s_mov_b32 s42, 262144
  s_mov_b32 s43, 0x00020000
  s_add_u32 s44, s4, 65536
  s_addc_u32 s45, s5, 0
  s_and_b32 s45, s45, 0xffff
  s_mov_b32 s46, 2048
  s_mov_b32 s47, 0x00020000
  s_lshl_b32 s38, s8, 1
  s_add_u32 s38, s38, s34
  s_cmp_lg_u32 s33, 0
  s_cbranch_scc1 k2_vtype
  s_lshl_b32 s36, s3, 12
  v_add_u32 v10, s36, v2
  v_add_u32 v10, 139264, v10
  ds_write_b128 v10, v[48:51] offset:0
  ds_write_b128 v10, v[52:55] offset:1024
  ds_write_b128 v10, v[56:59] offset:2048
  ds_write_b128 v10, v[60:63] offset:3072
  s_waitcnt lgkmcnt(0)
  s_barrier
  s_cmp_lg_u32 s3, 0
  s_cbranch_scc1 k2_kvdone
  v_add_u32 v10, 139264, v2
  ds_read_b128 v[64:67], v10 offset:4096
  ds_read_b128 v[68:71], v10 offset:5120
  ds_read_b128 v[72:75], v10 offset:6144
  ds_read_b128 v[76:79], v10 offset:7168
  ds_read_b128 v[80:83], v10 offset:8192
  ds_read_b128 v[84:87], v10 offset:9216
  ds_read_b128 v[88:91], v10 offset:10240
  ds_read_b128 v[92:95], v10 offset:11264
  ds_read_b128 v[96:99], v10 offset:12288
  ds_read_b128 v[100:103], v10 offset:13312
  ds_read_b128 v[104:107], v10 offset:14336
  ds_read_b128 v[108:111], v10 offset:15360
  s_waitcnt lgkmcnt(0)
  v_add_f32 v48, v48, v64
  v_add_f32 v49, v49, v65
  v_add_f32 v50, v50, v66
  v_add_f32 v51, v51, v67
  v_add_f32 v52, v52, v68
  v_add_f32 v53, v53, v69
  v_add_f32 v54, v54, v70
  v_add_f32 v55, v55, v71
  v_add_f32 v56, v56, v72
  v_add_f32 v57, v57, v73
  v_add_f32 v58, v58, v74
  v_add_f32 v59, v59, v75
  v_add_f32 v60, v60, v76
  v_add_f32 v61, v61, v77
  v_add_f32 v62, v62, v78
  v_add_f32 v63, v63, v79
  v_add_f32 v48, v48, v80
  v_add_f32 v49, v49, v81
  v_add_f32 v50, v50, v82
  v_add_f32 v51, v51, v83
  v_add_f32 v52, v52, v84
  v_add_f32 v53, v53, v85
  v_add_f32 v54, v54, v86
  v_add_f32 v55, v55, v87
  v_add_f32 v56, v56, v88
  v_add_f32 v57, v57, v89
  v_add_f32 v58, v58, v90
  v_add_f32 v59, v59, v91
  v_add_f32 v60, v60, v92
  v_add_f32 v61, v61, v93
  v_add_f32 v62, v62, v94
  v_add_f32 v63, v63, v95
  v_add_f32 v48, v48, v96
  v_add_f32 v49, v49, v97
  v_add_f32 v50, v50, v98
  v_add_f32 v51, v51, v99
  v_add_f32 v52, v52, v100
  v_add_f32 v53, v53, v101
  v_add_f32 v54, v54, v102
  v_add_f32 v55, v55, v103
  v_add_f32 v56, v56, v104
  v_add_f32 v57, v57, v105
  v_add_f32 v58, v58, v106
  v_add_f32 v59, v59, v107
  v_add_f32 v60, v60, v108
  v_add_f32 v61, v61, v109
  v_add_f32 v62, v62, v110
  v_add_f32 v63, v63, v111
  v_mul_f32 v11, v48, v48
  v_fmac_f32 v11, v49, v49
  v_fmac_f32 v11, v50, v50
  v_fmac_f32 v11, v51, v51
  v_fmac_f32 v11, v52, v52
  v_fmac_f32 v11, v53, v53
  v_fmac_f32 v11, v54, v54
  v_fmac_f32 v11, v55, v55
  v_fmac_f32 v11, v56, v56
  v_fmac_f32 v11, v57, v57
  v_fmac_f32 v11, v58, v58
  v_fmac_f32 v11, v59, v59
  v_fmac_f32 v11, v60, v60
  v_fmac_f32 v11, v61, v61
  v_fmac_f32 v11, v62, v62
  v_fmac_f32 v11, v63, v63
  v_mov_b32 v12, v11
  s_nop 1
  v_permlane32_swap_b32 v11, v12
  v_add_f32 v11, v11, v12
  s_nop 1
  v_max_f32_dpp v11, v11, v11 row_ror:1 row_mask:0xf bank_mask:0xf
  s_nop 1
  v_max_f32_dpp v11, v11, v11 row_ror:2 row_mask:0xf bank_mask:0xf
  s_nop 1
  v_max_f32_dpp v11, v11, v11 row_ror:4 row_mask:0xf bank_mask:0xf
  s_nop 1
  v_max_f32_dpp v11, v11, v11 row_ror:8 row_mask:0xf bank_mask:0xf
  v_mov_b32 v12, v11
  s_nop 1
  v_permlane16_swap_b32 v11, v12
  v_max_f32 v11, v11, v12
  v_mov_b32 v12, v11
  s_nop 1
  v_permlane32_swap_b32 v11, v12
  v_max_f32 v11, v11, v12
  v_cvt_pk_bf16_f32 v64, v48, v49
  v_cvt_pk_bf16_f32 v65, v50, v51
  v_cvt_pk_bf16_f32 v66, v52, v53
  v_cvt_pk_bf16_f32 v67, v54, v55
  v_cvt_pk_bf16_f32 v68, v56, v57
  v_cvt_pk_bf16_f32 v69, v58, v59
  v_cvt_pk_bf16_f32 v70, v60, v61
  v_cvt_pk_bf16_f32 v71, v62, v63
  s_lshl_b32 s39, s38, 12
  buffer_store_dwordx4 v[64:67], v2, s[40:43], s39 offen sc1
  buffer_store_dwordx4 v[68:71], v2, s[40:43], s39 offen offset:1024 sc1
  s_lshl_b32 s39, s38, 2
  v_mov_b32 v12, 0
  v_cmp_eq_u32 vcc, 0, v1
  s_nop 2
  s_and_saveexec_b64 s[48:49], vcc
  buffer_store_dword v11, v12, s[44:47], s39 offen
  s_mov_b64 exec, s[48:49]
  s_branch k2_kvdone
k2_vtype:
  v_and_b32 v10, 31, v1
  v_lshrrev_b32 v11, 5, v1
  v_mul_u32_u24 v12, 576, v11
  v_lshl_add_u32 v12, v10, 2, v12
  s_mul_i32 s36, s3, 4608
  v_add_u32 v12, s36, v12
  v_add_u32 v12, 139264, v12
  ds_write_b32 v12, v48 offset:0
  ds_write_b32 v12, v49 offset:144
  ds_write_b32 v12, v50 offset:288
  ds_write_b32 v12, v51 offset:432
  ds_write_b32 v12, v52 offset:1152
  ds_write_b32 v12, v53 offset:1296
  ds_write_b32 v12, v54 offset:1440
  ds_write_b32 v12, v55 offset:1584
  ds_write_b32 v12, v56 offset:2304
  ds_write_b32 v12, v57 offset:2448
  ds_write_b32 v12, v58 offset:2592
  ds_write_b32 v12, v59 offset:2736
  ds_write_b32 v12, v60 offset:3456
  ds_write_b32 v12, v61 offset:3600
  ds_write_b32 v12, v62 offset:3744
  ds_write_b32 v12, v63 offset:3888
  s_waitcnt lgkmcnt(0)
  s_barrier
  s_cmp_lg_u32 s3, 0
  s_cbranch_scc1 k2_kvdone
  v_mul_u32_u24 v12, 144, v10
  v_lshl_add_u32 v12, v11, 4, v12
  v_add_u32 v12, 139264, v12
  ds_read_b128 v[64:67], v12 offset:0
  ds_read_b128 v[68:71], v12 offset:32
  ds_read_b128 v[72:75], v12 offset:64
  ds_read_b128 v[76:79], v12 offset:96
  ds_read_b128 v[80:83], v12 offset:4608
  ds_read_b128 v[84:87], v12 offset:4640
  ds_read_b128 v[88:91], v12 offset:4672
  ds_read_b128 v[92:95], v12 offset:4704
  ds_read_b128 v[96:99], v12 offset:9216
  ds_read_b128 v[100:103], v12 offset:9248
  ds_read_b128 v[104:107], v12 offset:9280
  ds_read_b128 v[108:111], v12 offset:9312
  ds_read_b128 v[112:115], v12 offset:13824
  ds_read_b128 v[116:119], v12 offset:13856
  ds_read_b128 v[120:123], v12 offset:13888
  ds_read_b128 v[124:127], v12 offset:13920
  s_waitcnt lgkmcnt(0)
  v_add_f32 v64, v64, v80
  v_add_f32 v65, v65, v81
  v_add_f32 v66, v66, v82
  v_add_f32 v67, v67, v83
  v_add_f32 v68, v68, v84
  v_add_f32 v69, v69, v85
  v_add_f32 v70, v70, v86
  v_add_f32 v71, v71, v87
  v_add_f32 v72, v72, v88
  v_add_f32 v73, v73, v89
  v_add_f32 v74, v74, v90
  v_add_f32 v75, v75, v91
  v_add_f32 v76, v76, v92
  v_add_f32 v77, v77, v93
  v_add_f32 v78, v78, v94
  v_add_f32 v79, v79, v95
  v_add_f32 v64, v64, v96
  v_add_f32 v65, v65, v97
  v_add_f32 v66, v66, v98
  v_add_f32 v67, v67, v99
  v_add_f32 v68, v68, v100
  v_add_f32 v69, v69, v101
  v_add_f32 v70, v70, v102
  v_add_f32 v71, v71, v103
  v_add_f32 v72, v72, v104
  v_add_f32 v73, v73, v105
  v_add_f32 v74, v74, v106
  v_add_f32 v75, v75, v107
  v_add_f32 v76, v76, v108
  v_add_f32 v77, v77, v109
  v_add_f32 v78, v78, v110
  v_add_f32 v79, v79, v111
  v_add_f32 v64, v64, v112
  v_add_f32 v65, v65, v113
  v_add_f32 v66, v66, v114
  v_add_f32 v67, v67, v115
  v_add_f32 v68, v68, v116
  v_add_f32 v69, v69, v117
  v_add_f32 v70, v70, v118
  v_add_f32 v71, v71, v119
  v_add_f32 v72, v72, v120
  v_add_f32 v73, v73, v121
  v_add_f32 v74, v74, v122
  v_add_f32 v75, v75, v123
  v_add_f32 v76, v76, v124
  v_add_f32 v77, v77, v125
  v_add_f32 v78, v78, v126
  v_add_f32 v79, v79, v127
  v_and_b32 v11, 0x7fffffff, v64
  v_max_f32_e64 v11, v11, abs(v65)
  v_max_f32_e64 v11, v11, abs(v66)
  v_max_f32_e64 v11, v11, abs(v67)
  v_max_f32_e64 v11, v11, abs(v68)
  v_max_f32_e64 v11, v11, abs(v69)
  v_max_f32_e64 v11, v11, abs(v70)
  v_max_f32_e64 v11, v11, abs(v71)
  v_max_f32_e64 v11, v11, abs(v72)
  v_max_f32_e64 v11, v11, abs(v73)
  v_max_f32_e64 v11, v11, abs(v74)
  v_max_f32_e64 v11, v11, abs(v75)
  v_max_f32_e64 v11, v11, abs(v76)
  v_max_f32_e64 v11, v11, abs(v77)
  v_max_f32_e64 v11, v11, abs(v78)
  v_max_f32_e64 v11, v11, abs(v79)
  s_nop 1
  v_max_f32_dpp v11, v11, v11 row_ror:1 row_mask:0xf bank_mask:0xf
  s_nop 1
  v_max_f32_dpp v11, v11, v11 row_ror:2 row_mask:0xf bank_mask:0xf
  s_nop 1
  v_max_f32_dpp v11, v11, v11 row_ror:4 row_mask:0xf bank_mask:0xf
  s_nop 1
  v_max_f32_dpp v11, v11, v11 row_ror:8 row_mask:0xf bank_mask:0xf
  v_mov_b32 v12, v11
  s_nop 1
  v_permlane16_swap_b32 v11, v12
  v_max_f32 v11, v11, v12
  v_mov_b32 v12, v11
  s_nop 1
  v_permlane32_swap_b32 v11, v12
  v_max_f32 v11, v11, v12
  v_cvt_pk_bf16_f32 v80, v64, v65
  v_cvt_pk_bf16_f32 v81, v66, v67
  v_cvt_pk_bf16_f32 v82, v68, v69
  v_cvt_pk_bf16_f32 v83, v70, v71
  v_cvt_pk_bf16_f32 v84, v72, v73
  v_cvt_pk_bf16_f32 v85, v74, v75
  v_cvt_pk_bf16_f32 v86, v76, v77
  v_cvt_pk_bf16_f32 v87, v78, v79
  s_lshl_b32 s39, s38, 12
  s_add_u32 s39, s39, 2048
  buffer_store_dwordx4 v[80:83], v2, s[40:43], s39 offen sc1
  buffer_store_dwordx4 v[84:87], v2, s[40:43], s39 offen offset:1024 sc1
  s_lshl_b32 s39, s38, 2
  v_mov_b32 v12, 0
  v_cmp_eq_u32 vcc, 0, v1
  s_nop 2
  s_and_saveexec_b64 s[48:49], vcc
  buffer_store_dword v11, v12, s[44:47], s39 offen offset:256
  s_mov_b64 exec, s[48:49]
k2_kvdone:
  s_branch k2_epi
k2_nokv2:
  ds_read_b128 v[192:195], v8 offset:0
  ds_read_b128 v[196:199], v8 offset:16
  ds_read_b128 v[200:203], v8 offset:32
  ds_read_b128 v[204:207], v8 offset:48
  s_waitcnt vmcnt(18)
  ds_read_b128 v[208:211], v8 offset:128
  ds_read_b128 v[212:215], v8 offset:144
  ds_read_b128 v[216:219], v8 offset:160
  ds_read_b128 v[220:223], v8 offset:176
  s_waitcnt lgkmcnt(4)
  v_lshlrev_b32 v224, 16, v64
  buffer_load_dwordx4 v[128:131], v2, s[16:19], s29 offen offset:0
  v_and_b32 v225, 0xffff0000, v64
  v_lshlrev_b32 v226, 16, v65
  v_and_b32 v227, 0xffff0000, v65
  v_lshlrev_b32 v228, 16, v66
  v_and_b32 v229, 0xffff0000, v66
  buffer_load_dwordx4 v[132:135], v2, s[16:19], s29 offen offset:1024
  v_lshlrev_b32 v230, 16, v67
  v_and_b32 v231, 0xffff0000, v67
  v_fma_f32 v224, v224, v192, v200
  v_fma_f32 v225, v225, v193, v201
  v_fma_f32 v226, v226, v194, v202
  buffer_load_dwordx4 v[136:139], v2, s[16:19], s29 offen offset:2048
  v_fma_f32 v227, v227, v195, v203
  v_fma_f32 v228, v228, v196, v204
  v_fma_f32 v229, v229, v197, v205
  v_fma_f32 v230, v230, v198, v206
  v_fma_f32 v231, v231, v199, v207
  buffer_load_dwordx4 v[140:143], v2, s[16:19], s29 offen offset:3072
  v_cvt_pk_bf16_f32 v64, v224, v225
  v_cvt_pk_bf16_f32 v65, v226, v227
  v_cvt_pk_bf16_f32 v66, v228, v229
  v_cvt_pk_bf16_f32 v67, v230, v231
  ds_write_b128 v12, v[64:67] offset:0
  buffer_load_dwordx4 v[144:147], v2, s[16:19], s30 offen offset:0
  v_lshlrev_b32 v224, 16, v80
  v_and_b32 v225, 0xffff0000, v80
  v_lshlrev_b32 v226, 16, v81
  v_and_b32 v227, 0xffff0000, v81
  v_lshlrev_b32 v228, 16, v82
  buffer_load_dwordx4 v[148:151], v2, s[16:19], s30 offen offset:1024
  v_and_b32 v229, 0xffff0000, v82
  v_lshlrev_b32 v230, 16, v83
  v_and_b32 v231, 0xffff0000, v83
  v_fma_f32 v224, v224, v192, v200
  v_fma_f32 v225, v225, v193, v201
  buffer_load_dwordx4 v[152:155], v2, s[16:19], s30 offen offset:2048
  v_fma_f32 v226, v226, v194, v202
  v_fma_f32 v227, v227, v195, v203
  v_fma_f32 v228, v228, v196, v204
  v_fma_f32 v229, v229, v197, v205
  v_fma_f32 v230, v230, v198, v206
  buffer_load_dwordx4 v[156:159], v2, s[16:19], s30 offen offset:3072
  s_add_u32 s29, s29, 16384
  s_add_u32 s30, s30, 16384
  v_fma_f32 v231, v231, v199, v207
  v_cvt_pk_bf16_f32 v80, v224, v225
  v_cvt_pk_bf16_f32 v81, v226, v227
  v_cvt_pk_bf16_f32 v82, v228, v229
  v_cvt_pk_bf16_f32 v83, v230, v231
  buffer_load_dwordx4 a[32:35], v2, s[20:23], s31 offen offset:0
  ds_write_b128 v13, v[80:83] offset:0
  ds_read_b128 v[192:195], v8 offset:256
  ds_read_b128 v[196:199], v8 offset:272
  ds_read_b128 v[200:203], v8 offset:288
  ds_read_b128 v[204:207], v8 offset:304
  s_waitcnt lgkmcnt(6)
  v_lshlrev_b32 v224, 16, v68
  v_and_b32 v225, 0xffff0000, v68
  buffer_load_dwordx4 a[36:39], v2, s[20:23], s31 offen offset:1024
  v_lshlrev_b32 v226, 16, v69
  v_and_b32 v227, 0xffff0000, v69
  v_lshlrev_b32 v228, 16, v70
  v_and_b32 v229, 0xffff0000, v70
  v_lshlrev_b32 v230, 16, v71
  buffer_load_dwordx4 a[40:43], v2, s[20:23], s31 offen offset:2048
  v_and_b32 v231, 0xffff0000, v71
  v_fma_f32 v224, v224, v208, v216
  v_fma_f32 v225, v225, v209, v217
  v_fma_f32 v226, v226, v210, v218
  v_fma_f32 v227, v227, v211, v219
  buffer_load_dwordx4 a[44:47], v2, s[20:23], s31 offen offset:3072
  s_add_u32 s31, s31, 4096
  v_fma_f32 v228, v228, v212, v220
  v_fma_f32 v229, v229, v213, v221
  v_fma_f32 v230, v230, v214, v222
  v_fma_f32 v231, v231, v215, v223
  v_cvt_pk_bf16_f32 v68, v224, v225
  buffer_load_dwordx4 v[160:163], v2, s[16:19], s29 offen offset:0
  v_cvt_pk_bf16_f32 v69, v226, v227
  v_cvt_pk_bf16_f32 v70, v228, v229
  v_cvt_pk_bf16_f32 v71, v230, v231
  ds_write_b128 v12, v[68:71] offset:1024
  v_lshlrev_b32 v224, 16, v84
  buffer_load_dwordx4 v[164:167], v2, s[16:19], s29 offen offset:1024
  v_and_b32 v225, 0xffff0000, v84
  v_lshlrev_b32 v226, 16, v85
  v_and_b32 v227, 0xffff0000, v85
  v_lshlrev_b32 v228, 16, v86
  v_and_b32 v229, 0xffff0000, v86
  buffer_load_dwordx4 v[168:171], v2, s[16:19], s29 offen offset:2048
  v_lshlrev_b32 v230, 16, v87
  v_and_b32 v231, 0xffff0000, v87
  v_fma_f32 v224, v224, v208, v216
  v_fma_f32 v225, v225, v209, v217
  v_fma_f32 v226, v226, v210, v218
  buffer_load_dwordx4 v[172:175], v2, s[16:19], s29 offen offset:3072
  v_fma_f32 v227, v227, v211, v219
  v_fma_f32 v228, v228, v212, v220
  v_fma_f32 v229, v229, v213, v221
  v_fma_f32 v230, v230, v214, v222
  v_fma_f32 v231, v231, v215, v223
  buffer_load_dwordx4 v[176:179], v2, s[16:19], s30 offen offset:0
  v_cvt_pk_bf16_f32 v84, v224, v225
  v_cvt_pk_bf16_f32 v85, v226, v227
  v_cvt_pk_bf16_f32 v86, v228, v229
  v_cvt_pk_bf16_f32 v87, v230, v231
  ds_write_b128 v13, v[84:87] offset:1024
  buffer_load_dwordx4 v[180:183], v2, s[16:19], s30 offen offset:1024
  ds_read_b128 v[208:211], v8 offset:384
  ds_read_b128 v[212:215], v8 offset:400
  ds_read_b128 v[216:219], v8 offset:416
  ds_read_b128 v[220:223], v8 offset:432
  s_waitcnt lgkmcnt(6)
  v_lshlrev_b32 v224, 16, v72
  v_and_b32 v225, 0xffff0000, v72
  v_lshlrev_b32 v226, 16, v73
  buffer_load_dwordx4 v[184:187], v2, s[16:19], s30 offen offset:2048
  v_and_b32 v227, 0xffff0000, v73
  v_lshlrev_b32 v228, 16, v74
  v_and_b32 v229, 0xffff0000, v74
  v_lshlrev_b32 v230, 16, v75
  v_and_b32 v231, 0xffff0000, v75
  buffer_load_dwordx4 v[188:191], v2, s[16:19], s30 offen offset:3072
  s_add_u32 s29, s29, 16384
  s_add_u32 s30, s30, 16384
  v_fma_f32 v224, v224, v192, v200
  v_fma_f32 v225, v225, v193, v201
  v_fma_f32 v226, v226, v194, v202
  v_fma_f32 v227, v227, v195, v203
  v_fma_f32 v228, v228, v196, v204
  buffer_load_dwordx4 a[48:51], v2, s[20:23], s31 offen offset:0
  v_fma_f32 v229, v229, v197, v205
  v_fma_f32 v230, v230, v198, v206
  v_fma_f32 v231, v231, v199, v207
  v_cvt_pk_bf16_f32 v72, v224, v225
  v_cvt_pk_bf16_f32 v73, v226, v227
  buffer_load_dwordx4 a[52:55], v2, s[20:23], s31 offen offset:1024
  v_cvt_pk_bf16_f32 v74, v228, v229
  v_cvt_pk_bf16_f32 v75, v230, v231
  ds_write_b128 v12, v[72:75] offset:2048
  v_lshlrev_b32 v224, 16, v88
  v_and_b32 v225, 0xffff0000, v88
  buffer_load_dwordx4 a[56:59], v2, s[20:23], s31 offen offset:2048
  v_lshlrev_b32 v226, 16, v89
  v_and_b32 v227, 0xffff0000, v89
  v_lshlrev_b32 v228, 16, v90
  v_and_b32 v229, 0xffff0000, v90
  v_lshlrev_b32 v230, 16, v91
  buffer_load_dwordx4 a[60:63], v2, s[20:23], s31 offen offset:3072
  s_add_u32 s31, s31, 4096
  v_and_b32 v231, 0xffff0000, v91
  v_fma_f32 v224, v224, v192, v200
  v_fma_f32 v225, v225, v193, v201
  v_fma_f32 v226, v226, v194, v202
  v_fma_f32 v227, v227, v195, v203
  buffer_load_dwordx4 a[64:67], v2, s[20:23], s31 offen offset:0
  v_fma_f32 v228, v228, v196, v204
  v_fma_f32 v229, v229, v197, v205
  v_fma_f32 v230, v230, v198, v206
  v_fma_f32 v231, v231, v199, v207
  v_cvt_pk_bf16_f32 v88, v224, v225
  buffer_load_dwordx4 a[68:71], v2, s[20:23], s31 offen offset:1024
  v_cvt_pk_bf16_f32 v89, v226, v227
  v_cvt_pk_bf16_f32 v90, v228, v229
  v_cvt_pk_bf16_f32 v91, v230, v231
  ds_write_b128 v13, v[88:91] offset:2048
  buffer_load_dwordx4 a[72:75], v2, s[20:23], s31 offen offset:2048
  s_waitcnt lgkmcnt(2)
  v_lshlrev_b32 v224, 16, v76
  v_and_b32 v225, 0xffff0000, v76
  v_lshlrev_b32 v226, 16, v77
  v_and_b32 v227, 0xffff0000, v77
  buffer_load_dwordx4 a[76:79], v2, s[20:23], s31 offen offset:3072
  s_add_u32 s31, s31, 4096
  v_lshlrev_b32 v228, 16, v78
  v_and_b32 v229, 0xffff0000, v78
  v_lshlrev_b32 v230, 16, v79
  v_and_b32 v231, 0xffff0000, v79
  v_fma_f32 v224, v224, v208, v216
  v_fma_f32 v225, v225, v209, v217
  v_fma_f32 v226, v226, v210, v218
  v_fma_f32 v227, v227, v211, v219
  v_fma_f32 v228, v228, v212, v220
  v_fma_f32 v229, v229, v213, v221
  v_fma_f32 v230, v230, v214, v222
  v_fma_f32 v231, v231, v215, v223
  v_cvt_pk_bf16_f32 v76, v224, v225
  v_cvt_pk_bf16_f32 v77, v226, v227
  v_cvt_pk_bf16_f32 v78, v228, v229
  v_cvt_pk_bf16_f32 v79, v230, v231
  ds_write_b128 v12, v[76:79] offset:3072
  v_lshlrev_b32 v224, 16, v92
  v_and_b32 v225, 0xffff0000, v92
  v_lshlrev_b32 v226, 16, v93
  v_and_b32 v227, 0xffff0000, v93
  v_lshlrev_b32 v228, 16, v94
  v_and_b32 v229, 0xffff0000, v94
  v_lshlrev_b32 v230, 16, v95
  v_and_b32 v231, 0xffff0000, v95
  v_fma_f32 v224, v224, v208, v216
  v_fma_f32 v225, v225, v209, v217
  v_fma_f32 v226, v226, v210, v218
  v_fma_f32 v227, v227, v211, v219
  v_fma_f32 v228, v228, v212, v220
  v_fma_f32 v229, v229, v213, v221
  v_fma_f32 v230, v230, v214, v222
  v_fma_f32 v231, v231, v215, v223
  v_cvt_pk_bf16_f32 v92, v224, v225
  v_cvt_pk_bf16_f32 v93, v226, v227
  v_cvt_pk_bf16_f32 v94, v228, v229
  v_cvt_pk_bf16_f32 v95, v230, v231
  ds_write_b128 v13, v[92:95] offset:3072
  s_waitcnt lgkmcnt(0)
  s_barrier
  ds_read_b128 v[232:235], v2 offset:0
  ds_read_b128 v[236:239], v4 offset:0
  ds_read_b128 v[240:243], v2 offset:1024
  ds_read_b128 v[244:247], v4 offset:1024
  ds_read_b128 v[192:195], v8 offset:2048
  ds_read_b128 v[196:199], v8 offset:2064
  ds_read_b128 v[200:203], v8 offset:2080
  ds_read_b128 v[204:207], v8 offset:2096
  s_waitcnt vmcnt(34)
  ds_read_b128 v[208:211], v8 offset:2176
  ds_read_b128 v[212:215], v8 offset:2192
  ds_read_b128 v[216:219], v8 offset:2208
  ds_read_b128 v[220:223], v8 offset:2224
  s_waitcnt lgkmcnt(4)
  v_mfma_f32_32x32x16_bf16 v[16:31], a[0:3], v[232:235], v[16:31]
  v_lshlrev_b32 v224, 16, v96
  v_and_b32 v225, 0xffff0000, v96
  v_lshlrev_b32 v226, 16, v97
  v_and_b32 v227, 0xffff0000, v97
  v_lshlrev_b32 v228, 16, v98
  buffer_load_dwordx4 a[80:83], v2, s[20:23], s31 offen offset:0
  v_mfma_f32_32x32x16_bf16 v[32:47], a[0:3], v[236:239], v[32:47]
  v_and_b32 v229, 0xffff0000, v98
  v_lshlrev_b32 v230, 16, v99
  v_and_b32 v231, 0xffff0000, v99
  v_fma_f32 v224, v224, v192, v200
  buffer_load_dwordx4 a[84:87], v2, s[20:23], s31 offen offset:1024
  ds_read_b128 v[248:251], v2 offset:2048
  ds_read_b128 v[252:255], v4 offset:2048
  v_mfma_f32_32x32x16_bf16 v[16:31], a[4:7], v[240:243], v[16:31]
  v_fma_f32 v225, v225, v193, v201
  v_fma_f32 v226, v226, v194, v202
  v_fma_f32 v227, v227, v195, v203
  v_fma_f32 v228, v228, v196, v204
  v_fma_f32 v229, v229, v197, v205
  buffer_load_dwordx4 a[88:91], v2, s[20:23], s31 offen offset:2048
  v_mfma_f32_32x32x16_bf16 v[32:47], a[4:7], v[244:247], v[32:47]
  v_fma_f32 v230, v230, v198, v206
  v_fma_f32 v231, v231, v199, v207
  v_cvt_pk_bf16_f32 v96, v224, v225
  v_cvt_pk_bf16_f32 v97, v226, v227
  buffer_load_dwordx4 a[92:95], v2, s[20:23], s31 offen offset:3072
  s_add_u32 s31, s31, 4096
  ds_read_b128 v[232:235], v2 offset:3072
  ds_read_b128 v[236:239], v4 offset:3072
  s_waitcnt lgkmcnt(2)
  v_mfma_f32_32x32x16_bf16 v[16:31], a[8:11], v[248:251], v[16:31]
  v_cvt_pk_bf16_f32 v98, v228, v229
  v_cvt_pk_bf16_f32 v99, v230, v231
  ds_write_b128 v12, v[96:99] offset:16384
  v_lshlrev_b32 v224, 16, v112
  v_and_b32 v225, 0xffff0000, v112
  buffer_load_dwordx4 a[96:99], v2, s[20:23], s31 offen offset:0
  v_mfma_f32_32x32x16_bf16 v[32:47], a[8:11], v[252:255], v[32:47]
  v_lshlrev_b32 v226, 16, v113
  v_and_b32 v227, 0xffff0000, v113
  v_lshlrev_b32 v228, 16, v114
  v_and_b32 v229, 0xffff0000, v114
  v_lshlrev_b32 v230, 16, v115
  buffer_load_dwordx4 a[100:103], v2, s[20:23], s31 offen offset:1024
  ds_read_b128 v[240:243], v2 offset:4096
  ds_read_b128 v[244:247], v4 offset:4096
  s_waitcnt lgkmcnt(3)
  v_mfma_f32_32x32x16_bf16 v[16:31], a[12:15], v[232:235], v[16:31]
  v_and_b32 v231, 0xffff0000, v115
  v_fma_f32 v224, v224, v192, v200
  v_fma_f32 v225, v225, v193, v201
  v_fma_f32 v226, v226, v194, v202
  buffer_load_dwordx4 a[104:107], v2, s[20:23], s31 offen offset:2048
  v_mfma_f32_32x32x16_bf16 v[32:47], a[12:15], v[236:239], v[32:47]
  v_fma_f32 v227, v227, v195, v203
  v_fma_f32 v228, v228, v196, v204
  v_fma_f32 v229, v229, v197, v205
  v_fma_f32 v230, v230, v198, v206
  v_fma_f32 v231, v231, v199, v207
  buffer_load_dwordx4 a[108:111], v2, s[20:23], s31 offen offset:3072
  s_add_u32 s31, s31, 4096
  ds_read_b128 v[248:251], v2 offset:5120
  ds_read_b128 v[252:255], v4 offset:5120
  s_waitcnt vmcnt(41)
  s_waitcnt lgkmcnt(2)
  v_mfma_f32_32x32x16_bf16 v[16:31], a[16:19], v[240:243], v[16:31]
  v_cvt_pk_bf16_f32 v112, v224, v225
  v_cvt_pk_bf16_f32 v113, v226, v227
  v_cvt_pk_bf16_f32 v114, v228, v229
  v_cvt_pk_bf16_f32 v115, v230, v231
  v_mfma_f32_32x32x16_bf16 v[32:47], a[16:19], v[244:247], v[32:47]
  ds_write_b128 v13, v[112:115] offset:16384
  ds_read_b128 v[192:195], v8 offset:2304
  ds_read_b128 v[196:199], v8 offset:2320
  ds_read_b128 v[200:203], v8 offset:2336
  ds_read_b128 v[204:207], v8 offset:2352
  v_lshlrev_b32 v224, 16, v100
  v_and_b32 v225, 0xffff0000, v100
  buffer_load_dwordx4 a[112:115], v2, s[20:23], s31 offen offset:0
  ds_read_b128 v[232:235], v2 offset:6144
  ds_read_b128 v[236:239], v4 offset:6144
  s_waitcnt vmcnt(41)
  s_waitcnt lgkmcnt(7)
  v_mfma_f32_32x32x16_bf16 v[16:31], a[20:23], v[248:251], v[16:31]
  v_lshlrev_b32 v226, 16, v101
  v_and_b32 v227, 0xffff0000, v101
  v_lshlrev_b32 v228, 16, v102
  v_and_b32 v229, 0xffff0000, v102
  v_lshlrev_b32 v230, 16, v103
  buffer_load_dwordx4 a[116:119], v2, s[20:23], s31 offen offset:1024
  v_mfma_f32_32x32x16_bf16 v[32:47], a[20:23], v[252:255], v[32:47]
  v_and_b32 v231, 0xffff0000, v103
  v_fma_f32 v224, v224, v208, v216
  v_fma_f32 v225, v225, v209, v217
  v_fma_f32 v226, v226, v210, v218
  buffer_load_dwordx4 a[120:123], v2, s[20:23], s31 offen offset:2048
  ds_read_b128 v[240:243], v2 offset:7168
  ds_read_b128 v[244:247], v4 offset:7168
  s_waitcnt vmcnt(42)
  s_waitcnt lgkmcnt(2)
  v_mfma_f32_32x32x16_bf16 v[16:31], a[24:27], v[232:235], v[16:31]
  v_fma_f32 v227, v227, v211, v219
  v_fma_f32 v228, v228, v212, v220
  v_fma_f32 v229, v229, v213, v221
  v_fma_f32 v230, v230, v214, v222
  v_fma_f32 v231, v231, v215, v223
  buffer_load_dwordx4 a[124:127], v2, s[20:23], s31 offen offset:3072
  s_add_u32 s31, s31, 4096
  v_mfma_f32_32x32x16_bf16 v[32:47], a[24:27], v[236:239], v[32:47]
  v_cvt_pk_bf16_f32 v100, v224, v225
  v_cvt_pk_bf16_f32 v101, v226, v227
  v_cvt_pk_bf16_f32 v102, v228, v229
  v_cvt_pk_bf16_f32 v103, v230, v231
  buffer_load_dwordx4 a[0:3], v2, s[20:23], s31 offen offset:0
  ds_read_b128 v[248:251], v2 offset:8192
  ds_read_b128 v[252:255], v4 offset:8192
  s_waitcnt vmcnt(43)
  s_waitcnt lgkmcnt(2)
  v_mfma_f32_32x32x16_bf16 v[16:31], a[28:31], v[240:243], v[16:31]
  ds_write_b128 v12, v[100:103] offset:17408
  v_lshlrev_b32 v224, 16, v116
  v_and_b32 v225, 0xffff0000, v116
  v_lshlrev_b32 v226, 16, v117
  v_and_b32 v227, 0xffff0000, v117
  buffer_load_dwordx4 a[4:7], v2, s[20:23], s31 offen offset:1024
  v_mfma_f32_32x32x16_bf16 v[32:47], a[28:31], v[244:247], v[32:47]
  v_lshlrev_b32 v228, 16, v118
  v_and_b32 v229, 0xffff0000, v118
  v_lshlrev_b32 v230, 16, v119
  v_and_b32 v231, 0xffff0000, v119
  v_fma_f32 v224, v224, v208, v216
  buffer_load_dwordx4 a[8:11], v2, s[20:23], s31 offen offset:2048
  ds_read_b128 v[232:235], v2 offset:9216
  ds_read_b128 v[236:239], v4 offset:9216
  s_waitcnt vmcnt(34)
  s_waitcnt lgkmcnt(3)
  v_mfma_f32_32x32x16_bf16 v[16:31], a[32:35], v[248:251], v[16:31]
  v_fma_f32 v225, v225, v209, v217
  v_fma_f32 v226, v226, v210, v218
  v_fma_f32 v227, v227, v211, v219
  v_fma_f32 v228, v228, v212, v220
  buffer_load_dwordx4 a[12:15], v2, s[20:23], s31 offen offset:3072
  s_add_u32 s31, s31, 4096
  v_mfma_f32_32x32x16_bf16 v[32:47], a[32:35], v[252:255], v[32:47]
  v_fma_f32 v229, v229, v213, v221
  v_fma_f32 v230, v230, v214, v222
  v_fma_f32 v231, v231, v215, v223
  v_cvt_pk_bf16_f32 v116, v224, v225
  v_cvt_pk_bf16_f32 v117, v226, v227
  buffer_load_dwordx4 a[16:19], v2, s[20:23], s31 offen offset:0
  ds_read_b128 v[240:243], v2 offset:10240
  ds_read_b128 v[244:247], v4 offset:10240
  s_waitcnt vmcnt(35)
  s_waitcnt lgkmcnt(2)
  v_mfma_f32_32x32x16_bf16 v[16:31], a[36:39], v[232:235], v[16:31]
  v_cvt_pk_bf16_f32 v118, v228, v229
  v_cvt_pk_bf16_f32 v119, v230, v231
  ds_write_b128 v13, v[116:119] offset:17408
  ds_read_b128 v[208:211], v8 offset:2432
  ds_read_b128 v[212:215], v8 offset:2448
  ds_read_b128 v[216:219], v8 offset:2464
  ds_read_b128 v[220:223], v8 offset:2480
  v_mfma_f32_32x32x16_bf16 v[32:47], a[36:39], v[236:239], v[32:47]
  v_lshlrev_b32 v224, 16, v104
  v_and_b32 v225, 0xffff0000, v104
  v_lshlrev_b32 v226, 16, v105
  v_and_b32 v227, 0xffff0000, v105
  buffer_load_dwordx4 a[20:23], v2, s[20:23], s31 offen offset:1024
  ds_read_b128 v[248:251], v2 offset:11264
  ds_read_b128 v[252:255], v4 offset:11264
  s_waitcnt vmcnt(35)
  s_waitcnt lgkmcnt(7)
  v_mfma_f32_32x32x16_bf16 v[16:31], a[40:43], v[240:243], v[16:31]
  v_lshlrev_b32 v228, 16, v106
  v_and_b32 v229, 0xffff0000, v106
  v_lshlrev_b32 v230, 16, v107
  v_and_b32 v231, 0xffff0000, v107
  v_fma_f32 v224, v224, v192, v200
  buffer_load_dwordx4 a[24:27], v2, s[20:23], s31 offen offset:2048
  v_mfma_f32_32x32x16_bf16 v[32:47], a[40:43], v[244:247], v[32:47]
  v_fma_f32 v225, v225, v193, v201
  v_fma_f32 v226, v226, v194, v202
  v_fma_f32 v227, v227, v195, v203
  v_fma_f32 v228, v228, v196, v204
  buffer_load_dwordx4 a[28:31], v2, s[20:23], s31 offen offset:3072
  s_add_u32 s31, s31, 4096
  ds_read_b128 v[232:235], v2 offset:12288
  ds_read_b128 v[236:239], v4 offset:12288
  s_waitcnt vmcnt(36)
  s_waitcnt lgkmcnt(2)
  v_mfma_f32_32x32x16_bf16 v[16:31], a[44:47], v[248:251], v[16:31]
  v_fma_f32 v229, v229, v197, v205
  v_fma_f32 v230, v230, v198, v206
  v_fma_f32 v231, v231, v199, v207
  v_cvt_pk_bf16_f32 v104, v224, v225
  v_cvt_pk_bf16_f32 v105, v226, v227
  buffer_load_dwordx4 a[32:35], v2, s[20:23], s31 offen offset:0
  v_mfma_f32_32x32x16_bf16 v[32:47], a[44:47], v[252:255], v[32:47]
  v_cvt_pk_bf16_f32 v106, v228, v229
  v_cvt_pk_bf16_f32 v107, v230, v231
  ds_write_b128 v12, v[104:107] offset:18432
  v_lshlrev_b32 v224, 16, v120
  buffer_load_dwordx4 a[36:39], v2, s[20:23], s31 offen offset:1024
  ds_read_b128 v[240:243], v2 offset:13312
  ds_read_b128 v[244:247], v4 offset:13312
  s_waitcnt vmcnt(29)
  s_waitcnt lgkmcnt(3)
  v_mfma_f32_32x32x16_bf16 v[16:31], a[48:51], v[232:235], v[16:31]
  v_and_b32 v225, 0xffff0000, v120
  v_lshlrev_b32 v226, 16, v121
  v_and_b32 v227, 0xffff0000, v121
  v_lshlrev_b32 v228, 16, v122
  v_and_b32 v229, 0xffff0000, v122
  buffer_load_dwordx4 a[40:43], v2, s[20:23], s31 offen offset:2048
  v_mfma_f32_32x32x16_bf16 v[32:47], a[48:51], v[236:239], v[32:47]
  v_lshlrev_b32 v230, 16, v123
  v_and_b32 v231, 0xffff0000, v123
  v_fma_f32 v224, v224, v192, v200
  v_fma_f32 v225, v225, v193, v201
  v_fma_f32 v226, v226, v194, v202
  buffer_load_dwordx4 a[44:47], v2, s[20:23], s31 offen offset:3072
  s_add_u32 s31, s31, 4096
  ds_read_b128 v[248:251], v2 offset:14336
  ds_read_b128 v[252:255], v4 offset:14336
  s_waitcnt vmcnt(30)
  s_waitcnt lgkmcnt(2)
  v_mfma_f32_32x32x16_bf16 v[16:31], a[52:55], v[240:243], v[16:31]
  v_fma_f32 v227, v227, v195, v203
  v_fma_f32 v228, v228, v196, v204
  v_fma_f32 v229, v229, v197, v205
  v_fma_f32 v230, v230, v198, v206
  v_mfma_f32_32x32x16_bf16 v[32:47], a[52:55], v[244:247], v[32:47]
  v_fma_f32 v231, v231, v199, v207
  v_cvt_pk_bf16_f32 v120, v224, v225
  v_cvt_pk_bf16_f32 v121, v226, v227
  v_cvt_pk_bf16_f32 v122, v228, v229
  v_cvt_pk_bf16_f32 v123, v230, v231
  ds_read_b128 v[232:235], v2 offset:15360
  ds_read_b128 v[236:239], v4 offset:15360
  s_waitcnt vmcnt(29)
  s_waitcnt lgkmcnt(2)
  v_mfma_f32_32x32x16_bf16 v[16:31], a[56:59], v[248:251], v[16:31]
  ds_write_b128 v13, v[120:123] offset:18432
  v_lshlrev_b32 v224, 16, v108
  v_mfma_f32_32x32x16_bf16 v[32:47], a[56:59], v[252:255], v[32:47]
  v_and_b32 v225, 0xffff0000, v108
  v_lshlrev_b32 v226, 16, v109
  v_and_b32 v227, 0xffff0000, v109
  v_lshlrev_b32 v228, 16, v110
  v_and_b32 v229, 0xffff0000, v110
  s_waitcnt vmcnt(28)
  s_waitcnt lgkmcnt(1)
  v_mfma_f32_32x32x16_bf16 v[16:31], a[60:63], v[232:235], v[16:31]
  v_lshlrev_b32 v230, 16, v111
  v_and_b32 v231, 0xffff0000, v111
  v_fma_f32 v224, v224, v208, v216
  v_fma_f32 v225, v225, v209, v217
  v_fma_f32 v226, v226, v210, v218
  v_mfma_f32_32x32x16_bf16 v[32:47], a[60:63], v[236:239], v[32:47]
  v_fma_f32 v227, v227, v211, v219
  v_fma_f32 v228, v228, v212, v220
  v_fma_f32 v229, v229, v213, v221
  v_fma_f32 v230, v230, v214, v222
  v_fma_f32 v231, v231, v215, v223
  v_cvt_pk_bf16_f32 v108, v224, v225
  v_cvt_pk_bf16_f32 v109, v226, v227
  v_cvt_pk_bf16_f32 v110, v228, v229
  v_cvt_pk_bf16_f32 v111, v230, v231
  ds_write_b128 v12, v[108:111] offset:19456
  v_lshlrev_b32 v224, 16, v124
  v_and_b32 v225, 0xffff0000, v124
  v_lshlrev_b32 v226, 16, v125
  v_and_b32 v227, 0xffff0000, v125
  v_lshlrev_b32 v228, 16, v126
  v_and_b32 v229, 0xffff0000, v126
  v_lshlrev_b32 v230, 16, v127
  v_and_b32 v231, 0xffff0000, v127
  v_fma_f32 v224, v224, v208, v216
  v_fma_f32 v225, v225, v209, v217
  v_fma_f32 v226, v226, v210, v218
  v_fma_f32 v227, v227, v211, v219
  v_fma_f32 v228, v228, v212, v220
  v_fma_f32 v229, v229, v213, v221
  v_fma_f32 v230, v230, v214, v222
  v_fma_f32 v231, v231, v215, v223
  v_cvt_pk_bf16_f32 v124, v224, v225
  v_cvt_pk_bf16_f32 v125, v226, v227
  v_cvt_pk_bf16_f32 v126, v228, v229
  v_cvt_pk_bf16_f32 v127, v230, v231
  ds_write_b128 v13, v[124:127] offset:19456
  s_waitcnt lgkmcnt(0)
  s_barrier
  ds_read_b128 v[240:243], v2 offset:16384
  ds_read_b128 v[244:247], v4 offset:16384
  ds_read_b128 v[248:251], v2 offset:17408
  ds_read_b128 v[252:255], v4 offset:17408
  ds_read_b128 v[192:195], v8 offset:4096
  ds_read_b128 v[196:199], v8 offset:4112
  ds_read_b128 v[200:203], v8 offset:4128
  ds_read_b128 v[204:207], v8 offset:4144
  ds_read_b128 v[208:211], v8 offset:4224
  ds_read_b128 v[212:215], v8 offset:4240
  ds_read_b128 v[216:219], v8 offset:4256
  ds_read_b128 v[220:223], v8 offset:4272
  s_waitcnt lgkmcnt(4)
  s_waitcnt vmcnt(27)
  v_mfma_f32_32x32x16_bf16 v[16:31], a[64:67], v[240:243], v[16:31]
  v_lshlrev_b32 v224, 16, v128
  v_and_b32 v225, 0xffff0000, v128
  v_lshlrev_b32 v226, 16, v129
  v_and_b32 v227, 0xffff0000, v129
  v_lshlrev_b32 v228, 16, v130
  buffer_load_dwordx4 a[48:51], v2, s[20:23], s31 offen offset:0
  v_mfma_f32_32x32x16_bf16 v[32:47], a[64:67], v[244:247], v[32:47]
  v_and_b32 v229, 0xffff0000, v130
  v_lshlrev_b32 v230, 16, v131
  v_and_b32 v231, 0xffff0000, v131
  v_fma_f32 v224, v224, v192, v200
  buffer_load_dwordx4 a[52:55], v2, s[20:23], s31 offen offset:1024
  ds_read_b128 v[232:235], v2 offset:18432
  ds_read_b128 v[236:239], v4 offset:18432
  s_waitcnt vmcnt(28)
  v_mfma_f32_32x32x16_bf16 v[16:31], a[68:71], v[248:251], v[16:31]
  v_fma_f32 v225, v225, v193, v201
  v_fma_f32 v226, v226, v194, v202
  v_fma_f32 v227, v227, v195, v203
  v_fma_f32 v228, v228, v196, v204
  v_fma_f32 v229, v229, v197, v205
  buffer_load_dwordx4 a[56:59], v2, s[20:23], s31 offen offset:2048
  v_mfma_f32_32x32x16_bf16 v[32:47], a[68:71], v[252:255], v[32:47]
  v_fma_f32 v230, v230, v198, v206
  v_fma_f32 v231, v231, v199, v207
  v_cvt_pk_bf16_f32 v128, v224, v225
  v_cvt_pk_bf16_f32 v129, v226, v227
  buffer_load_dwordx4 a[60:63], v2, s[20:23], s31 offen offset:3072
  s_add_u32 s31, s31, 4096
  ds_read_b128 v[240:243], v2 offset:19456
  ds_read_b128 v[244:247], v4 offset:19456
  s_waitcnt vmcnt(29)
  s_waitcnt lgkmcnt(2)
  v_mfma_f32_32x32x16_bf16 v[16:31], a[72:75], v[232:235], v[16:31]
  v_cvt_pk_bf16_f32 v130, v228, v229
  v_cvt_pk_bf16_f32 v131, v230, v231
  ds_write_b128 v12, v[128:131] offset:32768
  v_lshlrev_b32 v224, 16, v144
  v_and_b32 v225, 0xffff0000, v144
  buffer_load_dwordx4 a[64:67], v2, s[20:23], s31 offen offset:0
  v_mfma_f32_32x32x16_bf16 v[32:47], a[72:75], v[236:239], v[32:47]
  v_lshlrev_b32 v226, 16, v145
  v_and_b32 v227, 0xffff0000, v145
  v_lshlrev_b32 v228, 16, v146
  v_and_b32 v229, 0xffff0000, v146
  v_lshlrev_b32 v230, 16, v147
  buffer_load_dwordx4 a[68:71], v2, s[20:23], s31 offen offset:1024
  ds_read_b128 v[248:251], v2 offset:20480
  ds_read_b128 v[252:255], v4 offset:20480
  s_waitcnt vmcnt(30)
  s_waitcnt lgkmcnt(3)
  v_mfma_f32_32x32x16_bf16 v[16:31], a[76:79], v[240:243], v[16:31]
  v_and_b32 v231, 0xffff0000, v147
  v_fma_f32 v224, v224, v192, v200
  v_fma_f32 v225, v225, v193, v201
  v_fma_f32 v226, v226, v194, v202
  buffer_load_dwordx4 a[72:75], v2, s[20:23], s31 offen offset:2048
  v_mfma_f32_32x32x16_bf16 v[32:47], a[76:79], v[244:247], v[32:47]
  v_fma_f32 v227, v227, v195, v203
  v_fma_f32 v228, v228, v196, v204
  v_fma_f32 v229, v229, v197, v205
  v_fma_f32 v230, v230, v198, v206
  v_fma_f32 v231, v231, v199, v207
  buffer_load_dwordx4 a[76:79], v2, s[20:23], s31 offen offset:3072
  s_add_u32 s31, s31, 4096
  ds_read_b128 v[232:235], v2 offset:21504
  ds_read_b128 v[236:239], v4 offset:21504
  s_waitcnt vmcnt(31)
  s_waitcnt lgkmcnt(2)
  v_mfma_f32_32x32x16_bf16 v[16:31], a[80:83], v[248:251], v[16:31]
  v_cvt_pk_bf16_f32 v144, v224, v225
  v_cvt_pk_bf16_f32 v145, v226, v227
  v_cvt_pk_bf16_f32 v146, v228, v229
  v_cvt_pk_bf16_f32 v147, v230, v231
  v_mfma_f32_32x32x16_bf16 v[32:47], a[80:83], v[252:255], v[32:47]
  ds_write_b128 v13, v[144:147] offset:32768
  ds_read_b128 v[192:195], v8 offset:4352
  ds_read_b128 v[196:199], v8 offset:4368
  ds_read_b128 v[200:203], v8 offset:4384
  ds_read_b128 v[204:207], v8 offset:4400
  v_lshlrev_b32 v224, 16, v132
  v_and_b32 v225, 0xffff0000, v132
  buffer_load_dwordx4 a[80:83], v2, s[20:23], s31 offen offset:0
  ds_read_b128 v[240:243], v2 offset:22528
  ds_read_b128 v[244:247], v4 offset:22528
  s_waitcnt vmcnt(31)
  s_waitcnt lgkmcnt(7)
  v_mfma_f32_32x32x16_bf16 v[16:31], a[84:87], v[232:235], v[16:31]
  v_lshlrev_b32 v226, 16, v133
  v_and_b32 v227, 0xffff0000, v133
  v_lshlrev_b32 v228, 16, v134
  v_and_b32 v229, 0xffff0000, v134
  v_lshlrev_b32 v230, 16, v135
  v_mfma_f32_32x32x16_bf16 v[32:47], a[84:87], v[236:239], v[32:47]
  v_and_b32 v231, 0xffff0000, v135
  v_fma_f32 v224, v224, v208, v216
  v_fma_f32 v225, v225, v209, v217
  v_fma_f32 v226, v226, v210, v218
  buffer_load_dwordx4 a[84:87], v2, s[20:23], s31 offen offset:1024
  ds_read_b128 v[248:251], v2 offset:23552
  ds_read_b128 v[252:255], v4 offset:23552
  s_waitcnt vmcnt(31)
  s_waitcnt lgkmcnt(2)
  v_mfma_f32_32x32x16_bf16 v[16:31], a[88:91], v[240:243], v[16:31]
  v_fma_f32 v227, v227, v211, v219
  v_fma_f32 v228, v228, v212, v220
  v_fma_f32 v229, v229, v213, v221
  v_fma_f32 v230, v230, v214, v222
  v_fma_f32 v231, v231, v215, v223
  v_mfma_f32_32x32x16_bf16 v[32:47], a[88:91], v[244:247], v[32:47]
  v_cvt_pk_bf16_f32 v132, v224, v225
  v_cvt_pk_bf16_f32 v133, v226, v227
  v_cvt_pk_bf16_f32 v134, v228, v229
  v_cvt_pk_bf16_f32 v135, v230, v231
  buffer_load_dwordx4 a[88:91], v2, s[20:23], s31 offen offset:2048
  ds_read_b128 v[232:235], v2 offset:24576
  ds_read_b128 v[236:239], v4 offset:24576
  s_waitcnt vmcnt(31)
  s_waitcnt lgkmcnt(2)
  v_mfma_f32_32x32x16_bf16 v[16:31], a[92:95], v[248:251], v[16:31]
  ds_write_b128 v12, v[132:135] offset:33792
  v_lshlrev_b32 v224, 16, v148
  v_and_b32 v225, 0xffff0000, v148
  v_lshlrev_b32 v226, 16, v149
  v_and_b32 v227, 0xffff0000, v149
  v_mfma_f32_32x32x16_bf16 v[32:47], a[92:95], v[252:255], v[32:47]
  v_lshlrev_b32 v228, 16, v150
  v_and_b32 v229, 0xffff0000, v150
  v_lshlrev_b32 v230, 16, v151
  v_and_b32 v231, 0xffff0000, v151
  v_fma_f32 v224, v224, v208, v216
  buffer_load_dwordx4 a[92:95], v2, s[20:23], s31 offen offset:3072
  s_add_u32 s31, s31, 4096
  ds_read_b128 v[240:243], v2 offset:25600
  ds_read_b128 v[244:247], v4 offset:25600
  s_waitcnt vmcnt(31)
  s_waitcnt lgkmcnt(3)
  v_mfma_f32_32x32x16_bf16 v[16:31], a[96:99], v[232:235], v[16:31]
  v_fma_f32 v225, v225, v209, v217
  v_fma_f32 v226, v226, v210, v218
  v_fma_f32 v227, v227, v211, v219
  v_fma_f32 v228, v228, v212, v220
  v_mfma_f32_32x32x16_bf16 v[32:47], a[96:99], v[236:239], v[32:47]
  v_fma_f32 v229, v229, v213, v221
  v_fma_f32 v230, v230, v214, v222
  v_fma_f32 v231, v231, v215, v223
  v_cvt_pk_bf16_f32 v148, v224, v225
  v_cvt_pk_bf16_f32 v149, v226, v227
  buffer_load_dwordx4 a[96:99], v2, s[20:23], s31 offen offset:0
  ds_read_b128 v[248:251], v2 offset:26624
  ds_read_b128 v[252:255], v4 offset:26624
  s_waitcnt vmcnt(31)
  s_waitcnt lgkmcnt(2)
  v_mfma_f32_32x32x16_bf16 v[16:31], a[100:103], v[240:243], v[16:31]
  v_cvt_pk_bf16_f32 v150, v228, v229
  v_cvt_pk_bf16_f32 v151, v230, v231
  ds_write_b128 v13, v[148:151] offset:33792
  ds_read_b128 v[208:211], v8 offset:4480
  ds_read_b128 v[212:215], v8 offset:4496
  ds_read_b128 v[216:219], v8 offset:4512
  ds_read_b128 v[220:223], v8 offset:4528
  v_mfma_f32_32x32x16_bf16 v[32:47], a[100:103], v[244:247], v[32:47]
  v_lshlrev_b32 v224, 16, v136
  v_and_b32 v225, 0xffff0000, v136
  v_lshlrev_b32 v226, 16, v137
  v_and_b32 v227, 0xffff0000, v137
  buffer_load_dwordx4 a[100:103], v2, s[20:23], s31 offen offset:1024
  ds_read_b128 v[232:235], v2 offset:27648
  ds_read_b128 v[236:239], v4 offset:27648
  s_waitcnt vmcnt(31)
  s_waitcnt lgkmcnt(7)
  v_mfma_f32_32x32x16_bf16 v[16:31], a[104:107], v[248:251], v[16:31]
  v_lshlrev_b32 v228, 16, v138
  v_and_b32 v229, 0xffff0000, v138
  v_lshlrev_b32 v230, 16, v139
  v_and_b32 v231, 0xffff0000, v139
  v_fma_f32 v224, v224, v192, v200
  v_mfma_f32_32x32x16_bf16 v[32:47], a[104:107], v[252:255], v[32:47]
  v_fma_f32 v225, v225, v193, v201
  v_fma_f32 v226, v226, v194, v202
  v_fma_f32 v227, v227, v195, v203
  v_fma_f32 v228, v228, v196, v204
  buffer_load_dwordx4 a[104:107], v2, s[20:23], s31 offen offset:2048
  ds_read_b128 v[240:243], v2 offset:28672
  ds_read_b128 v[244:247], v4 offset:28672
  s_waitcnt vmcnt(31)
  s_waitcnt lgkmcnt(2)
  v_mfma_f32_32x32x16_bf16 v[16:31], a[108:111], v[232:235], v[16:31]
  v_fma_f32 v229, v229, v197, v205
  v_fma_f32 v230, v230, v198, v206
  v_fma_f32 v231, v231, v199, v207
  v_cvt_pk_bf16_f32 v136, v224, v225
  v_cvt_pk_bf16_f32 v137, v226, v227
  v_mfma_f32_32x32x16_bf16 v[32:47], a[108:111], v[236:239], v[32:47]
  v_cvt_pk_bf16_f32 v138, v228, v229
  v_cvt_pk_bf16_f32 v139, v230, v231
  ds_write_b128 v12, v[136:139] offset:34816
  v_lshlrev_b32 v224, 16, v152
  buffer_load_dwordx4 a[108:111], v2, s[20:23], s31 offen offset:3072
  s_add_u32 s31, s31, 4096
  ds_read_b128 v[248:251], v2 offset:29696
  ds_read_b128 v[252:255], v4 offset:29696
  s_waitcnt vmcnt(31)
  s_waitcnt lgkmcnt(3)
  v_mfma_f32_32x32x16_bf16 v[16:31], a[112:115], v[240:243], v[16:31]
  v_and_b32 v225, 0xffff0000, v152
  v_lshlrev_b32 v226, 16, v153
  v_and_b32 v227, 0xffff0000, v153
  v_lshlrev_b32 v228, 16, v154
  v_and_b32 v229, 0xffff0000, v154
  v_mfma_f32_32x32x16_bf16 v[32:47], a[112:115], v[244:247], v[32:47]
  v_lshlrev_b32 v230, 16, v155
  v_and_b32 v231, 0xffff0000, v155
  v_fma_f32 v224, v224, v192, v200
  v_fma_f32 v225, v225, v193, v201
  v_fma_f32 v226, v226, v194, v202
  ds_read_b128 v[232:235], v2 offset:30720
  ds_read_b128 v[236:239], v4 offset:30720
  s_waitcnt vmcnt(30)
  s_waitcnt lgkmcnt(2)
  v_mfma_f32_32x32x16_bf16 v[16:31], a[116:119], v[248:251], v[16:31]
  v_fma_f32 v227, v227, v195, v203
  v_fma_f32 v228, v228, v196, v204
  v_fma_f32 v229, v229, v197, v205
  v_fma_f32 v230, v230, v198, v206
  v_mfma_f32_32x32x16_bf16 v[32:47], a[116:119], v[252:255], v[32:47]
  v_fma_f32 v231, v231, v199, v207
  v_cvt_pk_bf16_f32 v152, v224, v225
  v_cvt_pk_bf16_f32 v153, v226, v227
  v_cvt_pk_bf16_f32 v154, v228, v229
  v_cvt_pk_bf16_f32 v155, v230, v231
  ds_read_b128 v[240:243], v2 offset:31744
  ds_read_b128 v[244:247], v4 offset:31744
  s_waitcnt vmcnt(29)
  s_waitcnt lgkmcnt(2)
  v_mfma_f32_32x32x16_bf16 v[16:31], a[120:123], v[232:235], v[16:31]
  ds_write_b128 v13, v[152:155] offset:34816
  v_lshlrev_b32 v224, 16, v140
  v_mfma_f32_32x32x16_bf16 v[32:47], a[120:123], v[236:239], v[32:47]
  v_and_b32 v225, 0xffff0000, v140
  v_lshlrev_b32 v226, 16, v141
  v_and_b32 v227, 0xffff0000, v141
  v_lshlrev_b32 v228, 16, v142
  v_and_b32 v229, 0xffff0000, v142
  s_waitcnt vmcnt(28)
  s_waitcnt lgkmcnt(1)
  v_mfma_f32_32x32x16_bf16 v[16:31], a[124:127], v[240:243], v[16:31]
  v_lshlrev_b32 v230, 16, v143
  v_and_b32 v231, 0xffff0000, v143
  v_fma_f32 v224, v224, v208, v216
  v_fma_f32 v225, v225, v209, v217
  v_fma_f32 v226, v226, v210, v218
  v_mfma_f32_32x32x16_bf16 v[32:47], a[124:127], v[244:247], v[32:47]
  v_fma_f32 v227, v227, v211, v219
  v_fma_f32 v228, v228, v212, v220
  v_fma_f32 v229, v229, v213, v221
  v_fma_f32 v230, v230, v214, v222
  v_fma_f32 v231, v231, v215, v223
  v_cvt_pk_bf16_f32 v140, v224, v225
  v_cvt_pk_bf16_f32 v141, v226, v227
  v_cvt_pk_bf16_f32 v142, v228, v229
  v_cvt_pk_bf16_f32 v143, v230, v231
  ds_write_b128 v12, v[140:143] offset:35840
  v_lshlrev_b32 v224, 16, v156
  v_and_b32 v225, 0xffff0000, v156
  v_lshlrev_b32 v226, 16, v157
  v_and_b32 v227, 0xffff0000, v157
  v_lshlrev_b32 v228, 16, v158
  v_and_b32 v229, 0xffff0000, v158
  v_lshlrev_b32 v230, 16, v159
  v_and_b32 v231, 0xffff0000, v159
  v_fma_f32 v224, v224, v208, v216
  v_fma_f32 v225, v225, v209, v217
  v_fma_f32 v226, v226, v210, v218
  v_fma_f32 v227, v227, v211, v219
  v_fma_f32 v228, v228, v212, v220
  v_fma_f32 v229, v229, v213, v221
  v_fma_f32 v230, v230, v214, v222
  v_fma_f32 v231, v231, v215, v223
  v_cvt_pk_bf16_f32 v156, v224, v225
  v_cvt_pk_bf16_f32 v157, v226, v227
  v_cvt_pk_bf16_f32 v158, v228, v229
  v_cvt_pk_bf16_f32 v159, v230, v231
  ds_write_b128 v13, v[156:159] offset:35840
  s_waitcnt lgkmcnt(0)
  s_barrier
  ds_read_b128 v[248:251], v2 offset:32768
  ds_read_b128 v[252:255], v4 offset:32768
  ds_read_b128 v[232:235], v2 offset:33792
  ds_read_b128 v[236:239], v4 offset:33792
  ds_read_b128 v[192:195], v8 offset:6144
  ds_read_b128 v[196:199], v8 offset:6160
  ds_read_b128 v[200:203], v8 offset:6176
  ds_read_b128 v[204:207], v8 offset:6192
  ds_read_b128 v[208:211], v8 offset:6272
  ds_read_b128 v[212:215], v8 offset:6288
  ds_read_b128 v[216:219], v8 offset:6304
  ds_read_b128 v[220:223], v8 offset:6320
  s_waitcnt lgkmcnt(4)
  s_waitcnt vmcnt(27)
  v_mfma_f32_32x32x16_bf16 v[16:31], a[0:3], v[248:251], v[16:31]
  v_lshlrev_b32 v224, 16, v160
  v_and_b32 v225, 0xffff0000, v160
  v_lshlrev_b32 v226, 16, v161
  v_and_b32 v227, 0xffff0000, v161
  v_lshlrev_b32 v228, 16, v162
  buffer_load_dwordx4 a[112:115], v2, s[20:23], s31 offen offset:0
  v_mfma_f32_32x32x16_bf16 v[32:47], a[0:3], v[252:255], v[32:47]
  v_and_b32 v229, 0xffff0000, v162
  v_lshlrev_b32 v230, 16, v163
  v_and_b32 v231, 0xffff0000, v163
  v_fma_f32 v224, v224, v192, v200
  buffer_load_dwordx4 a[116:119], v2, s[20:23], s31 offen offset:1024
  ds_read_b128 v[240:243], v2 offset:34816
  ds_read_b128 v[244:247], v4 offset:34816
  s_waitcnt vmcnt(28)
  v_mfma_f32_32x32x16_bf16 v[16:31], a[4:7], v[232:235], v[16:31]
  v_fma_f32 v225, v225, v193, v201
  v_fma_f32 v226, v226, v194, v202
  v_fma_f32 v227, v227, v195, v203
  v_fma_f32 v228, v228, v196, v204
  v_fma_f32 v229, v229, v197, v205
  buffer_load_dwordx4 a[120:123], v2, s[20:23], s31 offen offset:2048
  v_mfma_f32_32x32x16_bf16 v[32:47], a[4:7], v[236:239], v[32:47]
  v_fma_f32 v230, v230, v198, v206
  v_fma_f32 v231, v231, v199, v207
  v_cvt_pk_bf16_f32 v160, v224, v225
  v_cvt_pk_bf16_f32 v161, v226, v227
  buffer_load_dwordx4 a[124:127], v2, s[20:23], s31 offen offset:3072
  s_add_u32 s31, s31, 4096
  ds_read_b128 v[248:251], v2 offset:35840
  ds_read_b128 v[252:255], v4 offset:35840
  s_waitcnt vmcnt(29)
  s_waitcnt lgkmcnt(2)
  v_mfma_f32_32x32x16_bf16 v[16:31], a[8:11], v[240:243], v[16:31]
  v_cvt_pk_bf16_f32 v162, v228, v229
  v_cvt_pk_bf16_f32 v163, v230, v231
  ds_write_b128 v12, v[160:163] offset:49152
  v_lshlrev_b32 v224, 16, v176
  v_and_b32 v225, 0xffff0000, v176
  v_mfma_f32_32x32x16_bf16 v[32:47], a[8:11], v[244:247], v[32:47]
  v_lshlrev_b32 v226, 16, v177
  v_and_b32 v227, 0xffff0000, v177
  v_lshlrev_b32 v228, 16, v178
  v_and_b32 v229, 0xffff0000, v178
  v_lshlrev_b32 v230, 16, v179
  ds_read_b128 v[232:235], v2 offset:36864
  ds_read_b128 v[236:239], v4 offset:36864
  s_waitcnt vmcnt(28)
  s_waitcnt lgkmcnt(3)
  v_mfma_f32_32x32x16_bf16 v[16:31], a[12:15], v[248:251], v[16:31]
  v_and_b32 v231, 0xffff0000, v179
  v_fma_f32 v224, v224, v192, v200
  v_fma_f32 v225, v225, v193, v201
  v_fma_f32 v226, v226, v194, v202
  v_mfma_f32_32x32x16_bf16 v[32:47], a[12:15], v[252:255], v[32:47]
  v_fma_f32 v227, v227, v195, v203
  v_fma_f32 v228, v228, v196, v204
  v_fma_f32 v229, v229, v197, v205
  v_fma_f32 v230, v230, v198, v206
  v_fma_f32 v231, v231, v199, v207
  ds_read_b128 v[240:243], v2 offset:37888
  ds_read_b128 v[244:247], v4 offset:37888
  s_waitcnt vmcnt(27)
  s_waitcnt lgkmcnt(2)
  v_mfma_f32_32x32x16_bf16 v[16:31], a[16:19], v[232:235], v[16:31]
  v_cvt_pk_bf16_f32 v176, v224, v225
  v_cvt_pk_bf16_f32 v177, v226, v227
  v_cvt_pk_bf16_f32 v178, v228, v229
  v_cvt_pk_bf16_f32 v179, v230, v231
  v_mfma_f32_32x32x16_bf16 v[32:47], a[16:19], v[236:239], v[32:47]
  ds_write_b128 v13, v[176:179] offset:49152
  ds_read_b128 v[192:195], v8 offset:6400
  ds_read_b128 v[196:199], v8 offset:6416
  ds_read_b128 v[200:203], v8 offset:6432
  ds_read_b128 v[204:207], v8 offset:6448
  v_lshlrev_b32 v224, 16, v164
  v_and_b32 v225, 0xffff0000, v164
  ds_read_b128 v[248:251], v2 offset:38912
  ds_read_b128 v[252:255], v4 offset:38912
  s_waitcnt vmcnt(26)
  s_waitcnt lgkmcnt(7)
  v_mfma_f32_32x32x16_bf16 v[16:31], a[20:23], v[240:243], v[16:31]
  v_lshlrev_b32 v226, 16, v165
  v_and_b32 v227, 0xffff0000, v165
  v_lshlrev_b32 v228, 16, v166
  v_and_b32 v229, 0xffff0000, v166
  v_lshlrev_b32 v230, 16, v167
  v_mfma_f32_32x32x16_bf16 v[32:47], a[20:23], v[244:247], v[32:47]
  v_and_b32 v231, 0xffff0000, v167
  v_fma_f32 v224, v224, v208, v216
  v_fma_f32 v225, v225, v209, v217
  v_fma_f32 v226, v226, v210, v218
  ds_read_b128 v[232:235], v2 offset:39936
  ds_read_b128 v[236:239], v4 offset:39936
  s_waitcnt vmcnt(25)
  s_waitcnt lgkmcnt(2)
  v_mfma_f32_32x32x16_bf16 v[16:31], a[24:27], v[248:251], v[16:31]
  v_fma_f32 v227, v227, v211, v219
  v_fma_f32 v228, v228, v212, v220
  v_fma_f32 v229, v229, v213, v221
  v_fma_f32 v230, v230, v214, v222
  v_fma_f32 v231, v231, v215, v223
  v_mfma_f32_32x32x16_bf16 v[32:47], a[24:27], v[252:255], v[32:47]
  v_cvt_pk_bf16_f32 v164, v224, v225
  v_cvt_pk_bf16_f32 v165, v226, v227
  v_cvt_pk_bf16_f32 v166, v228, v229
  v_cvt_pk_bf16_f32 v167, v230, v231
  ds_read_b128 v[240:243], v2 offset:40960
  ds_read_b128 v[244:247], v4 offset:40960
  s_waitcnt vmcnt(24)
  s_waitcnt lgkmcnt(2)
  v_mfma_f32_32x32x16_bf16 v[16:31], a[28:31], v[232:235], v[16:31]
  ds_write_b128 v12, v[164:167] offset:50176
  v_lshlrev_b32 v224, 16, v180
  v_and_b32 v225, 0xffff0000, v180
  v_lshlrev_b32 v226, 16, v181
  v_and_b32 v227, 0xffff0000, v181
  v_mfma_f32_32x32x16_bf16 v[32:47], a[28:31], v[236:239], v[32:47]
  v_lshlrev_b32 v228, 16, v182
  v_and_b32 v229, 0xffff0000, v182
  v_lshlrev_b32 v230, 16, v183
  v_and_b32 v231, 0xffff0000, v183
  v_fma_f32 v224, v224, v208, v216
  ds_read_b128 v[248:251], v2 offset:41984
  ds_read_b128 v[252:255], v4 offset:41984
  s_waitcnt vmcnt(23)
  s_waitcnt lgkmcnt(3)
  v_mfma_f32_32x32x16_bf16 v[16:31], a[32:35], v[240:243], v[16:31]
  v_fma_f32 v225, v225, v209, v217
  v_fma_f32 v226, v226, v210, v218
  v_fma_f32 v227, v227, v211, v219
  v_fma_f32 v228, v228, v212, v220
  v_mfma_f32_32x32x16_bf16 v[32:47], a[32:35], v[244:247], v[32:47]
  v_fma_f32 v229, v229, v213, v221
  v_fma_f32 v230, v230, v214, v222
  v_fma_f32 v231, v231, v215, v223
  v_cvt_pk_bf16_f32 v180, v224, v225
  v_cvt_pk_bf16_f32 v181, v226, v227
  ds_read_b128 v[232:235], v2 offset:43008
  ds_read_b128 v[236:239], v4 offset:43008
  s_waitcnt vmcnt(22)
  s_waitcnt lgkmcnt(2)
  v_mfma_f32_32x32x16_bf16 v[16:31], a[36:39], v[248:251], v[16:31]
  v_cvt_pk_bf16_f32 v182, v228, v229
  v_cvt_pk_bf16_f32 v183, v230, v231
  ds_write_b128 v13, v[180:183] offset:50176
  ds_read_b128 v[208:211], v8 offset:6528
  ds_read_b128 v[212:215], v8 offset:6544
  ds_read_b128 v[216:219], v8 offset:6560
  ds_read_b128 v[220:223], v8 offset:6576
  v_mfma_f32_32x32x16_bf16 v[32:47], a[36:39], v[252:255], v[32:47]
  v_lshlrev_b32 v224, 16, v168
  v_and_b32 v225, 0xffff0000, v168
  v_lshlrev_b32 v226, 16, v169
  v_and_b32 v227, 0xffff0000, v169
  ds_read_b128 v[240:243], v2 offset:44032
  ds_read_b128 v[244:247], v4 offset:44032
  s_waitcnt vmcnt(21)
  s_waitcnt lgkmcnt(7)
  v_mfma_f32_32x32x16_bf16 v[16:31], a[40:43], v[232:235], v[16:31]
  v_lshlrev_b32 v228, 16, v170
  v_and_b32 v229, 0xffff0000, v170
  v_lshlrev_b32 v230, 16, v171
  v_and_b32 v231, 0xffff0000, v171
  v_fma_f32 v224, v224, v192, v200
  v_mfma_f32_32x32x16_bf16 v[32:47], a[40:43], v[236:239], v[32:47]
  v_fma_f32 v225, v225, v193, v201
  v_fma_f32 v226, v226, v194, v202
  v_fma_f32 v227, v227, v195, v203
  v_fma_f32 v228, v228, v196, v204
  ds_read_b128 v[248:251], v2 offset:45056
  ds_read_b128 v[252:255], v4 offset:45056
  s_waitcnt vmcnt(20)
  s_waitcnt lgkmcnt(2)
  v_mfma_f32_32x32x16_bf16 v[16:31], a[44:47], v[240:243], v[16:31]
  v_fma_f32 v229, v229, v197, v205
  v_fma_f32 v230, v230, v198, v206
  v_fma_f32 v231, v231, v199, v207
  v_cvt_pk_bf16_f32 v168, v224, v225
  v_cvt_pk_bf16_f32 v169, v226, v227
  v_mfma_f32_32x32x16_bf16 v[32:47], a[44:47], v[244:247], v[32:47]
  v_cvt_pk_bf16_f32 v170, v228, v229
  v_cvt_pk_bf16_f32 v171, v230, v231
  ds_write_b128 v12, v[168:171] offset:51200
  v_lshlrev_b32 v224, 16, v184
  ds_read_b128 v[232:235], v2 offset:46080
  ds_read_b128 v[236:239], v4 offset:46080
  s_waitcnt vmcnt(19)
  s_waitcnt lgkmcnt(3)
  v_mfma_f32_32x32x16_bf16 v[16:31], a[48:51], v[248:251], v[16:31]
  v_and_b32 v225, 0xffff0000, v184
  v_lshlrev_b32 v226, 16, v185
  v_and_b32 v227, 0xffff0000, v185
  v_lshlrev_b32 v228, 16, v186
  v_and_b32 v229, 0xffff0000, v186
  v_mfma_f32_32x32x16_bf16 v[32:47], a[48:51], v[252:255], v[32:47]
  v_lshlrev_b32 v230, 16, v187
  v_and_b32 v231, 0xffff0000, v187
  v_fma_f32 v224, v224, v192, v200
  v_fma_f32 v225, v225, v193, v201
  v_fma_f32 v226, v226, v194, v202
  ds_read_b128 v[240:243], v2 offset:47104
  ds_read_b128 v[244:247], v4 offset:47104
  s_waitcnt vmcnt(18)
  s_waitcnt lgkmcnt(2)
  v_mfma_f32_32x32x16_bf16 v[16:31], a[52:55], v[232:235], v[16:31]
  v_fma_f32 v227, v227, v195, v203
  v_fma_f32 v228, v228, v196, v204
  v_fma_f32 v229, v229, v197, v205
  v_fma_f32 v230, v230, v198, v206
  v_mfma_f32_32x32x16_bf16 v[32:47], a[52:55], v[236:239], v[32:47]
  v_fma_f32 v231, v231, v199, v207
  v_cvt_pk_bf16_f32 v184, v224, v225
  v_cvt_pk_bf16_f32 v185, v226, v227
  v_cvt_pk_bf16_f32 v186, v228, v229
  v_cvt_pk_bf16_f32 v187, v230, v231
  ds_read_b128 v[248:251], v2 offset:48128
  ds_read_b128 v[252:255], v4 offset:48128
  s_waitcnt vmcnt(17)
  s_waitcnt lgkmcnt(2)
  v_mfma_f32_32x32x16_bf16 v[16:31], a[56:59], v[240:243], v[16:31]
  ds_write_b128 v13, v[184:187] offset:51200
  v_lshlrev_b32 v224, 16, v172
  v_mfma_f32_32x32x16_bf16 v[32:47], a[56:59], v[244:247], v[32:47]
  v_and_b32 v225, 0xffff0000, v172
  v_lshlrev_b32 v226, 16, v173
  v_and_b32 v227, 0xffff0000, v173
  v_lshlrev_b32 v228, 16, v174
  v_and_b32 v229, 0xffff0000, v174
  s_waitcnt vmcnt(16)
  s_waitcnt lgkmcnt(1)
  v_mfma_f32_32x32x16_bf16 v[16:31], a[60:63], v[248:251], v[16:31]
  v_lshlrev_b32 v230, 16, v175
  v_and_b32 v231, 0xffff0000, v175
  v_fma_f32 v224, v224, v208, v216
  v_fma_f32 v225, v225, v209, v217
  v_fma_f32 v226, v226, v210, v218
  v_mfma_f32_32x32x16_bf16 v[32:47], a[60:63], v[252:255], v[32:47]
  v_fma_f32 v227, v227, v211, v219
  v_fma_f32 v228, v228, v212, v220
  v_fma_f32 v229, v229, v213, v221
  v_fma_f32 v230, v230, v214, v222
  v_fma_f32 v231, v231, v215, v223
  v_cvt_pk_bf16_f32 v172, v224, v225
  v_cvt_pk_bf16_f32 v173, v226, v227
  v_cvt_pk_bf16_f32 v174, v228, v229
  v_cvt_pk_bf16_f32 v175, v230, v231
  ds_write_b128 v12, v[172:175] offset:52224
  v_lshlrev_b32 v224, 16, v188
  v_and_b32 v225, 0xffff0000, v188
  v_lshlrev_b32 v226, 16, v189
  v_and_b32 v227, 0xffff0000, v189
  v_lshlrev_b32 v228, 16, v190
  v_and_b32 v229, 0xffff0000, v190
  v_lshlrev_b32 v230, 16, v191
  v_and_b32 v231, 0xffff0000, v191
  v_fma_f32 v224, v224, v208, v216
  v_fma_f32 v225, v225, v209, v217
  v_fma_f32 v226, v226, v210, v218
  v_fma_f32 v227, v227, v211, v219
  v_fma_f32 v228, v228, v212, v220
  v_fma_f32 v229, v229, v213, v221
  v_fma_f32 v230, v230, v214, v222
  v_fma_f32 v231, v231, v215, v223
  v_cvt_pk_bf16_f32 v188, v224, v225
  v_cvt_pk_bf16_f32 v189, v226, v227
  v_cvt_pk_bf16_f32 v190, v228, v229
  v_cvt_pk_bf16_f32 v191, v230, v231
  ds_write_b128 v13, v[188:191] offset:52224
  s_waitcnt lgkmcnt(0)
  s_barrier
  ds_read_b128 v[232:235], v2 offset:49152
  ds_read_b128 v[236:239], v4 offset:49152
  ds_read_b128 v[240:243], v2 offset:50176
  ds_read_b128 v[244:247], v4 offset:50176
  s_waitcnt vmcnt(15)
  s_waitcnt lgkmcnt(2)
  v_mfma_f32_32x32x16_bf16 v[16:31], a[64:67], v[232:235], v[16:31]
  v_mfma_f32_32x32x16_bf16 v[32:47], a[64:67], v[236:239], v[32:47]
  ds_read_b128 v[248:251], v2 offset:51200
  ds_read_b128 v[252:255], v4 offset:51200
  s_waitcnt vmcnt(14)
  s_waitcnt lgkmcnt(2)
  v_mfma_f32_32x32x16_bf16 v[16:31], a[68:71], v[240:243], v[16:31]
  v_mfma_f32_32x32x16_bf16 v[32:47], a[68:71], v[244:247], v[32:47]
  ds_read_b128 v[232:235], v2 offset:52224
  ds_read_b128 v[236:239], v4 offset:52224
  s_waitcnt vmcnt(13)
  s_waitcnt lgkmcnt(2)
  v_mfma_f32_32x32x16_bf16 v[16:31], a[72:75], v[248:251], v[16:31]
  v_mfma_f32_32x32x16_bf16 v[32:47], a[72:75], v[252:255], v[32:47]
  ds_read_b128 v[240:243], v2 offset:53248
  ds_read_b128 v[244:247], v4 offset:53248
  s_waitcnt vmcnt(12)
  s_waitcnt lgkmcnt(2)
  v_mfma_f32_32x32x16_bf16 v[16:31], a[76:79], v[232:235], v[16:31]
  v_mfma_f32_32x32x16_bf16 v[32:47], a[76:79], v[236:239], v[32:47]
  ds_read_b128 v[248:251], v2 offset:54272
  ds_read_b128 v[252:255], v4 offset:54272
  s_waitcnt vmcnt(11)
  s_waitcnt lgkmcnt(2)
  v_mfma_f32_32x32x16_bf16 v[16:31], a[80:83], v[240:243], v[16:31]
  v_mfma_f32_32x32x16_bf16 v[32:47], a[80:83], v[244:247], v[32:47]
  ds_read_b128 v[232:235], v2 offset:55296
  ds_read_b128 v[236:239], v4 offset:55296
  s_waitcnt vmcnt(10)
  s_waitcnt lgkmcnt(2)
  v_mfma_f32_32x32x16_bf16 v[16:31], a[84:87], v[248:251], v[16:31]
  v_mfma_f32_32x32x16_bf16 v[32:47], a[84:87], v[252:255], v[32:47]
  ds_read_b128 v[240:243], v2 offset:56320
  ds_read_b128 v[244:247], v4 offset:56320
  s_waitcnt vmcnt(9)
  s_waitcnt lgkmcnt(2)
  v_mfma_f32_32x32x16_bf16 v[16:31], a[88:91], v[232:235], v[16:31]
  v_mfma_f32_32x32x16_bf16 v[32:47], a[88:91], v[236:239], v[32:47]
  ds_read_b128 v[248:251], v2 offset:57344
  ds_read_b128 v[252:255], v4 offset:57344
  s_waitcnt vmcnt(8)
  s_waitcnt lgkmcnt(2)
  v_mfma_f32_32x32x16_bf16 v[16:31], a[92:95], v[240:243], v[16:31]
  v_mfma_f32_32x32x16_bf16 v[32:47], a[92:95], v[244:247], v[32:47]
  ds_read_b128 v[232:235], v2 offset:58368
  ds_read_b128 v[236:239], v4 offset:58368
  s_waitcnt vmcnt(7)
  s_waitcnt lgkmcnt(2)
  v_mfma_f32_32x32x16_bf16 v[16:31], a[96:99], v[248:251], v[16:31]
  v_mfma_f32_32x32x16_bf16 v[32:47], a[96:99], v[252:255], v[32:47]
  ds_read_b128 v[240:243], v2 offset:59392
  ds_read_b128 v[244:247], v4 offset:59392
  s_waitcnt vmcnt(6)
  s_waitcnt lgkmcnt(2)
  v_mfma_f32_32x32x16_bf16 v[16:31], a[100:103], v[232:235], v[16:31]
  v_mfma_f32_32x32x16_bf16 v[32:47], a[100:103], v[236:239], v[32:47]
  ds_read_b128 v[248:251], v2 offset:60416
  ds_read_b128 v[252:255], v4 offset:60416
  s_waitcnt vmcnt(5)
  s_waitcnt lgkmcnt(2)
  v_mfma_f32_32x32x16_bf16 v[16:31], a[104:107], v[240:243], v[16:31]
  v_mfma_f32_32x32x16_bf16 v[32:47], a[104:107], v[244:247], v[32:47]
  ds_read_b128 v[232:235], v2 offset:61440
  ds_read_b128 v[236:239], v4 offset:61440
  s_waitcnt vmcnt(4)
  s_waitcnt lgkmcnt(2)
  v_mfma_f32_32x32x16_bf16 v[16:31], a[108:111], v[248:251], v[16:31]
  v_mfma_f32_32x32x16_bf16 v[32:47], a[108:111], v[252:255], v[32:47]
  ds_read_b128 v[240:243], v2 offset:62464
  ds_read_b128 v[244:247], v4 offset:62464
  s_waitcnt vmcnt(3)
  s_waitcnt lgkmcnt(2)
  v_mfma_f32_32x32x16_bf16 v[16:31], a[112:115], v[232:235], v[16:31]
  v_mfma_f32_32x32x16_bf16 v[32:47], a[112:115], v[236:239], v[32:47]
  ds_read_b128 v[248:251], v2 offset:63488
  ds_read_b128 v[252:255], v4 offset:63488
  s_waitcnt vmcnt(2)
  s_waitcnt lgkmcnt(2)
  v_mfma_f32_32x32x16_bf16 v[16:31], a[116:119], v[240:243], v[16:31]
  v_mfma_f32_32x32x16_bf16 v[32:47], a[116:119], v[244:247], v[32:47]
  ds_read_b128 v[232:235], v2 offset:64512
  ds_read_b128 v[236:239], v4 offset:64512
  s_waitcnt vmcnt(1)
  s_waitcnt lgkmcnt(2)
  v_mfma_f32_32x32x16_bf16 v[16:31], a[120:123], v[248:251], v[16:31]
  v_mfma_f32_32x32x16_bf16 v[32:47], a[120:123], v[252:255], v[32:47]
  s_waitcnt vmcnt(0)
  s_waitcnt lgkmcnt(0)
  v_mfma_f32_32x32x16_bf16 v[16:31], a[124:127], v[232:235], v[16:31]
  v_mfma_f32_32x32x16_bf16 v[32:47], a[124:127], v[236:239], v[32:47]
k2_epi:
  s_add_u32 s40, s4, 9437184
  s_addc_u32 s41, s5, 0
  s_and_b32 s41, s41, 0xffff
  s_mov_b32 s42, 4194304
  s_mov_b32 s43, 0x00020000
  s_lshl_b32 s38, s8, 17
  s_lshl_b32 s39, s9, 2
  s_add_u32 s39, s39, s3
  s_lshl_b32 s39, s39, 11
  s_add_u32 s38, s38, s39
  s_add_u32 s39, s38, 0x10000
  s_mov_b32 s36, 0x3e8293ee
  v_mul_f32 v16, s36, v16
  v_mul_f32 v17, s36, v17
  v_mul_f32 v18, s36, v18
  v_mul_f32 v19, s36, v19
  v_mul_f32 v20, s36, v20
  v_mul_f32 v21, s36, v21
  v_mul_f32 v22, s36, v22
  v_mul_f32 v23, s36, v23
  v_mul_f32 v24, s36, v24
  v_mul_f32 v25, s36, v25
  v_mul_f32 v26, s36, v26
  v_mul_f32 v27, s36, v27
  v_mul_f32 v28, s36, v28
  v_mul_f32 v29, s36, v29
  v_mul_f32 v30, s36, v30
  v_mul_f32 v31, s36, v31
  v_cvt_pk_bf16_f32 v64, v16, v17
  v_cvt_pk_bf16_f32 v65, v18, v19
  v_cvt_pk_bf16_f32 v66, v20, v21
  v_cvt_pk_bf16_f32 v67, v22, v23
  v_cvt_pk_bf16_f32 v68, v24, v25
  v_cvt_pk_bf16_f32 v69, v26, v27
  v_cvt_pk_bf16_f32 v70, v28, v29
  v_cvt_pk_bf16_f32 v71, v30, v31
  buffer_store_dwordx4 v[64:67], v2, s[40:43], s38 offen sc1
  buffer_store_dwordx4 v[68:71], v2, s[40:43], s38 offen offset:1024 sc1
  v_mul_f32 v32, s36, v32
  v_mul_f32 v33, s36, v33
  v_mul_f32 v34, s36, v34
  v_mul_f32 v35, s36, v35
  v_mul_f32 v36, s36, v36
  v_mul_f32 v37, s36, v37
  v_mul_f32 v38, s36, v38
  v_mul_f32 v39, s36, v39
  v_mul_f32 v40, s36, v40
  v_mul_f32 v41, s36, v41
  v_mul_f32 v42, s36, v42
  v_mul_f32 v43, s36, v43
  v_mul_f32 v44, s36, v44
  v_mul_f32 v45, s36, v45
  v_mul_f32 v46, s36, v46
  v_mul_f32 v47, s36, v47
  v_cvt_pk_bf16_f32 v72, v32, v33
  v_cvt_pk_bf16_f32 v73, v34, v35
  v_cvt_pk_bf16_f32 v74, v36, v37
  v_cvt_pk_bf16_f32 v75, v38, v39
  v_cvt_pk_bf16_f32 v76, v40, v41
  v_cvt_pk_bf16_f32 v77, v42, v43
  v_cvt_pk_bf16_f32 v78, v44, v45
  v_cvt_pk_bf16_f32 v79, v46, v47
  buffer_store_dwordx4 v[72:75], v2, s[40:43], s39 offen sc1
  buffer_store_dwordx4 v[76:79], v2, s[40:43], s39 offen offset:1024 sc1
k2_end:
  s_endpgm
.globl k3_kernel
.p2align 8
.type k3_kernel,@function
k3_kernel:
  s_cmp_ge_u32 s2, 256
  s_cbranch_scc1 k3_end
  s_load_dwordx2 s[4:5], s[0:1], 104
  s_load_dwordx2 s[6:7], s[0:1], 32
  s_load_dwordx4 s[8:11], s[0:1], 48
  s_load_dwordx2 s[12:13], s[0:1], 64
  v_and_b32 v1, 63, v0
  v_lshrrev_b32 v10, 6, v0
  v_lshlrev_b32 v2, 4, v1
  v_readfirstlane_b32 s3, v10
  s_lshr_b32 s14, s2, 2
  s_and_b32 s15, s2, 3
  s_lshl_b32 s15, s15, 3
  s_add_u32 s15, s15, s3
  s_waitcnt lgkmcnt(0)
  s_add_u32 s16, s4, 8650752
  s_addc_u32 s17, s5, 0
  s_and_b32 s17, s17, 0xffff
  s_mov_b32 s18, 262144
  s_mov_b32 s19, 0x00020000
  s_add_u32 s20, s4, 9437184
  s_addc_u32 s21, s5, 0
  s_and_b32 s21, s21, 0xffff
  s_mov_b32 s22, 4194304
  s_mov_b32 s23, 0x00020000
  s_add_u32 s24, s4, 65536
  s_addc_u32 s25, s5, 0
  s_and_b32 s25, s25, 0xffff
  s_mov_b32 s26, 2048
  s_mov_b32 s27, 0x00020000
  s_lshl_b32 s28, s3, 11
  s_mov_b32 s29, s28
  s_add_u32 m0, s29, 0
  s_nop 0
  buffer_load_dwordx4 v2, s[16:19], s28 offen lds
  buffer_load_dwordx4 v2, s[16:19], s28 offen offset:1024 lds
  s_add_u32 s28, s28, 16384
  s_lshl_b32 s30, s14, 16
  s_lshl_b32 s31, s15, 11
  s_add_u32 s30, s30, s31
  v_lshlrev_b32 v10, 2, v1
  buffer_load_dwordx4 v[96:99], v2, s[20:23], s30 offen
  buffer_load_dwordx4 v[100:103], v2, s[20:23], s30 offen offset:1024
  buffer_load_dword v11, v10, s[24:27], 0 offen
  buffer_load_dword v12, v10, s[24:27], 0 offen offset:256
  s_add_u32 m0, s29, 16384
  s_nop 0
  buffer_load_dwordx4 v2, s[16:19], s28 offen lds
  buffer_load_dwordx4 v2, s[16:19], s28 offen offset:1024 lds
  s_add_u32 s28, s28, 16384
  s_lshl_b32 s32, s2, 3
  s_add_u32 s32, s32, s3
  v_lshrrev_b32 v3, 3, v1
  v_and_b32 v4, 7, v1
  s_lshl_b32 s33, s3, 13
  s_add_u32 s33, s33, 98304
  s_mov_b32 s39, s33
  v_add_u32 v176, 0x10000, v2
  v_bfe_u32 v6, v1, 2, 2
  v_lshrrev_b32 v10, 5, v1
  v_lshl_add_u32 v6, v10, 2, v6
  v_lshlrev_b32 v6, 7, v6
  v_and_b32 v10, 3, v1
  v_lshl_add_u32 v6, v10, 3, v6
  v_bfe_u32 v10, v1, 4, 1
  v_lshl_add_u32 v6, v10, 5, v6
  v_add_u32 v14, s39, v6
  v_add_u32 v6, s33, v6
  s_cmp_ge_u32 s32, 1792
  s_cbranch_scc1 k3_wo
  s_cmp_ge_u32 s32, 896
  s_cselect_b32 s34, 1, 0
  s_cselect_b32 s36, s10, s8
  s_cselect_b32 s37, s11, s9
  s_mul_i32 s35, s34, 896
  s_sub_u32 s46, s32, s35
  s_mul_i32 s35, s46, 1171
  s_lshr_b32 s35, s35, 16
  s_mul_i32 s38, s35, 56
  s_sub_u32 s38, s46, s38
  s_mov_b32 s40, s36
  s_and_b32 s41, s37, 0xffff
  s_mov_b32 s42, 7340032
  s_mov_b32 s43, 0x00020000
  s_mov_b32 s44, 57344
  s_mul_i32 s45, s35, 458752
  s_lshl_b32 s46, s38, 7
  s_add_u32 s45, s45, s46
  v_mul_u32_u24 v5, 7168, v3
  v_lshl_add_u32 v5, v4, 4, v5
  s_mul_i32 s53, s35, 57344
  s_mul_i32 s46, s34, 14336
  s_add_u32 s53, s53, s46
  s_lshl_b32 s46, s38, 8
  s_add_u32 s53, s53, s46
  s_branch k3_aset
k3_wo:
  s_sub_u32 s46, s32, 1792
  s_lshr_b32 s35, s46, 4
  s_and_b32 s38, s46, 15
  s_mov_b32 s40, s6
  s_and_b32 s41, s7, 0xffff
  s_mov_b32 s42, 2097152
  s_mov_b32 s43, 0x00020000
  s_mov_b32 s44, 16384
  s_lshl_b32 s45, s35, 17
  s_lshl_b32 s46, s38, 7
  s_add_u32 s45, s45, s46
  v_lshlrev_b32 v5, 11, v3
  v_lshl_add_u32 v5, v4, 4, v5
  s_mov_b32 s53, 0x7ff00000
k3_aset:
  s_add_u32 s56, s4, 32768
  s_addc_u32 s57, s5, 0
  s_and_b32 s57, s57, 0xffff
  s_mov_b32 s58, 12288
  s_mov_b32 s59, 0x00020000
  v_and_b32 v10, 15, v1
  v_lshrrev_b32 v13, 4, v1
  v_lshrrev_b32 v9, 1, v13
  v_lshlrev_b32 v9, 3, v9
  s_lshl_b32 s46, s35, 7
  v_add_u32 v9, s46, v9
  v_and_b32 v15, 1, v10
  v_mul_u32_u24 v15, 2048, v15
  v_sub_u32 v9, v9, v15
  v_add_u32 v9, 8192, v9
  v_lshrrev_b32 v15, 1, v10
  v_and_b32 v13, 1, v13
  v_cmp_eq_u32 vcc, v15, v13
  v_mov_b32 v15, 0x7ff00000
  s_nop 0
  v_cndmask_b32 v9, v15, v9, vcc
  v_and_b32 v15, 1, v10
  v_mul_u32_u24 v15, 28672, v15
  v_lshrrev_b32 v13, 1, v10
  v_lshl_add_u32 v15, v13, 6, v15
  v_lshrrev_b32 v13, 4, v1
  v_lshl_add_u32 v15, v13, 4, v15
  v_cmp_gt_u32 vcc, 4, v10
  v_mov_b32 v13, 0x7ff00000
  s_nop 0
  v_cndmask_b32 v15, v13, v15, vcc
  s_mov_b32 s88, s12
  s_and_b32 s89, s13, 0xffff
  s_mov_b32 s90, 7340032
  s_mov_b32 s91, 0x00020000
  s_lshr_b32 s60, s32, 4
  s_and_b32 s61, s32, 15
  s_lshl_b32 s62, s60, 16
  s_lshl_b32 s63, s61, 7
  s_add_u32 s62, s62, s63
  v_lshlrev_b32 v13, 11, v3
  v_lshl_add_u32 v13, v4, 4, v13
  v_and_b32 v10, 15, v1
  v_lshrrev_b32 v10, 2, v10
  v_lshrrev_b32 v4, 4, v1
  v_xor_b32 v10, v10, v4
  v_and_b32 v10, 1, v10
  v_mov_b32 v4, 0x3f803f80
  v_cmp_eq_u32 vcc, 0, v10
  s_nop 1
  v_cndmask_b32 v124, 0, v4, vcc
  v_mov_b32 v125, v124
  v_mov_b32 v126, v124
  v_mov_b32 v127, v124
  v_mov_b32 v104, 0
  v_mov_b32 v105, 0
  v_mov_b32 v106, 0
  v_mov_b32 v107, 0
  v_mov_b32 v108, 0
  v_mov_b32 v109, 0
  v_mov_b32 v110, 0
  v_mov_b32 v111, 0
  v_mov_b32 v112, 0
  v_mov_b32 v113, 0
  v_mov_b32 v114, 0
  v_mov_b32 v115, 0
  v_mov_b32 v116, 0
  v_mov_b32 v117, 0
  v_mov_b32 v118, 0
  v_mov_b32 v119, 0
  v_mov_b32 v120, 0
  v_mov_b32 v121, 0
  v_mov_b32 v122, 0
  v_mov_b32 v123, 0
  v_mov_b32 v128, 0
  v_mov_b32 v129, 0
  v_mov_b32 v130, 0
  v_mov_b32 v131, 0
  v_mov_b32 v132, 0
  v_mov_b32 v133, 0
  v_mov_b32 v134, 0
  v_mov_b32 v135, 0
  v_mov_b32 v136, 0
  v_mov_b32 v137, 0
  v_mov_b32 v138, 0
  v_mov_b32 v139, 0
  v_mov_b32 v140, 0
  v_mov_b32 v141, 0
  v_mov_b32 v142, 0
  v_mov_b32 v143, 0
  s_waitcnt vmcnt(2)
  v_dot2_f32_bf16 v10, v96, v96, 0
  v_dot2_f32_bf16 v10, v97, v97, v10
  v_dot2_f32_bf16 v10, v98, v98, v10
  v_dot2_f32_bf16 v10, v99, v99, v10
  v_dot2_f32_bf16 v10, v100, v100, v10
  v_dot2_f32_bf16 v10, v101, v101, v10
  v_dot2_f32_bf16 v10, v102, v102, v10
  v_dot2_f32_bf16 v10, v103, v103, v10
  v_mov_b32 v4, v10
  s_nop 1
  v_permlane32_swap_b32 v10, v4
  v_add_f32 v10, v10, v4
  s_nop 1
  v_max_f32_dpp v10, v10, v10 row_ror:1 row_mask:0xf bank_mask:0xf
  s_nop 1
  v_max_f32_dpp v10, v10, v10 row_ror:2 row_mask:0xf bank_mask:0xf
  s_nop 1
  v_max_f32_dpp v10, v10, v10 row_ror:4 row_mask:0xf bank_mask:0xf
  s_nop 1
  v_max_f32_dpp v10, v10, v10 row_ror:8 row_mask:0xf bank_mask:0xf
  v_mov_b32 v4, v10
  s_nop 1
  v_permlane16_swap_b32 v10, v4
  v_max_f32 v10, v10, v4
  v_mov_b32 v4, v10
  s_nop 1
  v_permlane32_swap_b32 v10, v4
  v_max_f32 v10, v10, v4
  v_max_f32_dpp v11, v11, v11 row_ror:1 row_mask:0xf bank_mask:0xf
  s_nop 1
  v_max_f32_dpp v11, v11, v11 row_ror:2 row_mask:0xf bank_mask:0xf
  s_nop 1
  v_max_f32_dpp v11, v11, v11 row_ror:4 row_mask:0xf bank_mask:0xf
  s_nop 1
  v_max_f32_dpp v11, v11, v11 row_ror:8 row_mask:0xf bank_mask:0xf
  v_mov_b32 v4, v11
  s_nop 1
  v_permlane16_swap_b32 v11, v4
  v_max_f32 v11, v11, v4
  v_mov_b32 v4, v11
  s_nop 1
  v_permlane32_swap_b32 v11, v4
  v_max_f32 v11, v11, v4
  v_max_f32_dpp v12, v12, v12 row_ror:1 row_mask:0xf bank_mask:0xf
  s_nop 1
  v_max_f32_dpp v12, v12, v12 row_ror:2 row_mask:0xf bank_mask:0xf
  s_nop 1
  v_max_f32_dpp v12, v12, v12 row_ror:4 row_mask:0xf bank_mask:0xf
  s_nop 1
  v_max_f32_dpp v12, v12, v12 row_ror:8 row_mask:0xf bank_mask:0xf
  v_mov_b32 v4, v12
  s_nop 1
  v_permlane16_swap_b32 v12, v4
  v_max_f32 v12, v12, v4
  v_mov_b32 v4, v12
  s_nop 1
  v_permlane32_swap_b32 v12, v4
  v_max_f32 v12, v12, v4
  v_mul_f32 v10, v10, v11
  v_mov_b32 v4, 0x45fd2000
  v_cmp_le_f32 vcc, v10, v4
  v_mov_b32 v4, 0x49800000
  v_cmp_le_f32 s[30:31], v12, v4
  s_nop 2
  s_and_b64 vcc, vcc, s[30:31]
  s_cmp_eq_u64 vcc, exec
  s_cbranch_scc1 k3_fast
  v_mov_b32 v10, 0xff800000
  s_mov_b32 s30, 0
k3_mloop:
  buffer_load_dwordx4 v[64:67], v2, s[16:19], s30 offen
  buffer_load_dwordx4 v[68:71], v2, s[16:19], s30 offen offset:1024
  s_waitcnt vmcnt(0)
  v_mfma_f32_32x32x16_bf16 v[16:31], v[64:67], v[96:99], 0
  v_mfma_f32_32x32x16_bf16 v[16:31], v[68:71], v[100:103], v[16:31]
  s_nop 11
  v_max3_f32 v10, v16, v17, v10
  v_max3_f32 v10, v18, v19, v10
  v_max3_f32 v10, v20, v21, v10
  v_max3_f32 v10, v22, v23, v10
  v_max3_f32 v10, v24, v25, v10
  v_max3_f32 v10, v26, v27, v10
  v_max3_f32 v10, v28, v29, v10
  v_max3_f32 v10, v30, v31, v10
  s_add_u32 s30, s30, 4096
  s_cmp_lt_u32 s30, 262144
  s_nop 7
  s_cbranch_scc1 k3_mloop
  v_mov_b32 v4, v10
  s_nop 1
  v_permlane32_swap_b32 v10, v4
  v_max_f32 v10, v10, v4
  v_sub_f32 v128, 0, v10
  v_sub_f32 v129, 0, v10
  v_sub_f32 v130, 0, v10
  v_sub_f32 v131, 0, v10
  v_sub_f32 v132, 0, v10
  v_sub_f32 v133, 0, v10
  v_sub_f32 v134, 0, v10
  v_sub_f32 v135, 0, v10
  v_sub_f32 v136, 0, v10
  v_sub_f32 v137, 0, v10
  v_sub_f32 v138, 0, v10
  v_sub_f32 v139, 0, v10
  v_sub_f32 v140, 0, v10
  v_sub_f32 v141, 0, v10
  v_sub_f32 v142, 0, v10
  v_sub_f32 v143, 0, v10
  s_nop 7
k3_fast:
  s_barrier
  ds_read_b128 v[64:67], v2 offset:0
  ds_read_b128 v[68:71], v2 offset:1024
  ds_read_b128 v[72:75], v2 offset:4096
  ds_read_b128 v[76:79], v2 offset:5120
  s_waitcnt lgkmcnt(2)
  v_mfma_f32_32x32x16_bf16 v[16:31], v[64:67], v[96:99], v[128:143]
  v_mfma_f32_32x32x16_bf16 v[16:31], v[68:71], v[100:103], v[16:31]
  s_waitcnt lgkmcnt(0)
  v_mfma_f32_32x32x16_bf16 v[32:47], v[72:75], v[96:99], v[128:143]
  ds_read_b128 v[64:67], v2 offset:8192
  ds_read_b128 v[68:71], v2 offset:9216
  s_nop 7
  v_exp_f32 v16, v16
  v_exp_f32 v17, v17
  v_exp_f32 v18, v18
  ds_read_b128 v[80:83], v2 offset:2048
  ds_read_b128 v[84:87], v2 offset:3072
  v_exp_f32 v19, v19
  v_exp_f32 v20, v20
  v_exp_f32 v21, v21
  v_cvt_pk_bf16_f32 v48, v16, v17
  v_cvt_pk_bf16_f32 v49, v18, v19
  v_mfma_f32_32x32x16_bf16 v[32:47], v[76:79], v[100:103], v[32:47]
  s_add_u32 m0, s29, 32768
  s_nop 0
  buffer_load_dwordx4 v2, s[16:19], s28 offen lds
  buffer_load_dwordx4 v2, s[16:19], s28 offen offset:1024 lds
  s_add_u32 s28, s28, 16384
  v_exp_f32 v22, v22
  v_exp_f32 v23, v23
  v_exp_f32 v24, v24
  v_cvt_pk_bf16_f32 v50, v20, v21
  v_exp_f32 v25, v25
  v_exp_f32 v26, v26
  v_cvt_pk_bf16_f32 v51, v22, v23
  v_cvt_pk_bf16_f32 v52, v24, v25
  v_exp_f32 v27, v27
  v_exp_f32 v28, v28
  v_exp_f32 v29, v29
  v_cvt_pk_bf16_f32 v53, v26, v27
  v_exp_f32 v30, v30
  v_exp_f32 v31, v31
  v_cvt_pk_bf16_f32 v54, v28, v29
  v_cvt_pk_bf16_f32 v55, v30, v31
  s_waitcnt lgkmcnt(2)
  v_mfma_f32_32x32x16_bf16 v[16:31], v[64:67], v[96:99], v[128:143]
  ds_read_b128 v[72:75], v2 offset:12288
  ds_read_b128 v[76:79], v2 offset:13312
  v_exp_f32 v32, v32
  v_exp_f32 v33, v33
  v_exp_f32 v34, v34
  s_waitcnt lgkmcnt(2)
  v_mfma_f32_32x32x16_bf16 v[104:119], v[80:83], v[48:51], v[104:119]
  ds_read_b128 v[88:91], v2 offset:6144
  ds_read_b128 v[92:95], v2 offset:7168
  v_exp_f32 v35, v35
  v_exp_f32 v36, v36
  v_exp_f32 v37, v37
  v_cvt_pk_bf16_f32 v56, v32, v33
  v_cvt_pk_bf16_f32 v57, v34, v35
  v_mfma_f32_32x32x16_bf16 v[16:31], v[68:71], v[100:103], v[16:31]
  s_add_u32 m0, s29, 49152
  s_nop 0
  buffer_load_dwordx4 v2, s[16:19], s28 offen lds
  buffer_load_dwordx4 v2, s[16:19], s28 offen offset:1024 lds
  s_add_u32 s28, s28, 16384
  v_exp_f32 v38, v38
  v_exp_f32 v39, v39
  v_exp_f32 v40, v40
  v_cvt_pk_bf16_f32 v58, v36, v37
  v_mfma_f32_16x16x32_bf16 v[120:123], v[124:127], v[48:51], v[120:123]
  v_exp_f32 v41, v41
  v_exp_f32 v42, v42
  v_cvt_pk_bf16_f32 v59, v38, v39
  v_cvt_pk_bf16_f32 v60, v40, v41
  v_mfma_f32_32x32x16_bf16 v[104:119], v[84:87], v[52:55], v[104:119]
  v_exp_f32 v43, v43
  v_exp_f32 v44, v44
  v_exp_f32 v45, v45
  v_cvt_pk_bf16_f32 v61, v42, v43
  v_mfma_f32_16x16x32_bf16 v[120:123], v[124:127], v[52:55], v[120:123]
  v_exp_f32 v46, v46
  v_exp_f32 v47, v47
  v_cvt_pk_bf16_f32 v62, v44, v45
  v_cvt_pk_bf16_f32 v63, v46, v47
  s_waitcnt vmcnt(4)
  s_barrier
  s_waitcnt lgkmcnt(2)
  v_mfma_f32_32x32x16_bf16 v[32:47], v[72:75], v[96:99], v[128:143]
  ds_read_b128 v[64:67], v2 offset:16384
  ds_read_b128 v[68:71], v2 offset:17408
  v_exp_f32 v16, v16
  v_exp_f32 v17, v17
  v_exp_f32 v18, v18
  s_waitcnt lgkmcnt(2)
  v_mfma_f32_32x32x16_bf16 v[104:119], v[88:91], v[56:59], v[104:119]
  ds_read_b128 v[80:83], v2 offset:10240
  ds_read_b128 v[84:87], v2 offset:11264
  v_exp_f32 v19, v19
  v_exp_f32 v20, v20
  v_exp_f32 v21, v21
  v_cvt_pk_bf16_f32 v48, v16, v17
  v_cvt_pk_bf16_f32 v49, v18, v19
  v_mfma_f32_32x32x16_bf16 v[32:47], v[76:79], v[100:103], v[32:47]
  s_add_u32 m0, s29, 65536
  s_nop 0
  buffer_load_dwordx4 v2, s[16:19], s28 offen lds
  buffer_load_dwordx4 v2, s[16:19], s28 offen offset:1024 lds
  s_add_u32 s28, s28, 16384
  v_exp_f32 v22, v22
  v_exp_f32 v23, v23
  v_exp_f32 v24, v24
  v_cvt_pk_bf16_f32 v50, v20, v21
  v_mfma_f32_16x16x32_bf16 v[120:123], v[124:127], v[56:59], v[120:123]
  v_exp_f32 v25, v25
  v_exp_f32 v26, v26
  v_cvt_pk_bf16_f32 v51, v22, v23
  v_cvt_pk_bf16_f32 v52, v24, v25
  v_mfma_f32_32x32x16_bf16 v[104:119], v[92:95], v[60:63], v[104:119]
  v_exp_f32 v27, v27
  v_exp_f32 v28, v28
  v_exp_f32 v29, v29
  v_cvt_pk_bf16_f32 v53, v26, v27
  v_mfma_f32_16x16x32_bf16 v[120:123], v[124:127], v[60:63], v[120:123]
  v_exp_f32 v30, v30
  v_exp_f32 v31, v31
  v_cvt_pk_bf16_f32 v54, v28, v29
  v_cvt_pk_bf16_f32 v55, v30, v31
  s_waitcnt lgkmcnt(2)
  v_mfma_f32_32x32x16_bf16 v[16:31], v[64:67], v[96:99], v[128:143]
  ds_read_b128 v[72:75], v2 offset:20480
  ds_read_b128 v[76:79], v2 offset:21504
  v_exp_f32 v32, v32
  v_exp_f32 v33, v33
  v_exp_f32 v34, v34
  s_waitcnt lgkmcnt(2)
  v_mfma_f32_32x32x16_bf16 v[104:119], v[80:83], v[48:51], v[104:119]
  ds_read_b128 v[88:91], v2 offset:14336
  ds_read_b128 v[92:95], v2 offset:15360
  v_exp_f32 v35, v35
  v_exp_f32 v36, v36
  v_exp_f32 v37, v37
  v_cvt_pk_bf16_f32 v56, v32, v33
  v_cvt_pk_bf16_f32 v57, v34, v35
  v_mfma_f32_32x32x16_bf16 v[16:31], v[68:71], v[100:103], v[16:31]
  s_add_u32 m0, s29, 81920
  s_nop 0
  buffer_load_dwordx4 v2, s[16:19], s28 offen lds
  buffer_load_dwordx4 v2, s[16:19], s28 offen offset:1024 lds
  s_add_u32 s28, s28, 16384
  v_exp_f32 v38, v38
  v_exp_f32 v39, v39
  v_exp_f32 v40, v40
  v_cvt_pk_bf16_f32 v58, v36, v37
  v_mfma_f32_16x16x32_bf16 v[120:123], v[124:127], v[48:51], v[120:123]
  v_exp_f32 v41, v41
  v_exp_f32 v42, v42
  v_cvt_pk_bf16_f32 v59, v38, v39
  v_cvt_pk_bf16_f32 v60, v40, v41
  v_mfma_f32_32x32x16_bf16 v[104:119], v[84:87], v[52:55], v[104:119]
  v_exp_f32 v43, v43
  v_exp_f32 v44, v44
  v_exp_f32 v45, v45
  v_cvt_pk_bf16_f32 v61, v42, v43
  v_mfma_f32_16x16x32_bf16 v[120:123], v[124:127], v[52:55], v[120:123]
  v_exp_f32 v46, v46
  v_exp_f32 v47, v47
  v_cvt_pk_bf16_f32 v62, v44, v45
  v_cvt_pk_bf16_f32 v63, v46, v47
  s_waitcnt lgkmcnt(2)
  v_mfma_f32_32x32x16_bf16 v[32:47], v[72:75], v[96:99], v[128:143]
  ds_read_b128 v[64:67], v2 offset:24576
  ds_read_b128 v[68:71], v2 offset:25600
  v_exp_f32 v16, v16
  v_exp_f32 v17, v17
  v_exp_f32 v18, v18
  s_waitcnt lgkmcnt(2)
  v_mfma_f32_32x32x16_bf16 v[104:119], v[88:91], v[56:59], v[104:119]
  ds_read_b128 v[80:83], v2 offset:18432
  ds_read_b128 v[84:87], v2 offset:19456
  v_exp_f32 v19, v19
  v_exp_f32 v20, v20
  v_exp_f32 v21, v21
  v_cvt_pk_bf16_f32 v48, v16, v17
  v_cvt_pk_bf16_f32 v49, v18, v19
  v_mfma_f32_32x32x16_bf16 v[32:47], v[76:79], v[100:103], v[32:47]
  s_add_u32 m0, s33, 0
  s_nop 0
  buffer_load_dwordx4 v5, s[40:43], s45 offen lds
  s_add_u32 s45, s45, s44
  v_exp_f32 v22, v22
  v_exp_f32 v23, v23
  v_exp_f32 v24, v24
  v_cvt_pk_bf16_f32 v50, v20, v21
  v_mfma_f32_16x16x32_bf16 v[120:123], v[124:127], v[56:59], v[120:123]
  v_exp_f32 v25, v25
  v_exp_f32 v26, v26
  v_cvt_pk_bf16_f32 v51, v22, v23
  v_cvt_pk_bf16_f32 v52, v24, v25
  v_mfma_f32_32x32x16_bf16 v[104:119], v[92:95], v[60:63], v[104:119]
  v_exp_f32 v27, v27
  v_exp_f32 v28, v28
  v_exp_f32 v29, v29
  v_cvt_pk_bf16_f32 v53, v26, v27
  v_mfma_f32_16x16x32_bf16 v[120:123], v[124:127], v[60:63], v[120:123]
  v_exp_f32 v30, v30
  v_exp_f32 v31, v31
  v_cvt_pk_bf16_f32 v54, v28, v29
  v_cvt_pk_bf16_f32 v55, v30, v31
  s_waitcnt lgkmcnt(2)
  v_mfma_f32_32x32x16_bf16 v[16:31], v[64:67], v[96:99], v[128:143]
  ds_read_b128 v[72:75], v2 offset:28672
  ds_read_b128 v[76:79], v2 offset:29696
  v_exp_f32 v32, v32
  v_exp_f32 v33, v33
  v_exp_f32 v34, v34
  s_waitcnt lgkmcnt(2)
  v_mfma_f32_32x32x16_bf16 v[104:119], v[80:83], v[48:51], v[104:119]
  ds_read_b128 v[88:91], v2 offset:22528
  ds_read_b128 v[92:95], v2 offset:23552
  v_exp_f32 v35, v35
  v_exp_f32 v36, v36
  v_exp_f32 v37, v37
  v_cvt_pk_bf16_f32 v56, v32, v33
  v_cvt_pk_bf16_f32 v57, v34, v35
  v_mfma_f32_32x32x16_bf16 v[16:31], v[68:71], v[100:103], v[16:31]
  buffer_load_dwordx2 v[144:145], v9, s[56:59], 0 offen offset:0
  v_exp_f32 v38, v38
  v_exp_f32 v39, v39
  v_exp_f32 v40, v40
  v_cvt_pk_bf16_f32 v58, v36, v37
  v_mfma_f32_16x16x32_bf16 v[120:123], v[124:127], v[48:51], v[120:123]
  v_exp_f32 v41, v41
  v_exp_f32 v42, v42
  v_cvt_pk_bf16_f32 v59, v38, v39
  v_cvt_pk_bf16_f32 v60, v40, v41
  v_mfma_f32_32x32x16_bf16 v[104:119], v[84:87], v[52:55], v[104:119]
  v_exp_f32 v43, v43
  v_exp_f32 v44, v44
  v_exp_f32 v45, v45
  v_cvt_pk_bf16_f32 v61, v42, v43
  v_mfma_f32_16x16x32_bf16 v[120:123], v[124:127], v[52:55], v[120:123]
  v_exp_f32 v46, v46
  v_exp_f32 v47, v47
  v_cvt_pk_bf16_f32 v62, v44, v45
  v_cvt_pk_bf16_f32 v63, v46, v47
  s_waitcnt vmcnt(8)
  s_barrier
  s_add_u32 m0, s29, 0
  s_nop 0
  buffer_load_dwordx4 v2, s[16:19], s28 offen lds
  buffer_load_dwordx4 v2, s[16:19], s28 offen offset:1024 lds
  s_add_u32 s28, s28, 16384
  s_waitcnt lgkmcnt(2)
  v_mfma_f32_32x32x16_bf16 v[32:47], v[72:75], v[96:99], v[128:143]
  ds_read_b128 v[64:67], v2 offset:32768
  ds_read_b128 v[68:71], v2 offset:33792
  v_exp_f32 v16, v16
  v_exp_f32 v17, v17
  v_exp_f32 v18, v18
  s_waitcnt lgkmcnt(2)
  v_mfma_f32_32x32x16_bf16 v[104:119], v[88:91], v[56:59], v[104:119]
  ds_read_b128 v[80:83], v2 offset:26624
  ds_read_b128 v[84:87], v2 offset:27648
  v_exp_f32 v19, v19
  v_exp_f32 v20, v20
  v_exp_f32 v21, v21
  v_cvt_pk_bf16_f32 v48, v16, v17
  v_cvt_pk_bf16_f32 v49, v18, v19
  v_mfma_f32_32x32x16_bf16 v[32:47], v[76:79], v[100:103], v[32:47]
  s_add_u32 m0, s33, 1024
  s_nop 0
  buffer_load_dwordx4 v5, s[40:43], s45 offen lds
  s_add_u32 s45, s45, s44
  v_exp_f32 v22, v22
  v_exp_f32 v23, v23
  v_exp_f32 v24, v24
  v_cvt_pk_bf16_f32 v50, v20, v21
  v_mfma_f32_16x16x32_bf16 v[120:123], v[124:127], v[56:59], v[120:123]
  v_exp_f32 v25, v25
  v_exp_f32 v26, v26
  v_cvt_pk_bf16_f32 v51, v22, v23
  v_cvt_pk_bf16_f32 v52, v24, v25
  v_mfma_f32_32x32x16_bf16 v[104:119], v[92:95], v[60:63], v[104:119]
  v_exp_f32 v27, v27
  v_exp_f32 v28, v28
  v_exp_f32 v29, v29
  v_cvt_pk_bf16_f32 v53, v26, v27
  v_mfma_f32_16x16x32_bf16 v[120:123], v[124:127], v[60:63], v[120:123]
  v_exp_f32 v30, v30
  v_exp_f32 v31, v31
  v_cvt_pk_bf16_f32 v54, v28, v29
  v_cvt_pk_bf16_f32 v55, v30, v31
  s_waitcnt lgkmcnt(2)
  v_mfma_f32_32x32x16_bf16 v[16:31], v[64:67], v[96:99], v[128:143]
  ds_read_b128 v[72:75], v2 offset:36864
  ds_read_b128 v[76:79], v2 offset:37888
  v_exp_f32 v32, v32
  v_exp_f32 v33, v33
  v_exp_f32 v34, v34
  s_waitcnt lgkmcnt(2)
  v_mfma_f32_32x32x16_bf16 v[104:119], v[80:83], v[48:51], v[104:119]
  ds_read_b128 v[88:91], v2 offset:30720
  ds_read_b128 v[92:95], v2 offset:31744
  v_exp_f32 v35, v35
  v_exp_f32 v36, v36
  v_exp_f32 v37, v37
  v_cvt_pk_bf16_f32 v56, v32, v33
  v_cvt_pk_bf16_f32 v57, v34, v35
  v_mfma_f32_32x32x16_bf16 v[16:31], v[68:71], v[100:103], v[16:31]
  buffer_load_dwordx2 v[146:147], v9, s[56:59], 0 offen offset:16
  v_exp_f32 v38, v38
  v_exp_f32 v39, v39
  v_exp_f32 v40, v40
  v_cvt_pk_bf16_f32 v58, v36, v37
  v_mfma_f32_16x16x32_bf16 v[120:123], v[124:127], v[48:51], v[120:123]
  v_exp_f32 v41, v41
  v_exp_f32 v42, v42
  v_cvt_pk_bf16_f32 v59, v38, v39
  v_cvt_pk_bf16_f32 v60, v40, v41
  v_mfma_f32_32x32x16_bf16 v[104:119], v[84:87], v[52:55], v[104:119]
  v_exp_f32 v43, v43
  v_exp_f32 v44, v44
  v_exp_f32 v45, v45
  v_cvt_pk_bf16_f32 v61, v42, v43
  v_mfma_f32_16x16x32_bf16 v[120:123], v[124:127], v[52:55], v[120:123]
  v_exp_f32 v46, v46
  v_exp_f32 v47, v47
  v_cvt_pk_bf16_f32 v62, v44, v45
  v_cvt_pk_bf16_f32 v63, v46, v47
  s_waitcnt lgkmcnt(2)
  v_mfma_f32_32x32x16_bf16 v[32:47], v[72:75], v[96:99], v[128:143]
  ds_read_b128 v[64:67], v2 offset:40960
  ds_read_b128 v[68:71], v2 offset:41984
  v_exp_f32 v16, v16
  v_exp_f32 v17, v17
  v_exp_f32 v18, v18
  s_waitcnt lgkmcnt(2)
  v_mfma_f32_32x32x16_bf16 v[104:119], v[88:91], v[56:59], v[104:119]
  ds_read_b128 v[80:83], v2 offset:34816
  ds_read_b128 v[84:87], v2 offset:35840
  v_exp_f32 v19, v19
  v_exp_f32 v20, v20
  v_exp_f32 v21, v21
  v_cvt_pk_bf16_f32 v48, v16, v17
  v_cvt_pk_bf16_f32 v49, v18, v19
  v_mfma_f32_32x32x16_bf16 v[32:47], v[76:79], v[100:103], v[32:47]
  s_add_u32 m0, s33, 2048
  s_nop 0
  buffer_load_dwordx4 v5, s[40:43], s45 offen lds
  s_add_u32 s45, s45, s44
  v_exp_f32 v22, v22
  v_exp_f32 v23, v23
  v_exp_f32 v24, v24
  v_cvt_pk_bf16_f32 v50, v20, v21
  v_mfma_f32_16x16x32_bf16 v[120:123], v[124:127], v[56:59], v[120:123]
  v_exp_f32 v25, v25
  v_exp_f32 v26, v26
  v_cvt_pk_bf16_f32 v51, v22, v23
  v_cvt_pk_bf16_f32 v52, v24, v25
  v_mfma_f32_32x32x16_bf16 v[104:119], v[92:95], v[60:63], v[104:119]
  v_exp_f32 v27, v27
  v_exp_f32 v28, v28
  v_exp_f32 v29, v29
  v_cvt_pk_bf16_f32 v53, v26, v27
  v_mfma_f32_16x16x32_bf16 v[120:123], v[124:127], v[60:63], v[120:123]
  v_exp_f32 v30, v30
  v_exp_f32 v31, v31
  v_cvt_pk_bf16_f32 v54, v28, v29
  v_cvt_pk_bf16_f32 v55, v30, v31
  s_waitcnt lgkmcnt(2)
  v_mfma_f32_32x32x16_bf16 v[16:31], v[64:67], v[96:99], v[128:143]
  ds_read_b128 v[72:75], v2 offset:45056
  ds_read_b128 v[76:79], v2 offset:46080
  v_exp_f32 v32, v32
  v_exp_f32 v33, v33
  v_exp_f32 v34, v34
  s_waitcnt lgkmcnt(2)
  v_mfma_f32_32x32x16_bf16 v[104:119], v[80:83], v[48:51], v[104:119]
  ds_read_b128 v[88:91], v2 offset:38912
  ds_read_b128 v[92:95], v2 offset:39936
  v_exp_f32 v35, v35
  v_exp_f32 v36, v36
  v_exp_f32 v37, v37
  v_cvt_pk_bf16_f32 v56, v32, v33
  v_cvt_pk_bf16_f32 v57, v34, v35
  v_mfma_f32_32x32x16_bf16 v[16:31], v[68:71], v[100:103], v[16:31]
  buffer_load_dwordx2 v[148:149], v9, s[56:59], 0 offen offset:32
  v_exp_f32 v38, v38
  v_exp_f32 v39, v39
  v_exp_f32 v40, v40
  v_cvt_pk_bf16_f32 v58, v36, v37
  v_mfma_f32_16x16x32_bf16 v[120:123], v[124:127], v[48:51], v[120:123]
  v_exp_f32 v41, v41
  v_exp_f32 v42, v42
  v_cvt_pk_bf16_f32 v59, v38, v39
  v_cvt_pk_bf16_f32 v60, v40, v41
  v_mfma_f32_32x32x16_bf16 v[104:119], v[84:87], v[52:55], v[104:119]
  v_exp_f32 v43, v43
  v_exp_f32 v44, v44
  v_exp_f32 v45, v45
  v_cvt_pk_bf16_f32 v61, v42, v43
  v_mfma_f32_16x16x32_bf16 v[120:123], v[124:127], v[52:55], v[120:123]
  v_exp_f32 v46, v46
  v_exp_f32 v47, v47
  v_cvt_pk_bf16_f32 v62, v44, v45
  v_cvt_pk_bf16_f32 v63, v46, v47
  s_waitcnt vmcnt(12)
  s_barrier
  s_add_u32 m0, s29, 16384
  s_nop 0
  buffer_load_dwordx4 v2, s[16:19], s28 offen lds
  buffer_load_dwordx4 v2, s[16:19], s28 offen offset:1024 lds
  s_add_u32 s28, s28, 16384
  s_waitcnt lgkmcnt(2)
  v_mfma_f32_32x32x16_bf16 v[32:47], v[72:75], v[96:99], v[128:143]
  ds_read_b128 v[64:67], v2 offset:49152
  ds_read_b128 v[68:71], v2 offset:50176
  v_exp_f32 v16, v16
  v_exp_f32 v17, v17
  v_exp_f32 v18, v18
  s_waitcnt lgkmcnt(2)
  v_mfma_f32_32x32x16_bf16 v[104:119], v[88:91], v[56:59], v[104:119]
  ds_read_b128 v[80:83], v2 offset:43008
  ds_read_b128 v[84:87], v2 offset:44032
  v_exp_f32 v19, v19
  v_exp_f32 v20, v20
  v_exp_f32 v21, v21
  v_cvt_pk_bf16_f32 v48, v16, v17
  v_cvt_pk_bf16_f32 v49, v18, v19
  v_mfma_f32_32x32x16_bf16 v[32:47], v[76:79], v[100:103], v[32:47]
  s_add_u32 m0, s33, 3072
  s_nop 0
  buffer_load_dwordx4 v5, s[40:43], s45 offen lds
  s_add_u32 s45, s45, s44
  v_exp_f32 v22, v22
  v_exp_f32 v23, v23
  v_exp_f32 v24, v24
  v_cvt_pk_bf16_f32 v50, v20, v21
  v_mfma_f32_16x16x32_bf16 v[120:123], v[124:127], v[56:59], v[120:123]
  v_exp_f32 v25, v25
  v_exp_f32 v26, v26
  v_cvt_pk_bf16_f32 v51, v22, v23
  v_cvt_pk_bf16_f32 v52, v24, v25
  v_mfma_f32_32x32x16_bf16 v[104:119], v[92:95], v[60:63], v[104:119]
  v_exp_f32 v27, v27
  v_exp_f32 v28, v28
  v_exp_f32 v29, v29
  v_cvt_pk_bf16_f32 v53, v26, v27
  v_mfma_f32_16x16x32_bf16 v[120:123], v[124:127], v[60:63], v[120:123]
  v_exp_f32 v30, v30
  v_exp_f32 v31, v31
  v_cvt_pk_bf16_f32 v54, v28, v29
  v_cvt_pk_bf16_f32 v55, v30, v31
  s_waitcnt lgkmcnt(2)
  v_mfma_f32_32x32x16_bf16 v[16:31], v[64:67], v[96:99], v[128:143]
  ds_read_b128 v[72:75], v2 offset:53248
  ds_read_b128 v[76:79], v2 offset:54272
  v_exp_f32 v32, v32
  v_exp_f32 v33, v33
  v_exp_f32 v34, v34
  s_waitcnt lgkmcnt(2)
  v_mfma_f32_32x32x16_bf16 v[104:119], v[80:83], v[48:51], v[104:119]
  ds_read_b128 v[88:91], v2 offset:47104
  ds_read_b128 v[92:95], v2 offset:48128
  v_exp_f32 v35, v35
  v_exp_f32 v36, v36
  v_exp_f32 v37, v37
  v_cvt_pk_bf16_f32 v56, v32, v33
  v_cvt_pk_bf16_f32 v57, v34, v35
  v_mfma_f32_32x32x16_bf16 v[16:31], v[68:71], v[100:103], v[16:31]
  buffer_load_dwordx2 v[150:151], v9, s[56:59], 0 offen offset:48
  v_exp_f32 v38, v38
  v_exp_f32 v39, v39
  v_exp_f32 v40, v40
  v_cvt_pk_bf16_f32 v58, v36, v37
  v_mfma_f32_16x16x32_bf16 v[120:123], v[124:127], v[48:51], v[120:123]
  v_exp_f32 v41, v41
  v_exp_f32 v42, v42
  v_cvt_pk_bf16_f32 v59, v38, v39
  v_cvt_pk_bf16_f32 v60, v40, v41
  v_mfma_f32_32x32x16_bf16 v[104:119], v[84:87], v[52:55], v[104:119]
  v_exp_f32 v43, v43
  v_exp_f32 v44, v44
  v_exp_f32 v45, v45
  v_cvt_pk_bf16_f32 v61, v42, v43
  v_mfma_f32_16x16x32_bf16 v[120:123], v[124:127], v[52:55], v[120:123]
  v_exp_f32 v46, v46
  v_exp_f32 v47, v47
  v_cvt_pk_bf16_f32 v62, v44, v45
  v_cvt_pk_bf16_f32 v63, v46, v47
  s_waitcnt lgkmcnt(2)
  v_mfma_f32_32x32x16_bf16 v[32:47], v[72:75], v[96:99], v[128:143]
  ds_read_b128 v[64:67], v2 offset:57344
  ds_read_b128 v[68:71], v2 offset:58368
  v_exp_f32 v16, v16
  v_exp_f32 v17, v17
  v_exp_f32 v18, v18
  s_waitcnt lgkmcnt(2)
  v_mfma_f32_32x32x16_bf16 v[104:119], v[88:91], v[56:59], v[104:119]
  ds_read_b128 v[80:83], v2 offset:51200
  ds_read_b128 v[84:87], v2 offset:52224
  v_exp_f32 v19, v19
  v_exp_f32 v20, v20
  v_exp_f32 v21, v21
  v_cvt_pk_bf16_f32 v48, v16, v17
  v_cvt_pk_bf16_f32 v49, v18, v19
  v_mfma_f32_32x32x16_bf16 v[32:47], v[76:79], v[100:103], v[32:47]
  s_add_u32 m0, s33, 4096
  s_nop 0
  buffer_load_dwordx4 v5, s[40:43], s45 offen lds
  s_add_u32 s45, s45, s44
  v_exp_f32 v22, v22
  v_exp_f32 v23, v23
  v_exp_f32 v24, v24
  v_cvt_pk_bf16_f32 v50, v20, v21
  v_mfma_f32_16x16x32_bf16 v[120:123], v[124:127], v[56:59], v[120:123]
  v_exp_f32 v25, v25
  v_exp_f32 v26, v26
  v_cvt_pk_bf16_f32 v51, v22, v23
  v_cvt_pk_bf16_f32 v52, v24, v25
  v_mfma_f32_32x32x16_bf16 v[104:119], v[92:95], v[60:63], v[104:119]
  v_exp_f32 v27, v27
  v_exp_f32 v28, v28
  v_exp_f32 v29, v29
  v_cvt_pk_bf16_f32 v53, v26, v27
  v_mfma_f32_16x16x32_bf16 v[120:123], v[124:127], v[60:63], v[120:123]
  v_exp_f32 v30, v30
  v_exp_f32 v31, v31
  v_cvt_pk_bf16_f32 v54, v28, v29
  v_cvt_pk_bf16_f32 v55, v30, v31
  s_waitcnt lgkmcnt(2)
  v_mfma_f32_32x32x16_bf16 v[16:31], v[64:67], v[96:99], v[128:143]
  ds_read_b128 v[72:75], v2 offset:61440
  ds_read_b128 v[76:79], v2 offset:62464
  v_exp_f32 v32, v32
  v_exp_f32 v33, v33
  v_exp_f32 v34, v34
  s_waitcnt lgkmcnt(2)
  v_mfma_f32_32x32x16_bf16 v[104:119], v[80:83], v[48:51], v[104:119]
  ds_read_b128 v[88:91], v2 offset:55296
  ds_read_b128 v[92:95], v2 offset:56320
  v_exp_f32 v35, v35
  v_exp_f32 v36, v36
  v_exp_f32 v37, v37
  v_cvt_pk_bf16_f32 v56, v32, v33
  v_cvt_pk_bf16_f32 v57, v34, v35
  v_mfma_f32_32x32x16_bf16 v[16:31], v[68:71], v[100:103], v[16:31]
  buffer_load_dwordx2 v[152:153], v9, s[56:59], 0 offen offset:64
  v_exp_f32 v38, v38
  v_exp_f32 v39, v39
  v_exp_f32 v40, v40
  v_cvt_pk_bf16_f32 v58, v36, v37
  v_mfma_f32_16x16x32_bf16 v[120:123], v[124:127], v[48:51], v[120:123]
  v_exp_f32 v41, v41
  v_exp_f32 v42, v42
  v_cvt_pk_bf16_f32 v59, v38, v39
  v_cvt_pk_bf16_f32 v60, v40, v41
  v_mfma_f32_32x32x16_bf16 v[104:119], v[84:87], v[52:55], v[104:119]
  v_exp_f32 v43, v43
  v_exp_f32 v44, v44
  v_exp_f32 v45, v45
  v_cvt_pk_bf16_f32 v61, v42, v43
  v_mfma_f32_16x16x32_bf16 v[120:123], v[124:127], v[52:55], v[120:123]
  v_exp_f32 v46, v46
  v_exp_f32 v47, v47
  v_cvt_pk_bf16_f32 v62, v44, v45
  v_cvt_pk_bf16_f32 v63, v46, v47
  s_waitcnt vmcnt(16)
  s_barrier
  s_add_u32 m0, s29, 32768
  s_nop 0
  buffer_load_dwordx4 v2, s[16:19], s28 offen lds
  buffer_load_dwordx4 v2, s[16:19], s28 offen offset:1024 lds
  s_add_u32 s28, s28, 16384
  s_waitcnt lgkmcnt(2)
  v_mfma_f32_32x32x16_bf16 v[32:47], v[72:75], v[96:99], v[128:143]
  ds_read_b128 v[64:67], v176 offset:0
  ds_read_b128 v[68:71], v176 offset:1024
  v_exp_f32 v16, v16
  v_exp_f32 v17, v17
  v_exp_f32 v18, v18
  s_waitcnt lgkmcnt(2)
  v_mfma_f32_32x32x16_bf16 v[104:119], v[88:91], v[56:59], v[104:119]
  ds_read_b128 v[80:83], v2 offset:59392
  ds_read_b128 v[84:87], v2 offset:60416
  v_exp_f32 v19, v19
  v_exp_f32 v20, v20
  v_exp_f32 v21, v21
  v_cvt_pk_bf16_f32 v48, v16, v17
  v_cvt_pk_bf16_f32 v49, v18, v19
  v_mfma_f32_32x32x16_bf16 v[32:47], v[76:79], v[100:103], v[32:47]
  s_add_u32 m0, s33, 5120
  s_nop 0
  buffer_load_dwordx4 v5, s[40:43], s45 offen lds
  s_add_u32 s45, s45, s44
  v_exp_f32 v22, v22
  v_exp_f32 v23, v23
  v_exp_f32 v24, v24
  v_cvt_pk_bf16_f32 v50, v20, v21
  v_mfma_f32_16x16x32_bf16 v[120:123], v[124:127], v[56:59], v[120:123]
  v_exp_f32 v25, v25
  v_exp_f32 v26, v26
  v_cvt_pk_bf16_f32 v51, v22, v23
  v_cvt_pk_bf16_f32 v52, v24, v25
  v_mfma_f32_32x32x16_bf16 v[104:119], v[92:95], v[60:63], v[104:119]
  v_exp_f32 v27, v27
  v_exp_f32 v28, v28
  v_exp_f32 v29, v29
  v_cvt_pk_bf16_f32 v53, v26, v27
  v_mfma_f32_16x16x32_bf16 v[120:123], v[124:127], v[60:63], v[120:123]
  v_exp_f32 v30, v30
  v_exp_f32 v31, v31
  v_cvt_pk_bf16_f32 v54, v28, v29
  v_cvt_pk_bf16_f32 v55, v30, v31
  s_waitcnt lgkmcnt(2)
  v_mfma_f32_32x32x16_bf16 v[16:31], v[64:67], v[96:99], v[128:143]
  ds_read_b128 v[72:75], v176 offset:4096
  ds_read_b128 v[76:79], v176 offset:5120
  v_exp_f32 v32, v32
  v_exp_f32 v33, v33
  v_exp_f32 v34, v34
  s_waitcnt lgkmcnt(2)
  v_mfma_f32_32x32x16_bf16 v[104:119], v[80:83], v[48:51], v[104:119]
  ds_read_b128 v[88:91], v2 offset:63488
  ds_read_b128 v[92:95], v2 offset:64512
  v_exp_f32 v35, v35
  v_exp_f32 v36, v36
  v_exp_f32 v37, v37
  v_cvt_pk_bf16_f32 v56, v32, v33
  v_cvt_pk_bf16_f32 v57, v34, v35
  v_mfma_f32_32x32x16_bf16 v[16:31], v[68:71], v[100:103], v[16:31]
  buffer_load_dwordx2 v[154:155], v9, s[56:59], 0 offen offset:80
  v_exp_f32 v38, v38
  v_exp_f32 v39, v39
  v_exp_f32 v40, v40
  v_cvt_pk_bf16_f32 v58, v36, v37
  v_mfma_f32_16x16x32_bf16 v[120:123], v[124:127], v[48:51], v[120:123]
  v_exp_f32 v41, v41
  v_exp_f32 v42, v42
  v_cvt_pk_bf16_f32 v59, v38, v39
  v_cvt_pk_bf16_f32 v60, v40, v41
  v_mfma_f32_32x32x16_bf16 v[104:119], v[84:87], v[52:55], v[104:119]
  v_exp_f32 v43, v43
  v_exp_f32 v44, v44
  v_exp_f32 v45, v45
  v_cvt_pk_bf16_f32 v61, v42, v43
  v_mfma_f32_16x16x32_bf16 v[120:123], v[124:127], v[52:55], v[120:123]
  v_exp_f32 v46, v46
  v_exp_f32 v47, v47
  v_cvt_pk_bf16_f32 v62, v44, v45
  v_cvt_pk_bf16_f32 v63, v46, v47
  s_waitcnt lgkmcnt(2)
  v_mfma_f32_32x32x16_bf16 v[32:47], v[72:75], v[96:99], v[128:143]
  ds_read_b128 v[64:67], v176 offset:8192
  ds_read_b128 v[68:71], v176 offset:9216
  v_exp_f32 v16, v16
  v_exp_f32 v17, v17
  v_exp_f32 v18, v18
  s_waitcnt lgkmcnt(2)
  v_mfma_f32_32x32x16_bf16 v[104:119], v[88:91], v[56:59], v[104:119]
  ds_read_b128 v[80:83], v176 offset:2048
  ds_read_b128 v[84:87], v176 offset:3072
  v_exp_f32 v19, v19
  v_exp_f32 v20, v20
  v_exp_f32 v21, v21
  v_cvt_pk_bf16_f32 v48, v16, v17
  v_cvt_pk_bf16_f32 v49, v18, v19
  v_mfma_f32_32x32x16_bf16 v[32:47], v[76:79], v[100:103], v[32:47]
  s_add_u32 m0, s33, 6144
  s_nop 0
  buffer_load_dwordx4 v5, s[40:43], s45 offen lds
  s_add_u32 s45, s45, s44
  v_exp_f32 v22, v22
  v_exp_f32 v23, v23
  v_exp_f32 v24, v24
  v_cvt_pk_bf16_f32 v50, v20, v21
  v_mfma_f32_16x16x32_bf16 v[120:123], v[124:127], v[56:59], v[120:123]
  v_exp_f32 v25, v25
  v_exp_f32 v26, v26
  v_cvt_pk_bf16_f32 v51, v22, v23
  v_cvt_pk_bf16_f32 v52, v24, v25
  v_mfma_f32_32x32x16_bf16 v[104:119], v[92:95], v[60:63], v[104:119]
  v_exp_f32 v27, v27
  v_exp_f32 v28, v28
  v_exp_f32 v29, v29
  v_cvt_pk_bf16_f32 v53, v26, v27
  v_mfma_f32_16x16x32_bf16 v[120:123], v[124:127], v[60:63], v[120:123]
  v_exp_f32 v30, v30
  v_exp_f32 v31, v31
  v_cvt_pk_bf16_f32 v54, v28, v29
  v_cvt_pk_bf16_f32 v55, v30, v31
  s_waitcnt lgkmcnt(2)
  v_mfma_f32_32x32x16_bf16 v[16:31], v[64:67], v[96:99], v[128:143]
  ds_read_b128 v[72:75], v176 offset:12288
  ds_read_b128 v[76:79], v176 offset:13312
  v_exp_f32 v32, v32
  v_exp_f32 v33, v33
  v_exp_f32 v34, v34
  s_waitcnt lgkmcnt(2)
  v_mfma_f32_32x32x16_bf16 v[104:119], v[80:83], v[48:51], v[104:119]
  ds_read_b128 v[88:91], v176 offset:6144
  ds_read_b128 v[92:95], v176 offset:7168
  v_exp_f32 v35, v35
  v_exp_f32 v36, v36
  v_exp_f32 v37, v37
  v_cvt_pk_bf16_f32 v56, v32, v33
  v_cvt_pk_bf16_f32 v57, v34, v35
  v_mfma_f32_32x32x16_bf16 v[16:31], v[68:71], v[100:103], v[16:31]
  buffer_load_dwordx2 v[156:157], v9, s[56:59], 0 offen offset:96
  v_exp_f32 v38, v38
  v_exp_f32 v39, v39
  v_exp_f32 v40, v40
  v_cvt_pk_bf16_f32 v58, v36, v37
  v_mfma_f32_16x16x32_bf16 v[120:123], v[124:127], v[48:51], v[120:123]
  v_exp_f32 v41, v41
  v_exp_f32 v42, v42
  v_cvt_pk_bf16_f32 v59, v38, v39
  v_cvt_pk_bf16_f32 v60, v40, v41
  v_mfma_f32_32x32x16_bf16 v[104:119], v[84:87], v[52:55], v[104:119]
  v_exp_f32 v43, v43
  v_exp_f32 v44, v44
  v_exp_f32 v45, v45
  v_cvt_pk_bf16_f32 v61, v42, v43
  v_mfma_f32_16x16x32_bf16 v[120:123], v[124:127], v[52:55], v[120:123]
  v_exp_f32 v46, v46
  v_exp_f32 v47, v47
  v_cvt_pk_bf16_f32 v62, v44, v45
  v_cvt_pk_bf16_f32 v63, v46, v47
  s_waitcnt vmcnt(20)
  s_barrier
  s_add_u32 m0, s29, 49152
  s_nop 0
  buffer_load_dwordx4 v2, s[16:19], s28 offen lds
  buffer_load_dwordx4 v2, s[16:19], s28 offen offset:1024 lds
  s_add_u32 s28, s28, 16384
  s_waitcnt lgkmcnt(2)
  v_mfma_f32_32x32x16_bf16 v[32:47], v[72:75], v[96:99], v[128:143]
  ds_read_b128 v[64:67], v176 offset:16384
  ds_read_b128 v[68:71], v176 offset:17408
  v_exp_f32 v16, v16
  v_exp_f32 v17, v17
  v_exp_f32 v18, v18
  s_waitcnt lgkmcnt(2)
  v_mfma_f32_32x32x16_bf16 v[104:119], v[88:91], v[56:59], v[104:119]
  ds_read_b128 v[80:83], v176 offset:10240
  ds_read_b128 v[84:87], v176 offset:11264
  v_exp_f32 v19, v19
  v_exp_f32 v20, v20
  v_exp_f32 v21, v21
  v_cvt_pk_bf16_f32 v48, v16, v17
  v_cvt_pk_bf16_f32 v49, v18, v19
  v_mfma_f32_32x32x16_bf16 v[32:47], v[76:79], v[100:103], v[32:47]
  s_add_u32 m0, s33, 7168
  s_nop 0
  buffer_load_dwordx4 v5, s[40:43], s45 offen lds
  s_add_u32 s45, s45, s44
  v_exp_f32 v22, v22
  v_exp_f32 v23, v23
  v_exp_f32 v24, v24
  v_cvt_pk_bf16_f32 v50, v20, v21
  v_mfma_f32_16x16x32_bf16 v[120:123], v[124:127], v[56:59], v[120:123]
  v_exp_f32 v25, v25
  v_exp_f32 v26, v26
  v_cvt_pk_bf16_f32 v51, v22, v23
  v_cvt_pk_bf16_f32 v52, v24, v25
  v_mfma_f32_32x32x16_bf16 v[104:119], v[92:95], v[60:63], v[104:119]
  v_exp_f32 v27, v27
  v_exp_f32 v28, v28
  v_exp_f32 v29, v29
  v_cvt_pk_bf16_f32 v53, v26, v27
  v_mfma_f32_16x16x32_bf16 v[120:123], v[124:127], v[60:63], v[120:123]
  v_exp_f32 v30, v30
  v_exp_f32 v31, v31
  v_cvt_pk_bf16_f32 v54, v28, v29
  v_cvt_pk_bf16_f32 v55, v30, v31
  s_waitcnt lgkmcnt(2)
  v_mfma_f32_32x32x16_bf16 v[16:31], v[64:67], v[96:99], v[128:143]
  ds_read_b128 v[72:75], v176 offset:20480
  ds_read_b128 v[76:79], v176 offset:21504
  v_exp_f32 v32, v32
  v_exp_f32 v33, v33
  v_exp_f32 v34, v34
  s_waitcnt lgkmcnt(2)
  v_mfma_f32_32x32x16_bf16 v[104:119], v[80:83], v[48:51], v[104:119]
  ds_read_b128 v[88:91], v176 offset:14336
  ds_read_b128 v[92:95], v176 offset:15360
  v_exp_f32 v35, v35
  v_exp_f32 v36, v36
  v_exp_f32 v37, v37
  v_cvt_pk_bf16_f32 v56, v32, v33
  v_cvt_pk_bf16_f32 v57, v34, v35
  v_mfma_f32_32x32x16_bf16 v[16:31], v[68:71], v[100:103], v[16:31]
  buffer_load_dwordx2 v[158:159], v9, s[56:59], 0 offen offset:112
  v_exp_f32 v38, v38
  v_exp_f32 v39, v39
  v_exp_f32 v40, v40
  v_cvt_pk_bf16_f32 v58, v36, v37
  v_mfma_f32_16x16x32_bf16 v[120:123], v[124:127], v[48:51], v[120:123]
  v_exp_f32 v41, v41
  v_exp_f32 v42, v42
  v_cvt_pk_bf16_f32 v59, v38, v39
  v_cvt_pk_bf16_f32 v60, v40, v41
  v_mfma_f32_32x32x16_bf16 v[104:119], v[84:87], v[52:55], v[104:119]
  v_exp_f32 v43, v43
  v_exp_f32 v44, v44
  v_exp_f32 v45, v45
  v_cvt_pk_bf16_f32 v61, v42, v43
  v_mfma_f32_16x16x32_bf16 v[120:123], v[124:127], v[52:55], v[120:123]
  v_exp_f32 v46, v46
  v_exp_f32 v47, v47
  v_cvt_pk_bf16_f32 v62, v44, v45
  v_cvt_pk_bf16_f32 v63, v46, v47
  s_waitcnt lgkmcnt(2)
  v_mfma_f32_32x32x16_bf16 v[32:47], v[72:75], v[96:99], v[128:143]
  ds_read_b128 v[64:67], v176 offset:24576
  ds_read_b128 v[68:71], v176 offset:25600
  v_exp_f32 v16, v16
  v_exp_f32 v17, v17
  v_exp_f32 v18, v18
  s_waitcnt lgkmcnt(2)
  v_mfma_f32_32x32x16_bf16 v[104:119], v[88:91], v[56:59], v[104:119]
  ds_read_b128 v[80:83], v176 offset:18432
  ds_read_b128 v[84:87], v176 offset:19456
  v_exp_f32 v19, v19
  v_exp_f32 v20, v20
  v_exp_f32 v21, v21
  v_cvt_pk_bf16_f32 v48, v16, v17
  v_cvt_pk_bf16_f32 v49, v18, v19
  v_mfma_f32_32x32x16_bf16 v[32:47], v[76:79], v[100:103], v[32:47]
  v_exp_f32 v22, v22
  v_exp_f32 v23, v23
  v_exp_f32 v24, v24
  v_cvt_pk_bf16_f32 v50, v20, v21
  v_mfma_f32_16x16x32_bf16 v[120:123], v[124:127], v[56:59], v[120:123]
  v_exp_f32 v25, v25
  v_exp_f32 v26, v26
  v_cvt_pk_bf16_f32 v51, v22, v23
  v_cvt_pk_bf16_f32 v52, v24, v25
  v_mfma_f32_32x32x16_bf16 v[104:119], v[92:95], v[60:63], v[104:119]
  v_exp_f32 v27, v27
  v_exp_f32 v28, v28
  v_exp_f32 v29, v29
  v_cvt_pk_bf16_f32 v53, v26, v27
  v_mfma_f32_16x16x32_bf16 v[120:123], v[124:127], v[60:63], v[120:123]
  v_exp_f32 v30, v30
  v_exp_f32 v31, v31
  v_cvt_pk_bf16_f32 v54, v28, v29
  v_cvt_pk_bf16_f32 v55, v30, v31
  s_waitcnt lgkmcnt(2)
  v_mfma_f32_32x32x16_bf16 v[16:31], v[64:67], v[96:99], v[128:143]
  ds_read_b128 v[72:75], v176 offset:28672
  ds_read_b128 v[76:79], v176 offset:29696
  v_exp_f32 v32, v32
  v_exp_f32 v33, v33
  v_exp_f32 v34, v34
  s_waitcnt lgkmcnt(2)
  v_mfma_f32_32x32x16_bf16 v[104:119], v[80:83], v[48:51], v[104:119]
  ds_read_b128 v[88:91], v176 offset:22528
  ds_read_b128 v[92:95], v176 offset:23552
  v_exp_f32 v35, v35
  v_exp_f32 v36, v36
  v_exp_f32 v37, v37
  v_cvt_pk_bf16_f32 v56, v32, v33
  v_cvt_pk_bf16_f32 v57, v34, v35
  v_mfma_f32_32x32x16_bf16 v[16:31], v[68:71], v[100:103], v[16:31]
  v_exp_f32 v38, v38
  v_exp_f32 v39, v39
  v_exp_f32 v40, v40
  v_cvt_pk_bf16_f32 v58, v36, v37
  v_mfma_f32_16x16x32_bf16 v[120:123], v[124:127], v[48:51], v[120:123]
  v_exp_f32 v41, v41
  v_exp_f32 v42, v42
  v_cvt_pk_bf16_f32 v59, v38, v39
  v_cvt_pk_bf16_f32 v60, v40, v41
  v_mfma_f32_32x32x16_bf16 v[104:119], v[84:87], v[52:55], v[104:119]
  v_exp_f32 v43, v43
  v_exp_f32 v44, v44
  v_exp_f32 v45, v45
  v_cvt_pk_bf16_f32 v61, v42, v43
  v_mfma_f32_16x16x32_bf16 v[120:123], v[124:127], v[52:55], v[120:123]
  v_exp_f32 v46, v46
  v_exp_f32 v47, v47
  v_cvt_pk_bf16_f32 v62, v44, v45
  v_cvt_pk_bf16_f32 v63, v46, v47
  s_waitcnt vmcnt(20)
  s_barrier
  s_add_u32 m0, s29, 65536
  s_nop 0
  buffer_load_dwordx4 v2, s[16:19], s28 offen lds
  buffer_load_dwordx4 v2, s[16:19], s28 offen offset:1024 lds
  s_add_u32 s28, s28, 16384
  s_waitcnt lgkmcnt(2)
  v_mfma_f32_32x32x16_bf16 v[32:47], v[72:75], v[96:99], v[128:143]
  ds_read_b128 v[64:67], v2 offset:0
  ds_read_b128 v[68:71], v2 offset:1024
  v_exp_f32 v16, v16
  v_exp_f32 v17, v17
  v_exp_f32 v18, v18
  s_waitcnt lgkmcnt(2)
  v_mfma_f32_32x32x16_bf16 v[104:119], v[88:91], v[56:59], v[104:119]
  ds_read_b128 v[80:83], v176 offset:26624
  ds_read_b128 v[84:87], v176 offset:27648
  v_exp_f32 v19, v19
  v_exp_f32 v20, v20
  v_exp_f32 v21, v21
  v_cvt_pk_bf16_f32 v48, v16, v17
  v_cvt_pk_bf16_f32 v49, v18, v19
  v_mfma_f32_32x32x16_bf16 v[32:47], v[76:79], v[100:103], v[32:47]
  v_exp_f32 v22, v22
  v_exp_f32 v23, v23
  v_exp_f32 v24, v24
  v_cvt_pk_bf16_f32 v50, v20, v21
  v_mfma_f32_16x16x32_bf16 v[120:123], v[124:127], v[56:59], v[120:123]
  v_exp_f32 v25, v25
  v_exp_f32 v26, v26
  v_cvt_pk_bf16_f32 v51, v22, v23
  v_cvt_pk_bf16_f32 v52, v24, v25
  v_mfma_f32_32x32x16_bf16 v[104:119], v[92:95], v[60:63], v[104:119]
  s_waitcnt vmcnt(21)
  ds_read_b64_tr_b16 v[160:161], v6 offset:0
  ds_read_b64_tr_b16 v[162:163], v6 offset:1024
  v_exp_f32 v27, v27
  v_exp_f32 v28, v28
  v_exp_f32 v29, v29
  v_cvt_pk_bf16_f32 v53, v26, v27
  v_mfma_f32_16x16x32_bf16 v[120:123], v[124:127], v[60:63], v[120:123]
  v_exp_f32 v30, v30
  v_exp_f32 v31, v31
  v_cvt_pk_bf16_f32 v54, v28, v29
  v_cvt_pk_bf16_f32 v55, v30, v31
  s_waitcnt lgkmcnt(4)
  v_mfma_f32_32x32x16_bf16 v[16:31], v[64:67], v[96:99], v[128:143]
  ds_read_b128 v[72:75], v2 offset:4096
  ds_read_b128 v[76:79], v2 offset:5120
  v_exp_f32 v32, v32
  v_exp_f32 v33, v33
  v_exp_f32 v34, v34
  s_waitcnt lgkmcnt(4)
  v_mfma_f32_32x32x16_bf16 v[104:119], v[80:83], v[48:51], v[104:119]
  ds_read_b128 v[88:91], v176 offset:30720
  ds_read_b128 v[92:95], v176 offset:31744
  v_exp_f32 v35, v35
  v_exp_f32 v36, v36
  v_exp_f32 v37, v37
  v_cvt_pk_bf16_f32 v56, v32, v33
  v_cvt_pk_bf16_f32 v57, v34, v35
  v_mfma_f32_32x32x16_bf16 v[16:31], v[68:71], v[100:103], v[16:31]
  v_exp_f32 v38, v38
  v_exp_f32 v39, v39
  v_exp_f32 v40, v40
  v_cvt_pk_bf16_f32 v58, v36, v37
  v_mfma_f32_16x16x32_bf16 v[120:123], v[124:127], v[48:51], v[120:123]
  v_exp_f32 v41, v41
  v_exp_f32 v42, v42
  v_cvt_pk_bf16_f32 v59, v38, v39
  v_cvt_pk_bf16_f32 v60, v40, v41
  v_mfma_f32_32x32x16_bf16 v[104:119], v[84:87], v[52:55], v[104:119]
  s_waitcnt lgkmcnt(4)
  s_waitcnt vmcnt(2)
  v_mfma_f32_16x16x32_bf16 v[168:171], v[160:163], v[144:147], 0
  v_exp_f32 v43, v43
  v_exp_f32 v44, v44
  v_exp_f32 v45, v45
  v_cvt_pk_bf16_f32 v61, v42, v43
  v_mfma_f32_16x16x32_bf16 v[120:123], v[124:127], v[52:55], v[120:123]
  v_exp_f32 v46, v46
  v_exp_f32 v47, v47
  v_cvt_pk_bf16_f32 v62, v44, v45
  v_cvt_pk_bf16_f32 v63, v46, v47
  s_waitcnt lgkmcnt(2)
  v_mfma_f32_32x32x16_bf16 v[32:47], v[72:75], v[96:99], v[128:143]
  ds_read_b128 v[64:67], v2 offset:8192
  ds_read_b128 v[68:71], v2 offset:9216
  v_exp_f32 v16, v16
  v_exp_f32 v17, v17
  v_exp_f32 v18, v18
  s_waitcnt lgkmcnt(2)
  v_mfma_f32_32x32x16_bf16 v[104:119], v[88:91], v[56:59], v[104:119]
  ds_read_b128 v[80:83], v2 offset:2048
  ds_read_b128 v[84:87], v2 offset:3072
  v_exp_f32 v19, v19
  v_exp_f32 v20, v20
  v_exp_f32 v21, v21
  v_cvt_pk_bf16_f32 v48, v16, v17
  v_cvt_pk_bf16_f32 v49, v18, v19
  v_mfma_f32_32x32x16_bf16 v[32:47], v[76:79], v[100:103], v[32:47]
  v_exp_f32 v22, v22
  v_exp_f32 v23, v23
  v_exp_f32 v24, v24
  v_cvt_pk_bf16_f32 v50, v20, v21
  v_mfma_f32_16x16x32_bf16 v[120:123], v[124:127], v[56:59], v[120:123]
  v_exp_f32 v25, v25
  v_exp_f32 v26, v26
  v_cvt_pk_bf16_f32 v51, v22, v23
  v_cvt_pk_bf16_f32 v52, v24, v25
  v_mfma_f32_32x32x16_bf16 v[104:119], v[92:95], v[60:63], v[104:119]
  v_exp_f32 v27, v27
  v_exp_f32 v28, v28
  v_exp_f32 v29, v29
  v_cvt_pk_bf16_f32 v53, v26, v27
  v_mfma_f32_16x16x32_bf16 v[120:123], v[124:127], v[60:63], v[120:123]
  v_exp_f32 v30, v30
  v_exp_f32 v31, v31
  v_cvt_pk_bf16_f32 v54, v28, v29
  v_cvt_pk_bf16_f32 v55, v30, v31
  s_waitcnt lgkmcnt(2)
  v_mfma_f32_32x32x16_bf16 v[16:31], v[64:67], v[96:99], v[128:143]
  ds_read_b128 v[72:75], v2 offset:12288
  ds_read_b128 v[76:79], v2 offset:13312
  v_exp_f32 v32, v32
  v_exp_f32 v33, v33
  v_exp_f32 v34, v34
  s_waitcnt lgkmcnt(2)
  v_mfma_f32_32x32x16_bf16 v[104:119], v[80:83], v[48:51], v[104:119]
  ds_read_b128 v[88:91], v2 offset:6144
  ds_read_b128 v[92:95], v2 offset:7168
  v_exp_f32 v35, v35
  v_exp_f32 v36, v36
  v_exp_f32 v37, v37
  v_cvt_pk_bf16_f32 v56, v32, v33
  v_cvt_pk_bf16_f32 v57, v34, v35
  v_mfma_f32_32x32x16_bf16 v[16:31], v[68:71], v[100:103], v[16:31]
  v_exp_f32 v38, v38
  v_exp_f32 v39, v39
  v_exp_f32 v40, v40
  v_cvt_pk_bf16_f32 v58, v36, v37
  v_mfma_f32_16x16x32_bf16 v[120:123], v[124:127], v[48:51], v[120:123]
  v_exp_f32 v41, v41
  v_exp_f32 v42, v42
  v_cvt_pk_bf16_f32 v59, v38, v39
  v_cvt_pk_bf16_f32 v60, v40, v41
  v_mfma_f32_32x32x16_bf16 v[104:119], v[84:87], v[52:55], v[104:119]
  ds_read_b64_tr_b16 v[164:165], v6 offset:64
  ds_read_b64_tr_b16 v[166:167], v6 offset:1088
  v_exp_f32 v43, v43
  v_exp_f32 v44, v44
  v_exp_f32 v45, v45
  v_cvt_pk_bf16_f32 v61, v42, v43
  v_mfma_f32_16x16x32_bf16 v[120:123], v[124:127], v[52:55], v[120:123]
  v_exp_f32 v46, v46
  v_exp_f32 v47, v47
  v_cvt_pk_bf16_f32 v62, v44, v45
  v_cvt_pk_bf16_f32 v63, v46, v47
  s_barrier
  s_add_u32 m0, s29, 81920
  s_nop 0
  buffer_load_dwordx4 v2, s[16:19], s28 offen lds
  buffer_load_dwordx4 v2, s[16:19], s28 offen offset:1024 lds
  s_add_u32 s28, s28, 16384
  s_waitcnt lgkmcnt(4)
  v_mfma_f32_32x32x16_bf16 v[32:47], v[72:75], v[96:99], v[128:143]
  ds_read_b128 v[64:67], v2 offset:16384
  ds_read_b128 v[68:71], v2 offset:17408
  v_exp_f32 v16, v16
  v_exp_f32 v17, v17
  v_exp_f32 v18, v18
  s_waitcnt lgkmcnt(4)
  v_mfma_f32_32x32x16_bf16 v[104:119], v[88:91], v[56:59], v[104:119]
  ds_read_b128 v[80:83], v2 offset:10240
  ds_read_b128 v[84:87], v2 offset:11264
  v_exp_f32 v19, v19
  v_exp_f32 v20, v20
  v_exp_f32 v21, v21
  v_cvt_pk_bf16_f32 v48, v16, v17
  v_cvt_pk_bf16_f32 v49, v18, v19
  v_mfma_f32_32x32x16_bf16 v[32:47], v[76:79], v[100:103], v[32:47]
  v_exp_f32 v22, v22
  v_exp_f32 v23, v23
  v_exp_f32 v24, v24
  v_cvt_pk_bf16_f32 v50, v20, v21
  v_mfma_f32_16x16x32_bf16 v[120:123], v[124:127], v[56:59], v[120:123]
  v_exp_f32 v25, v25
  v_exp_f32 v26, v26
  v_cvt_pk_bf16_f32 v51, v22, v23
  v_cvt_pk_bf16_f32 v52, v24, v25
  v_mfma_f32_32x32x16_bf16 v[104:119], v[92:95], v[60:63], v[104:119]
  s_waitcnt lgkmcnt(4)
  v_mfma_f32_16x16x32_bf16 v[172:175], v[164:167], v[144:147], 0
  v_exp_f32 v27, v27
  v_exp_f32 v28, v28
  v_exp_f32 v29, v29
  v_cvt_pk_bf16_f32 v53, v26, v27
  v_mfma_f32_16x16x32_bf16 v[120:123], v[124:127], v[60:63], v[120:123]
  v_exp_f32 v30, v30
  v_exp_f32 v31, v31
  v_cvt_pk_bf16_f32 v54, v28, v29
  v_cvt_pk_bf16_f32 v55, v30, v31
  s_waitcnt lgkmcnt(2)
  v_mfma_f32_32x32x16_bf16 v[16:31], v[64:67], v[96:99], v[128:143]
  ds_read_b128 v[72:75], v2 offset:20480
  ds_read_b128 v[76:79], v2 offset:21504
  v_exp_f32 v32, v32
  v_exp_f32 v33, v33
  v_exp_f32 v34, v34
  s_waitcnt lgkmcnt(2)
  v_mfma_f32_32x32x16_bf16 v[104:119], v[80:83], v[48:51], v[104:119]
  ds_read_b128 v[88:91], v2 offset:14336
  ds_read_b128 v[92:95], v2 offset:15360
  v_exp_f32 v35, v35
  v_exp_f32 v36, v36
  v_exp_f32 v37, v37
  v_cvt_pk_bf16_f32 v56, v32, v33
  v_cvt_pk_bf16_f32 v57, v34, v35
  v_mfma_f32_32x32x16_bf16 v[16:31], v[68:71], v[100:103], v[16:31]
  v_exp_f32 v38, v38
  v_exp_f32 v39, v39
  v_exp_f32 v40, v40
  v_cvt_pk_bf16_f32 v58, v36, v37
  v_mfma_f32_16x16x32_bf16 v[120:123], v[124:127], v[48:51], v[120:123]
  v_exp_f32 v41, v41
  v_exp_f32 v42, v42
  v_cvt_pk_bf16_f32 v59, v38, v39
  v_cvt_pk_bf16_f32 v60, v40, v41
  v_mfma_f32_32x32x16_bf16 v[104:119], v[84:87], v[52:55], v[104:119]
  v_exp_f32 v43, v43
  v_exp_f32 v44, v44
  v_exp_f32 v45, v45
  v_cvt_pk_bf16_f32 v61, v42, v43
  v_mfma_f32_16x16x32_bf16 v[120:123], v[124:127], v[52:55], v[120:123]
  v_exp_f32 v46, v46
  v_exp_f32 v47, v47
  v_cvt_pk_bf16_f32 v62, v44, v45
  v_cvt_pk_bf16_f32 v63, v46, v47
  s_waitcnt lgkmcnt(2)
  v_mfma_f32_32x32x16_bf16 v[32:47], v[72:75], v[96:99], v[128:143]
  ds_read_b128 v[64:67], v2 offset:24576
  ds_read_b128 v[68:71], v2 offset:25600
  v_exp_f32 v16, v16
  v_exp_f32 v17, v17
  v_exp_f32 v18, v18
  s_waitcnt lgkmcnt(2)
  v_mfma_f32_32x32x16_bf16 v[104:119], v[88:91], v[56:59], v[104:119]
  ds_read_b128 v[80:83], v2 offset:18432
  ds_read_b128 v[84:87], v2 offset:19456
  v_exp_f32 v19, v19
  v_exp_f32 v20, v20
  v_exp_f32 v21, v21
  v_cvt_pk_bf16_f32 v48, v16, v17
  v_cvt_pk_bf16_f32 v49, v18, v19
  v_mfma_f32_32x32x16_bf16 v[32:47], v[76:79], v[100:103], v[32:47]
  v_exp_f32 v22, v22
  v_exp_f32 v23, v23
  v_exp_f32 v24, v24
  v_cvt_pk_bf16_f32 v50, v20, v21
  v_mfma_f32_16x16x32_bf16 v[120:123], v[124:127], v[56:59], v[120:123]
  v_exp_f32 v25, v25
  v_exp_f32 v26, v26
  v_cvt_pk_bf16_f32 v51, v22, v23
  v_cvt_pk_bf16_f32 v52, v24, v25
  v_mfma_f32_32x32x16_bf16 v[104:119], v[92:95], v[60:63], v[104:119]
  ds_read_b64_tr_b16 v[160:161], v6 offset:2048
  ds_read_b64_tr_b16 v[162:163], v6 offset:3072
  v_exp_f32 v27, v27
  v_exp_f32 v28, v28
  v_exp_f32 v29, v29
  v_cvt_pk_bf16_f32 v53, v26, v27
  v_mfma_f32_16x16x32_bf16 v[120:123], v[124:127], v[60:63], v[120:123]
  v_exp_f32 v30, v30
  v_exp_f32 v31, v31
  v_cvt_pk_bf16_f32 v54, v28, v29
  v_cvt_pk_bf16_f32 v55, v30, v31
  s_waitcnt lgkmcnt(4)
  v_mfma_f32_32x32x16_bf16 v[16:31], v[64:67], v[96:99], v[128:143]
  ds_read_b128 v[72:75], v2 offset:28672
  ds_read_b128 v[76:79], v2 offset:29696
  v_exp_f32 v32, v32
  v_exp_f32 v33, v33
  v_exp_f32 v34, v34
  s_waitcnt lgkmcnt(4)
  v_mfma_f32_32x32x16_bf16 v[104:119], v[80:83], v[48:51], v[104:119]
  ds_read_b128 v[88:91], v2 offset:22528
  ds_read_b128 v[92:95], v2 offset:23552
  v_exp_f32 v35, v35
  v_exp_f32 v36, v36
  v_exp_f32 v37, v37
  v_cvt_pk_bf16_f32 v56, v32, v33
  v_cvt_pk_bf16_f32 v57, v34, v35
  v_mfma_f32_32x32x16_bf16 v[16:31], v[68:71], v[100:103], v[16:31]
  v_exp_f32 v38, v38
  v_exp_f32 v39, v39
  v_exp_f32 v40, v40
  v_cvt_pk_bf16_f32 v58, v36, v37
  v_mfma_f32_16x16x32_bf16 v[120:123], v[124:127], v[48:51], v[120:123]
  v_exp_f32 v41, v41
  v_exp_f32 v42, v42
  v_cvt_pk_bf16_f32 v59, v38, v39
  v_cvt_pk_bf16_f32 v60, v40, v41
  v_mfma_f32_32x32x16_bf16 v[104:119], v[84:87], v[52:55], v[104:119]
  s_waitcnt lgkmcnt(4)
  v_mfma_f32_16x16x32_bf16 v[168:171], v[160:163], v[148:151], v[168:171]
  v_exp_f32 v43, v43
  v_exp_f32 v44, v44
  v_exp_f32 v45, v45
  v_cvt_pk_bf16_f32 v61, v42, v43
  v_mfma_f32_16x16x32_bf16 v[120:123], v[124:127], v[52:55], v[120:123]
  v_exp_f32 v46, v46
  v_exp_f32 v47, v47
  v_cvt_pk_bf16_f32 v62, v44, v45
  v_cvt_pk_bf16_f32 v63, v46, v47
  s_barrier
  s_add_u32 m0, s29, 0
  s_nop 0
  buffer_load_dwordx4 v2, s[16:19], s28 offen lds
  buffer_load_dwordx4 v2, s[16:19], s28 offen offset:1024 lds
  s_add_u32 s28, s28, 16384
  s_waitcnt lgkmcnt(2)
  v_mfma_f32_32x32x16_bf16 v[32:47], v[72:75], v[96:99], v[128:143]
  ds_read_b128 v[64:67], v2 offset:32768
  ds_read_b128 v[68:71], v2 offset:33792
  v_exp_f32 v16, v16
  v_exp_f32 v17, v17
  v_exp_f32 v18, v18
  s_waitcnt lgkmcnt(2)
  v_mfma_f32_32x32x16_bf16 v[104:119], v[88:91], v[56:59], v[104:119]
  ds_read_b128 v[80:83], v2 offset:26624
  ds_read_b128 v[84:87], v2 offset:27648
  v_exp_f32 v19, v19
  v_exp_f32 v20, v20
  v_exp_f32 v21, v21
  v_cvt_pk_bf16_f32 v48, v16, v17
  v_cvt_pk_bf16_f32 v49, v18, v19
  v_mfma_f32_32x32x16_bf16 v[32:47], v[76:79], v[100:103], v[32:47]
  v_exp_f32 v22, v22
  v_exp_f32 v23, v23
  v_exp_f32 v24, v24
  v_cvt_pk_bf16_f32 v50, v20, v21
  v_mfma_f32_16x16x32_bf16 v[120:123], v[124:127], v[56:59], v[120:123]
  v_exp_f32 v25, v25
  v_exp_f32 v26, v26
  v_cvt_pk_bf16_f32 v51, v22, v23
  v_cvt_pk_bf16_f32 v52, v24, v25
  v_mfma_f32_32x32x16_bf16 v[104:119], v[92:95], v[60:63], v[104:119]
  v_exp_f32 v27, v27
  v_exp_f32 v28, v28
  v_exp_f32 v29, v29
  v_cvt_pk_bf16_f32 v53, v26, v27
  v_mfma_f32_16x16x32_bf16 v[120:123], v[124:127], v[60:63], v[120:123]
  v_exp_f32 v30, v30
  v_exp_f32 v31, v31
  v_cvt_pk_bf16_f32 v54, v28, v29
  v_cvt_pk_bf16_f32 v55, v30, v31
  s_waitcnt lgkmcnt(2)
  v_mfma_f32_32x32x16_bf16 v[16:31], v[64:67], v[96:99], v[128:143]
  ds_read_b128 v[72:75], v2 offset:36864
  ds_read_b128 v[76:79], v2 offset:37888
  v_exp_f32 v32, v32
  v_exp_f32 v33, v33
  v_exp_f32 v34, v34
  s_waitcnt lgkmcnt(2)
  v_mfma_f32_32x32x16_bf16 v[104:119], v[80:83], v[48:51], v[104:119]
  ds_read_b128 v[88:91], v2 offset:30720
  ds_read_b128 v[92:95], v2 offset:31744
  v_exp_f32 v35, v35
  v_exp_f32 v36, v36
  v_exp_f32 v37, v37
  v_cvt_pk_bf16_f32 v56, v32, v33
  v_cvt_pk_bf16_f32 v57, v34, v35
  v_mfma_f32_32x32x16_bf16 v[16:31], v[68:71], v[100:103], v[16:31]
  v_exp_f32 v38, v38
  v_exp_f32 v39, v39
  v_exp_f32 v40, v40
  v_cvt_pk_bf16_f32 v58, v36, v37
  v_mfma_f32_16x16x32_bf16 v[120:123], v[124:127], v[48:51], v[120:123]
  v_exp_f32 v41, v41
  v_exp_f32 v42, v42
  v_cvt_pk_bf16_f32 v59, v38, v39
  v_cvt_pk_bf16_f32 v60, v40, v41
  v_mfma_f32_32x32x16_bf16 v[104:119], v[84:87], v[52:55], v[104:119]
  ds_read_b64_tr_b16 v[164:165], v6 offset:2112
  ds_read_b64_tr_b16 v[166:167], v6 offset:3136
  v_exp_f32 v43, v43
  v_exp_f32 v44, v44
  v_exp_f32 v45, v45
  v_cvt_pk_bf16_f32 v61, v42, v43
  v_mfma_f32_16x16x32_bf16 v[120:123], v[124:127], v[52:55], v[120:123]
  v_exp_f32 v46, v46
  v_exp_f32 v47, v47
  v_cvt_pk_bf16_f32 v62, v44, v45
  v_cvt_pk_bf16_f32 v63, v46, v47
  s_waitcnt lgkmcnt(4)
  v_mfma_f32_32x32x16_bf16 v[32:47], v[72:75], v[96:99], v[128:143]
  ds_read_b128 v[64:67], v2 offset:40960
  ds_read_b128 v[68:71], v2 offset:41984
  v_exp_f32 v16, v16
  v_exp_f32 v17, v17
  v_exp_f32 v18, v18
  s_waitcnt lgkmcnt(4)
  v_mfma_f32_32x32x16_bf16 v[104:119], v[88:91], v[56:59], v[104:119]
  ds_read_b128 v[80:83], v2 offset:34816
  ds_read_b128 v[84:87], v2 offset:35840
  v_exp_f32 v19, v19
  v_exp_f32 v20, v20
  v_exp_f32 v21, v21
  v_cvt_pk_bf16_f32 v48, v16, v17
  v_cvt_pk_bf16_f32 v49, v18, v19
  v_mfma_f32_32x32x16_bf16 v[32:47], v[76:79], v[100:103], v[32:47]
  v_exp_f32 v22, v22
  v_exp_f32 v23, v23
  v_exp_f32 v24, v24
  v_cvt_pk_bf16_f32 v50, v20, v21
  v_mfma_f32_16x16x32_bf16 v[120:123], v[124:127], v[56:59], v[120:123]
  v_exp_f32 v25, v25
  v_exp_f32 v26, v26
  v_cvt_pk_bf16_f32 v51, v22, v23
  v_cvt_pk_bf16_f32 v52, v24, v25
  v_mfma_f32_32x32x16_bf16 v[104:119], v[92:95], v[60:63], v[104:119]
  s_waitcnt lgkmcnt(4)
  v_mfma_f32_16x16x32_bf16 v[172:175], v[164:167], v[148:151], v[172:175]
  v_exp_f32 v27, v27
  v_exp_f32 v28, v28
  v_exp_f32 v29, v29
  v_cvt_pk_bf16_f32 v53, v26, v27
  v_mfma_f32_16x16x32_bf16 v[120:123], v[124:127], v[60:63], v[120:123]
  v_exp_f32 v30, v30
  v_exp_f32 v31, v31
  v_cvt_pk_bf16_f32 v54, v28, v29
  v_cvt_pk_bf16_f32 v55, v30, v31
  s_waitcnt lgkmcnt(2)
  v_mfma_f32_32x32x16_bf16 v[16:31], v[64:67], v[96:99], v[128:143]
  ds_read_b128 v[72:75], v2 offset:45056
  ds_read_b128 v[76:79], v2 offset:46080
  v_exp_f32 v32, v32
  v_exp_f32 v33, v33
  v_exp_f32 v34, v34
  s_waitcnt lgkmcnt(2)
  v_mfma_f32_32x32x16_bf16 v[104:119], v[80:83], v[48:51], v[104:119]
  ds_read_b128 v[88:91], v2 offset:38912
  ds_read_b128 v[92:95], v2 offset:39936
  v_exp_f32 v35, v35
  v_exp_f32 v36, v36
  v_exp_f32 v37, v37
  v_cvt_pk_bf16_f32 v56, v32, v33
  v_cvt_pk_bf16_f32 v57, v34, v35
  v_mfma_f32_32x32x16_bf16 v[16:31], v[68:71], v[100:103], v[16:31]
  v_exp_f32 v38, v38
  v_exp_f32 v39, v39
  v_exp_f32 v40, v40
  v_cvt_pk_bf16_f32 v58, v36, v37
  v_mfma_f32_16x16x32_bf16 v[120:123], v[124:127], v[48:51], v[120:123]
  v_exp_f32 v41, v41
  v_exp_f32 v42, v42
  v_cvt_pk_bf16_f32 v59, v38, v39
  v_cvt_pk_bf16_f32 v60, v40, v41
  v_mfma_f32_32x32x16_bf16 v[104:119], v[84:87], v[52:55], v[104:119]
  v_exp_f32 v43, v43
  v_exp_f32 v44, v44
  v_exp_f32 v45, v45
  v_cvt_pk_bf16_f32 v61, v42, v43
  v_mfma_f32_16x16x32_bf16 v[120:123], v[124:127], v[52:55], v[120:123]
  v_exp_f32 v46, v46
  v_exp_f32 v47, v47
  v_cvt_pk_bf16_f32 v62, v44, v45
  v_cvt_pk_bf16_f32 v63, v46, v47
  s_barrier
  s_add_u32 m0, s29, 16384
  s_nop 0
  buffer_load_dwordx4 v2, s[16:19], s28 offen lds
  buffer_load_dwordx4 v2, s[16:19], s28 offen offset:1024 lds
  s_add_u32 s28, s28, 16384
  s_waitcnt lgkmcnt(2)
  v_mfma_f32_32x32x16_bf16 v[32:47], v[72:75], v[96:99], v[128:143]
  ds_read_b128 v[64:67], v2 offset:49152
  ds_read_b128 v[68:71], v2 offset:50176
  v_exp_f32 v16, v16
  v_exp_f32 v17, v17
  v_exp_f32 v18, v18
  s_waitcnt lgkmcnt(2)
  v_mfma_f32_32x32x16_bf16 v[104:119], v[88:91], v[56:59], v[104:119]
  ds_read_b128 v[80:83], v2 offset:43008
  ds_read_b128 v[84:87], v2 offset:44032
  v_exp_f32 v19, v19
  v_exp_f32 v20, v20
  v_exp_f32 v21, v21
  v_cvt_pk_bf16_f32 v48, v16, v17
  v_cvt_pk_bf16_f32 v49, v18, v19
  v_mfma_f32_32x32x16_bf16 v[32:47], v[76:79], v[100:103], v[32:47]
  v_exp_f32 v22, v22
  v_exp_f32 v23, v23
  v_exp_f32 v24, v24
  v_cvt_pk_bf16_f32 v50, v20, v21
  v_mfma_f32_16x16x32_bf16 v[120:123], v[124:127], v[56:59], v[120:123]
  v_exp_f32 v25, v25
  v_exp_f32 v26, v26
  v_cvt_pk_bf16_f32 v51, v22, v23
  v_cvt_pk_bf16_f32 v52, v24, v25
  v_mfma_f32_32x32x16_bf16 v[104:119], v[92:95], v[60:63], v[104:119]
  ds_read_b64_tr_b16 v[160:161], v6 offset:4096
  ds_read_b64_tr_b16 v[162:163], v6 offset:5120
  v_exp_f32 v27, v27
  v_exp_f32 v28, v28
  v_exp_f32 v29, v29
  v_cvt_pk_bf16_f32 v53, v26, v27
  v_mfma_f32_16x16x32_bf16 v[120:123], v[124:127], v[60:63], v[120:123]
  v_exp_f32 v30, v30
  v_exp_f32 v31, v31
  v_cvt_pk_bf16_f32 v54, v28, v29
  v_cvt_pk_bf16_f32 v55, v30, v31
  s_waitcnt lgkmcnt(4)
  v_mfma_f32_32x32x16_bf16 v[16:31], v[64:67], v[96:99], v[128:143]
  ds_read_b128 v[72:75], v2 offset:53248
  ds_read_b128 v[76:79], v2 offset:54272
  v_exp_f32 v32, v32
  v_exp_f32 v33, v33
  v_exp_f32 v34, v34
  s_waitcnt lgkmcnt(4)
  v_mfma_f32_32x32x16_bf16 v[104:119], v[80:83], v[48:51], v[104:119]
  ds_read_b128 v[88:91], v2 offset:47104
  ds_read_b128 v[92:95], v2 offset:48128
  v_exp_f32 v35, v35
  v_exp_f32 v36, v36
  v_exp_f32 v37, v37
  v_cvt_pk_bf16_f32 v56, v32, v33
  v_cvt_pk_bf16_f32 v57, v34, v35
  v_mfma_f32_32x32x16_bf16 v[16:31], v[68:71], v[100:103], v[16:31]
  v_exp_f32 v38, v38
  v_exp_f32 v39, v39
  v_exp_f32 v40, v40
  v_cvt_pk_bf16_f32 v58, v36, v37
  v_mfma_f32_16x16x32_bf16 v[120:123], v[124:127], v[48:51], v[120:123]
  v_exp_f32 v41, v41
  v_exp_f32 v42, v42
  v_cvt_pk_bf16_f32 v59, v38, v39
  v_cvt_pk_bf16_f32 v60, v40, v41
  v_mfma_f32_32x32x16_bf16 v[104:119], v[84:87], v[52:55], v[104:119]
  s_waitcnt lgkmcnt(4)
  v_mfma_f32_16x16x32_bf16 v[168:171], v[160:163], v[152:155], v[168:171]
  v_exp_f32 v43, v43
  v_exp_f32 v44, v44
  v_exp_f32 v45, v45
  v_cvt_pk_bf16_f32 v61, v42, v43
  v_mfma_f32_16x16x32_bf16 v[120:123], v[124:127], v[52:55], v[120:123]
  v_exp_f32 v46, v46
  v_exp_f32 v47, v47
  v_cvt_pk_bf16_f32 v62, v44, v45
  v_cvt_pk_bf16_f32 v63, v46, v47
  s_waitcnt lgkmcnt(2)
  v_mfma_f32_32x32x16_bf16 v[32:47], v[72:75], v[96:99], v[128:143]
  ds_read_b128 v[64:67], v2 offset:57344
  ds_read_b128 v[68:71], v2 offset:58368
  v_exp_f32 v16, v16
  v_exp_f32 v17, v17
  v_exp_f32 v18, v18
  s_waitcnt lgkmcnt(2)
  v_mfma_f32_32x32x16_bf16 v[104:119], v[88:91], v[56:59], v[104:119]
  ds_read_b128 v[80:83], v2 offset:51200
  ds_read_b128 v[84:87], v2 offset:52224
  v_exp_f32 v19, v19
  v_exp_f32 v20, v20
  v_exp_f32 v21, v21
  v_cvt_pk_bf16_f32 v48, v16, v17
  v_cvt_pk_bf16_f32 v49, v18, v19
  v_mfma_f32_32x32x16_bf16 v[32:47], v[76:79], v[100:103], v[32:47]
  s_add_u32 m0, s39, 0
  s_nop 0
  buffer_load_dwordx4 v13, s[88:91], s62 offen lds
  s_add_u32 s62, s62, 16384
  v_exp_f32 v22, v22
  v_exp_f32 v23, v23
  v_exp_f32 v24, v24
  v_cvt_pk_bf16_f32 v50, v20, v21
  v_mfma_f32_16x16x32_bf16 v[120:123], v[124:127], v[56:59], v[120:123]
  v_exp_f32 v25, v25
  v_exp_f32 v26, v26
  v_cvt_pk_bf16_f32 v51, v22, v23
  v_cvt_pk_bf16_f32 v52, v24, v25
  v_mfma_f32_32x32x16_bf16 v[104:119], v[92:95], v[60:63], v[104:119]
  v_exp_f32 v27, v27
  v_exp_f32 v28, v28
  v_exp_f32 v29, v29
  v_cvt_pk_bf16_f32 v53, v26, v27
  v_mfma_f32_16x16x32_bf16 v[120:123], v[124:127], v[60:63], v[120:123]
  v_exp_f32 v30, v30
  v_exp_f32 v31, v31
  v_cvt_pk_bf16_f32 v54, v28, v29
  v_cvt_pk_bf16_f32 v55, v30, v31
  s_waitcnt lgkmcnt(2)
  v_mfma_f32_32x32x16_bf16 v[16:31], v[64:67], v[96:99], v[128:143]
  ds_read_b128 v[72:75], v2 offset:61440
  ds_read_b128 v[76:79], v2 offset:62464
  v_exp_f32 v32, v32
  v_exp_f32 v33, v33
  v_exp_f32 v34, v34
  s_waitcnt lgkmcnt(2)
  v_mfma_f32_32x32x16_bf16 v[104:119], v[80:83], v[48:51], v[104:119]
  ds_read_b128 v[88:91], v2 offset:55296
  ds_read_b128 v[92:95], v2 offset:56320
  v_exp_f32 v35, v35
  v_exp_f32 v36, v36
  v_exp_f32 v37, v37
  v_cvt_pk_bf16_f32 v56, v32, v33
  v_cvt_pk_bf16_f32 v57, v34, v35
  v_mfma_f32_32x32x16_bf16 v[16:31], v[68:71], v[100:103], v[16:31]
  v_exp_f32 v38, v38
  v_exp_f32 v39, v39
  v_exp_f32 v40, v40
  v_cvt_pk_bf16_f32 v58, v36, v37
  v_mfma_f32_16x16x32_bf16 v[120:123], v[124:127], v[48:51], v[120:123]
  v_exp_f32 v41, v41
  v_exp_f32 v42, v42
  v_cvt_pk_bf16_f32 v59, v38, v39
  v_cvt_pk_bf16_f32 v60, v40, v41
  v_mfma_f32_32x32x16_bf16 v[104:119], v[84:87], v[52:55], v[104:119]
  ds_read_b64_tr_b16 v[164:165], v6 offset:4160
  ds_read_b64_tr_b16 v[166:167], v6 offset:5184
  v_exp_f32 v43, v43
  v_exp_f32 v44, v44
  v_exp_f32 v45, v45
  v_cvt_pk_bf16_f32 v61, v42, v43
  v_mfma_f32_16x16x32_bf16 v[120:123], v[124:127], v[52:55], v[120:123]
  v_exp_f32 v46, v46
  v_exp_f32 v47, v47
  v_cvt_pk_bf16_f32 v62, v44, v45
  v_cvt_pk_bf16_f32 v63, v46, v47
  s_waitcnt vmcnt(7)
  s_barrier
  s_add_u32 m0, s29, 32768
  s_nop 0
  buffer_load_dwordx4 v2, s[16:19], s28 offen lds
  buffer_load_dwordx4 v2, s[16:19], s28 offen offset:1024 lds
  s_add_u32 s28, s28, 16384
  s_waitcnt lgkmcnt(4)
  v_mfma_f32_32x32x16_bf16 v[32:47], v[72:75], v[96:99], v[128:143]
  ds_read_b128 v[64:67], v176 offset:0
  ds_read_b128 v[68:71], v176 offset:1024
  v_exp_f32 v16, v16
  v_exp_f32 v17, v17
  v_exp_f32 v18, v18
  s_waitcnt lgkmcnt(4)
  v_mfma_f32_32x32x16_bf16 v[104:119], v[88:91], v[56:59], v[104:119]
  ds_read_b128 v[80:83], v2 offset:59392
  ds_read_b128 v[84:87], v2 offset:60416
  v_exp_f32 v19, v19
  v_exp_f32 v20, v20
  v_exp_f32 v21, v21
  v_cvt_pk_bf16_f32 v48, v16, v17
  v_cvt_pk_bf16_f32 v49, v18, v19
  v_mfma_f32_32x32x16_bf16 v[32:47], v[76:79], v[100:103], v[32:47]
  s_add_u32 m0, s39, 1024
  s_nop 0
  buffer_load_dwordx4 v13, s[88:91], s62 offen lds
  s_add_u32 s62, s62, 16384
  v_exp_f32 v22, v22
  v_exp_f32 v23, v23
  v_exp_f32 v24, v24
  v_cvt_pk_bf16_f32 v50, v20, v21
  v_mfma_f32_16x16x32_bf16 v[120:123], v[124:127], v[56:59], v[120:123]
  v_exp_f32 v25, v25
  v_exp_f32 v26, v26
  v_cvt_pk_bf16_f32 v51, v22, v23
  v_cvt_pk_bf16_f32 v52, v24, v25
  v_mfma_f32_32x32x16_bf16 v[104:119], v[92:95], v[60:63], v[104:119]
  s_waitcnt lgkmcnt(4)
  v_mfma_f32_16x16x32_bf16 v[172:175], v[164:167], v[152:155], v[172:175]
  v_exp_f32 v27, v27
  v_exp_f32 v28, v28
  v_exp_f32 v29, v29
  v_cvt_pk_bf16_f32 v53, v26, v27
  v_mfma_f32_16x16x32_bf16 v[120:123], v[124:127], v[60:63], v[120:123]
  v_exp_f32 v30, v30
  v_exp_f32 v31, v31
  v_cvt_pk_bf16_f32 v54, v28, v29
  v_cvt_pk_bf16_f32 v55, v30, v31
  s_waitcnt lgkmcnt(2)
  v_mfma_f32_32x32x16_bf16 v[16:31], v[64:67], v[96:99], v[128:143]
  ds_read_b128 v[72:75], v176 offset:4096
  ds_read_b128 v[76:79], v176 offset:5120
  v_exp_f32 v32, v32
  v_exp_f32 v33, v33
  v_exp_f32 v34, v34
  s_waitcnt lgkmcnt(2)
  v_mfma_f32_32x32x16_bf16 v[104:119], v[80:83], v[48:51], v[104:119]
  ds_read_b128 v[88:91], v2 offset:63488
  ds_read_b128 v[92:95], v2 offset:64512
  v_exp_f32 v35, v35
  v_exp_f32 v36, v36
  v_exp_f32 v37, v37
  v_cvt_pk_bf16_f32 v56, v32, v33
  v_cvt_pk_bf16_f32 v57, v34, v35
  v_mfma_f32_32x32x16_bf16 v[16:31], v[68:71], v[100:103], v[16:31]
  v_exp_f32 v38, v38
  v_exp_f32 v39, v39
  v_exp_f32 v40, v40
  v_cvt_pk_bf16_f32 v58, v36, v37
  v_mfma_f32_16x16x32_bf16 v[120:123], v[124:127], v[48:51], v[120:123]
  v_exp_f32 v41, v41
  v_exp_f32 v42, v42
  v_cvt_pk_bf16_f32 v59, v38, v39
  v_cvt_pk_bf16_f32 v60, v40, v41
  v_mfma_f32_32x32x16_bf16 v[104:119], v[84:87], v[52:55], v[104:119]
  v_exp_f32 v43, v43
  v_exp_f32 v44, v44
  v_exp_f32 v45, v45
  v_cvt_pk_bf16_f32 v61, v42, v43
  v_mfma_f32_16x16x32_bf16 v[120:123], v[124:127], v[52:55], v[120:123]
  v_exp_f32 v46, v46
  v_exp_f32 v47, v47
  v_cvt_pk_bf16_f32 v62, v44, v45
  v_cvt_pk_bf16_f32 v63, v46, v47
  s_waitcnt lgkmcnt(2)
  v_mfma_f32_32x32x16_bf16 v[32:47], v[72:75], v[96:99], v[128:143]
  ds_read_b128 v[64:67], v176 offset:8192
  ds_read_b128 v[68:71], v176 offset:9216
  v_exp_f32 v16, v16
  v_exp_f32 v17, v17
  v_exp_f32 v18, v18
  s_waitcnt lgkmcnt(2)
  v_mfma_f32_32x32x16_bf16 v[104:119], v[88:91], v[56:59], v[104:119]
  ds_read_b128 v[80:83], v176 offset:2048
  ds_read_b128 v[84:87], v176 offset:3072
  v_exp_f32 v19, v19
  v_exp_f32 v20, v20
  v_exp_f32 v21, v21
  v_cvt_pk_bf16_f32 v48, v16, v17
  v_cvt_pk_bf16_f32 v49, v18, v19
  v_mfma_f32_32x32x16_bf16 v[32:47], v[76:79], v[100:103], v[32:47]
  s_add_u32 m0, s39, 2048
  s_nop 0
  buffer_load_dwordx4 v13, s[88:91], s62 offen lds
  s_add_u32 s62, s62, 16384
  v_exp_f32 v22, v22
  v_exp_f32 v23, v23
  v_exp_f32 v24, v24
  v_cvt_pk_bf16_f32 v50, v20, v21
  v_mfma_f32_16x16x32_bf16 v[120:123], v[124:127], v[56:59], v[120:123]
  v_exp_f32 v25, v25
  v_exp_f32 v26, v26
  v_cvt_pk_bf16_f32 v51, v22, v23
  v_cvt_pk_bf16_f32 v52, v24, v25
  v_mfma_f32_32x32x16_bf16 v[104:119], v[92:95], v[60:63], v[104:119]
  ds_read_b64_tr_b16 v[160:161], v6 offset:6144
  ds_read_b64_tr_b16 v[162:163], v6 offset:7168
  v_exp_f32 v27, v27
  v_exp_f32 v28, v28
  v_exp_f32 v29, v29
  v_cvt_pk_bf16_f32 v53, v26, v27
  v_mfma_f32_16x16x32_bf16 v[120:123], v[124:127], v[60:63], v[120:123]
  v_exp_f32 v30, v30
  v_exp_f32 v31, v31
  v_cvt_pk_bf16_f32 v54, v28, v29
  v_cvt_pk_bf16_f32 v55, v30, v31
  s_waitcnt lgkmcnt(4)
  v_mfma_f32_32x32x16_bf16 v[16:31], v[64:67], v[96:99], v[128:143]
  ds_read_b128 v[72:75], v176 offset:12288
  ds_read_b128 v[76:79], v176 offset:13312
  v_exp_f32 v32, v32
  v_exp_f32 v33, v33
  v_exp_f32 v34, v34
  s_waitcnt lgkmcnt(4)
  v_mfma_f32_32x32x16_bf16 v[104:119], v[80:83], v[48:51], v[104:119]
  ds_read_b128 v[88:91], v176 offset:6144
  ds_read_b128 v[92:95], v176 offset:7168
  v_exp_f32 v35, v35
  v_exp_f32 v36, v36
  v_exp_f32 v37, v37
  v_cvt_pk_bf16_f32 v56, v32, v33
  v_cvt_pk_bf16_f32 v57, v34, v35
  v_mfma_f32_32x32x16_bf16 v[16:31], v[68:71], v[100:103], v[16:31]
  v_exp_f32 v38, v38
  v_exp_f32 v39, v39
  v_exp_f32 v40, v40
  v_cvt_pk_bf16_f32 v58, v36, v37
  v_mfma_f32_16x16x32_bf16 v[120:123], v[124:127], v[48:51], v[120:123]
  v_exp_f32 v41, v41
  v_exp_f32 v42, v42
  v_cvt_pk_bf16_f32 v59, v38, v39
  v_cvt_pk_bf16_f32 v60, v40, v41
  v_mfma_f32_32x32x16_bf16 v[104:119], v[84:87], v[52:55], v[104:119]
  s_waitcnt lgkmcnt(4)
  v_mfma_f32_16x16x32_bf16 v[168:171], v[160:163], v[156:159], v[168:171]
  v_exp_f32 v43, v43
  v_exp_f32 v44, v44
  v_exp_f32 v45, v45
  v_cvt_pk_bf16_f32 v61, v42, v43
  v_mfma_f32_16x16x32_bf16 v[120:123], v[124:127], v[52:55], v[120:123]
  v_exp_f32 v46, v46
  v_exp_f32 v47, v47
  v_cvt_pk_bf16_f32 v62, v44, v45
  v_cvt_pk_bf16_f32 v63, v46, v47
  s_waitcnt vmcnt(9)
  s_barrier
  s_add_u32 m0, s29, 49152
  s_nop 0
  buffer_load_dwordx4 v2, s[16:19], s28 offen lds
  buffer_load_dwordx4 v2, s[16:19], s28 offen offset:1024 lds
  s_add_u32 s28, s28, 16384
  s_waitcnt lgkmcnt(2)
  v_mfma_f32_32x32x16_bf16 v[32:47], v[72:75], v[96:99], v[128:143]
  ds_read_b128 v[64:67], v176 offset:16384
  ds_read_b128 v[68:71], v176 offset:17408
  v_exp_f32 v16, v16
  v_exp_f32 v17, v17
  v_exp_f32 v18, v18
  s_waitcnt lgkmcnt(2)
  v_mfma_f32_32x32x16_bf16 v[104:119], v[88:91], v[56:59], v[104:119]
  ds_read_b128 v[80:83], v176 offset:10240
  ds_read_b128 v[84:87], v176 offset:11264
  v_exp_f32 v19, v19
  v_exp_f32 v20, v20
  v_exp_f32 v21, v21
  v_cvt_pk_bf16_f32 v48, v16, v17
  v_cvt_pk_bf16_f32 v49, v18, v19
  v_mfma_f32_32x32x16_bf16 v[32:47], v[76:79], v[100:103], v[32:47]
  s_add_u32 m0, s39, 3072
  s_nop 0
  buffer_load_dwordx4 v13, s[88:91], s62 offen lds
  s_add_u32 s62, s62, 16384
  v_exp_f32 v22, v22
  v_exp_f32 v23, v23
  v_exp_f32 v24, v24
  v_cvt_pk_bf16_f32 v50, v20, v21
  v_mfma_f32_16x16x32_bf16 v[120:123], v[124:127], v[56:59], v[120:123]
  v_exp_f32 v25, v25
  v_exp_f32 v26, v26
  v_cvt_pk_bf16_f32 v51, v22, v23
  v_cvt_pk_bf16_f32 v52, v24, v25
  v_mfma_f32_32x32x16_bf16 v[104:119], v[92:95], v[60:63], v[104:119]
  v_exp_f32 v27, v27
  v_exp_f32 v28, v28
  v_exp_f32 v29, v29
  v_cvt_pk_bf16_f32 v53, v26, v27
  v_mfma_f32_16x16x32_bf16 v[120:123], v[124:127], v[60:63], v[120:123]
  v_exp_f32 v30, v30
  v_exp_f32 v31, v31
  v_cvt_pk_bf16_f32 v54, v28, v29
  v_cvt_pk_bf16_f32 v55, v30, v31
  s_waitcnt lgkmcnt(2)
  v_mfma_f32_32x32x16_bf16 v[16:31], v[64:67], v[96:99], v[128:143]
  ds_read_b128 v[72:75], v176 offset:20480
  ds_read_b128 v[76:79], v176 offset:21504
  v_exp_f32 v32, v32
  v_exp_f32 v33, v33
  v_exp_f32 v34, v34
  s_waitcnt lgkmcnt(2)
  v_mfma_f32_32x32x16_bf16 v[104:119], v[80:83], v[48:51], v[104:119]
  ds_read_b128 v[88:91], v176 offset:14336
  ds_read_b128 v[92:95], v176 offset:15360
  v_exp_f32 v35, v35
  v_exp_f32 v36, v36
  v_exp_f32 v37, v37
  v_cvt_pk_bf16_f32 v56, v32, v33
  v_cvt_pk_bf16_f32 v57, v34, v35
  v_mfma_f32_32x32x16_bf16 v[16:31], v[68:71], v[100:103], v[16:31]
  v_exp_f32 v38, v38
  v_exp_f32 v39, v39
  v_exp_f32 v40, v40
  v_cvt_pk_bf16_f32 v58, v36, v37
  v_mfma_f32_16x16x32_bf16 v[120:123], v[124:127], v[48:51], v[120:123]
  v_exp_f32 v41, v41
  v_exp_f32 v42, v42
  v_cvt_pk_bf16_f32 v59, v38, v39
  v_cvt_pk_bf16_f32 v60, v40, v41
  v_mfma_f32_32x32x16_bf16 v[104:119], v[84:87], v[52:55], v[104:119]
  ds_read_b64_tr_b16 v[164:165], v6 offset:6208
  ds_read_b64_tr_b16 v[166:167], v6 offset:7232
  v_exp_f32 v43, v43
  v_exp_f32 v44, v44
  v_exp_f32 v45, v45
  v_cvt_pk_bf16_f32 v61, v42, v43
  v_mfma_f32_16x16x32_bf16 v[120:123], v[124:127], v[52:55], v[120:123]
  v_exp_f32 v46, v46
  v_exp_f32 v47, v47
  v_cvt_pk_bf16_f32 v62, v44, v45
  v_cvt_pk_bf16_f32 v63, v46, v47
  s_waitcnt lgkmcnt(4)
  v_mfma_f32_32x32x16_bf16 v[32:47], v[72:75], v[96:99], v[128:143]
  ds_read_b128 v[64:67], v176 offset:24576
  ds_read_b128 v[68:71], v176 offset:25600
  v_exp_f32 v16, v16
  v_exp_f32 v17, v17
  v_exp_f32 v18, v18
  s_waitcnt lgkmcnt(4)
  v_mfma_f32_32x32x16_bf16 v[104:119], v[88:91], v[56:59], v[104:119]
  ds_read_b128 v[80:83], v176 offset:18432
  ds_read_b128 v[84:87], v176 offset:19456
  v_exp_f32 v19, v19
  v_exp_f32 v20, v20
  v_exp_f32 v21, v21
  v_cvt_pk_bf16_f32 v48, v16, v17
  v_cvt_pk_bf16_f32 v49, v18, v19
  v_mfma_f32_32x32x16_bf16 v[32:47], v[76:79], v[100:103], v[32:47]
  v_exp_f32 v22, v22
  v_exp_f32 v23, v23
  v_exp_f32 v24, v24
  v_cvt_pk_bf16_f32 v50, v20, v21
  v_mfma_f32_16x16x32_bf16 v[120:123], v[124:127], v[56:59], v[120:123]
  v_exp_f32 v25, v25
  v_exp_f32 v26, v26
  v_cvt_pk_bf16_f32 v51, v22, v23
  v_cvt_pk_bf16_f32 v52, v24, v25
  v_mfma_f32_32x32x16_bf16 v[104:119], v[92:95], v[60:63], v[104:119]
  s_waitcnt lgkmcnt(4)
  v_mfma_f32_16x16x32_bf16 v[172:175], v[164:167], v[156:159], v[172:175]
  v_exp_f32 v27, v27
  v_exp_f32 v28, v28
  v_exp_f32 v29, v29
  v_cvt_pk_bf16_f32 v53, v26, v27
  v_mfma_f32_16x16x32_bf16 v[120:123], v[124:127], v[60:63], v[120:123]
  v_exp_f32 v30, v30
  v_exp_f32 v31, v31
  v_cvt_pk_bf16_f32 v54, v28, v29
  v_cvt_pk_bf16_f32 v55, v30, v31
  s_waitcnt lgkmcnt(2)
  v_mfma_f32_32x32x16_bf16 v[16:31], v[64:67], v[96:99], v[128:143]
  ds_read_b128 v[72:75], v176 offset:28672
  ds_read_b128 v[76:79], v176 offset:29696
  v_exp_f32 v32, v32
  v_exp_f32 v33, v33
  v_exp_f32 v34, v34
  s_waitcnt lgkmcnt(2)
  v_mfma_f32_32x32x16_bf16 v[104:119], v[80:83], v[48:51], v[104:119]
  ds_read_b128 v[88:91], v176 offset:22528
  ds_read_b128 v[92:95], v176 offset:23552
  v_exp_f32 v35, v35
  v_exp_f32 v36, v36
  v_exp_f32 v37, v37
  v_cvt_pk_bf16_f32 v56, v32, v33
  v_cvt_pk_bf16_f32 v57, v34, v35
  v_mfma_f32_32x32x16_bf16 v[16:31], v[68:71], v[100:103], v[16:31]
  v_exp_f32 v38, v38
  v_exp_f32 v39, v39
  v_exp_f32 v40, v40
  v_cvt_pk_bf16_f32 v58, v36, v37
  v_mfma_f32_16x16x32_bf16 v[120:123], v[124:127], v[48:51], v[120:123]
  v_exp_f32 v41, v41
  v_exp_f32 v42, v42
  v_cvt_pk_bf16_f32 v59, v38, v39
  v_cvt_pk_bf16_f32 v60, v40, v41
  v_mfma_f32_32x32x16_bf16 v[104:119], v[84:87], v[52:55], v[104:119]
  v_exp_f32 v43, v43
  v_exp_f32 v44, v44
  v_exp_f32 v45, v45
  v_cvt_pk_bf16_f32 v61, v42, v43
  v_mfma_f32_16x16x32_bf16 v[120:123], v[124:127], v[52:55], v[120:123]
  v_exp_f32 v46, v46
  v_exp_f32 v47, v47
  v_cvt_pk_bf16_f32 v62, v44, v45
  v_cvt_pk_bf16_f32 v63, v46, v47
  s_waitcnt vmcnt(10)
  s_barrier
  s_waitcnt lgkmcnt(2)
  v_mfma_f32_32x32x16_bf16 v[32:47], v[72:75], v[96:99], v[128:143]
  ds_read_b128 v[64:67], v2 offset:0
  ds_read_b128 v[68:71], v2 offset:1024
  v_exp_f32 v16, v16
  v_exp_f32 v17, v17
  v_exp_f32 v18, v18
  s_waitcnt lgkmcnt(2)
  v_mfma_f32_32x32x16_bf16 v[104:119], v[88:91], v[56:59], v[104:119]
  ds_read_b128 v[80:83], v176 offset:26624
  ds_read_b128 v[84:87], v176 offset:27648
  v_exp_f32 v19, v19
  v_exp_f32 v20, v20
  v_exp_f32 v21, v21
  v_cvt_pk_bf16_f32 v48, v16, v17
  v_cvt_pk_bf16_f32 v49, v18, v19
  v_mfma_f32_32x32x16_bf16 v[32:47], v[76:79], v[100:103], v[32:47]
  v_exp_f32 v22, v22
  v_exp_f32 v23, v23
  v_exp_f32 v24, v24
  v_cvt_pk_bf16_f32 v50, v20, v21
  v_mfma_f32_16x16x32_bf16 v[120:123], v[124:127], v[56:59], v[120:123]
  v_exp_f32 v25, v25
  v_exp_f32 v26, v26
  v_cvt_pk_bf16_f32 v51, v22, v23
  v_cvt_pk_bf16_f32 v52, v24, v25
  v_mfma_f32_32x32x16_bf16 v[104:119], v[92:95], v[60:63], v[104:119]
  s_add_u32 s56, s4, 1048576
  s_addc_u32 s57, s5, 0
  s_and_b32 s57, s57, 0xffff
  s_mov_b32 s58, 917504
  s_mov_b32 s59, 0x00020000
  buffer_store_dwordx4 v[168:171], v15, s[56:59], s53 offen
  buffer_store_dwordx4 v[172:175], v15, s[56:59], s53 offen offset:128
  v_exp_f32 v27, v27
  v_exp_f32 v28, v28
  v_exp_f32 v29, v29
  v_cvt_pk_bf16_f32 v53, v26, v27
  v_mfma_f32_16x16x32_bf16 v[120:123], v[124:127], v[60:63], v[120:123]
  v_exp_f32 v30, v30
  v_exp_f32 v31, v31
  v_cvt_pk_bf16_f32 v54, v28, v29
  v_cvt_pk_bf16_f32 v55, v30, v31
  s_waitcnt lgkmcnt(2)
  v_mfma_f32_32x32x16_bf16 v[16:31], v[64:67], v[96:99], v[128:143]
  ds_read_b128 v[72:75], v2 offset:4096
  ds_read_b128 v[76:79], v2 offset:5120
  v_exp_f32 v32, v32
  v_exp_f32 v33, v33
  v_exp_f32 v34, v34
  s_waitcnt lgkmcnt(2)
  v_mfma_f32_32x32x16_bf16 v[104:119], v[80:83], v[48:51], v[104:119]
  ds_read_b128 v[88:91], v176 offset:30720
  ds_read_b128 v[92:95], v176 offset:31744
  v_exp_f32 v35, v35
  v_exp_f32 v36, v36
  v_exp_f32 v37, v37
  v_cvt_pk_bf16_f32 v56, v32, v33
  v_cvt_pk_bf16_f32 v57, v34, v35
  v_mfma_f32_32x32x16_bf16 v[16:31], v[68:71], v[100:103], v[16:31]
  v_exp_f32 v38, v38
  v_exp_f32 v39, v39
  v_exp_f32 v40, v40
  v_cvt_pk_bf16_f32 v58, v36, v37
  v_mfma_f32_16x16x32_bf16 v[120:123], v[124:127], v[48:51], v[120:123]
  v_exp_f32 v41, v41
  v_exp_f32 v42, v42
  v_cvt_pk_bf16_f32 v59, v38, v39
  v_cvt_pk_bf16_f32 v60, v40, v41
  v_mfma_f32_32x32x16_bf16 v[104:119], v[84:87], v[52:55], v[104:119]
  v_exp_f32 v43, v43
  v_exp_f32 v44, v44
  v_exp_f32 v45, v45
  v_cvt_pk_bf16_f32 v61, v42, v43
  v_mfma_f32_16x16x32_bf16 v[120:123], v[124:127], v[52:55], v[120:123]
  v_exp_f32 v46, v46
  v_exp_f32 v47, v47
  v_cvt_pk_bf16_f32 v62, v44, v45
  v_cvt_pk_bf16_f32 v63, v46, v47
  s_waitcnt lgkmcnt(2)
  v_mfma_f32_32x32x16_bf16 v[32:47], v[72:75], v[96:99], v[128:143]
  ds_read_b128 v[64:67], v2 offset:8192
  ds_read_b128 v[68:71], v2 offset:9216
  v_exp_f32 v16, v16
  v_exp_f32 v17, v17
  v_exp_f32 v18, v18
  s_waitcnt lgkmcnt(2)
  v_mfma_f32_32x32x16_bf16 v[104:119], v[88:91], v[56:59], v[104:119]
  ds_read_b128 v[80:83], v2 offset:2048
  ds_read_b128 v[84:87], v2 offset:3072
  v_exp_f32 v19, v19
  v_exp_f32 v20, v20
  v_exp_f32 v21, v21
  v_cvt_pk_bf16_f32 v48, v16, v17
  v_cvt_pk_bf16_f32 v49, v18, v19
  v_mfma_f32_32x32x16_bf16 v[32:47], v[76:79], v[100:103], v[32:47]
  v_exp_f32 v22, v22
  v_exp_f32 v23, v23
  v_exp_f32 v24, v24
  v_cvt_pk_bf16_f32 v50, v20, v21
  v_mfma_f32_16x16x32_bf16 v[120:123], v[124:127], v[56:59], v[120:123]
  v_exp_f32 v25, v25
  v_exp_f32 v26, v26
  v_cvt_pk_bf16_f32 v51, v22, v23
  v_cvt_pk_bf16_f32 v52, v24, v25
  v_mfma_f32_32x32x16_bf16 v[104:119], v[92:95], v[60:63], v[104:119]
  v_exp_f32 v27, v27
  v_exp_f32 v28, v28
  v_exp_f32 v29, v29
  v_cvt_pk_bf16_f32 v53, v26, v27
  v_mfma_f32_16x16x32_bf16 v[120:123], v[124:127], v[60:63], v[120:123]
  v_exp_f32 v30, v30
  v_exp_f32 v31, v31
  v_cvt_pk_bf16_f32 v54, v28, v29
  v_cvt_pk_bf16_f32 v55, v30, v31
  s_waitcnt lgkmcnt(2)
  v_mfma_f32_32x32x16_bf16 v[16:31], v[64:67], v[96:99], v[128:143]
  ds_read_b128 v[72:75], v2 offset:12288
  ds_read_b128 v[76:79], v2 offset:13312
  v_exp_f32 v32, v32
  v_exp_f32 v33, v33
  v_exp_f32 v34, v34
  s_waitcnt lgkmcnt(2)
  v_mfma_f32_32x32x16_bf16 v[104:119], v[80:83], v[48:51], v[104:119]
  ds_read_b128 v[88:91], v2 offset:6144
  ds_read_b128 v[92:95], v2 offset:7168
  v_exp_f32 v35, v35
  v_exp_f32 v36, v36
  v_exp_f32 v37, v37
  v_cvt_pk_bf16_f32 v56, v32, v33
  v_cvt_pk_bf16_f32 v57, v34, v35
  v_mfma_f32_32x32x16_bf16 v[16:31], v[68:71], v[100:103], v[16:31]
  v_exp_f32 v38, v38
  v_exp_f32 v39, v39
  v_exp_f32 v40, v40
  v_cvt_pk_bf16_f32 v58, v36, v37
  v_mfma_f32_16x16x32_bf16 v[120:123], v[124:127], v[48:51], v[120:123]
  v_exp_f32 v41, v41
  v_exp_f32 v42, v42
  v_cvt_pk_bf16_f32 v59, v38, v39
  v_cvt_pk_bf16_f32 v60, v40, v41
  v_mfma_f32_32x32x16_bf16 v[104:119], v[84:87], v[52:55], v[104:119]
  v_exp_f32 v43, v43
  v_exp_f32 v44, v44
  v_exp_f32 v45, v45
  v_cvt_pk_bf16_f32 v61, v42, v43
  v_mfma_f32_16x16x32_bf16 v[120:123], v[124:127], v[52:55], v[120:123]
  v_exp_f32 v46, v46
  v_exp_f32 v47, v47
  v_cvt_pk_bf16_f32 v62, v44, v45
  v_cvt_pk_bf16_f32 v63, v46, v47
  s_waitcnt vmcnt(10)
  s_barrier
  s_waitcnt lgkmcnt(2)
  v_mfma_f32_32x32x16_bf16 v[32:47], v[72:75], v[96:99], v[128:143]
  ds_read_b128 v[64:67], v2 offset:16384
  ds_read_b128 v[68:71], v2 offset:17408
  v_exp_f32 v16, v16
  v_exp_f32 v17, v17
  v_exp_f32 v18, v18
  s_waitcnt lgkmcnt(2)
  v_mfma_f32_32x32x16_bf16 v[104:119], v[88:91], v[56:59], v[104:119]
  ds_read_b128 v[80:83], v2 offset:10240
  ds_read_b128 v[84:87], v2 offset:11264
  v_exp_f32 v19, v19
  v_exp_f32 v20, v20
  v_exp_f32 v21, v21
  v_cvt_pk_bf16_f32 v48, v16, v17
  v_cvt_pk_bf16_f32 v49, v18, v19
  v_mfma_f32_32x32x16_bf16 v[32:47], v[76:79], v[100:103], v[32:47]
  v_exp_f32 v22, v22
  v_exp_f32 v23, v23
  v_exp_f32 v24, v24
  v_cvt_pk_bf16_f32 v50, v20, v21
  v_mfma_f32_16x16x32_bf16 v[120:123], v[124:127], v[56:59], v[120:123]
  v_exp_f32 v25, v25
  v_exp_f32 v26, v26
  v_cvt_pk_bf16_f32 v51, v22, v23
  v_cvt_pk_bf16_f32 v52, v24, v25
  v_mfma_f32_32x32x16_bf16 v[104:119], v[92:95], v[60:63], v[104:119]
  v_exp_f32 v27, v27
  v_exp_f32 v28, v28
  v_exp_f32 v29, v29
  v_cvt_pk_bf16_f32 v53, v26, v27
  v_mfma_f32_16x16x32_bf16 v[120:123], v[124:127], v[60:63], v[120:123]
  v_exp_f32 v30, v30
  v_exp_f32 v31, v31
  v_cvt_pk_bf16_f32 v54, v28, v29
  v_cvt_pk_bf16_f32 v55, v30, v31
  s_waitcnt lgkmcnt(2)
  v_mfma_f32_32x32x16_bf16 v[16:31], v[64:67], v[96:99], v[128:143]
  ds_read_b128 v[72:75], v2 offset:20480
  ds_read_b128 v[76:79], v2 offset:21504
  v_exp_f32 v32, v32
  v_exp_f32 v33, v33
  v_exp_f32 v34, v34
  s_waitcnt lgkmcnt(2)
  v_mfma_f32_32x32x16_bf16 v[104:119], v[80:83], v[48:51], v[104:119]
  ds_read_b128 v[88:91], v2 offset:14336
  ds_read_b128 v[92:95], v2 offset:15360
  v_exp_f32 v35, v35
  v_exp_f32 v36, v36
  v_exp_f32 v37, v37
  v_cvt_pk_bf16_f32 v56, v32, v33
  v_cvt_pk_bf16_f32 v57, v34, v35
  v_mfma_f32_32x32x16_bf16 v[16:31], v[68:71], v[100:103], v[16:31]
  v_exp_f32 v38, v38
  v_exp_f32 v39, v39
  v_exp_f32 v40, v40
  v_cvt_pk_bf16_f32 v58, v36, v37
  v_mfma_f32_16x16x32_bf16 v[120:123], v[124:127], v[48:51], v[120:123]
  v_exp_f32 v41, v41
  v_exp_f32 v42, v42
  v_cvt_pk_bf16_f32 v59, v38, v39
  v_cvt_pk_bf16_f32 v60, v40, v41
  v_mfma_f32_32x32x16_bf16 v[104:119], v[84:87], v[52:55], v[104:119]
  v_exp_f32 v43, v43
  v_exp_f32 v44, v44
  v_exp_f32 v45, v45
  v_cvt_pk_bf16_f32 v61, v42, v43
  v_mfma_f32_16x16x32_bf16 v[120:123], v[124:127], v[52:55], v[120:123]
  v_exp_f32 v46, v46
  v_exp_f32 v47, v47
  v_cvt_pk_bf16_f32 v62, v44, v45
  v_cvt_pk_bf16_f32 v63, v46, v47
  s_waitcnt lgkmcnt(2)
  v_mfma_f32_32x32x16_bf16 v[32:47], v[72:75], v[96:99], v[128:143]
  ds_read_b128 v[64:67], v2 offset:24576
  ds_read_b128 v[68:71], v2 offset:25600
  v_exp_f32 v16, v16
  v_exp_f32 v17, v17
  v_exp_f32 v18, v18
  s_waitcnt lgkmcnt(2)
  v_mfma_f32_32x32x16_bf16 v[104:119], v[88:91], v[56:59], v[104:119]
  ds_read_b128 v[80:83], v2 offset:18432
  ds_read_b128 v[84:87], v2 offset:19456
  v_exp_f32 v19, v19
  v_exp_f32 v20, v20
  v_exp_f32 v21, v21
  v_cvt_pk_bf16_f32 v48, v16, v17
  v_cvt_pk_bf16_f32 v49, v18, v19
  v_mfma_f32_32x32x16_bf16 v[32:47], v[76:79], v[100:103], v[32:47]
  v_exp_f32 v22, v22
  v_exp_f32 v23, v23
  v_exp_f32 v24, v24
  v_cvt_pk_bf16_f32 v50, v20, v21
  v_mfma_f32_16x16x32_bf16 v[120:123], v[124:127], v[56:59], v[120:123]
  v_exp_f32 v25, v25
  v_exp_f32 v26, v26
  v_cvt_pk_bf16_f32 v51, v22, v23
  v_cvt_pk_bf16_f32 v52, v24, v25
  v_mfma_f32_32x32x16_bf16 v[104:119], v[92:95], v[60:63], v[104:119]
  v_exp_f32 v27, v27
  v_exp_f32 v28, v28
  v_exp_f32 v29, v29
  v_cvt_pk_bf16_f32 v53, v26, v27
  v_mfma_f32_16x16x32_bf16 v[120:123], v[124:127], v[60:63], v[120:123]
  v_exp_f32 v30, v30
  v_exp_f32 v31, v31
  v_cvt_pk_bf16_f32 v54, v28, v29
  v_cvt_pk_bf16_f32 v55, v30, v31
  s_waitcnt lgkmcnt(2)
  v_mfma_f32_32x32x16_bf16 v[16:31], v[64:67], v[96:99], v[128:143]
  ds_read_b128 v[72:75], v2 offset:28672
  ds_read_b128 v[76:79], v2 offset:29696
  v_exp_f32 v32, v32
  v_exp_f32 v33, v33
  v_exp_f32 v34, v34
  s_waitcnt lgkmcnt(2)
  v_mfma_f32_32x32x16_bf16 v[104:119], v[80:83], v[48:51], v[104:119]
  ds_read_b128 v[88:91], v2 offset:22528
  ds_read_b128 v[92:95], v2 offset:23552
  v_exp_f32 v35, v35
  v_exp_f32 v36, v36
  v_exp_f32 v37, v37
  v_cvt_pk_bf16_f32 v56, v32, v33
  v_cvt_pk_bf16_f32 v57, v34, v35
  v_mfma_f32_32x32x16_bf16 v[16:31], v[68:71], v[100:103], v[16:31]
  v_exp_f32 v38, v38
  v_exp_f32 v39, v39
  v_exp_f32 v40, v40
  v_cvt_pk_bf16_f32 v58, v36, v37
  v_mfma_f32_16x16x32_bf16 v[120:123], v[124:127], v[48:51], v[120:123]
  v_exp_f32 v41, v41
  v_exp_f32 v42, v42
  v_cvt_pk_bf16_f32 v59, v38, v39
  v_cvt_pk_bf16_f32 v60, v40, v41
  v_mfma_f32_32x32x16_bf16 v[104:119], v[84:87], v[52:55], v[104:119]
  v_exp_f32 v43, v43
  v_exp_f32 v44, v44
  v_exp_f32 v45, v45
  v_cvt_pk_bf16_f32 v61, v42, v43
  v_mfma_f32_16x16x32_bf16 v[120:123], v[124:127], v[52:55], v[120:123]
  v_exp_f32 v46, v46
  v_exp_f32 v47, v47
  v_cvt_pk_bf16_f32 v62, v44, v45
  v_cvt_pk_bf16_f32 v63, v46, v47
  s_waitcnt vmcnt(7)
  s_barrier
  s_waitcnt lgkmcnt(2)
  v_mfma_f32_32x32x16_bf16 v[32:47], v[72:75], v[96:99], v[128:143]
  ds_read_b128 v[64:67], v2 offset:32768
  ds_read_b128 v[68:71], v2 offset:33792
  v_exp_f32 v16, v16
  v_exp_f32 v17, v17
  v_exp_f32 v18, v18
  s_waitcnt lgkmcnt(2)
  v_mfma_f32_32x32x16_bf16 v[104:119], v[88:91], v[56:59], v[104:119]
  ds_read_b128 v[80:83], v2 offset:26624
  ds_read_b128 v[84:87], v2 offset:27648
  v_exp_f32 v19, v19
  v_exp_f32 v20, v20
  v_exp_f32 v21, v21
  v_cvt_pk_bf16_f32 v48, v16, v17
  v_cvt_pk_bf16_f32 v49, v18, v19
  v_mfma_f32_32x32x16_bf16 v[32:47], v[76:79], v[100:103], v[32:47]
  v_exp_f32 v22, v22
  v_exp_f32 v23, v23
  v_exp_f32 v24, v24
  v_cvt_pk_bf16_f32 v50, v20, v21
  v_mfma_f32_16x16x32_bf16 v[120:123], v[124:127], v[56:59], v[120:123]
  v_exp_f32 v25, v25
  v_exp_f32 v26, v26
  v_cvt_pk_bf16_f32 v51, v22, v23
  v_cvt_pk_bf16_f32 v52, v24, v25
  v_mfma_f32_32x32x16_bf16 v[104:119], v[92:95], v[60:63], v[104:119]
  v_exp_f32 v27, v27
  v_exp_f32 v28, v28
  v_exp_f32 v29, v29
  v_cvt_pk_bf16_f32 v53, v26, v27
  v_mfma_f32_16x16x32_bf16 v[120:123], v[124:127], v[60:63], v[120:123]
  v_exp_f32 v30, v30
  v_exp_f32 v31, v31
  v_cvt_pk_bf16_f32 v54, v28, v29
  v_cvt_pk_bf16_f32 v55, v30, v31
  s_waitcnt lgkmcnt(2)
  v_mfma_f32_32x32x16_bf16 v[16:31], v[64:67], v[96:99], v[128:143]
  ds_read_b128 v[72:75], v2 offset:36864
  ds_read_b128 v[76:79], v2 offset:37888
  v_exp_f32 v32, v32
  v_exp_f32 v33, v33
  v_exp_f32 v34, v34
  s_waitcnt lgkmcnt(2)
  v_mfma_f32_32x32x16_bf16 v[104:119], v[80:83], v[48:51], v[104:119]
  ds_read_b128 v[88:91], v2 offset:30720
  ds_read_b128 v[92:95], v2 offset:31744
  v_exp_f32 v35, v35
  v_exp_f32 v36, v36
  v_exp_f32 v37, v37
  v_cvt_pk_bf16_f32 v56, v32, v33
  v_cvt_pk_bf16_f32 v57, v34, v35
  v_mfma_f32_32x32x16_bf16 v[16:31], v[68:71], v[100:103], v[16:31]
  v_exp_f32 v38, v38
  v_exp_f32 v39, v39
  v_exp_f32 v40, v40
  v_cvt_pk_bf16_f32 v58, v36, v37
  v_mfma_f32_16x16x32_bf16 v[120:123], v[124:127], v[48:51], v[120:123]
  v_exp_f32 v41, v41
  v_exp_f32 v42, v42
  v_cvt_pk_bf16_f32 v59, v38, v39
  v_cvt_pk_bf16_f32 v60, v40, v41
  v_mfma_f32_32x32x16_bf16 v[104:119], v[84:87], v[52:55], v[104:119]
  v_exp_f32 v43, v43
  v_exp_f32 v44, v44
  v_exp_f32 v45, v45
  v_cvt_pk_bf16_f32 v61, v42, v43
  v_mfma_f32_16x16x32_bf16 v[120:123], v[124:127], v[52:55], v[120:123]
  v_exp_f32 v46, v46
  v_exp_f32 v47, v47
  v_cvt_pk_bf16_f32 v62, v44, v45
  v_cvt_pk_bf16_f32 v63, v46, v47
  s_waitcnt lgkmcnt(2)
  v_mfma_f32_32x32x16_bf16 v[32:47], v[72:75], v[96:99], v[128:143]
  ds_read_b128 v[64:67], v2 offset:40960
  ds_read_b128 v[68:71], v2 offset:41984
  v_exp_f32 v16, v16
  v_exp_f32 v17, v17
  v_exp_f32 v18, v18
  s_waitcnt lgkmcnt(2)
  v_mfma_f32_32x32x16_bf16 v[104:119], v[88:91], v[56:59], v[104:119]
  ds_read_b128 v[80:83], v2 offset:34816
  ds_read_b128 v[84:87], v2 offset:35840
  v_exp_f32 v19, v19
  v_exp_f32 v20, v20
  v_exp_f32 v21, v21
  v_cvt_pk_bf16_f32 v48, v16, v17
  v_cvt_pk_bf16_f32 v49, v18, v19
  v_mfma_f32_32x32x16_bf16 v[32:47], v[76:79], v[100:103], v[32:47]
  v_exp_f32 v22, v22
  v_exp_f32 v23, v23
  v_exp_f32 v24, v24
  v_cvt_pk_bf16_f32 v50, v20, v21
  v_mfma_f32_16x16x32_bf16 v[120:123], v[124:127], v[56:59], v[120:123]
  v_exp_f32 v25, v25
  v_exp_f32 v26, v26
  v_cvt_pk_bf16_f32 v51, v22, v23
  v_cvt_pk_bf16_f32 v52, v24, v25
  v_mfma_f32_32x32x16_bf16 v[104:119], v[92:95], v[60:63], v[104:119]
  v_exp_f32 v27, v27
  v_exp_f32 v28, v28
  v_exp_f32 v29, v29
  v_cvt_pk_bf16_f32 v53, v26, v27
  v_mfma_f32_16x16x32_bf16 v[120:123], v[124:127], v[60:63], v[120:123]
  v_exp_f32 v30, v30
  v_exp_f32 v31, v31
  v_cvt_pk_bf16_f32 v54, v28, v29
  v_cvt_pk_bf16_f32 v55, v30, v31
  s_waitcnt lgkmcnt(2)
  v_mfma_f32_32x32x16_bf16 v[16:31], v[64:67], v[96:99], v[128:143]
  ds_read_b128 v[72:75], v2 offset:45056
  ds_read_b128 v[76:79], v2 offset:46080
  v_exp_f32 v32, v32
  v_exp_f32 v33, v33
  v_exp_f32 v34, v34
  s_waitcnt lgkmcnt(2)
  v_mfma_f32_32x32x16_bf16 v[104:119], v[80:83], v[48:51], v[104:119]
  ds_read_b128 v[88:91], v2 offset:38912
  ds_read_b128 v[92:95], v2 offset:39936
  v_exp_f32 v35, v35
  v_exp_f32 v36, v36
  v_exp_f32 v37, v37
  v_cvt_pk_bf16_f32 v56, v32, v33
  v_cvt_pk_bf16_f32 v57, v34, v35
  v_mfma_f32_32x32x16_bf16 v[16:31], v[68:71], v[100:103], v[16:31]
  v_exp_f32 v38, v38
  v_exp_f32 v39, v39
  v_exp_f32 v40, v40
  v_cvt_pk_bf16_f32 v58, v36, v37
  v_mfma_f32_16x16x32_bf16 v[120:123], v[124:127], v[48:51], v[120:123]
  v_exp_f32 v41, v41
  v_exp_f32 v42, v42
  v_cvt_pk_bf16_f32 v59, v38, v39
  v_cvt_pk_bf16_f32 v60, v40, v41
  v_mfma_f32_32x32x16_bf16 v[104:119], v[84:87], v[52:55], v[104:119]
  v_exp_f32 v43, v43
  v_exp_f32 v44, v44
  v_exp_f32 v45, v45
  v_cvt_pk_bf16_f32 v61, v42, v43
  v_mfma_f32_16x16x32_bf16 v[120:123], v[124:127], v[52:55], v[120:123]
  v_exp_f32 v46, v46
  v_exp_f32 v47, v47
  v_cvt_pk_bf16_f32 v62, v44, v45
  v_cvt_pk_bf16_f32 v63, v46, v47
  s_waitcnt vmcnt(3)
  s_barrier
  s_waitcnt lgkmcnt(2)
  v_mfma_f32_32x32x16_bf16 v[32:47], v[72:75], v[96:99], v[128:143]
  ds_read_b128 v[64:67], v2 offset:49152
  ds_read_b128 v[68:71], v2 offset:50176
  v_exp_f32 v16, v16
  v_exp_f32 v17, v17
  v_exp_f32 v18, v18
  s_waitcnt lgkmcnt(2)
  v_mfma_f32_32x32x16_bf16 v[104:119], v[88:91], v[56:59], v[104:119]
  ds_read_b128 v[80:83], v2 offset:43008
  ds_read_b128 v[84:87], v2 offset:44032
  v_exp_f32 v19, v19
  v_exp_f32 v20, v20
  v_exp_f32 v21, v21
  v_cvt_pk_bf16_f32 v48, v16, v17
  v_cvt_pk_bf16_f32 v49, v18, v19
  v_mfma_f32_32x32x16_bf16 v[32:47], v[76:79], v[100:103], v[32:47]
  v_exp_f32 v22, v22
  v_exp_f32 v23, v23
  v_exp_f32 v24, v24
  v_cvt_pk_bf16_f32 v50, v20, v21
  v_mfma_f32_16x16x32_bf16 v[120:123], v[124:127], v[56:59], v[120:123]
  v_exp_f32 v25, v25
  v_exp_f32 v26, v26
  v_cvt_pk_bf16_f32 v51, v22, v23
  v_cvt_pk_bf16_f32 v52, v24, v25
  v_mfma_f32_32x32x16_bf16 v[104:119], v[92:95], v[60:63], v[104:119]
  v_exp_f32 v27, v27
  v_exp_f32 v28, v28
  v_exp_f32 v29, v29
  v_cvt_pk_bf16_f32 v53, v26, v27
  v_mfma_f32_16x16x32_bf16 v[120:123], v[124:127], v[60:63], v[120:123]
  v_exp_f32 v30, v30
  v_exp_f32 v31, v31
  v_cvt_pk_bf16_f32 v54, v28, v29
  v_cvt_pk_bf16_f32 v55, v30, v31
  s_waitcnt lgkmcnt(2)
  v_mfma_f32_32x32x16_bf16 v[16:31], v[64:67], v[96:99], v[128:143]
  ds_read_b128 v[72:75], v2 offset:53248
  ds_read_b128 v[76:79], v2 offset:54272
  v_exp_f32 v32, v32
  v_exp_f32 v33, v33
  v_exp_f32 v34, v34
  s_waitcnt lgkmcnt(2)
  v_mfma_f32_32x32x16_bf16 v[104:119], v[80:83], v[48:51], v[104:119]
  ds_read_b128 v[88:91], v2 offset:47104
  ds_read_b128 v[92:95], v2 offset:48128
  v_exp_f32 v35, v35
  v_exp_f32 v36, v36
  v_exp_f32 v37, v37
  v_cvt_pk_bf16_f32 v56, v32, v33
  v_cvt_pk_bf16_f32 v57, v34, v35
  v_mfma_f32_32x32x16_bf16 v[16:31], v[68:71], v[100:103], v[16:31]
  v_exp_f32 v38, v38
  v_exp_f32 v39, v39
  v_exp_f32 v40, v40
  v_cvt_pk_bf16_f32 v58, v36, v37
  v_mfma_f32_16x16x32_bf16 v[120:123], v[124:127], v[48:51], v[120:123]
  v_exp_f32 v41, v41
  v_exp_f32 v42, v42
  v_cvt_pk_bf16_f32 v59, v38, v39
  v_cvt_pk_bf16_f32 v60, v40, v41
  v_mfma_f32_32x32x16_bf16 v[104:119], v[84:87], v[52:55], v[104:119]
  v_exp_f32 v43, v43
  v_exp_f32 v44, v44
  v_exp_f32 v45, v45
  v_cvt_pk_bf16_f32 v61, v42, v43
  v_mfma_f32_16x16x32_bf16 v[120:123], v[124:127], v[52:55], v[120:123]
  v_exp_f32 v46, v46
  v_exp_f32 v47, v47
  v_cvt_pk_bf16_f32 v62, v44, v45
  v_cvt_pk_bf16_f32 v63, v46, v47
  s_waitcnt lgkmcnt(2)
  v_mfma_f32_32x32x16_bf16 v[32:47], v[72:75], v[96:99], v[128:143]
  ds_read_b128 v[64:67], v2 offset:57344
  ds_read_b128 v[68:71], v2 offset:58368
  v_exp_f32 v16, v16
  v_exp_f32 v17, v17
  v_exp_f32 v18, v18
  s_waitcnt lgkmcnt(2)
  v_mfma_f32_32x32x16_bf16 v[104:119], v[88:91], v[56:59], v[104:119]
  ds_read_b128 v[80:83], v2 offset:51200
  ds_read_b128 v[84:87], v2 offset:52224
  v_exp_f32 v19, v19
  v_exp_f32 v20, v20
  v_exp_f32 v21, v21
  v_cvt_pk_bf16_f32 v48, v16, v17
  v_cvt_pk_bf16_f32 v49, v18, v19
  v_mfma_f32_32x32x16_bf16 v[32:47], v[76:79], v[100:103], v[32:47]
  v_exp_f32 v22, v22
  v_exp_f32 v23, v23
  v_exp_f32 v24, v24
  v_cvt_pk_bf16_f32 v50, v20, v21
  v_mfma_f32_16x16x32_bf16 v[120:123], v[124:127], v[56:59], v[120:123]
  v_exp_f32 v25, v25
  v_exp_f32 v26, v26
  v_cvt_pk_bf16_f32 v51, v22, v23
  v_cvt_pk_bf16_f32 v52, v24, v25
  v_mfma_f32_32x32x16_bf16 v[104:119], v[92:95], v[60:63], v[104:119]
  v_exp_f32 v27, v27
  v_exp_f32 v28, v28
  v_exp_f32 v29, v29
  v_cvt_pk_bf16_f32 v53, v26, v27
  v_mfma_f32_16x16x32_bf16 v[120:123], v[124:127], v[60:63], v[120:123]
  v_exp_f32 v30, v30
  v_exp_f32 v31, v31
  v_cvt_pk_bf16_f32 v54, v28, v29
  v_cvt_pk_bf16_f32 v55, v30, v31
  s_waitcnt lgkmcnt(2)
  v_mfma_f32_32x32x16_bf16 v[16:31], v[64:67], v[96:99], v[128:143]
  ds_read_b128 v[72:75], v2 offset:61440
  ds_read_b128 v[76:79], v2 offset:62464
  v_exp_f32 v32, v32
  v_exp_f32 v33, v33
  v_exp_f32 v34, v34
  s_waitcnt lgkmcnt(2)
  v_mfma_f32_32x32x16_bf16 v[104:119], v[80:83], v[48:51], v[104:119]
  ds_read_b128 v[88:91], v2 offset:55296
  ds_read_b128 v[92:95], v2 offset:56320
  v_exp_f32 v35, v35
  v_exp_f32 v36, v36
  v_exp_f32 v37, v37
  v_cvt_pk_bf16_f32 v56, v32, v33
  v_cvt_pk_bf16_f32 v57, v34, v35
  v_mfma_f32_32x32x16_bf16 v[16:31], v[68:71], v[100:103], v[16:31]
  v_exp_f32 v38, v38
  v_exp_f32 v39, v39
  v_exp_f32 v40, v40
  v_cvt_pk_bf16_f32 v58, v36, v37
  v_mfma_f32_16x16x32_bf16 v[120:123], v[124:127], v[48:51], v[120:123]
  v_exp_f32 v41, v41
  v_exp_f32 v42, v42
  v_cvt_pk_bf16_f32 v59, v38, v39
  v_cvt_pk_bf16_f32 v60, v40, v41
  v_mfma_f32_32x32x16_bf16 v[104:119], v[84:87], v[52:55], v[104:119]
  v_exp_f32 v43, v43
  v_exp_f32 v44, v44
  v_exp_f32 v45, v45
  v_cvt_pk_bf16_f32 v61, v42, v43
  v_mfma_f32_16x16x32_bf16 v[120:123], v[124:127], v[52:55], v[120:123]
  v_exp_f32 v46, v46
  v_exp_f32 v47, v47
  v_cvt_pk_bf16_f32 v62, v44, v45
  v_cvt_pk_bf16_f32 v63, v46, v47
  s_waitcnt lgkmcnt(2)
  v_mfma_f32_32x32x16_bf16 v[32:47], v[72:75], v[96:99], v[128:143]
  v_exp_f32 v16, v16
  v_exp_f32 v17, v17
  v_exp_f32 v18, v18
  s_waitcnt lgkmcnt(0)
  v_mfma_f32_32x32x16_bf16 v[104:119], v[88:91], v[56:59], v[104:119]
  ds_read_b128 v[80:83], v2 offset:59392
  ds_read_b128 v[84:87], v2 offset:60416
  v_exp_f32 v19, v19
  v_exp_f32 v20, v20
  v_exp_f32 v21, v21
  v_cvt_pk_bf16_f32 v48, v16, v17
  v_cvt_pk_bf16_f32 v49, v18, v19
  v_mfma_f32_32x32x16_bf16 v[32:47], v[76:79], v[100:103], v[32:47]
  v_exp_f32 v22, v22
  v_exp_f32 v23, v23
  v_exp_f32 v24, v24
  v_cvt_pk_bf16_f32 v50, v20, v21
  v_mfma_f32_16x16x32_bf16 v[120:123], v[124:127], v[56:59], v[120:123]
  v_exp_f32 v25, v25
  v_exp_f32 v26, v26
  v_cvt_pk_bf16_f32 v51, v22, v23
  v_cvt_pk_bf16_f32 v52, v24, v25
  v_mfma_f32_32x32x16_bf16 v[104:119], v[92:95], v[60:63], v[104:119]
  v_exp_f32 v27, v27
  v_exp_f32 v28, v28
  v_exp_f32 v29, v29
  v_cvt_pk_bf16_f32 v53, v26, v27
  v_mfma_f32_16x16x32_bf16 v[120:123], v[124:127], v[60:63], v[120:123]
  v_exp_f32 v30, v30
  v_exp_f32 v31, v31
  v_cvt_pk_bf16_f32 v54, v28, v29
  v_cvt_pk_bf16_f32 v55, v30, v31
  v_exp_f32 v32, v32
  v_exp_f32 v33, v33
  v_exp_f32 v34, v34
  s_waitcnt lgkmcnt(0)
  v_mfma_f32_32x32x16_bf16 v[104:119], v[80:83], v[48:51], v[104:119]
  ds_read_b128 v[88:91], v2 offset:63488
  ds_read_b128 v[92:95], v2 offset:64512
  v_exp_f32 v35, v35
  v_exp_f32 v36, v36
  v_exp_f32 v37, v37
  v_cvt_pk_bf16_f32 v56, v32, v33
  v_cvt_pk_bf16_f32 v57, v34, v35
  v_exp_f32 v38, v38
  v_exp_f32 v39, v39
  v_exp_f32 v40, v40
  v_cvt_pk_bf16_f32 v58, v36, v37
  v_mfma_f32_16x16x32_bf16 v[120:123], v[124:127], v[48:51], v[120:123]
  v_exp_f32 v41, v41
  v_exp_f32 v42, v42
  v_cvt_pk_bf16_f32 v59, v38, v39
  v_cvt_pk_bf16_f32 v60, v40, v41
  v_mfma_f32_32x32x16_bf16 v[104:119], v[84:87], v[52:55], v[104:119]
  v_exp_f32 v43, v43
  v_exp_f32 v44, v44
  v_exp_f32 v45, v45
  v_cvt_pk_bf16_f32 v61, v42, v43
  v_mfma_f32_16x16x32_bf16 v[120:123], v[124:127], v[52:55], v[120:123]
  v_exp_f32 v46, v46
  v_exp_f32 v47, v47
  v_cvt_pk_bf16_f32 v62, v44, v45
  v_cvt_pk_bf16_f32 v63, v46, v47
  s_waitcnt lgkmcnt(0)
  v_mfma_f32_32x32x16_bf16 v[104:119], v[88:91], v[56:59], v[104:119]
  v_mfma_f32_16x16x32_bf16 v[120:123], v[124:127], v[56:59], v[120:123]
  v_mfma_f32_32x32x16_bf16 v[104:119], v[92:95], v[60:63], v[104:119]
  v_mfma_f32_16x16x32_bf16 v[120:123], v[124:127], v[60:63], v[120:123]
  s_add_u32 s20, s4, 13631488
  s_addc_u32 s21, s5, 0
  s_and_b32 s21, s21, 0xffff
  s_mov_b32 s22, 4194304
  s_mov_b32 s23, 0x00020000
  s_nop 2
  v_rcp_f32 v10, v120
  s_nop 1
  v_mul_f32 v104, v104, v10
  v_mul_f32 v105, v105, v10
  v_mul_f32 v106, v106, v10
  v_mul_f32 v107, v107, v10
  v_mul_f32 v108, v108, v10
  v_mul_f32 v109, v109, v10
  v_mul_f32 v110, v110, v10
  v_mul_f32 v111, v111, v10
  v_mul_f32 v112, v112, v10
  v_mul_f32 v113, v113, v10
  v_mul_f32 v114, v114, v10
  v_mul_f32 v115, v115, v10
  v_mul_f32 v116, v116, v10
  v_mul_f32 v117, v117, v10
  v_mul_f32 v118, v118, v10
  v_mul_f32 v119, v119, v10
  v_cvt_pk_bf16_f32 v48, v104, v105
  v_cvt_pk_bf16_f32 v49, v106, v107
  v_cvt_pk_bf16_f32 v50, v108, v109
  v_cvt_pk_bf16_f32 v51, v110, v111
  v_cvt_pk_bf16_f32 v52, v112, v113
  v_cvt_pk_bf16_f32 v53, v114, v115
  v_cvt_pk_bf16_f32 v54, v116, v117
  v_cvt_pk_bf16_f32 v55, v118, v119
  s_lshl_b32 s30, s14, 16
  s_lshl_b32 s31, s15, 11
  s_add_u32 s30, s30, s31
  buffer_store_dwordx4 v[48:51], v2, s[20:23], s30 offen sc1
  buffer_store_dwordx4 v[52:55], v2, s[20:23], s30 offen offset:1024 sc1
k3_end:
  s_endpgm
.globl k4_kernel
.p2align 8
.type k4_kernel,@function
k4_kernel:
  s_cmp_ge_u32 s2, 256
  s_cbranch_scc1 k4_end
  s_load_dwordx2 s[4:5], s[0:1], 104
  s_load_dwordx2 s[12:13], s[0:1], 0
  s_load_dwordx2 s[14:15], s[0:1], 32
  v_and_b32 v1, 63, v0
  v_lshrrev_b32 v10, 6, v0
  v_lshlrev_b32 v2, 4, v1
  v_readfirstlane_b32 s3, v10
  s_and_b32 s6, s2, 7
  s_lshr_b32 s7, s2, 3
  s_lshr_b32 s8, s6, 1
  s_lshl_b32 s8, s8, 2
  s_and_b32 s10, s7, 3
  s_add_u32 s8, s8, s10
  s_and_b32 s9, s6, 1
  s_lshl_b32 s9, s9, 3
  s_lshr_b32 s10, s7, 2
  s_add_u32 s9, s9, s10
  s_lshr_b32 s11, s3, 2
  s_and_b32 s7, s3, 3
  s_waitcnt lgkmcnt(0)
  s_mov_b32 s16, s14
  s_and_b32 s17, s15, 0xffff
  s_mov_b32 s18, 2097152
  s_mov_b32 s19, 0x00020000
  s_add_u32 s20, s4, 13631488
  s_addc_u32 s21, s5, 0
  s_and_b32 s21, s21, 0xffff
  s_mov_b32 s22, 4194304
  s_mov_b32 s23, 0x00020000
  v_lshrrev_b32 v10, 3, v1
  v_lshlrev_b32 v5, 11, v10
  v_and_b32 v10, 7, v1
  v_bfe_u32 v12, v1, 4, 1
  v_lshlrev_b32 v12, 2, v12
  v_xor_b32 v10, v10, v12
  v_lshl_add_u32 v5, v10, 4, v5
  v_bfe_u32 v10, v1, 2, 2
  v_lshrrev_b32 v12, 5, v1
  v_lshl_add_u32 v12, v12, 2, v10
  v_lshlrev_b32 v13, 7, v12
  v_and_b32 v12, 3, v1
  v_lshl_add_u32 v13, v12, 3, v13
  v_bfe_u32 v12, v1, 4, 1
  v_lshl_add_u32 v13, v12, 5, v13
  s_lshl_b32 s31, s11, 11
  v_add_u32 v13, s31, v13
  v_lshrrev_b32 v10, 1, v10
  v_xor_b32 v12, 0, v10
  v_lshl_add_u32 v3, v12, 6, v13
  v_xor_b32 v12, 1, v10
  v_lshl_add_u32 v4, v12, 6, v13
  s_lshl_b32 s29, s3, 11
  s_lshl_b32 s28, s3, 15
  s_lshl_b32 s30, s9, 7
  s_add_u32 s28, s28, s30
  s_lshl_b32 s30, s8, 2
  s_add_u32 s30, s30, s7
  s_lshl_b32 s33, s30, 16
  s_lshl_b32 s30, s11, 10
  s_add_u32 s30, s30, s33
  s_add_u32 m0, s29, 0
  s_add_u32 s31, s28, 0
  buffer_load_dwordx4 v5, s[16:19], s31 offen lds
  s_add_u32 m0, s29, 1024
  s_add_u32 s31, s28, 16384
  buffer_load_dwordx4 v5, s[16:19], s31 offen lds
  buffer_load_dwordx4 v[72:75], v2, s[20:23], s30 offen offset:0
  buffer_load_dwordx4 v[76:79], v2, s[20:23], s30 offen offset:2048
  s_add_u32 s30, s30, 4096
  buffer_load_dwordx4 v[80:83], v2, s[20:23], s30 offen offset:0
  buffer_load_dwordx4 v[84:87], v2, s[20:23], s30 offen offset:2048
  s_add_u32 s30, s30, 4096
  buffer_load_dwordx4 v[88:91], v2, s[20:23], s30 offen offset:0
  buffer_load_dwordx4 v[92:95], v2, s[20:23], s30 offen offset:2048
  s_mov_b32 s36, s12
  s_and_b32 s37, s13, 0xffff
  s_mov_b32 s38, 4194304
  s_mov_b32 s39, 0x00020000
  s_mov_b32 s40, s4
  s_and_b32 s41, s5, 0xffff
  s_mov_b32 s42, 24576
  s_mov_b32 s43, 0x00020000
  s_add_u32 s52, s4, 1048576
  s_addc_u32 s53, s5, 0
  s_and_b32 s53, s53, 0xffff
  s_mov_b32 s54, 917504
  s_mov_b32 s55, 0x00020000
  v_and_b32 v12, 31, v1
  v_lshrrev_b32 v6, 5, v1
  s_lshr_b32 s34, s33, 11
  v_add_u32 v7, s34, v12
  v_lshlrev_b32 v8, 11, v7
  v_lshl_add_u32 v8, v6, 4, v8
  s_lshl_b32 s35, s9, 7
  s_lshl_b32 s46, s11, 6
  s_add_u32 s35, s35, s46
  v_and_b32 v9, 15, v1
  v_lshlrev_b32 v9, 4, v9
  v_bfe_u32 v11, v1, 4, 1
  v_lshl_add_u32 v9, v11, 13, v9
  v_cmp_gt_u32 vcc, 32, v1
  v_mov_b32 v11, 0x7ff00000
  s_nop 0
  v_cndmask_b32 v9, v11, v9, vcc
  s_lshl_b32 s48, s9, 8
  s_add_u32 s48, s48, 8192
  v_lshlrev_b32 v11, 4, v6
  s_lshl_b32 s46, s11, 7
  s_add_u32 s46, s46, 65536
  v_add_u32 v11, s46, v11
  v_lshrrev_b32 v10, 3, v0
  s_mul_i32 s50, s2, 28
  v_cmp_gt_u32 vcc, 28, v10
  v_add_u32 v10, s50, v10
  v_lshrrev_b32 v13, 5, v10
  v_lshlrev_b32 v13, 4, v13
  v_and_b32 v14, 15, v10
  v_add_u32 v13, v13, v14
  v_bfe_u32 v14, v10, 4, 1
  v_and_b32 v15, 1, v0
  v_lshl_add_u32 v14, v15, 1, v14
  v_mul_u32_u24 v14, 3584, v14
  v_add_u32 v13, v13, v14
  v_bfe_u32 v14, v0, 1, 2
  v_mul_u32_u24 v14, 57344, v14
  v_add_u32 v13, v13, v14
  v_lshlrev_b32 v13, 2, v13
  v_mov_b32 v14, 0x7ff00000
  v_cndmask_b32 v13, v14, v13, vcc
  v_cndmask_b32 v10, v14, v10, vcc
  buffer_load_dwordx4 v[136:139], v8, s[36:39], s35 offen offset:0
  buffer_load_dwordx4 v[140:143], v8, s[36:39], s35 offen offset:32
  s_mov_b32 m0, 65536
  s_nop 0
  buffer_load_dwordx4 v9, s[40:43], s48 offen lds
  s_mov_b32 s50, 0
  buffer_load_dword v176, v13, s[52:55], s50 offen
  s_add_u32 s50, s50, 57344
  buffer_load_dword v177, v13, s[52:55], s50 offen
  s_add_u32 s50, s50, 57344
  buffer_load_dword v178, v13, s[52:55], s50 offen
  s_add_u32 s50, s50, 57344
  buffer_load_dword v179, v13, s[52:55], s50 offen
  s_add_u32 s50, s50, 57344
  s_waitcnt vmcnt(13)
  s_barrier
  ds_read_b64_tr_b16 v[48:49], v3 offset:0
  ds_read_b64_tr_b16 v[50:51], v3 offset:1024
  ds_read_b64_tr_b16 v[52:53], v4 offset:0
  ds_read_b64_tr_b16 v[54:55], v4 offset:1024
  ds_read_b64_tr_b16 v[56:57], v3 offset:4096
  ds_read_b64_tr_b16 v[58:59], v3 offset:5120
  ds_read_b64_tr_b16 v[60:61], v4 offset:4096
  ds_read_b64_tr_b16 v[62:63], v4 offset:5120
  s_waitcnt vmcnt(12)
  s_waitcnt lgkmcnt(6)
  v_mfma_f32_32x32x16_bf16 v[16:31], v[48:51], v[72:75], 0
  ds_read_b64_tr_b16 v[64:65], v3 offset:8192
  ds_read_b64_tr_b16 v[66:67], v3 offset:9216
  ds_read_b64_tr_b16 v[68:69], v4 offset:8192
  ds_read_b64_tr_b16 v[70:71], v4 offset:9216
  s_add_u32 m0, s29, 16384
  s_add_u32 s31, s28, 262144
  buffer_load_dwordx4 v5, s[16:19], s31 offen lds
  s_waitcnt lgkmcnt(8)
  v_mfma_f32_32x32x16_bf16 v[32:47], v[52:55], v[72:75], 0
  s_add_u32 m0, s29, 17408
  s_add_u32 s31, s28, 278528
  buffer_load_dwordx4 v5, s[16:19], s31 offen lds
  s_add_u32 m0, s29, 32768
  s_add_u32 s31, s28, 524288
  buffer_load_dwordx4 v5, s[16:19], s31 offen lds
  s_add_u32 m0, s29, 33792
  s_add_u32 s31, s28, 540672
  buffer_load_dwordx4 v5, s[16:19], s31 offen lds
  s_waitcnt vmcnt(15)
  s_waitcnt lgkmcnt(6)
  v_mfma_f32_32x32x16_bf16 v[16:31], v[56:59], v[76:79], v[16:31]
  ds_read_b64_tr_b16 v[48:49], v3 offset:12288
  ds_read_b64_tr_b16 v[50:51], v3 offset:13312
  ds_read_b64_tr_b16 v[52:53], v4 offset:12288
  ds_read_b64_tr_b16 v[54:55], v4 offset:13312
  s_add_u32 s30, s30, 4096
  buffer_load_dwordx4 v[96:99], v2, s[20:23], s30 offen offset:0
  s_waitcnt lgkmcnt(8)
  v_mfma_f32_32x32x16_bf16 v[32:47], v[60:63], v[76:79], v[32:47]
  buffer_load_dwordx4 v[100:103], v2, s[20:23], s30 offen offset:2048
  s_add_u32 s30, s30, 4096
  buffer_load_dwordx4 v[104:107], v2, s[20:23], s30 offen offset:0
  buffer_load_dwordx4 v[108:111], v2, s[20:23], s30 offen offset:2048
  s_waitcnt vmcnt(18)
  s_waitcnt lgkmcnt(6)
  v_mfma_f32_32x32x16_bf16 v[16:31], v[64:67], v[80:83], v[16:31]
  s_waitcnt vmcnt(6)
  s_barrier
  s_waitcnt lgkmcnt(4)
  v_mfma_f32_32x32x16_bf16 v[32:47], v[68:71], v[80:83], v[32:47]
  ds_read_b64_tr_b16 v[56:57], v3 offset:16384
  ds_read_b64_tr_b16 v[58:59], v3 offset:17408
  ds_read_b64_tr_b16 v[60:61], v4 offset:16384
  ds_read_b64_tr_b16 v[62:63], v4 offset:17408
  s_add_u32 m0, s29, 49152
  s_add_u32 s31, s28, 786432
  buffer_load_dwordx4 v5, s[16:19], s31 offen lds
  s_add_u32 m0, s29, 50176
  s_add_u32 s31, s28, 802816
  buffer_load_dwordx4 v5, s[16:19], s31 offen lds
  s_add_u32 s30, s30, 4096
  buffer_load_dwordx4 v[112:115], v2, s[20:23], s30 offen offset:0
  buffer_load_dwordx4 v[116:119], v2, s[20:23], s30 offen offset:2048
  s_waitcnt lgkmcnt(6)
  v_mfma_f32_32x32x16_bf16 v[16:31], v[48:51], v[84:87], v[16:31]
  ds_read_b64_tr_b16 v[64:65], v3 offset:20480
  ds_read_b64_tr_b16 v[66:67], v3 offset:21504
  ds_read_b64_tr_b16 v[68:69], v4 offset:20480
  ds_read_b64_tr_b16 v[70:71], v4 offset:21504
  s_add_u32 s30, s30, 4096
  buffer_load_dwordx4 v[120:123], v2, s[20:23], s30 offen offset:0
  s_waitcnt lgkmcnt(8)
  v_mfma_f32_32x32x16_bf16 v[32:47], v[52:55], v[84:87], v[32:47]
  buffer_load_dwordx4 v[124:127], v2, s[20:23], s30 offen offset:2048
  s_add_u32 s30, s30, 4096
  buffer_load_dwordx4 v[128:131], v2, s[20:23], s30 offen offset:0
  buffer_load_dwordx4 v[132:135], v2, s[20:23], s30 offen offset:2048
  s_waitcnt lgkmcnt(6)
  v_mfma_f32_32x32x16_bf16 v[16:31], v[56:59], v[88:91], v[16:31]
  ds_read_b64_tr_b16 v[48:49], v3 offset:24576
  ds_read_b64_tr_b16 v[50:51], v3 offset:25600
  ds_read_b64_tr_b16 v[52:53], v4 offset:24576
  ds_read_b64_tr_b16 v[54:55], v4 offset:25600
  s_add_u32 s30, s30, 4096
  buffer_load_dwordx4 v[72:75], v2, s[20:23], s30 offen offset:0
  s_waitcnt lgkmcnt(8)
  v_mfma_f32_32x32x16_bf16 v[32:47], v[60:63], v[88:91], v[32:47]
  buffer_load_dwordx4 v[76:79], v2, s[20:23], s30 offen offset:2048
  s_add_u32 s30, s30, 4096
  buffer_load_dwordx4 v[80:83], v2, s[20:23], s30 offen offset:0
  buffer_load_dwordx4 v[84:87], v2, s[20:23], s30 offen offset:2048
  s_waitcnt lgkmcnt(6)
  v_mfma_f32_32x32x16_bf16 v[16:31], v[64:67], v[92:95], v[16:31]
  ds_read_b64_tr_b16 v[56:57], v3 offset:28672
  ds_read_b64_tr_b16 v[58:59], v3 offset:29696
  ds_read_b64_tr_b16 v[60:61], v4 offset:28672
  ds_read_b64_tr_b16 v[62:63], v4 offset:29696
  s_waitcnt lgkmcnt(8)
  v_mfma_f32_32x32x16_bf16 v[32:47], v[68:71], v[92:95], v[32:47]
  s_add_u32 s30, s30, 4096
  buffer_load_dwordx4 v[88:91], v2, s[20:23], s30 offen offset:0
  s_waitcnt vmcnt(16)
  s_waitcnt lgkmcnt(6)
  v_mfma_f32_32x32x16_bf16 v[16:31], v[48:51], v[96:99], v[16:31]
  s_barrier
  s_waitcnt lgkmcnt(4)
  v_mfma_f32_32x32x16_bf16 v[32:47], v[52:55], v[96:99], v[32:47]
  ds_read_b64_tr_b16 v[64:65], v3 offset:32768
  ds_read_b64_tr_b16 v[66:67], v3 offset:33792
  ds_read_b64_tr_b16 v[68:69], v4 offset:32768
  ds_read_b64_tr_b16 v[70:71], v4 offset:33792
  s_add_u32 m0, s29, 0
  s_add_u32 s31, s28, 1048576
  buffer_load_dwordx4 v5, s[16:19], s31 offen lds
  s_add_u32 m0, s29, 1024
  s_add_u32 s31, s28, 1064960
  buffer_load_dwordx4 v5, s[16:19], s31 offen lds
  buffer_load_dwordx4 v[92:95], v2, s[20:23], s30 offen offset:2048
  s_waitcnt vmcnt(18)
  s_waitcnt lgkmcnt(6)
  v_mfma_f32_32x32x16_bf16 v[16:31], v[56:59], v[100:103], v[16:31]
  ds_read_b64_tr_b16 v[48:49], v3 offset:36864
  ds_read_b64_tr_b16 v[50:51], v3 offset:37888
  ds_read_b64_tr_b16 v[52:53], v4 offset:36864
  ds_read_b64_tr_b16 v[54:55], v4 offset:37888
  s_waitcnt lgkmcnt(8)
  v_mfma_f32_32x32x16_bf16 v[32:47], v[60:63], v[100:103], v[32:47]
  s_add_u32 s30, s30, 4096
  buffer_load_dwordx4 v[96:99], v2, s[20:23], s30 offen offset:0
  s_waitcnt vmcnt(18)
  s_waitcnt lgkmcnt(6)
  v_mfma_f32_32x32x16_bf16 v[16:31], v[64:67], v[104:107], v[16:31]
  ds_read_b64_tr_b16 v[56:57], v3 offset:40960
  ds_read_b64_tr_b16 v[58:59], v3 offset:41984
  ds_read_b64_tr_b16 v[60:61], v4 offset:40960
  ds_read_b64_tr_b16 v[62:63], v4 offset:41984
  s_waitcnt lgkmcnt(8)
  v_mfma_f32_32x32x16_bf16 v[32:47], v[68:71], v[104:107], v[32:47]
  buffer_load_dwordx4 v[100:103], v2, s[20:23], s30 offen offset:2048
  s_waitcnt vmcnt(18)
  s_waitcnt lgkmcnt(6)
  v_mfma_f32_32x32x16_bf16 v[16:31], v[48:51], v[108:111], v[16:31]
  ds_read_b64_tr_b16 v[64:65], v3 offset:45056
  ds_read_b64_tr_b16 v[66:67], v3 offset:46080
  ds_read_b64_tr_b16 v[68:69], v4 offset:45056
  ds_read_b64_tr_b16 v[70:71], v4 offset:46080
  s_waitcnt lgkmcnt(8)
  v_mfma_f32_32x32x16_bf16 v[32:47], v[52:55], v[108:111], v[32:47]
  s_add_u32 s30, s30, 4096
  buffer_load_dwordx4 v[104:107], v2, s[20:23], s30 offen offset:0
  s_waitcnt vmcnt(16)
  s_waitcnt lgkmcnt(6)
  v_mfma_f32_32x32x16_bf16 v[16:31], v[56:59], v[112:115], v[16:31]
  s_barrier
  s_waitcnt lgkmcnt(4)
  v_mfma_f32_32x32x16_bf16 v[32:47], v[60:63], v[112:115], v[32:47]
  ds_read_b64_tr_b16 v[48:49], v3 offset:49152
  ds_read_b64_tr_b16 v[50:51], v3 offset:50176
  ds_read_b64_tr_b16 v[52:53], v4 offset:49152
  ds_read_b64_tr_b16 v[54:55], v4 offset:50176
  s_add_u32 m0, s29, 16384
  s_add_u32 s31, s28, 1310720
  buffer_load_dwordx4 v5, s[16:19], s31 offen lds
  s_add_u32 m0, s29, 17408
  s_add_u32 s31, s28, 1327104
  buffer_load_dwordx4 v5, s[16:19], s31 offen lds
  buffer_load_dwordx4 v[108:111], v2, s[20:23], s30 offen offset:2048
  s_waitcnt vmcnt(18)
  s_waitcnt lgkmcnt(6)
  v_mfma_f32_32x32x16_bf16 v[16:31], v[64:67], v[116:119], v[16:31]
  ds_read_b64_tr_b16 v[56:57], v3 offset:53248
  ds_read_b64_tr_b16 v[58:59], v3 offset:54272
  ds_read_b64_tr_b16 v[60:61], v4 offset:53248
  ds_read_b64_tr_b16 v[62:63], v4 offset:54272
  s_waitcnt lgkmcnt(8)
  v_mfma_f32_32x32x16_bf16 v[32:47], v[68:71], v[116:119], v[32:47]
  s_add_u32 s30, s30, 4096
  buffer_load_dwordx4 v[112:115], v2, s[20:23], s30 offen offset:0
  s_waitcnt vmcnt(18)
  s_waitcnt lgkmcnt(6)
  v_mfma_f32_32x32x16_bf16 v[16:31], v[48:51], v[120:123], v[16:31]
  ds_read_b64_tr_b16 v[64:65], v3 offset:57344
  ds_read_b64_tr_b16 v[66:67], v3 offset:58368
  ds_read_b64_tr_b16 v[68:69], v4 offset:57344
  ds_read_b64_tr_b16 v[70:71], v4 offset:58368
  s_waitcnt lgkmcnt(8)
  v_mfma_f32_32x32x16_bf16 v[32:47], v[52:55], v[120:123], v[32:47]
  buffer_load_dwordx4 v[116:119], v2, s[20:23], s30 offen offset:2048
  s_waitcnt vmcnt(18)
  s_waitcnt lgkmcnt(6)
  v_mfma_f32_32x32x16_bf16 v[16:31], v[56:59], v[124:127], v[16:31]
  ds_read_b64_tr_b16 v[48:49], v3 offset:61440
  ds_read_b64_tr_b16 v[50:51], v3 offset:62464
  ds_read_b64_tr_b16 v[52:53], v4 offset:61440
  ds_read_b64_tr_b16 v[54:55], v4 offset:62464
  s_waitcnt lgkmcnt(8)
  v_mfma_f32_32x32x16_bf16 v[32:47], v[60:63], v[124:127], v[32:47]
  s_add_u32 s30, s30, 4096
  buffer_load_dwordx4 v[120:123], v2, s[20:23], s30 offen offset:0
  s_waitcnt vmcnt(18)
  s_waitcnt lgkmcnt(6)
  v_mfma_f32_32x32x16_bf16 v[16:31], v[64:67], v[128:131], v[16:31]
  s_waitcnt vmcnt(10)
  s_barrier
  s_waitcnt lgkmcnt(4)
  v_mfma_f32_32x32x16_bf16 v[32:47], v[68:71], v[128:131], v[32:47]
  ds_read_b64_tr_b16 v[56:57], v3 offset:0
  ds_read_b64_tr_b16 v[58:59], v3 offset:1024
  ds_read_b64_tr_b16 v[60:61], v4 offset:0
  ds_read_b64_tr_b16 v[62:63], v4 offset:1024
  s_add_u32 m0, s29, 32768
  s_add_u32 s31, s28, 1572864
  buffer_load_dwordx4 v5, s[16:19], s31 offen lds
  s_add_u32 m0, s29, 33792
  s_add_u32 s31, s28, 1589248
  buffer_load_dwordx4 v5, s[16:19], s31 offen lds
  buffer_load_dwordx4 v[124:127], v2, s[20:23], s30 offen offset:2048
  s_waitcnt lgkmcnt(6)
  v_mfma_f32_32x32x16_bf16 v[16:31], v[48:51], v[132:135], v[16:31]
  ds_read_b64_tr_b16 v[64:65], v3 offset:4096
  ds_read_b64_tr_b16 v[66:67], v3 offset:5120
  ds_read_b64_tr_b16 v[68:69], v4 offset:4096
  ds_read_b64_tr_b16 v[70:71], v4 offset:5120
  s_waitcnt lgkmcnt(8)
  v_mfma_f32_32x32x16_bf16 v[32:47], v[52:55], v[132:135], v[32:47]
  s_add_u32 s30, s30, 4096
  buffer_load_dwordx4 v[128:131], v2, s[20:23], s30 offen offset:0
  s_waitcnt lgkmcnt(6)
  v_mfma_f32_32x32x16_bf16 v[16:31], v[56:59], v[72:75], v[16:31]
  ds_read_b64_tr_b16 v[48:49], v3 offset:8192
  ds_read_b64_tr_b16 v[50:51], v3 offset:9216
  ds_read_b64_tr_b16 v[52:53], v4 offset:8192
  ds_read_b64_tr_b16 v[54:55], v4 offset:9216
  s_waitcnt lgkmcnt(8)
  v_mfma_f32_32x32x16_bf16 v[32:47], v[60:63], v[72:75], v[32:47]
  buffer_load_dwordx4 v[132:135], v2, s[20:23], s30 offen offset:2048
  s_waitcnt lgkmcnt(6)
  v_mfma_f32_32x32x16_bf16 v[16:31], v[64:67], v[76:79], v[16:31]
  ds_read_b64_tr_b16 v[56:57], v3 offset:12288
  ds_read_b64_tr_b16 v[58:59], v3 offset:13312
  s_waitcnt lgkmcnt(6)
  v_mfma_f32_32x32x16_bf16 v[32:47], v[68:71], v[76:79], v[32:47]
  ds_read_b64_tr_b16 v[60:61], v4 offset:12288
  ds_read_b64_tr_b16 v[62:63], v4 offset:13312
  s_waitcnt lgkmcnt(6)
  v_mfma_f32_32x32x16_bf16 v[16:31], v[48:51], v[80:83], v[16:31]
  s_waitcnt vmcnt(9)
  s_barrier
  s_waitcnt lgkmcnt(4)
  v_mfma_f32_32x32x16_bf16 v[32:47], v[52:55], v[80:83], v[32:47]
  ds_read_b64_tr_b16 v[64:65], v3 offset:16384
  ds_read_b64_tr_b16 v[66:67], v3 offset:17408
  ds_read_b64_tr_b16 v[68:69], v4 offset:16384
  ds_read_b64_tr_b16 v[70:71], v4 offset:17408
  s_add_u32 m0, s29, 49152
  s_add_u32 s31, s28, 1835008
  buffer_load_dwordx4 v5, s[16:19], s31 offen lds
  s_add_u32 m0, s29, 50176
  s_add_u32 s31, s28, 1851392
  buffer_load_dwordx4 v5, s[16:19], s31 offen lds
  s_waitcnt lgkmcnt(6)
  v_mfma_f32_32x32x16_bf16 v[16:31], v[56:59], v[84:87], v[16:31]
  ds_read_b64_tr_b16 v[48:49], v3 offset:20480
  ds_read_b64_tr_b16 v[50:51], v3 offset:21504
  s_waitcnt lgkmcnt(6)
  v_mfma_f32_32x32x16_bf16 v[32:47], v[60:63], v[84:87], v[32:47]
  ds_read_b64_tr_b16 v[52:53], v4 offset:20480
  ds_read_b64_tr_b16 v[54:55], v4 offset:21504
  s_waitcnt lgkmcnt(6)
  v_mfma_f32_32x32x16_bf16 v[16:31], v[64:67], v[88:91], v[16:31]
  ds_read_b64_tr_b16 v[56:57], v3 offset:24576
  ds_read_b64_tr_b16 v[58:59], v3 offset:25600
  s_waitcnt lgkmcnt(6)
  v_mfma_f32_32x32x16_bf16 v[32:47], v[68:71], v[88:91], v[32:47]
  ds_read_b64_tr_b16 v[60:61], v4 offset:24576
  ds_read_b64_tr_b16 v[62:63], v4 offset:25600
  s_waitcnt lgkmcnt(6)
  v_mfma_f32_32x32x16_bf16 v[16:31], v[48:51], v[92:95], v[16:31]
  ds_read_b64_tr_b16 v[64:65], v3 offset:28672
  ds_read_b64_tr_b16 v[66:67], v3 offset:29696
  s_waitcnt lgkmcnt(6)
  v_mfma_f32_32x32x16_bf16 v[32:47], v[52:55], v[92:95], v[32:47]
  ds_read_b64_tr_b16 v[68:69], v4 offset:28672
  ds_read_b64_tr_b16 v[70:71], v4 offset:29696
  s_waitcnt lgkmcnt(6)
  v_mfma_f32_32x32x16_bf16 v[16:31], v[56:59], v[96:99], v[16:31]
  s_waitcnt vmcnt(5)
  s_barrier
  s_waitcnt lgkmcnt(4)
  v_mfma_f32_32x32x16_bf16 v[32:47], v[60:63], v[96:99], v[32:47]
  ds_read_b64_tr_b16 v[48:49], v3 offset:32768
  ds_read_b64_tr_b16 v[50:51], v3 offset:33792
  ds_read_b64_tr_b16 v[52:53], v4 offset:32768
  ds_read_b64_tr_b16 v[54:55], v4 offset:33792
  s_waitcnt lgkmcnt(6)
  v_mfma_f32_32x32x16_bf16 v[16:31], v[64:67], v[100:103], v[16:31]
  ds_read_b64_tr_b16 v[56:57], v3 offset:36864
  ds_read_b64_tr_b16 v[58:59], v3 offset:37888
  s_waitcnt lgkmcnt(6)
  v_mfma_f32_32x32x16_bf16 v[32:47], v[68:71], v[100:103], v[32:47]
  ds_read_b64_tr_b16 v[60:61], v4 offset:36864
  ds_read_b64_tr_b16 v[62:63], v4 offset:37888
  s_waitcnt lgkmcnt(6)
  v_mfma_f32_32x32x16_bf16 v[16:31], v[48:51], v[104:107], v[16:31]
  ds_read_b64_tr_b16 v[64:65], v3 offset:40960
  ds_read_b64_tr_b16 v[66:67], v3 offset:41984
  s_waitcnt lgkmcnt(6)
  v_mfma_f32_32x32x16_bf16 v[32:47], v[52:55], v[104:107], v[32:47]
  ds_read_b64_tr_b16 v[68:69], v4 offset:40960
  ds_read_b64_tr_b16 v[70:71], v4 offset:41984
  s_waitcnt lgkmcnt(6)
  v_mfma_f32_32x32x16_bf16 v[16:31], v[56:59], v[108:111], v[16:31]
  ds_read_b64_tr_b16 v[48:49], v3 offset:45056
  ds_read_b64_tr_b16 v[50:51], v3 offset:46080
  s_waitcnt lgkmcnt(6)
  v_mfma_f32_32x32x16_bf16 v[32:47], v[60:63], v[108:111], v[32:47]
  ds_read_b64_tr_b16 v[52:53], v4 offset:45056
  ds_read_b64_tr_b16 v[54:55], v4 offset:46080
  s_waitcnt lgkmcnt(6)
  v_mfma_f32_32x32x16_bf16 v[16:31], v[64:67], v[112:115], v[16:31]
  s_waitcnt vmcnt(0)
  s_barrier
  s_waitcnt lgkmcnt(4)
  v_mfma_f32_32x32x16_bf16 v[32:47], v[68:71], v[112:115], v[32:47]
  ds_read_b64_tr_b16 v[56:57], v3 offset:49152
  ds_read_b64_tr_b16 v[58:59], v3 offset:50176
  ds_read_b64_tr_b16 v[60:61], v4 offset:49152
  ds_read_b64_tr_b16 v[62:63], v4 offset:50176
  s_waitcnt lgkmcnt(6)
  v_mfma_f32_32x32x16_bf16 v[16:31], v[48:51], v[116:119], v[16:31]
  ds_read_b64_tr_b16 v[64:65], v3 offset:53248
  ds_read_b64_tr_b16 v[66:67], v3 offset:54272
  s_waitcnt lgkmcnt(6)
  v_mfma_f32_32x32x16_bf16 v[32:47], v[52:55], v[116:119], v[32:47]
  ds_read_b64_tr_b16 v[68:69], v4 offset:53248
  ds_read_b64_tr_b16 v[70:71], v4 offset:54272
  s_waitcnt lgkmcnt(6)
  v_mfma_f32_32x32x16_bf16 v[16:31], v[56:59], v[120:123], v[16:31]
  ds_read_b64_tr_b16 v[48:49], v3 offset:57344
  ds_read_b64_tr_b16 v[50:51], v3 offset:58368
  s_waitcnt lgkmcnt(6)
  v_mfma_f32_32x32x16_bf16 v[32:47], v[60:63], v[120:123], v[32:47]
  ds_read_b64_tr_b16 v[52:53], v4 offset:57344
  ds_read_b64_tr_b16 v[54:55], v4 offset:58368
  s_waitcnt lgkmcnt(6)
  v_mfma_f32_32x32x16_bf16 v[16:31], v[64:67], v[124:127], v[16:31]
  ds_read_b64_tr_b16 v[56:57], v3 offset:61440
  ds_read_b64_tr_b16 v[58:59], v3 offset:62464
  s_waitcnt lgkmcnt(6)
  v_mfma_f32_32x32x16_bf16 v[32:47], v[68:71], v[124:127], v[32:47]
  ds_read_b64_tr_b16 v[60:61], v4 offset:61440
  ds_read_b64_tr_b16 v[62:63], v4 offset:62464
  s_waitcnt lgkmcnt(6)
  v_mfma_f32_32x32x16_bf16 v[16:31], v[48:51], v[128:131], v[16:31]
  s_waitcnt lgkmcnt(4)
  v_mfma_f32_32x32x16_bf16 v[32:47], v[52:55], v[128:131], v[32:47]
  s_waitcnt lgkmcnt(2)
  v_mfma_f32_32x32x16_bf16 v[16:31], v[56:59], v[132:135], v[16:31]
  s_waitcnt lgkmcnt(0)
  v_mfma_f32_32x32x16_bf16 v[32:47], v[60:63], v[132:135], v[32:47]
  s_lshl_b32 s36, s3, 12
  s_add_u32 s36, s36, 66560
  v_add_u32 v14, s36, v2
  s_xor_b32 s37, s3, 4
  s_lshl_b32 s37, s37, 12
  s_add_u32 s37, s37, 66560
  v_add_u32 v15, s37, v2
  s_cmp_eq_u32 s11, 0
  s_cselect_b64 s[38:39], -1, 0
  s_nop 2
  v_cndmask_b32 v72, v16, v32, s[38:39]
  v_cndmask_b32 v88, v32, v16, s[38:39]
  v_cndmask_b32 v73, v17, v33, s[38:39]
  v_cndmask_b32 v89, v33, v17, s[38:39]
  v_cndmask_b32 v74, v18, v34, s[38:39]
  v_cndmask_b32 v90, v34, v18, s[38:39]
  v_cndmask_b32 v75, v19, v35, s[38:39]
  v_cndmask_b32 v91, v35, v19, s[38:39]
  v_cndmask_b32 v76, v20, v36, s[38:39]
  v_cndmask_b32 v92, v36, v20, s[38:39]
  v_cndmask_b32 v77, v21, v37, s[38:39]
  v_cndmask_b32 v93, v37, v21, s[38:39]
  v_cndmask_b32 v78, v22, v38, s[38:39]
  v_cndmask_b32 v94, v38, v22, s[38:39]
  v_cndmask_b32 v79, v23, v39, s[38:39]
  v_cndmask_b32 v95, v39, v23, s[38:39]
  v_cndmask_b32 v80, v24, v40, s[38:39]
  v_cndmask_b32 v96, v40, v24, s[38:39]
  v_cndmask_b32 v81, v25, v41, s[38:39]
  v_cndmask_b32 v97, v41, v25, s[38:39]
  v_cndmask_b32 v82, v26, v42, s[38:39]
  v_cndmask_b32 v98, v42, v26, s[38:39]
  v_cndmask_b32 v83, v27, v43, s[38:39]
  v_cndmask_b32 v99, v43, v27, s[38:39]
  v_cndmask_b32 v84, v28, v44, s[38:39]
  v_cndmask_b32 v100, v44, v28, s[38:39]
  v_cndmask_b32 v85, v29, v45, s[38:39]
  v_cndmask_b32 v101, v45, v29, s[38:39]
  v_cndmask_b32 v86, v30, v46, s[38:39]
  v_cndmask_b32 v102, v46, v30, s[38:39]
  v_cndmask_b32 v87, v31, v47, s[38:39]
  v_cndmask_b32 v103, v47, v31, s[38:39]
  ds_write_b128 v14, v[72:75] offset:0
  ds_write_b128 v14, v[76:79] offset:1024
  ds_write_b128 v14, v[80:83] offset:2048
  ds_write_b128 v14, v[84:87] offset:3072
  s_waitcnt lgkmcnt(0)
  s_barrier
  ds_read_b128 v[72:75], v15 offset:0
  ds_read_b128 v[76:79], v15 offset:1024
  ds_read_b128 v[80:83], v15 offset:2048
  ds_read_b128 v[84:87], v15 offset:3072
  ds_read_b128 v[144:147], v11 offset:0
  ds_read_b128 v[148:151], v11 offset:32
  ds_read_b128 v[152:155], v11 offset:64
  ds_read_b128 v[156:159], v11 offset:96
  ds_read_b128 v[160:163], v11 offset:256
  ds_read_b128 v[164:167], v11 offset:288
  ds_read_b128 v[168:171], v11 offset:320
  ds_read_b128 v[172:175], v11 offset:352
  s_add_u32 s16, s4, 19922944
  s_addc_u32 s17, s5, 0
  s_and_b32 s17, s17, 0xffff
  s_mov_b32 s18, 4194304
  s_mov_b32 s19, 0x00020000
  s_add_u32 s20, s4, 24117248
  s_addc_u32 s21, s5, 0
  s_and_b32 s21, s21, 0xffff
  s_mov_b32 s22, 4194304
  s_mov_b32 s23, 0x00020000
  s_add_u32 s24, s4, 262144
  s_addc_u32 s25, s5, 0
  s_and_b32 s25, s25, 0xffff
  s_mov_b32 s26, 262144
  s_mov_b32 s27, 0x00020000
  v_permlane32_swap_b32 v136, v138
  v_permlane32_swap_b32 v137, v139
  v_permlane32_swap_b32 v140, v142
  v_permlane32_swap_b32 v141, v143
  v_lshlrev_b32 v104, 16, v136
  v_and_b32 v105, 0xffff0000, v136
  v_lshlrev_b32 v106, 16, v137
  v_and_b32 v107, 0xffff0000, v137
  v_lshlrev_b32 v108, 16, v138
  v_and_b32 v109, 0xffff0000, v138
  v_lshlrev_b32 v110, 16, v139
  v_and_b32 v111, 0xffff0000, v139
  v_lshlrev_b32 v112, 16, v140
  v_and_b32 v113, 0xffff0000, v140
  v_lshlrev_b32 v114, 16, v141
  v_and_b32 v115, 0xffff0000, v141
  v_lshlrev_b32 v116, 16, v142
  v_and_b32 v117, 0xffff0000, v142
  v_lshlrev_b32 v118, 16, v143
  v_and_b32 v119, 0xffff0000, v143
  s_waitcnt lgkmcnt(8)
  v_add_f32 v88, v88, v72
  v_add_f32 v89, v89, v73
  v_add_f32 v90, v90, v74
  v_add_f32 v91, v91, v75
  v_add_f32 v92, v92, v76
  v_add_f32 v93, v93, v77
  v_add_f32 v94, v94, v78
  v_add_f32 v95, v95, v79
  v_add_f32 v96, v96, v80
  v_add_f32 v97, v97, v81
  v_add_f32 v98, v98, v82
  v_add_f32 v99, v99, v83
  v_add_f32 v100, v100, v84
  v_add_f32 v101, v101, v85
  v_add_f32 v102, v102, v86
  v_add_f32 v103, v103, v87
  s_waitcnt lgkmcnt(4)
  v_fmac_f32 v104, v144, v88
  v_fmac_f32 v105, v145, v89
  v_fmac_f32 v106, v146, v90
  v_fmac_f32 v107, v147, v91
  v_fmac_f32 v108, v148, v92
  v_fmac_f32 v109, v149, v93
  v_fmac_f32 v110, v150, v94
  v_fmac_f32 v111, v151, v95
  v_fmac_f32 v112, v152, v96
  v_fmac_f32 v113, v153, v97
  v_fmac_f32 v114, v154, v98
  v_fmac_f32 v115, v155, v99
  v_fmac_f32 v116, v156, v100
  v_fmac_f32 v117, v157, v101
  v_fmac_f32 v118, v158, v102
  v_fmac_f32 v119, v159, v103
  v_cvt_pk_bf16_f32 v120, v104, v105
  v_cvt_pk_bf16_f32 v121, v106, v107
  v_cvt_pk_bf16_f32 v122, v108, v109
  v_cvt_pk_bf16_f32 v123, v110, v111
  v_cvt_pk_bf16_f32 v124, v112, v113
  v_cvt_pk_bf16_f32 v125, v114, v115
  v_cvt_pk_bf16_f32 v126, v116, v117
  v_cvt_pk_bf16_f32 v127, v118, v119
  s_lshl_b32 s34, s9, 12
  s_add_u32 s34, s34, s33
  s_lshl_b32 s36, s11, 11
  s_add_u32 s34, s34, s36
  buffer_store_dwordx4 v[120:123], v2, s[16:19], s34 offen offset:0 sc1
  buffer_store_dwordx4 v[124:127], v2, s[16:19], s34 offen offset:1024 sc1
  v_lshlrev_b32 v104, 16, v120
  v_and_b32 v105, 0xffff0000, v120
  v_lshlrev_b32 v106, 16, v121
  v_and_b32 v107, 0xffff0000, v121
  v_lshlrev_b32 v108, 16, v122
  v_and_b32 v109, 0xffff0000, v122
  v_lshlrev_b32 v110, 16, v123
  v_and_b32 v111, 0xffff0000, v123
  v_lshlrev_b32 v112, 16, v124
  v_and_b32 v113, 0xffff0000, v124
  v_lshlrev_b32 v114, 16, v125
  v_and_b32 v115, 0xffff0000, v125
  v_lshlrev_b32 v116, 16, v126
  v_and_b32 v117, 0xffff0000, v126
  v_lshlrev_b32 v118, 16, v127
  v_and_b32 v119, 0xffff0000, v127
  s_waitcnt lgkmcnt(0)
  v_mul_f32 v88, v160, v104
  v_mul_f32 v89, v161, v105
  v_mul_f32 v90, v162, v106
  v_mul_f32 v91, v163, v107
  v_mul_f32 v92, v164, v108
  v_mul_f32 v93, v165, v109
  v_mul_f32 v94, v166, v110
  v_mul_f32 v95, v167, v111
  v_mul_f32 v96, v168, v112
  v_mul_f32 v97, v169, v113
  v_mul_f32 v98, v170, v114
  v_mul_f32 v99, v171, v115
  v_mul_f32 v100, v172, v116
  v_mul_f32 v101, v173, v117
  v_mul_f32 v102, v174, v118
  v_mul_f32 v103, v175, v119
  v_cvt_pk_bf16_f32 v72, v88, v89
  v_cvt_pk_bf16_f32 v73, v90, v91
  v_cvt_pk_bf16_f32 v74, v92, v93
  v_cvt_pk_bf16_f32 v75, v94, v95
  v_cvt_pk_bf16_f32 v76, v96, v97
  v_cvt_pk_bf16_f32 v77, v98, v99
  v_cvt_pk_bf16_f32 v78, v100, v101
  v_cvt_pk_bf16_f32 v79, v102, v103
  buffer_store_dwordx4 v[72:75], v2, s[20:23], s34 offen offset:0 sc1
  buffer_store_dwordx4 v[76:79], v2, s[20:23], s34 offen offset:1024 sc1
  v_add_f32 v16, v104, v108
  v_add_f32 v17, v105, v109
  v_add_f32 v18, v106, v110
  v_add_f32 v19, v107, v111
  v_add_f32 v16, v16, v112
  v_add_f32 v17, v17, v113
  v_add_f32 v18, v18, v114
  v_add_f32 v19, v19, v115
  v_add_f32 v16, v16, v116
  v_add_f32 v17, v17, v117
  v_add_f32 v18, v18, v118
  v_add_f32 v19, v19, v119
  v_add_f32 v16, v16, v17
  v_add_f32 v18, v18, v19
  v_add_f32 v16, v16, v18
  v_mov_b32 v17, v16
  s_nop 1
  v_permlane32_swap_b32 v16, v17
  v_add_f32 v16, v16, v17
  v_mul_f32 v16, 0x3d000000, v16
  v_sub_f32 v24, v104, v16
  v_mul_f32 v20, v24, v24
  v_sub_f32 v25, v105, v16
  v_mul_f32 v21, v25, v25
  v_sub_f32 v26, v106, v16
  v_mul_f32 v22, v26, v26
  v_sub_f32 v27, v107, v16
  v_mul_f32 v23, v27, v27
  v_sub_f32 v24, v108, v16
  v_fmac_f32 v20, v24, v24
  v_sub_f32 v25, v109, v16
  v_fmac_f32 v21, v25, v25
  v_sub_f32 v26, v110, v16
  v_fmac_f32 v22, v26, v26
  v_sub_f32 v27, v111, v16
  v_fmac_f32 v23, v27, v27
  v_sub_f32 v24, v112, v16
  v_fmac_f32 v20, v24, v24
  v_sub_f32 v25, v113, v16
  v_fmac_f32 v21, v25, v25
  v_sub_f32 v26, v114, v16
  v_fmac_f32 v22, v26, v26
  v_sub_f32 v27, v115, v16
  v_fmac_f32 v23, v27, v27
  v_sub_f32 v24, v116, v16
  v_fmac_f32 v20, v24, v24
  v_sub_f32 v25, v117, v16
  v_fmac_f32 v21, v25, v25
  v_sub_f32 v26, v118, v16
  v_fmac_f32 v22, v26, v26
  v_sub_f32 v27, v119, v16
  v_fmac_f32 v23, v27, v27
  v_add_f32 v20, v20, v21
  v_add_f32 v22, v22, v23
  v_add_f32 v17, v20, v22
  v_mov_b32 v18, v17
  s_nop 1
  v_permlane32_swap_b32 v17, v18
  v_add_f32 v17, v17, v18
  v_lshlrev_b32 v12, 3, v12
  s_lshl_b32 s36, s3, 8
  s_add_u32 s36, s36, 99328
  v_add_u32 v14, s36, v12
  s_xor_b32 s37, s3, 4
  s_lshl_b32 s37, s37, 8
  s_add_u32 s37, s37, 99328
  v_add_u32 v15, s37, v12
  ds_write_b64 v14, v[16:17]
  s_waitcnt lgkmcnt(0)
  s_barrier
  ds_read_b64 v[18:19], v15
  s_waitcnt lgkmcnt(0)
  v_sub_f32 v20, v16, v18
  v_add_f32 v16, v16, v18
  v_mul_f32 v16, 0.5, v16
  v_add_f32 v17, v17, v19
  v_mul_f32 v20, v20, v20
  v_fmac_f32 v17, 0x41800000, v20
  v_lshlrev_b32 v12, 7, v7
  s_lshl_b32 s34, s9, 3
  s_cmp_eq_u32 s11, 0
  s_cselect_b32 s34, s34, 0x7ff00000
  v_cmp_gt_u32 vcc, 32, v1
  s_nop 2
  s_and_saveexec_b64 s[50:51], vcc
  buffer_store_dwordx2 v[16:17], v12, s[24:27], s34 offen
  s_mov_b64 exec, s[50:51]
  s_add_u32 s40, s4, 65011712
  s_addc_u32 s41, s5, 0
  s_and_b32 s41, s41, 0xffff
  s_mov_b32 s42, 229376
  s_mov_b32 s43, 0x00020000
  v_add_f32 v176, v176, v177
  v_add_f32 v178, v178, v179
  v_add_f32 v176, v176, v178
  s_nop 1
  v_add_f32_dpp v176, v176, v176 quad_perm:[2,3,0,1] row_mask:0xf bank_mask:0xf
  s_nop 1
  v_mov_b32_dpp v177, v176 row_half_mirror row_mask:0xf bank_mask:0xf
  s_nop 1
  v_mov_b32_dpp v177, v177 quad_perm:[3,2,1,0] row_mask:0xf bank_mask:0xf
  v_add_f32 v176, v176, v177
  s_nop 1
  v_mov_b32_dpp v41, v176 quad_perm:[1,0,3,2] row_mask:0xf bank_mask:0xf
  v_cvt_pk_bf16_f32 v177, v176, v176
  v_and_b32 v178, 0xffff0000, v177
  v_sub_f32 v178, v176, v178
  v_cvt_pk_bf16_f32 v178, v178, v178
  v_cvt_pk_bf16_f32 v179, v41, v41
  v_and_b32 v40, 0xffff0000, v179
  v_sub_f32 v40, v41, v40
  v_cvt_pk_bf16_f32 v40, v40, v40
  s_mov_b32 s34, 0x05040100
  v_perm_b32 v32, v178, v177, s34
  v_perm_b32 v33, v179, v177, s34
  v_perm_b32 v34, v179, v40, s34
  v_mov_b32 v35, 0
  v_mov_b32 v36, 0
  v_mov_b32 v37, 0
  v_mov_b32 v38, 0
  v_mov_b32 v39, 0
  v_lshrrev_b32 v13, 5, v10
  v_lshlrev_b32 v13, 10, v13
  v_and_b32 v14, 31, v10
  v_lshl_add_u32 v13, v14, 4, v13
  v_and_b32 v14, 7, v0
  v_cmp_eq_u32 vcc, 0, v14
  v_mov_b32 v14, 0x7ff00000
  s_nop 0
  v_cndmask_b32 v13, v14, v13, vcc
  buffer_store_dwordx4 v[32:35], v13, s[40:43], 0 offen sc1
  buffer_store_dwordx4 v[36:39], v13, s[40:43], 0 offen offset:512 sc1
k4_end:
  s_endpgm
.globl k5_kernel
.p2align 8
.type k5_kernel,@function
k5_kernel:
  s_cmp_ge_u32 s2, 256
  s_cbranch_scc1 k5_end
  s_load_dwordx2 s[4:5], s[0:1], 104
  s_load_dwordx4 s[12:15], s[0:1], 48
  v_and_b32 v1, 63, v0
  v_lshrrev_b32 v10, 6, v0
  v_lshlrev_b32 v2, 4, v1
  v_readfirstlane_b32 s3, v10
  s_and_b32 s6, s2, 7
  s_lshr_b32 s7, s2, 3
  s_and_b32 s8, s6, 1
  s_lshl_b32 s8, s8, 2
  s_and_b32 s10, s7, 3
  s_add_u32 s8, s8, s10
  s_lshr_b32 s9, s6, 1
  s_lshl_b32 s9, s9, 3
  s_lshr_b32 s10, s7, 2
  s_add_u32 s9, s9, s10
  s_waitcnt lgkmcnt(0)
  s_cmp_ge_u32 s3, 2
  s_cselect_b32 s12, s14, s12
  s_cselect_b32 s13, s15, s13
  s_mov_b32 s16, s12
  s_and_b32 s17, s13, 0xffff
  s_mov_b32 s18, 7340032
  s_mov_b32 s19, 0x00020000
  s_add_u32 s20, s4, 24117248
  s_addc_u32 s21, s5, 0
  s_and_b32 s21, s21, 0xffff
  s_mov_b32 s22, 4194304
  s_mov_b32 s23, 0x00020000
  v_add_u32 v20, 0, v1
  v_mul_u32_u24 v21, 2341, v20
  v_lshrrev_b32 v21, 15, v21
  v_mul_u32_u24 v22, 14, v21
  v_sub_u32 v22, v20, v22
  v_mul_u32_u24 v21, 7168, v21
  v_lshl_add_u32 v12, v22, 4, v21
  v_add_u32 v20, 64, v1
  v_mul_u32_u24 v21, 2341, v20
  v_lshrrev_b32 v21, 15, v21
  v_mul_u32_u24 v22, 14, v21
  v_sub_u32 v22, v20, v22
  v_mul_u32_u24 v21, 7168, v21
  v_lshl_add_u32 v13, v22, 4, v21
  v_add_u32 v20, 128, v1
  v_mul_u32_u24 v21, 2341, v20
  v_lshrrev_b32 v21, 15, v21
  v_mul_u32_u24 v22, 14, v21
  v_sub_u32 v22, v20, v22
  v_mul_u32_u24 v21, 7168, v21
  v_lshl_add_u32 v14, v22, 4, v21
  v_add_u32 v20, 192, v1
  v_mul_u32_u24 v21, 2341, v20
  v_lshrrev_b32 v21, 15, v21
  v_mul_u32_u24 v22, 14, v21
  v_sub_u32 v22, v20, v22
  v_mul_u32_u24 v21, 7168, v21
  v_lshl_add_u32 v15, v22, 4, v21
  v_add_u32 v20, 256, v1
  v_mul_u32_u24 v21, 2341, v20
  v_lshrrev_b32 v21, 15, v21
  v_mul_u32_u24 v22, 14, v21
  v_sub_u32 v22, v20, v22
  v_mul_u32_u24 v21, 7168, v21
  v_lshl_add_u32 v16, v22, 4, v21
  v_add_u32 v20, 320, v1
  v_mul_u32_u24 v21, 2341, v20
  v_lshrrev_b32 v21, 15, v21
  v_mul_u32_u24 v22, 14, v21
  v_sub_u32 v22, v20, v22
  v_mul_u32_u24 v21, 7168, v21
  v_lshl_add_u32 v17, v22, 4, v21
  v_add_u32 v20, 384, v1
  v_mul_u32_u24 v21, 2341, v20
  v_lshrrev_b32 v21, 15, v21
  v_mul_u32_u24 v22, 14, v21
  v_sub_u32 v22, v20, v22
  v_mul_u32_u24 v21, 7168, v21
  v_lshl_add_u32 v18, v22, 4, v21
  v_bfe_u32 v20, v1, 2, 2
  v_lshrrev_b32 v21, 5, v1
  v_lshl_add_u32 v20, v21, 2, v20
  v_mul_u32_u24 v3, 224, v20
  v_and_b32 v20, 3, v1
  v_lshl_add_u32 v3, v20, 3, v3
  v_bfe_u32 v20, v1, 4, 1
  v_mul_u32_u24 v20, 14464, v20
  v_add_u32 v3, v3, v20
  v_add_u32 v4, 0x10000, v3
  v_add_u32 v5, 0x20000, v3
  s_lshr_b32 s29, s3, 1
  s_mul_i32 s29, s29, 14464
  s_and_b32 s30, s3, 1
  s_mul_i32 s28, s30, 7168
  s_add_u32 s29, s29, s28
  s_mul_i32 s28, s30, 229376
  s_mul_i32 s30, s9, 224
  s_add_u32 s28, s28, s30
  s_lshl_b32 s30, s8, 3
  s_lshl_b32 s33, s3, 1
  s_add_u32 s30, s30, s33
  s_lshl_b32 s30, s30, 16
  s_add_u32 s32, s30, 0x10000
  s_lshr_b32 s33, s30, 16
  s_add_u32 m0, s29, 0
  s_add_u32 s31, s28, 0
  buffer_load_dwordx4 v12, s[16:19], s31 offen lds
  s_add_u32 m0, s29, 1024
  s_nop 0
  buffer_load_dwordx4 v13, s[16:19], s31 offen lds
  s_add_u32 m0, s29, 2048
  s_nop 0
  buffer_load_dwordx4 v14, s[16:19], s31 offen lds
  s_add_u32 m0, s29, 3072
  s_nop 0
  buffer_load_dwordx4 v15, s[16:19], s31 offen lds
  s_add_u32 m0, s29, 4096
  s_nop 0
  buffer_load_dwordx4 v16, s[16:19], s31 offen lds
  s_add_u32 m0, s29, 5120
  s_nop 0
  buffer_load_dwordx4 v17, s[16:19], s31 offen lds
  s_add_u32 m0, s29, 6144
  s_nop 0
  buffer_load_dwordx4 v18, s[16:19], s31 offen lds
  buffer_load_dwordx4 a[56:59], v2, s[20:23], s30 offen offset:0
  buffer_load_dwordx4 a[60:63], v2, s[20:23], s32 offen offset:0
  buffer_load_dwordx4 a[64:67], v2, s[20:23], s30 offen offset:1024
  buffer_load_dwordx4 a[68:71], v2, s[20:23], s32 offen offset:1024
  buffer_load_dwordx4 a[72:75], v2, s[20:23], s30 offen offset:2048
  buffer_load_dwordx4 a[76:79], v2, s[20:23], s32 offen offset:2048
  buffer_load_dwordx4 a[80:83], v2, s[20:23], s30 offen offset:3072
  buffer_load_dwordx4 a[84:87], v2, s[20:23], s32 offen offset:3072
  s_add_u32 m0, s29, 28928
  s_add_u32 s31, s28, 458752
  buffer_load_dwordx4 v12, s[16:19], s31 offen lds
  s_add_u32 m0, s29, 29952
  s_nop 0
  buffer_load_dwordx4 v13, s[16:19], s31 offen lds
  s_add_u32 m0, s29, 30976
  s_nop 0
  buffer_load_dwordx4 v14, s[16:19], s31 offen lds
  s_add_u32 m0, s29, 32000
  s_nop 0
  buffer_load_dwordx4 v15, s[16:19], s31 offen lds
  s_add_u32 m0, s29, 33024
  s_nop 0
  buffer_load_dwordx4 v16, s[16:19], s31 offen lds
  s_add_u32 m0, s29, 34048
  s_nop 0
  buffer_load_dwordx4 v17, s[16:19], s31 offen lds
  s_add_u32 m0, s29, 35072
  s_nop 0
  buffer_load_dwordx4 v18, s[16:19], s31 offen lds
  s_add_u32 s36, s4, 262144
  s_addc_u32 s37, s5, 0
  s_and_b32 s37, s37, 0xffff
  s_mov_b32 s38, 262144
  s_mov_b32 s39, 0x00020000
  s_add_u32 s40, s4, 65011712
  s_addc_u32 s41, s5, 0
  s_and_b32 s41, s41, 0xffff
  s_mov_b32 s42, 229376
  s_mov_b32 s43, 0x00020000
  v_and_b32 v10, 31, v1
  v_lshrrev_b32 v6, 5, v1
  v_lshlrev_b32 v7, 7, v10
  v_lshl_add_u32 v7, v6, 6, v7
  s_lshl_b32 s34, s33, 12
  s_add_u32 s35, s34, 4096
  s_mul_i32 s44, s9, 7168
  s_add_u32 s45, s44, 4096
  s_waitcnt vmcnt(15)
  s_barrier
  ds_read_b64_tr_b16 a[0:1], v3 offset:0
  ds_read_b64_tr_b16 a[2:3], v3 offset:1792
  ds_read_b64_tr_b16 a[4:5], v3 offset:32
  ds_read_b64_tr_b16 a[6:7], v3 offset:1824
  ds_read_b64_tr_b16 a[8:9], v3 offset:64
  ds_read_b64_tr_b16 a[10:11], v3 offset:1856
  ds_read_b64_tr_b16 a[12:13], v3 offset:96
  ds_read_b64_tr_b16 a[14:15], v3 offset:1888
  ds_read_b64_tr_b16 a[16:17], v3 offset:128
  ds_read_b64_tr_b16 a[18:19], v3 offset:1920
  ds_read_b64_tr_b16 a[20:21], v3 offset:160
  ds_read_b64_tr_b16 a[22:23], v3 offset:1952
  ds_read_b64_tr_b16 a[24:25], v3 offset:192
  ds_read_b64_tr_b16 a[26:27], v3 offset:1984
  s_waitcnt vmcnt(13)
  s_waitcnt lgkmcnt(12)
  v_mfma_f32_32x32x16_bf16 v[32:47], a[0:3], a[56:59], 0
  ds_read_b64_tr_b16 a[28:29], v3 offset:3584
  ds_read_b64_tr_b16 a[30:31], v3 offset:5376
  v_mfma_f32_32x32x16_bf16 v[48:63], a[0:3], a[60:63], 0
  ds_read_b64_tr_b16 a[32:33], v3 offset:3616
  ds_read_b64_tr_b16 a[34:35], v3 offset:5408
  s_waitcnt lgkmcnt(14)
  v_mfma_f32_32x32x16_bf16 v[64:79], a[4:7], a[56:59], 0
  v_mfma_f32_32x32x16_bf16 v[80:95], a[4:7], a[60:63], 0
  ds_read_b64_tr_b16 a[36:37], v3 offset:3648
  ds_read_b64_tr_b16 a[38:39], v3 offset:5440
  s_waitcnt lgkmcnt(14)
  v_mfma_f32_32x32x16_bf16 v[96:111], a[8:11], a[56:59], 0
  ds_read_b64_tr_b16 a[40:41], v3 offset:3680
  ds_read_b64_tr_b16 a[42:43], v3 offset:5472
  v_mfma_f32_32x32x16_bf16 v[112:127], a[8:11], a[60:63], 0
  s_waitcnt lgkmcnt(14)
  v_mfma_f32_32x32x16_bf16 v[128:143], a[12:15], a[56:59], 0
  ds_read_b64_tr_b16 a[44:45], v3 offset:3712
  ds_read_b64_tr_b16 a[46:47], v3 offset:5504
  v_mfma_f32_32x32x16_bf16 v[144:159], a[12:15], a[60:63], 0
  ds_read_b64_tr_b16 a[48:49], v3 offset:3744
  ds_read_b64_tr_b16 a[50:51], v3 offset:5536
  s_waitcnt lgkmcnt(15)
  v_mfma_f32_32x32x16_bf16 v[160:175], a[16:19], a[56:59], 0
  v_mfma_f32_32x32x16_bf16 v[176:191], a[16:19], a[60:63], 0
  ds_read_b64_tr_b16 a[52:53], v3 offset:3776
  ds_read_b64_tr_b16 a[54:55], v3 offset:5568
  s_waitcnt lgkmcnt(15)
  v_mfma_f32_32x32x16_bf16 v[192:207], a[20:23], a[56:59], 0
  s_add_u32 s30, s30, 4096
  buffer_load_dwordx4 a[88:91], v2, s[20:23], s30 offen offset:0
  s_add_u32 s32, s32, 4096
  buffer_load_dwordx4 a[92:95], v2, s[20:23], s32 offen offset:0
  v_mfma_f32_32x32x16_bf16 v[208:223], a[20:23], a[60:63], 0
  s_waitcnt lgkmcnt(14)
  v_mfma_f32_32x32x16_bf16 v[224:239], a[24:27], a[56:59], 0
  buffer_load_dwordx4 a[96:99], v2, s[20:23], s30 offen offset:1024
  buffer_load_dwordx4 a[100:103], v2, s[20:23], s32 offen offset:1024
  v_mfma_f32_32x32x16_bf16 v[240:255], a[24:27], a[60:63], 0
  s_waitcnt vmcnt(15)
  s_waitcnt lgkmcnt(12)
  v_mfma_f32_32x32x16_bf16 v[32:47], a[28:31], a[64:67], v[32:47]
  ds_read_b64_tr_b16 a[0:1], v3 offset:7168
  ds_read_b64_tr_b16 a[2:3], v3 offset:8960
  v_mfma_f32_32x32x16_bf16 v[48:63], a[28:31], a[68:71], v[48:63]
  ds_read_b64_tr_b16 a[4:5], v3 offset:7200
  ds_read_b64_tr_b16 a[6:7], v3 offset:8992
  s_waitcnt lgkmcnt(14)
  v_mfma_f32_32x32x16_bf16 v[64:79], a[32:35], a[64:67], v[64:79]
  ds_read_b64_tr_b16 a[8:9], v3 offset:7232
  ds_read_b64_tr_b16 a[10:11], v3 offset:9024
  v_mfma_f32_32x32x16_bf16 v[80:95], a[32:35], a[68:71], v[80:95]
  s_waitcnt lgkmcnt(14)
  v_mfma_f32_32x32x16_bf16 v[96:111], a[36:39], a[64:67], v[96:111]
  ds_read_b64_tr_b16 a[12:13], v3 offset:7264
  ds_read_b64_tr_b16 a[14:15], v3 offset:9056
  v_mfma_f32_32x32x16_bf16 v[112:127], a[36:39], a[68:71], v[112:127]
  ds_read_b64_tr_b16 a[16:17], v3 offset:7296
  ds_read_b64_tr_b16 a[18:19], v3 offset:9088
  s_waitcnt lgkmcnt(15)
  v_mfma_f32_32x32x16_bf16 v[128:143], a[40:43], a[64:67], v[128:143]
  v_mfma_f32_32x32x16_bf16 v[144:159], a[40:43], a[68:71], v[144:159]
  ds_read_b64_tr_b16 a[20:21], v3 offset:7328
  ds_read_b64_tr_b16 a[22:23], v3 offset:9120
  s_waitcnt lgkmcnt(15)
  v_mfma_f32_32x32x16_bf16 v[160:175], a[44:47], a[64:67], v[160:175]
  ds_read_b64_tr_b16 a[24:25], v3 offset:7360
  ds_read_b64_tr_b16 a[26:27], v3 offset:9152
  v_mfma_f32_32x32x16_bf16 v[176:191], a[44:47], a[68:71], v[176:191]
  buffer_load_dwordx4 a[104:107], v2, s[20:23], s30 offen offset:2048
  buffer_load_dwordx4 a[108:111], v2, s[20:23], s32 offen offset:2048
  s_waitcnt lgkmcnt(15)
  v_mfma_f32_32x32x16_bf16 v[192:207], a[48:51], a[64:67], v[192:207]
  v_mfma_f32_32x32x16_bf16 v[208:223], a[48:51], a[68:71], v[208:223]
  s_add_u32 m0, s29, 57856
  s_add_u32 s31, s28, 917504
  buffer_load_dwordx4 v12, s[16:19], s31 offen lds
  s_waitcnt lgkmcnt(14)
  v_mfma_f32_32x32x16_bf16 v[224:239], a[52:55], a[64:67], v[224:239]
  s_add_u32 m0, s29, 58880
  s_nop 0
  buffer_load_dwordx4 v13, s[16:19], s31 offen lds
  v_mfma_f32_32x32x16_bf16 v[240:255], a[52:55], a[68:71], v[240:255]
  s_waitcnt vmcnt(17)
  s_waitcnt lgkmcnt(12)
  v_mfma_f32_32x32x16_bf16 v[32:47], a[0:3], a[72:75], v[32:47]
  ds_read_b64_tr_b16 a[28:29], v3 offset:10752
  ds_read_b64_tr_b16 a[30:31], v3 offset:12544
  v_mfma_f32_32x32x16_bf16 v[48:63], a[0:3], a[76:79], v[48:63]
  ds_read_b64_tr_b16 a[32:33], v3 offset:10784
  ds_read_b64_tr_b16 a[34:35], v3 offset:12576
  s_waitcnt lgkmcnt(14)
  v_mfma_f32_32x32x16_bf16 v[64:79], a[4:7], a[72:75], v[64:79]
  ds_read_b64_tr_b16 a[36:37], v3 offset:10816
  ds_read_b64_tr_b16 a[38:39], v3 offset:12608
  v_mfma_f32_32x32x16_bf16 v[80:95], a[4:7], a[76:79], v[80:95]
  ds_read_b64_tr_b16 a[40:41], v3 offset:10848
  ds_read_b64_tr_b16 a[42:43], v3 offset:12640
  s_waitcnt lgkmcnt(15)
  v_mfma_f32_32x32x16_bf16 v[96:111], a[8:11], a[72:75], v[96:111]
  v_mfma_f32_32x32x16_bf16 v[112:127], a[8:11], a[76:79], v[112:127]
  ds_read_b64_tr_b16 a[44:45], v3 offset:10880
  ds_read_b64_tr_b16 a[46:47], v3 offset:12672
  s_waitcnt lgkmcnt(15)
  v_mfma_f32_32x32x16_bf16 v[128:143], a[12:15], a[72:75], v[128:143]
  ds_read_b64_tr_b16 a[48:49], v3 offset:10912
  ds_read_b64_tr_b16 a[50:51], v3 offset:12704
  v_mfma_f32_32x32x16_bf16 v[144:159], a[12:15], a[76:79], v[144:159]
  ds_read_b64_tr_b16 a[52:53], v3 offset:10944
  ds_read_b64_tr_b16 a[54:55], v3 offset:12736
  s_waitcnt lgkmcnt(15)
  v_mfma_f32_32x32x16_bf16 v[160:175], a[16:19], a[72:75], v[160:175]
  s_add_u32 m0, s29, 59904
  s_nop 0
  buffer_load_dwordx4 v14, s[16:19], s31 offen lds
  v_mfma_f32_32x32x16_bf16 v[176:191], a[16:19], a[76:79], v[176:191]
  v_mfma_f32_32x32x16_bf16 v[192:207], a[20:23], a[72:75], v[192:207]
  s_add_u32 m0, s29, 60928
  s_nop 0
  buffer_load_dwordx4 v15, s[16:19], s31 offen lds
  v_mfma_f32_32x32x16_bf16 v[208:223], a[20:23], a[76:79], v[208:223]
  s_add_u32 m0, s29, 61952
  s_nop 0
  buffer_load_dwordx4 v16, s[16:19], s31 offen lds
  s_waitcnt lgkmcnt(14)
  v_mfma_f32_32x32x16_bf16 v[224:239], a[24:27], a[72:75], v[224:239]
  s_add_u32 m0, s29, 62976
  s_nop 0
  buffer_load_dwordx4 v17, s[16:19], s31 offen lds
  v_mfma_f32_32x32x16_bf16 v[240:255], a[24:27], a[76:79], v[240:255]
  s_waitcnt vmcnt(19)
  s_waitcnt lgkmcnt(12)
  v_mfma_f32_32x32x16_bf16 v[32:47], a[28:31], a[80:83], v[32:47]
  s_waitcnt vmcnt(12)
  s_waitcnt lgkmcnt(0)
  s_barrier
  v_mfma_f32_32x32x16_bf16 v[48:63], a[28:31], a[84:87], v[48:63]
  ds_read_b64_tr_b16 a[0:1], v3 offset:28928
  ds_read_b64_tr_b16 a[2:3], v3 offset:30720
  v_mfma_f32_32x32x16_bf16 v[64:79], a[32:35], a[80:83], v[64:79]
  ds_read_b64_tr_b16 a[4:5], v3 offset:28960
  ds_read_b64_tr_b16 a[6:7], v3 offset:30752
  v_mfma_f32_32x32x16_bf16 v[80:95], a[32:35], a[84:87], v[80:95]
  ds_read_b64_tr_b16 a[8:9], v3 offset:28992
  ds_read_b64_tr_b16 a[10:11], v3 offset:30784
  v_mfma_f32_32x32x16_bf16 v[96:111], a[36:39], a[80:83], v[96:111]
  ds_read_b64_tr_b16 a[12:13], v3 offset:29024
  ds_read_b64_tr_b16 a[14:15], v3 offset:30816
  v_mfma_f32_32x32x16_bf16 v[112:127], a[36:39], a[84:87], v[112:127]
  v_mfma_f32_32x32x16_bf16 v[128:143], a[40:43], a[80:83], v[128:143]
  ds_read_b64_tr_b16 a[16:17], v3 offset:29056
  ds_read_b64_tr_b16 a[18:19], v3 offset:30848
  v_mfma_f32_32x32x16_bf16 v[144:159], a[40:43], a[84:87], v[144:159]
  ds_read_b64_tr_b16 a[20:21], v3 offset:29088
  ds_read_b64_tr_b16 a[22:23], v3 offset:30880
  v_mfma_f32_32x32x16_bf16 v[160:175], a[44:47], a[80:83], v[160:175]
  ds_read_b64_tr_b16 a[24:25], v3 offset:29120
  ds_read_b64_tr_b16 a[26:27], v3 offset:30912
  v_mfma_f32_32x32x16_bf16 v[176:191], a[44:47], a[84:87], v[176:191]
  v_mfma_f32_32x32x16_bf16 v[192:207], a[48:51], a[80:83], v[192:207]
  s_add_u32 m0, s29, 64000
  s_nop 0
  buffer_load_dwordx4 v18, s[16:19], s31 offen lds
  v_mfma_f32_32x32x16_bf16 v[208:223], a[48:51], a[84:87], v[208:223]
  buffer_load_dwordx4 a[112:115], v2, s[20:23], s30 offen offset:3072
  buffer_load_dwordx4 a[116:119], v2, s[20:23], s32 offen offset:3072
  v_mfma_f32_32x32x16_bf16 v[224:239], a[52:55], a[80:83], v[224:239]
  s_add_u32 s30, s30, 4096
  buffer_load_dwordx4 a[120:123], v2, s[20:23], s30 offen offset:0
  s_add_u32 s32, s32, 4096
  buffer_load_dwordx4 a[124:127], v2, s[20:23], s32 offen offset:0
  v_mfma_f32_32x32x16_bf16 v[240:255], a[52:55], a[84:87], v[240:255]
  s_waitcnt vmcnt(15)
  s_waitcnt lgkmcnt(12)
  v_mfma_f32_32x32x16_bf16 v[32:47], a[0:3], a[88:91], v[32:47]
  ds_read_b64_tr_b16 a[28:29], v3 offset:32512
  ds_read_b64_tr_b16 a[30:31], v3 offset:34304
  v_mfma_f32_32x32x16_bf16 v[48:63], a[0:3], a[92:95], v[48:63]
  ds_read_b64_tr_b16 a[32:33], v3 offset:32544
  ds_read_b64_tr_b16 a[34:35], v3 offset:34336
  s_waitcnt lgkmcnt(14)
  v_mfma_f32_32x32x16_bf16 v[64:79], a[4:7], a[88:91], v[64:79]
  v_mfma_f32_32x32x16_bf16 v[80:95], a[4:7], a[92:95], v[80:95]
  ds_read_b64_tr_b16 a[36:37], v3 offset:32576
  ds_read_b64_tr_b16 a[38:39], v3 offset:34368
  s_waitcnt lgkmcnt(14)
  v_mfma_f32_32x32x16_bf16 v[96:111], a[8:11], a[88:91], v[96:111]
  ds_read_b64_tr_b16 a[40:41], v3 offset:32608
  ds_read_b64_tr_b16 a[42:43], v3 offset:34400
  v_mfma_f32_32x32x16_bf16 v[112:127], a[8:11], a[92:95], v[112:127]
  s_waitcnt lgkmcnt(14)
  v_mfma_f32_32x32x16_bf16 v[128:143], a[12:15], a[88:91], v[128:143]
  ds_read_b64_tr_b16 a[44:45], v3 offset:32640
  ds_read_b64_tr_b16 a[46:47], v3 offset:34432
  v_mfma_f32_32x32x16_bf16 v[144:159], a[12:15], a[92:95], v[144:159]
  ds_read_b64_tr_b16 a[48:49], v3 offset:32672
  ds_read_b64_tr_b16 a[50:51], v3 offset:34464
  s_waitcnt lgkmcnt(15)
  v_mfma_f32_32x32x16_bf16 v[160:175], a[16:19], a[88:91], v[160:175]
  v_mfma_f32_32x32x16_bf16 v[176:191], a[16:19], a[92:95], v[176:191]
  ds_read_b64_tr_b16 a[52:53], v3 offset:32704
  ds_read_b64_tr_b16 a[54:55], v3 offset:34496
  s_waitcnt lgkmcnt(15)
  v_mfma_f32_32x32x16_bf16 v[192:207], a[20:23], a[88:91], v[192:207]
  buffer_load_dwordx4 a[128:131], v2, s[20:23], s30 offen offset:1024
  buffer_load_dwordx4 a[132:135], v2, s[20:23], s32 offen offset:1024
  v_mfma_f32_32x32x16_bf16 v[208:223], a[20:23], a[92:95], v[208:223]
  s_waitcnt lgkmcnt(14)
  v_mfma_f32_32x32x16_bf16 v[224:239], a[24:27], a[88:91], v[224:239]
  buffer_load_dwordx4 a[136:139], v2, s[20:23], s30 offen offset:2048
  buffer_load_dwordx4 a[140:143], v2, s[20:23], s32 offen offset:2048
  v_mfma_f32_32x32x16_bf16 v[240:255], a[24:27], a[92:95], v[240:255]
  s_waitcnt vmcnt(17)
  s_waitcnt lgkmcnt(12)
  v_mfma_f32_32x32x16_bf16 v[32:47], a[28:31], a[96:99], v[32:47]
  ds_read_b64_tr_b16 a[0:1], v3 offset:36096
  ds_read_b64_tr_b16 a[2:3], v3 offset:37888
  v_mfma_f32_32x32x16_bf16 v[48:63], a[28:31], a[100:103], v[48:63]
  ds_read_b64_tr_b16 a[4:5], v3 offset:36128
  ds_read_b64_tr_b16 a[6:7], v3 offset:37920
  s_waitcnt lgkmcnt(14)
  v_mfma_f32_32x32x16_bf16 v[64:79], a[32:35], a[96:99], v[64:79]
  ds_read_b64_tr_b16 a[8:9], v3 offset:36160
  ds_read_b64_tr_b16 a[10:11], v3 offset:37952
  v_mfma_f32_32x32x16_bf16 v[80:95], a[32:35], a[100:103], v[80:95]
  ds_read_b64_tr_b16 a[12:13], v3 offset:36192
  ds_read_b64_tr_b16 a[14:15], v3 offset:37984
  s_waitcnt lgkmcnt(15)
  v_mfma_f32_32x32x16_bf16 v[96:111], a[36:39], a[96:99], v[96:111]
  v_mfma_f32_32x32x16_bf16 v[112:127], a[36:39], a[100:103], v[112:127]
  ds_read_b64_tr_b16 a[16:17], v3 offset:36224
  ds_read_b64_tr_b16 a[18:19], v3 offset:38016
  s_waitcnt lgkmcnt(15)
  v_mfma_f32_32x32x16_bf16 v[128:143], a[40:43], a[96:99], v[128:143]
  ds_read_b64_tr_b16 a[20:21], v3 offset:36256
  ds_read_b64_tr_b16 a[22:23], v3 offset:38048
  v_mfma_f32_32x32x16_bf16 v[144:159], a[40:43], a[100:103], v[144:159]
  ds_read_b64_tr_b16 a[24:25], v3 offset:36288
  ds_read_b64_tr_b16 a[26:27], v3 offset:38080
  s_waitcnt lgkmcnt(15)
  v_mfma_f32_32x32x16_bf16 v[160:175], a[44:47], a[96:99], v[160:175]
  s_add_u32 m0, s29, 86784
  s_add_u32 s31, s28, 1376256
  buffer_load_dwordx4 v12, s[16:19], s31 offen lds
  v_mfma_f32_32x32x16_bf16 v[176:191], a[44:47], a[100:103], v[176:191]
  v_mfma_f32_32x32x16_bf16 v[192:207], a[48:51], a[96:99], v[192:207]
  s_add_u32 m0, s29, 87808
  s_nop 0
  buffer_load_dwordx4 v13, s[16:19], s31 offen lds
  v_mfma_f32_32x32x16_bf16 v[208:223], a[48:51], a[100:103], v[208:223]
  s_add_u32 m0, s29, 88832
  s_nop 0
  buffer_load_dwordx4 v14, s[16:19], s31 offen lds
  s_waitcnt lgkmcnt(14)
  v_mfma_f32_32x32x16_bf16 v[224:239], a[52:55], a[96:99], v[224:239]
  s_add_u32 m0, s29, 89856
  s_nop 0
  buffer_load_dwordx4 v15, s[16:19], s31 offen lds
  v_mfma_f32_32x32x16_bf16 v[240:255], a[52:55], a[100:103], v[240:255]
  s_waitcnt vmcnt(19)
  s_waitcnt lgkmcnt(12)
  v_mfma_f32_32x32x16_bf16 v[32:47], a[0:3], a[104:107], v[32:47]
  ds_read_b64_tr_b16 a[28:29], v3 offset:39680
  ds_read_b64_tr_b16 a[30:31], v3 offset:41472
  v_mfma_f32_32x32x16_bf16 v[48:63], a[0:3], a[108:111], v[48:63]
  ds_read_b64_tr_b16 a[32:33], v3 offset:39712
  ds_read_b64_tr_b16 a[34:35], v3 offset:41504
  s_waitcnt lgkmcnt(14)
  v_mfma_f32_32x32x16_bf16 v[64:79], a[4:7], a[104:107], v[64:79]
  ds_read_b64_tr_b16 a[36:37], v3 offset:39744
  ds_read_b64_tr_b16 a[38:39], v3 offset:41536
  v_mfma_f32_32x32x16_bf16 v[80:95], a[4:7], a[108:111], v[80:95]
  ds_read_b64_tr_b16 a[40:41], v3 offset:39776
  ds_read_b64_tr_b16 a[42:43], v3 offset:41568
  s_waitcnt lgkmcnt(15)
  v_mfma_f32_32x32x16_bf16 v[96:111], a[8:11], a[104:107], v[96:111]
  ds_read_b64_tr_b16 a[44:45], v3 offset:39808
  ds_read_b64_tr_b16 a[46:47], v3 offset:41600
  v_mfma_f32_32x32x16_bf16 v[112:127], a[8:11], a[108:111], v[112:127]
  ds_read_b64_tr_b16 a[48:49], v3 offset:39840
  ds_read_b64_tr_b16 a[50:51], v3 offset:41632
  s_waitcnt lgkmcnt(15)
  v_mfma_f32_32x32x16_bf16 v[128:143], a[12:15], a[104:107], v[128:143]
  ds_read_b64_tr_b16 a[52:53], v3 offset:39872
  ds_read_b64_tr_b16 a[54:55], v3 offset:41664
  v_mfma_f32_32x32x16_bf16 v[144:159], a[12:15], a[108:111], v[144:159]
  s_add_u32 m0, s29, 90880
  s_nop 0
  buffer_load_dwordx4 v16, s[16:19], s31 offen lds
  v_mfma_f32_32x32x16_bf16 v[160:175], a[16:19], a[104:107], v[160:175]
  s_add_u32 m0, s29, 91904
  s_nop 0
  buffer_load_dwordx4 v17, s[16:19], s31 offen lds
  v_mfma_f32_32x32x16_bf16 v[176:191], a[16:19], a[108:111], v[176:191]
  s_add_u32 m0, s29, 92928
  s_nop 0
  buffer_load_dwordx4 v18, s[16:19], s31 offen lds
  s_waitcnt lgkmcnt(15)
  v_mfma_f32_32x32x16_bf16 v[192:207], a[20:23], a[104:107], v[192:207]
  buffer_load_dwordx4 a[144:147], v2, s[20:23], s30 offen offset:3072
  buffer_load_dwordx4 a[148:151], v2, s[20:23], s32 offen offset:3072
  v_mfma_f32_32x32x16_bf16 v[208:223], a[20:23], a[108:111], v[208:223]
  buffer_load_dwordx4 a[184:187], v2, s[40:43], s44 offen offset:0
  s_waitcnt lgkmcnt(14)
  v_mfma_f32_32x32x16_bf16 v[224:239], a[24:27], a[104:107], v[224:239]
  buffer_load_dwordx4 a[188:191], v2, s[40:43], s44 offen offset:1024
  v_mfma_f32_32x32x16_bf16 v[240:255], a[24:27], a[108:111], v[240:255]
  s_waitcnt vmcnt(17)
  s_waitcnt lgkmcnt(12)
  v_mfma_f32_32x32x16_bf16 v[32:47], a[28:31], a[112:115], v[32:47]
  s_waitcnt lgkmcnt(0)
  s_barrier
  v_mfma_f32_32x32x16_bf16 v[48:63], a[28:31], a[116:119], v[48:63]
  ds_read_b64_tr_b16 a[0:1], v3 offset:57856
  ds_read_b64_tr_b16 a[2:3], v3 offset:59648
  v_mfma_f32_32x32x16_bf16 v[64:79], a[32:35], a[112:115], v[64:79]
  ds_read_b64_tr_b16 a[4:5], v3 offset:57888
  ds_read_b64_tr_b16 a[6:7], v3 offset:59680
  v_mfma_f32_32x32x16_bf16 v[80:95], a[32:35], a[116:119], v[80:95]
  ds_read_b64_tr_b16 a[8:9], v3 offset:57920
  ds_read_b64_tr_b16 a[10:11], v3 offset:59712
  v_mfma_f32_32x32x16_bf16 v[96:111], a[36:39], a[112:115], v[96:111]
  ds_read_b64_tr_b16 a[12:13], v3 offset:57952
  ds_read_b64_tr_b16 a[14:15], v3 offset:59744
  v_mfma_f32_32x32x16_bf16 v[112:127], a[36:39], a[116:119], v[112:127]
  ds_read_b64_tr_b16 a[16:17], v3 offset:57984
  ds_read_b64_tr_b16 a[18:19], v3 offset:59776
  v_mfma_f32_32x32x16_bf16 v[128:143], a[40:43], a[112:115], v[128:143]
  ds_read_b64_tr_b16 a[20:21], v3 offset:58016
  ds_read_b64_tr_b16 a[22:23], v3 offset:59808
  v_mfma_f32_32x32x16_bf16 v[144:159], a[40:43], a[116:119], v[144:159]
  v_mfma_f32_32x32x16_bf16 v[160:175], a[44:47], a[112:115], v[160:175]
  ds_read_b64_tr_b16 a[24:25], v3 offset:58048
  ds_read_b64_tr_b16 a[26:27], v3 offset:59840
  v_mfma_f32_32x32x16_bf16 v[176:191], a[44:47], a[116:119], v[176:191]
  s_add_u32 s30, s30, 4096
  buffer_load_dwordx4 a[152:155], v2, s[20:23], s30 offen offset:0
  s_add_u32 s32, s32, 4096
  buffer_load_dwordx4 a[156:159], v2, s[20:23], s32 offen offset:0
  v_mfma_f32_32x32x16_bf16 v[192:207], a[48:51], a[112:115], v[192:207]
  buffer_load_dwordx4 a[160:163], v2, s[20:23], s30 offen offset:1024
  buffer_load_dwordx4 a[164:167], v2, s[20:23], s32 offen offset:1024
  v_mfma_f32_32x32x16_bf16 v[208:223], a[48:51], a[116:119], v[208:223]
  buffer_load_dwordx4 a[192:195], v2, s[40:43], s44 offen offset:2048
  v_mfma_f32_32x32x16_bf16 v[224:239], a[52:55], a[112:115], v[224:239]
  buffer_load_dwordx4 a[196:199], v2, s[40:43], s44 offen offset:3072
  v_mfma_f32_32x32x16_bf16 v[240:255], a[52:55], a[116:119], v[240:255]
  s_waitcnt vmcnt(21)
  s_waitcnt lgkmcnt(12)
  v_mfma_f32_32x32x16_bf16 v[32:47], a[0:3], a[120:123], v[32:47]
  ds_read_b64_tr_b16 a[28:29], v3 offset:61440
  ds_read_b64_tr_b16 a[30:31], v3 offset:63232
  v_mfma_f32_32x32x16_bf16 v[48:63], a[0:3], a[124:127], v[48:63]
  ds_read_b64_tr_b16 a[32:33], v3 offset:61472
  ds_read_b64_tr_b16 a[34:35], v3 offset:63264
  s_waitcnt lgkmcnt(14)
  v_mfma_f32_32x32x16_bf16 v[64:79], a[4:7], a[120:123], v[64:79]
  ds_read_b64_tr_b16 a[36:37], v3 offset:61504
  ds_read_b64_tr_b16 a[38:39], v3 offset:63296
  v_mfma_f32_32x32x16_bf16 v[80:95], a[4:7], a[124:127], v[80:95]
  ds_read_b64_tr_b16 a[40:41], v3 offset:61536
  ds_read_b64_tr_b16 a[42:43], v3 offset:63328
  s_waitcnt lgkmcnt(15)
  v_mfma_f32_32x32x16_bf16 v[96:111], a[8:11], a[120:123], v[96:111]
  ds_read_b64_tr_b16 a[44:45], v3 offset:61568
  ds_read_b64_tr_b16 a[46:47], v3 offset:63360
  v_mfma_f32_32x32x16_bf16 v[112:127], a[8:11], a[124:127], v[112:127]
  ds_read_b64_tr_b16 a[48:49], v3 offset:61600
  ds_read_b64_tr_b16 a[50:51], v3 offset:63392
  s_waitcnt lgkmcnt(15)
  v_mfma_f32_32x32x16_bf16 v[128:143], a[12:15], a[120:123], v[128:143]
  v_mfma_f32_32x32x16_bf16 v[144:159], a[12:15], a[124:127], v[144:159]
  ds_read_b64_tr_b16 a[52:53], v3 offset:61632
  ds_read_b64_tr_b16 a[54:55], v3 offset:63424
  v_mfma_f32_32x32x16_bf16 v[160:175], a[16:19], a[120:123], v[160:175]
  buffer_load_dwordx4 a[168:171], v2, s[20:23], s30 offen offset:2048
  buffer_load_dwordx4 a[172:175], v2, s[20:23], s32 offen offset:2048
  v_mfma_f32_32x32x16_bf16 v[176:191], a[16:19], a[124:127], v[176:191]
  s_add_u32 m0, s29, 115712
  s_add_u32 s31, s28, 1835008
  buffer_load_dwordx4 v12, s[16:19], s31 offen lds
  s_waitcnt lgkmcnt(15)
  v_mfma_f32_32x32x16_bf16 v[192:207], a[20:23], a[120:123], v[192:207]
  s_add_u32 m0, s29, 116736
  s_nop 0
  buffer_load_dwordx4 v13, s[16:19], s31 offen lds
  v_mfma_f32_32x32x16_bf16 v[208:223], a[20:23], a[124:127], v[208:223]
  buffer_load_dwordx4 a[200:203], v2, s[40:43], s45 offen offset:0
  s_waitcnt lgkmcnt(14)
  v_mfma_f32_32x32x16_bf16 v[224:239], a[24:27], a[120:123], v[224:239]
  buffer_load_dwordx4 a[204:207], v2, s[40:43], s45 offen offset:1024
  v_mfma_f32_32x32x16_bf16 v[240:255], a[24:27], a[124:127], v[240:255]
  s_waitcnt vmcnt(25)
  s_waitcnt lgkmcnt(12)
  v_mfma_f32_32x32x16_bf16 v[32:47], a[28:31], a[128:131], v[32:47]
  ds_read_b64_tr_b16 a[0:1], v3 offset:65024
  ds_read_b64_tr_b16 a[2:3], v4 offset:1280
  v_mfma_f32_32x32x16_bf16 v[48:63], a[28:31], a[132:135], v[48:63]
  ds_read_b64_tr_b16 a[4:5], v3 offset:65056
  ds_read_b64_tr_b16 a[6:7], v4 offset:1312
  s_waitcnt lgkmcnt(14)
  v_mfma_f32_32x32x16_bf16 v[64:79], a[32:35], a[128:131], v[64:79]
  ds_read_b64_tr_b16 a[8:9], v3 offset:65088
  ds_read_b64_tr_b16 a[10:11], v4 offset:1344
  v_mfma_f32_32x32x16_bf16 v[80:95], a[32:35], a[132:135], v[80:95]
  ds_read_b64_tr_b16 a[12:13], v3 offset:65120
  ds_read_b64_tr_b16 a[14:15], v4 offset:1376
  s_waitcnt lgkmcnt(15)
  v_mfma_f32_32x32x16_bf16 v[96:111], a[36:39], a[128:131], v[96:111]
  ds_read_b64_tr_b16 a[16:17], v3 offset:65152
  ds_read_b64_tr_b16 a[18:19], v4 offset:1408
  v_mfma_f32_32x32x16_bf16 v[112:127], a[36:39], a[132:135], v[112:127]
  ds_read_b64_tr_b16 a[20:21], v3 offset:65184
  ds_read_b64_tr_b16 a[22:23], v4 offset:1440
  s_waitcnt lgkmcnt(15)
  v_mfma_f32_32x32x16_bf16 v[128:143], a[40:43], a[128:131], v[128:143]
  ds_read_b64_tr_b16 a[24:25], v3 offset:65216
  ds_read_b64_tr_b16 a[26:27], v4 offset:1472
  v_mfma_f32_32x32x16_bf16 v[144:159], a[40:43], a[132:135], v[144:159]
  s_add_u32 m0, s29, 117760
  s_nop 0
  buffer_load_dwordx4 v14, s[16:19], s31 offen lds
  v_mfma_f32_32x32x16_bf16 v[160:175], a[44:47], a[128:131], v[160:175]
  s_add_u32 m0, s29, 118784
  s_nop 0
  buffer_load_dwordx4 v15, s[16:19], s31 offen lds
  v_mfma_f32_32x32x16_bf16 v[176:191], a[44:47], a[132:135], v[176:191]
  s_add_u32 m0, s29, 119808
  s_nop 0
  buffer_load_dwordx4 v16, s[16:19], s31 offen lds
  s_waitcnt lgkmcnt(15)
  v_mfma_f32_32x32x16_bf16 v[192:207], a[48:51], a[128:131], v[192:207]
  s_add_u32 m0, s29, 120832
  s_nop 0
  buffer_load_dwordx4 v17, s[16:19], s31 offen lds
  v_mfma_f32_32x32x16_bf16 v[208:223], a[48:51], a[132:135], v[208:223]
  buffer_load_dwordx4 a[208:211], v2, s[40:43], s45 offen offset:2048
  s_waitcnt lgkmcnt(14)
  v_mfma_f32_32x32x16_bf16 v[224:239], a[52:55], a[128:131], v[224:239]
  s_mov_b32 s46, 0x05040100
  v_mfma_f32_32x32x16_bf16 v[240:255], a[52:55], a[132:135], v[240:255]
  s_waitcnt vmcnt(28)
  s_waitcnt lgkmcnt(12)
  v_mfma_f32_32x32x16_bf16 v[32:47], a[0:3], a[136:139], v[32:47]
  ds_read_b64_tr_b16 a[28:29], v4 offset:3072
  ds_read_b64_tr_b16 a[30:31], v4 offset:4864
  v_mfma_f32_32x32x16_bf16 v[48:63], a[0:3], a[140:143], v[48:63]
  ds_read_b64_tr_b16 a[32:33], v4 offset:3104
  ds_read_b64_tr_b16 a[34:35], v4 offset:4896
  s_waitcnt lgkmcnt(14)
  v_mfma_f32_32x32x16_bf16 v[64:79], a[4:7], a[136:139], v[64:79]
  ds_read_b64_tr_b16 a[36:37], v4 offset:3136
  ds_read_b64_tr_b16 a[38:39], v4 offset:4928
  v_mfma_f32_32x32x16_bf16 v[80:95], a[4:7], a[140:143], v[80:95]
  ds_read_b64_tr_b16 a[40:41], v4 offset:3168
  ds_read_b64_tr_b16 a[42:43], v4 offset:4960
  s_waitcnt lgkmcnt(15)
  v_mfma_f32_32x32x16_bf16 v[96:111], a[8:11], a[136:139], v[96:111]
  ds_read_b64_tr_b16 a[44:45], v4 offset:3200
  ds_read_b64_tr_b16 a[46:47], v4 offset:4992
  v_mfma_f32_32x32x16_bf16 v[112:127], a[8:11], a[140:143], v[112:127]
  ds_read_b64_tr_b16 a[48:49], v4 offset:3232
  ds_read_b64_tr_b16 a[50:51], v4 offset:5024
  s_waitcnt lgkmcnt(15)
  v_mfma_f32_32x32x16_bf16 v[128:143], a[12:15], a[136:139], v[128:143]
  v_mfma_f32_32x32x16_bf16 v[144:159], a[12:15], a[140:143], v[144:159]
  ds_read_b64_tr_b16 a[52:53], v4 offset:3264
  ds_read_b64_tr_b16 a[54:55], v4 offset:5056
  v_mfma_f32_32x32x16_bf16 v[160:175], a[16:19], a[136:139], v[160:175]
  s_add_u32 m0, s29, 121856
  s_nop 0
  buffer_load_dwordx4 v18, s[16:19], s31 offen lds
  v_mfma_f32_32x32x16_bf16 v[176:191], a[16:19], a[140:143], v[176:191]
  buffer_load_dwordx4 a[176:179], v2, s[20:23], s30 offen offset:3072
  buffer_load_dwordx4 a[180:183], v2, s[20:23], s32 offen offset:3072
  s_waitcnt lgkmcnt(15)
  v_mfma_f32_32x32x16_bf16 v[192:207], a[20:23], a[136:139], v[192:207]
  s_add_u32 s30, s30, 4096
  buffer_load_dwordx4 a[56:59], v2, s[20:23], s30 offen offset:0
  s_add_u32 s32, s32, 4096
  buffer_load_dwordx4 a[60:63], v2, s[20:23], s32 offen offset:0
  v_mfma_f32_32x32x16_bf16 v[208:223], a[20:23], a[140:143], v[208:223]
  buffer_load_dwordx4 a[220:223], v7, s[36:39], s34 offen offset:0
  buffer_load_dwordx4 a[224:227], v7, s[36:39], s34 offen offset:16
  buffer_load_dwordx4 a[228:231], v7, s[36:39], s34 offen offset:32
  buffer_load_dwordx4 a[232:235], v7, s[36:39], s34 offen offset:48
  s_waitcnt lgkmcnt(14)
  v_mfma_f32_32x32x16_bf16 v[224:239], a[24:27], a[136:139], v[224:239]
  v_mfma_f32_32x32x16_bf16 v[240:255], a[24:27], a[140:143], v[240:255]
  s_waitcnt vmcnt(28)
  s_waitcnt lgkmcnt(12)
  v_mfma_f32_32x32x16_bf16 v[32:47], a[28:31], a[144:147], v[32:47]
  s_waitcnt lgkmcnt(0)
  s_barrier
  v_mfma_f32_32x32x16_bf16 v[48:63], a[28:31], a[148:151], v[48:63]
  ds_read_b64_tr_b16 a[0:1], v4 offset:21248
  ds_read_b64_tr_b16 a[2:3], v4 offset:23040
  v_mfma_f32_32x32x16_bf16 v[64:79], a[32:35], a[144:147], v[64:79]
  ds_read_b64_tr_b16 a[4:5], v4 offset:21280
  ds_read_b64_tr_b16 a[6:7], v4 offset:23072
  v_mfma_f32_32x32x16_bf16 v[80:95], a[32:35], a[148:151], v[80:95]
  ds_read_b64_tr_b16 a[8:9], v4 offset:21312
  ds_read_b64_tr_b16 a[10:11], v4 offset:23104
  v_mfma_f32_32x32x16_bf16 v[96:111], a[36:39], a[144:147], v[96:111]
  ds_read_b64_tr_b16 a[12:13], v4 offset:21344
  ds_read_b64_tr_b16 a[14:15], v4 offset:23136
  v_mfma_f32_32x32x16_bf16 v[112:127], a[36:39], a[148:151], v[112:127]
  ds_read_b64_tr_b16 a[16:17], v4 offset:21376
  ds_read_b64_tr_b16 a[18:19], v4 offset:23168
  v_mfma_f32_32x32x16_bf16 v[128:143], a[40:43], a[144:147], v[128:143]
  ds_read_b64_tr_b16 a[20:21], v4 offset:21408
  ds_read_b64_tr_b16 a[22:23], v4 offset:23200
  v_mfma_f32_32x32x16_bf16 v[144:159], a[40:43], a[148:151], v[144:159]
  v_mfma_f32_32x32x16_bf16 v[160:175], a[44:47], a[144:147], v[160:175]
  ds_read_b64_tr_b16 a[24:25], v4 offset:21440
  ds_read_b64_tr_b16 a[26:27], v4 offset:23232
  v_mfma_f32_32x32x16_bf16 v[176:191], a[44:47], a[148:151], v[176:191]
  buffer_load_dwordx4 a[64:67], v2, s[20:23], s30 offen offset:1024
  buffer_load_dwordx4 a[68:71], v2, s[20:23], s32 offen offset:1024
  v_mfma_f32_32x32x16_bf16 v[192:207], a[48:51], a[144:147], v[192:207]
  buffer_load_dwordx4 a[72:75], v2, s[20:23], s30 offen offset:2048
  buffer_load_dwordx4 a[76:79], v2, s[20:23], s32 offen offset:2048
  v_mfma_f32_32x32x16_bf16 v[208:223], a[48:51], a[148:151], v[208:223]
  v_mfma_f32_32x32x16_bf16 v[224:239], a[52:55], a[144:147], v[224:239]
  v_mfma_f32_32x32x16_bf16 v[240:255], a[52:55], a[148:151], v[240:255]
  s_waitcnt vmcnt(28)
  s_waitcnt lgkmcnt(12)
  v_mfma_f32_32x32x16_bf16 v[32:47], a[0:3], a[152:155], v[32:47]
  ds_read_b64_tr_b16 a[28:29], v4 offset:24832
  ds_read_b64_tr_b16 a[30:31], v4 offset:26624
  v_mfma_f32_32x32x16_bf16 v[48:63], a[0:3], a[156:159], v[48:63]
  ds_read_b64_tr_b16 a[32:33], v4 offset:24864
  ds_read_b64_tr_b16 a[34:35], v4 offset:26656
  s_waitcnt lgkmcnt(14)
  v_mfma_f32_32x32x16_bf16 v[64:79], a[4:7], a[152:155], v[64:79]
  ds_read_b64_tr_b16 a[36:37], v4 offset:24896
  ds_read_b64_tr_b16 a[38:39], v4 offset:26688
  v_mfma_f32_32x32x16_bf16 v[80:95], a[4:7], a[156:159], v[80:95]
  ds_read_b64_tr_b16 a[40:41], v4 offset:24928
  ds_read_b64_tr_b16 a[42:43], v4 offset:26720
  s_waitcnt lgkmcnt(15)
  v_mfma_f32_32x32x16_bf16 v[96:111], a[8:11], a[152:155], v[96:111]
  ds_read_b64_tr_b16 a[44:45], v4 offset:24960
  ds_read_b64_tr_b16 a[46:47], v4 offset:26752
  v_mfma_f32_32x32x16_bf16 v[112:127], a[8:11], a[156:159], v[112:127]
  ds_read_b64_tr_b16 a[48:49], v4 offset:24992
  ds_read_b64_tr_b16 a[50:51], v4 offset:26784
  s_waitcnt lgkmcnt(15)
  v_mfma_f32_32x32x16_bf16 v[128:143], a[12:15], a[152:155], v[128:143]
  ds_read_b64_tr_b16 a[52:53], v4 offset:25024
  ds_read_b64_tr_b16 a[54:55], v4 offset:26816
  v_mfma_f32_32x32x16_bf16 v[144:159], a[12:15], a[156:159], v[144:159]
  s_add_u32 m0, s29, 0
  s_add_u32 s31, s28, 2293760
  buffer_load_dwordx4 v12, s[16:19], s31 offen lds
  v_mfma_f32_32x32x16_bf16 v[160:175], a[16:19], a[152:155], v[160:175]
  s_add_u32 m0, s29, 1024
  s_nop 0
  buffer_load_dwordx4 v13, s[16:19], s31 offen lds
  v_mfma_f32_32x32x16_bf16 v[176:191], a[16:19], a[156:159], v[176:191]
  s_add_u32 m0, s29, 2048
  s_nop 0
  buffer_load_dwordx4 v14, s[16:19], s31 offen lds
  s_waitcnt lgkmcnt(15)
  v_mfma_f32_32x32x16_bf16 v[192:207], a[20:23], a[152:155], v[192:207]
  s_add_u32 m0, s29, 3072
  s_nop 0
  buffer_load_dwordx4 v15, s[16:19], s31 offen lds
  v_mfma_f32_32x32x16_bf16 v[208:223], a[20:23], a[156:159], v[208:223]
  s_waitcnt lgkmcnt(14)
  v_mfma_f32_32x32x16_bf16 v[224:239], a[24:27], a[152:155], v[224:239]
  v_mfma_f32_32x32x16_bf16 v[240:255], a[24:27], a[156:159], v[240:255]
  s_waitcnt vmcnt(30)
  s_waitcnt lgkmcnt(12)
  v_mfma_f32_32x32x16_bf16 v[32:47], a[28:31], a[160:163], v[32:47]
  ds_read_b64_tr_b16 a[0:1], v4 offset:28416
  ds_read_b64_tr_b16 a[2:3], v4 offset:30208
  v_mfma_f32_32x32x16_bf16 v[48:63], a[28:31], a[164:167], v[48:63]
  ds_read_b64_tr_b16 a[4:5], v4 offset:28448
  ds_read_b64_tr_b16 a[6:7], v4 offset:30240
  s_waitcnt lgkmcnt(14)
  v_mfma_f32_32x32x16_bf16 v[64:79], a[32:35], a[160:163], v[64:79]
  ds_read_b64_tr_b16 a[8:9], v4 offset:28480
  ds_read_b64_tr_b16 a[10:11], v4 offset:30272
  v_mfma_f32_32x32x16_bf16 v[80:95], a[32:35], a[164:167], v[80:95]
  ds_read_b64_tr_b16 a[12:13], v4 offset:28512
  ds_read_b64_tr_b16 a[14:15], v4 offset:30304
  s_waitcnt lgkmcnt(15)
  v_mfma_f32_32x32x16_bf16 v[96:111], a[36:39], a[160:163], v[96:111]
  ds_read_b64_tr_b16 a[16:17], v4 offset:28544
  ds_read_b64_tr_b16 a[18:19], v4 offset:30336
  v_mfma_f32_32x32x16_bf16 v[112:127], a[36:39], a[164:167], v[112:127]
  ds_read_b64_tr_b16 a[20:21], v4 offset:28576
  ds_read_b64_tr_b16 a[22:23], v4 offset:30368
  s_waitcnt lgkmcnt(15)
  v_mfma_f32_32x32x16_bf16 v[128:143], a[40:43], a[160:163], v[128:143]
  ds_read_b64_tr_b16 a[24:25], v4 offset:28608
  ds_read_b64_tr_b16 a[26:27], v4 offset:30400
  v_mfma_f32_32x32x16_bf16 v[144:159], a[40:43], a[164:167], v[144:159]
  s_add_u32 m0, s29, 4096
  s_nop 0
  buffer_load_dwordx4 v16, s[16:19], s31 offen lds
  v_mfma_f32_32x32x16_bf16 v[160:175], a[44:47], a[160:163], v[160:175]
  s_add_u32 m0, s29, 5120
  s_nop 0
  buffer_load_dwordx4 v17, s[16:19], s31 offen lds
  v_mfma_f32_32x32x16_bf16 v[176:191], a[44:47], a[164:167], v[176:191]
  s_add_u32 m0, s29, 6144
  s_nop 0
  buffer_load_dwordx4 v18, s[16:19], s31 offen lds
  s_waitcnt lgkmcnt(15)
  v_mfma_f32_32x32x16_bf16 v[192:207], a[48:51], a[160:163], v[192:207]
  buffer_load_dwordx4 a[80:83], v2, s[20:23], s30 offen offset:3072
  buffer_load_dwordx4 a[84:87], v2, s[20:23], s32 offen offset:3072
  v_mfma_f32_32x32x16_bf16 v[208:223], a[48:51], a[164:167], v[208:223]
  s_waitcnt lgkmcnt(14)
  v_mfma_f32_32x32x16_bf16 v[224:239], a[52:55], a[160:163], v[224:239]
  v_mfma_f32_32x32x16_bf16 v[240:255], a[52:55], a[164:167], v[240:255]
  s_waitcnt vmcnt(31)
  s_waitcnt lgkmcnt(12)
  v_mfma_f32_32x32x16_bf16 v[32:47], a[0:3], a[168:171], v[32:47]
  ds_read_b64_tr_b16 a[28:29], v4 offset:32000
  ds_read_b64_tr_b16 a[30:31], v4 offset:33792
  v_mfma_f32_32x32x16_bf16 v[48:63], a[0:3], a[172:175], v[48:63]
  ds_read_b64_tr_b16 a[32:33], v4 offset:32032
  ds_read_b64_tr_b16 a[34:35], v4 offset:33824
  s_waitcnt lgkmcnt(14)
  v_mfma_f32_32x32x16_bf16 v[64:79], a[4:7], a[168:171], v[64:79]
  ds_read_b64_tr_b16 a[36:37], v4 offset:32064
  ds_read_b64_tr_b16 a[38:39], v4 offset:33856
  v_mfma_f32_32x32x16_bf16 v[80:95], a[4:7], a[172:175], v[80:95]
  ds_read_b64_tr_b16 a[40:41], v4 offset:32096
  ds_read_b64_tr_b16 a[42:43], v4 offset:33888
  s_waitcnt lgkmcnt(15)
  v_mfma_f32_32x32x16_bf16 v[96:111], a[8:11], a[168:171], v[96:111]
  v_mfma_f32_32x32x16_bf16 v[112:127], a[8:11], a[172:175], v[112:127]
  ds_read_b64_tr_b16 a[44:45], v4 offset:32128
  ds_read_b64_tr_b16 a[46:47], v4 offset:33920
  s_waitcnt lgkmcnt(15)
  v_mfma_f32_32x32x16_bf16 v[128:143], a[12:15], a[168:171], v[128:143]
  ds_read_b64_tr_b16 a[48:49], v4 offset:32160
  ds_read_b64_tr_b16 a[50:51], v4 offset:33952
  v_mfma_f32_32x32x16_bf16 v[144:159], a[12:15], a[172:175], v[144:159]
  ds_read_b64_tr_b16 a[52:53], v4 offset:32192
  ds_read_b64_tr_b16 a[54:55], v4 offset:33984
  s_waitcnt lgkmcnt(15)
  v_mfma_f32_32x32x16_bf16 v[160:175], a[16:19], a[168:171], v[160:175]
  s_add_u32 s30, s30, 4096
  buffer_load_dwordx4 a[88:91], v2, s[20:23], s30 offen offset:0
  s_add_u32 s32, s32, 4096
  buffer_load_dwordx4 a[92:95], v2, s[20:23], s32 offen offset:0
  v_mfma_f32_32x32x16_bf16 v[176:191], a[16:19], a[172:175], v[176:191]
  v_mfma_f32_32x32x16_bf16 v[192:207], a[20:23], a[168:171], v[192:207]
  buffer_load_dwordx4 a[96:99], v2, s[20:23], s30 offen offset:1024
  buffer_load_dwordx4 a[100:103], v2, s[20:23], s32 offen offset:1024
  v_mfma_f32_32x32x16_bf16 v[208:223], a[20:23], a[172:175], v[208:223]
  s_waitcnt lgkmcnt(14)
  v_mfma_f32_32x32x16_bf16 v[224:239], a[24:27], a[168:171], v[224:239]
  v_mfma_f32_32x32x16_bf16 v[240:255], a[24:27], a[172:175], v[240:255]
  s_waitcnt vmcnt(23)
  s_waitcnt lgkmcnt(12)
  v_mfma_f32_32x32x16_bf16 v[32:47], a[28:31], a[176:179], v[32:47]
  s_waitcnt lgkmcnt(0)
  s_barrier
  v_mfma_f32_32x32x16_bf16 v[48:63], a[28:31], a[180:183], v[48:63]
  ds_read_b64_tr_b16 a[0:1], v4 offset:50176
  ds_read_b64_tr_b16 a[2:3], v4 offset:51968
  v_mfma_f32_32x32x16_bf16 v[64:79], a[32:35], a[176:179], v[64:79]
  ds_read_b64_tr_b16 a[4:5], v4 offset:50208
  ds_read_b64_tr_b16 a[6:7], v4 offset:52000
  v_mfma_f32_32x32x16_bf16 v[80:95], a[32:35], a[180:183], v[80:95]
  ds_read_b64_tr_b16 a[8:9], v4 offset:50240
  ds_read_b64_tr_b16 a[10:11], v4 offset:52032
  v_mfma_f32_32x32x16_bf16 v[96:111], a[36:39], a[176:179], v[96:111]
  ds_read_b64_tr_b16 a[12:13], v4 offset:50272
  ds_read_b64_tr_b16 a[14:15], v4 offset:52064
  v_mfma_f32_32x32x16_bf16 v[112:127], a[36:39], a[180:183], v[112:127]
  ds_read_b64_tr_b16 a[16:17], v4 offset:50304
  ds_read_b64_tr_b16 a[18:19], v4 offset:52096
  v_mfma_f32_32x32x16_bf16 v[128:143], a[40:43], a[176:179], v[128:143]
  ds_read_b64_tr_b16 a[20:21], v4 offset:50336
  ds_read_b64_tr_b16 a[22:23], v4 offset:52128
  v_mfma_f32_32x32x16_bf16 v[144:159], a[40:43], a[180:183], v[144:159]
  ds_read_b64_tr_b16 a[24:25], v4 offset:50368
  ds_read_b64_tr_b16 a[26:27], v4 offset:52160
  v_mfma_f32_32x32x16_bf16 v[160:175], a[44:47], a[176:179], v[160:175]
  buffer_load_dwordx4 a[104:107], v2, s[20:23], s30 offen offset:2048
  buffer_load_dwordx4 a[108:111], v2, s[20:23], s32 offen offset:2048
  v_mfma_f32_32x32x16_bf16 v[176:191], a[44:47], a[180:183], v[176:191]
  s_add_u32 m0, s29, 28928
  s_add_u32 s31, s28, 2752512
  buffer_load_dwordx4 v12, s[16:19], s31 offen lds
  v_mfma_f32_32x32x16_bf16 v[192:207], a[48:51], a[176:179], v[192:207]
  s_add_u32 m0, s29, 29952
  s_nop 0
  buffer_load_dwordx4 v13, s[16:19], s31 offen lds
  v_mfma_f32_32x32x16_bf16 v[208:223], a[48:51], a[180:183], v[208:223]
  v_mfma_f32_32x32x16_bf16 v[224:239], a[52:55], a[176:179], v[224:239]
  v_mfma_f32_32x32x16_bf16 v[240:255], a[52:55], a[180:183], v[240:255]
  s_waitcnt vmcnt(25)
  s_waitcnt lgkmcnt(12)
  v_mfma_f32_32x32x16_bf16 v[32:47], a[0:3], a[56:59], v[32:47]
  ds_read_b64_tr_b16 a[28:29], v4 offset:53760
  ds_read_b64_tr_b16 a[30:31], v4 offset:55552
  v_mfma_f32_32x32x16_bf16 v[48:63], a[0:3], a[60:63], v[48:63]
  ds_read_b64_tr_b16 a[32:33], v4 offset:53792
  ds_read_b64_tr_b16 a[34:35], v4 offset:55584
  s_waitcnt lgkmcnt(14)
  v_mfma_f32_32x32x16_bf16 v[64:79], a[4:7], a[56:59], v[64:79]
  ds_read_b64_tr_b16 a[36:37], v4 offset:53824
  ds_read_b64_tr_b16 a[38:39], v4 offset:55616
  v_mfma_f32_32x32x16_bf16 v[80:95], a[4:7], a[60:63], v[80:95]
  ds_read_b64_tr_b16 a[40:41], v4 offset:53856
  ds_read_b64_tr_b16 a[42:43], v4 offset:55648
  s_waitcnt lgkmcnt(15)
  v_mfma_f32_32x32x16_bf16 v[96:111], a[8:11], a[56:59], v[96:111]
  ds_read_b64_tr_b16 a[44:45], v4 offset:53888
  ds_read_b64_tr_b16 a[46:47], v4 offset:55680
  v_mfma_f32_32x32x16_bf16 v[112:127], a[8:11], a[60:63], v[112:127]
  ds_read_b64_tr_b16 a[48:49], v4 offset:53920
  ds_read_b64_tr_b16 a[50:51], v4 offset:55712
  s_waitcnt lgkmcnt(15)
  v_mfma_f32_32x32x16_bf16 v[128:143], a[12:15], a[56:59], v[128:143]
  ds_read_b64_tr_b16 a[52:53], v4 offset:53952
  ds_read_b64_tr_b16 a[54:55], v4 offset:55744
  v_mfma_f32_32x32x16_bf16 v[144:159], a[12:15], a[60:63], v[144:159]
  s_add_u32 m0, s29, 30976
  s_nop 0
  buffer_load_dwordx4 v14, s[16:19], s31 offen lds
  v_mfma_f32_32x32x16_bf16 v[160:175], a[16:19], a[56:59], v[160:175]
  s_add_u32 m0, s29, 32000
  s_nop 0
  buffer_load_dwordx4 v15, s[16:19], s31 offen lds
  v_mfma_f32_32x32x16_bf16 v[176:191], a[16:19], a[60:63], v[176:191]
  s_add_u32 m0, s29, 33024
  s_nop 0
  buffer_load_dwordx4 v16, s[16:19], s31 offen lds
  s_waitcnt lgkmcnt(15)
  v_mfma_f32_32x32x16_bf16 v[192:207], a[20:23], a[56:59], v[192:207]
  s_add_u32 m0, s29, 34048
  s_nop 0
  buffer_load_dwordx4 v17, s[16:19], s31 offen lds
  v_mfma_f32_32x32x16_bf16 v[208:223], a[20:23], a[60:63], v[208:223]
  s_waitcnt lgkmcnt(14)
  v_mfma_f32_32x32x16_bf16 v[224:239], a[24:27], a[56:59], v[224:239]
  v_mfma_f32_32x32x16_bf16 v[240:255], a[24:27], a[60:63], v[240:255]
  s_waitcnt vmcnt(23)
  s_waitcnt lgkmcnt(12)
  v_mfma_f32_32x32x16_bf16 v[32:47], a[28:31], a[64:67], v[32:47]
  ds_read_b64_tr_b16 a[0:1], v4 offset:57344
  ds_read_b64_tr_b16 a[2:3], v4 offset:59136
  v_mfma_f32_32x32x16_bf16 v[48:63], a[28:31], a[68:71], v[48:63]
  ds_read_b64_tr_b16 a[4:5], v4 offset:57376
  ds_read_b64_tr_b16 a[6:7], v4 offset:59168
  s_waitcnt lgkmcnt(14)
  v_mfma_f32_32x32x16_bf16 v[64:79], a[32:35], a[64:67], v[64:79]
  ds_read_b64_tr_b16 a[8:9], v4 offset:57408
  ds_read_b64_tr_b16 a[10:11], v4 offset:59200
  v_mfma_f32_32x32x16_bf16 v[80:95], a[32:35], a[68:71], v[80:95]
  ds_read_b64_tr_b16 a[12:13], v4 offset:57440
  ds_read_b64_tr_b16 a[14:15], v4 offset:59232
  s_waitcnt lgkmcnt(15)
  v_mfma_f32_32x32x16_bf16 v[96:111], a[36:39], a[64:67], v[96:111]
  ds_read_b64_tr_b16 a[16:17], v4 offset:57472
  ds_read_b64_tr_b16 a[18:19], v4 offset:59264
  v_mfma_f32_32x32x16_bf16 v[112:127], a[36:39], a[68:71], v[112:127]
  ds_read_b64_tr_b16 a[20:21], v4 offset:57504
  ds_read_b64_tr_b16 a[22:23], v4 offset:59296
  s_waitcnt lgkmcnt(15)
  v_mfma_f32_32x32x16_bf16 v[128:143], a[40:43], a[64:67], v[128:143]
  v_mfma_f32_32x32x16_bf16 v[144:159], a[40:43], a[68:71], v[144:159]
  ds_read_b64_tr_b16 a[24:25], v4 offset:57536
  ds_read_b64_tr_b16 a[26:27], v4 offset:59328
  v_mfma_f32_32x32x16_bf16 v[160:175], a[44:47], a[64:67], v[160:175]
  s_add_u32 m0, s29, 35072
  s_nop 0
  buffer_load_dwordx4 v18, s[16:19], s31 offen lds
  v_mfma_f32_32x32x16_bf16 v[176:191], a[44:47], a[68:71], v[176:191]
  buffer_load_dwordx4 a[112:115], v2, s[20:23], s30 offen offset:3072
  buffer_load_dwordx4 a[116:119], v2, s[20:23], s32 offen offset:3072
  s_waitcnt lgkmcnt(15)
  v_mfma_f32_32x32x16_bf16 v[192:207], a[48:51], a[64:67], v[192:207]
  s_add_u32 s30, s30, 4096
  buffer_load_dwordx4 a[120:123], v2, s[20:23], s30 offen offset:0
  s_add_u32 s32, s32, 4096
  buffer_load_dwordx4 a[124:127], v2, s[20:23], s32 offen offset:0
  v_mfma_f32_32x32x16_bf16 v[208:223], a[48:51], a[68:71], v[208:223]
  s_waitcnt lgkmcnt(14)
  v_mfma_f32_32x32x16_bf16 v[224:239], a[52:55], a[64:67], v[224:239]
  v_mfma_f32_32x32x16_bf16 v[240:255], a[52:55], a[68:71], v[240:255]
  s_waitcnt vmcnt(26)
  s_waitcnt lgkmcnt(12)
  v_mfma_f32_32x32x16_bf16 v[32:47], a[0:3], a[72:75], v[32:47]
  ds_read_b64_tr_b16 a[28:29], v4 offset:60928
  ds_read_b64_tr_b16 a[30:31], v4 offset:62720
  v_mfma_f32_32x32x16_bf16 v[48:63], a[0:3], a[76:79], v[48:63]
  ds_read_b64_tr_b16 a[32:33], v4 offset:60960
  ds_read_b64_tr_b16 a[34:35], v4 offset:62752
  s_waitcnt lgkmcnt(14)
  v_mfma_f32_32x32x16_bf16 v[64:79], a[4:7], a[72:75], v[64:79]
  ds_read_b64_tr_b16 a[36:37], v4 offset:60992
  ds_read_b64_tr_b16 a[38:39], v4 offset:62784
  v_mfma_f32_32x32x16_bf16 v[80:95], a[4:7], a[76:79], v[80:95]
  ds_read_b64_tr_b16 a[40:41], v4 offset:61024
  ds_read_b64_tr_b16 a[42:43], v4 offset:62816
  s_waitcnt lgkmcnt(15)
  v_mfma_f32_32x32x16_bf16 v[96:111], a[8:11], a[72:75], v[96:111]
  v_mfma_f32_32x32x16_bf16 v[112:127], a[8:11], a[76:79], v[112:127]
  ds_read_b64_tr_b16 a[44:45], v4 offset:61056
  ds_read_b64_tr_b16 a[46:47], v4 offset:62848
  s_waitcnt lgkmcnt(15)
  v_mfma_f32_32x32x16_bf16 v[128:143], a[12:15], a[72:75], v[128:143]
  ds_read_b64_tr_b16 a[48:49], v4 offset:61088
  ds_read_b64_tr_b16 a[50:51], v4 offset:62880
  v_mfma_f32_32x32x16_bf16 v[144:159], a[12:15], a[76:79], v[144:159]
  ds_read_b64_tr_b16 a[52:53], v4 offset:61120
  ds_read_b64_tr_b16 a[54:55], v4 offset:62912
  s_waitcnt lgkmcnt(15)
  v_mfma_f32_32x32x16_bf16 v[160:175], a[16:19], a[72:75], v[160:175]
  buffer_load_dwordx4 a[128:131], v2, s[20:23], s30 offen offset:1024
  buffer_load_dwordx4 a[132:135], v2, s[20:23], s32 offen offset:1024
  v_mfma_f32_32x32x16_bf16 v[176:191], a[16:19], a[76:79], v[176:191]
  v_mfma_f32_32x32x16_bf16 v[192:207], a[20:23], a[72:75], v[192:207]
  buffer_load_dwordx4 a[136:139], v2, s[20:23], s30 offen offset:2048
  buffer_load_dwordx4 a[140:143], v2, s[20:23], s32 offen offset:2048
  v_mfma_f32_32x32x16_bf16 v[208:223], a[20:23], a[76:79], v[208:223]
  s_waitcnt lgkmcnt(14)
  v_mfma_f32_32x32x16_bf16 v[224:239], a[24:27], a[72:75], v[224:239]
  v_mfma_f32_32x32x16_bf16 v[240:255], a[24:27], a[76:79], v[240:255]
  s_waitcnt vmcnt(21)
  s_waitcnt lgkmcnt(12)
  v_mfma_f32_32x32x16_bf16 v[32:47], a[28:31], a[80:83], v[32:47]
  s_waitcnt lgkmcnt(0)
  s_barrier
  v_mfma_f32_32x32x16_bf16 v[48:63], a[28:31], a[84:87], v[48:63]
  ds_read_b64_tr_b16 a[0:1], v3 offset:0
  ds_read_b64_tr_b16 a[2:3], v3 offset:1792
  v_mfma_f32_32x32x16_bf16 v[64:79], a[32:35], a[80:83], v[64:79]
  ds_read_b64_tr_b16 a[4:5], v3 offset:32
  ds_read_b64_tr_b16 a[6:7], v3 offset:1824
  v_mfma_f32_32x32x16_bf16 v[80:95], a[32:35], a[84:87], v[80:95]
  ds_read_b64_tr_b16 a[8:9], v3 offset:64
  ds_read_b64_tr_b16 a[10:11], v3 offset:1856
  v_mfma_f32_32x32x16_bf16 v[96:111], a[36:39], a[80:83], v[96:111]
  ds_read_b64_tr_b16 a[12:13], v3 offset:96
  ds_read_b64_tr_b16 a[14:15], v3 offset:1888
  v_mfma_f32_32x32x16_bf16 v[112:127], a[36:39], a[84:87], v[112:127]
  ds_read_b64_tr_b16 a[16:17], v3 offset:128
  ds_read_b64_tr_b16 a[18:19], v3 offset:1920
  v_mfma_f32_32x32x16_bf16 v[128:143], a[40:43], a[80:83], v[128:143]
  ds_read_b64_tr_b16 a[20:21], v3 offset:160
  ds_read_b64_tr_b16 a[22:23], v3 offset:1952
  v_mfma_f32_32x32x16_bf16 v[144:159], a[40:43], a[84:87], v[144:159]
  ds_read_b64_tr_b16 a[24:25], v3 offset:192
  ds_read_b64_tr_b16 a[26:27], v3 offset:1984
  v_mfma_f32_32x32x16_bf16 v[160:175], a[44:47], a[80:83], v[160:175]
  s_add_u32 m0, s29, 57856
  s_add_u32 s31, s28, 3211264
  buffer_load_dwordx4 v12, s[16:19], s31 offen lds
  v_mfma_f32_32x32x16_bf16 v[176:191], a[44:47], a[84:87], v[176:191]
  s_add_u32 m0, s29, 58880
  s_nop 0
  buffer_load_dwordx4 v13, s[16:19], s31 offen lds
  v_mfma_f32_32x32x16_bf16 v[192:207], a[48:51], a[80:83], v[192:207]
  s_add_u32 m0, s29, 59904
  s_nop 0
  buffer_load_dwordx4 v14, s[16:19], s31 offen lds
  v_mfma_f32_32x32x16_bf16 v[208:223], a[48:51], a[84:87], v[208:223]
  s_add_u32 m0, s29, 60928
  s_nop 0
  buffer_load_dwordx4 v15, s[16:19], s31 offen lds
  v_mfma_f32_32x32x16_bf16 v[224:239], a[52:55], a[80:83], v[224:239]
  v_accvgpr_read_b32 v19, a220
  v_accvgpr_read_b32 v20, a222
  v_accvgpr_read_b32 v21, a224
  v_accvgpr_read_b32 v22, a226
  v_mfma_f32_32x32x16_bf16 v[240:255], a[52:55], a[84:87], v[240:255]
  v_accvgpr_read_b32 v23, a228
  v_accvgpr_read_b32 v24, a230
  v_accvgpr_read_b32 v25, a232
  v_accvgpr_read_b32 v26, a234
  s_waitcnt vmcnt(23)
  s_waitcnt lgkmcnt(12)
  v_mfma_f32_32x32x16_bf16 v[32:47], a[0:3], a[88:91], v[32:47]
  ds_read_b64_tr_b16 a[28:29], v3 offset:3584
  ds_read_b64_tr_b16 a[30:31], v3 offset:5376
  v_mfma_f32_32x32x16_bf16 v[48:63], a[0:3], a[92:95], v[48:63]
  ds_read_b64_tr_b16 a[32:33], v3 offset:3616
  ds_read_b64_tr_b16 a[34:35], v3 offset:5408
  s_waitcnt lgkmcnt(14)
  v_mfma_f32_32x32x16_bf16 v[64:79], a[4:7], a[88:91], v[64:79]
  ds_read_b64_tr_b16 a[36:37], v3 offset:3648
  ds_read_b64_tr_b16 a[38:39], v3 offset:5440
  v_mfma_f32_32x32x16_bf16 v[80:95], a[4:7], a[92:95], v[80:95]
  ds_read_b64_tr_b16 a[40:41], v3 offset:3680
  ds_read_b64_tr_b16 a[42:43], v3 offset:5472
  s_waitcnt lgkmcnt(15)
  v_mfma_f32_32x32x16_bf16 v[96:111], a[8:11], a[88:91], v[96:111]
  ds_read_b64_tr_b16 a[44:45], v3 offset:3712
  ds_read_b64_tr_b16 a[46:47], v3 offset:5504
  v_mfma_f32_32x32x16_bf16 v[112:127], a[8:11], a[92:95], v[112:127]
  ds_read_b64_tr_b16 a[48:49], v3 offset:3744
  ds_read_b64_tr_b16 a[50:51], v3 offset:5536
  s_waitcnt lgkmcnt(15)
  v_mfma_f32_32x32x16_bf16 v[128:143], a[12:15], a[88:91], v[128:143]
  ds_read_b64_tr_b16 a[52:53], v3 offset:3776
  ds_read_b64_tr_b16 a[54:55], v3 offset:5568
  v_mfma_f32_32x32x16_bf16 v[144:159], a[12:15], a[92:95], v[144:159]
  s_add_u32 m0, s29, 61952
  s_nop 0
  buffer_load_dwordx4 v16, s[16:19], s31 offen lds
  v_mfma_f32_32x32x16_bf16 v[160:175], a[16:19], a[88:91], v[160:175]
  s_add_u32 m0, s29, 62976
  s_nop 0
  buffer_load_dwordx4 v17, s[16:19], s31 offen lds
  v_mfma_f32_32x32x16_bf16 v[176:191], a[16:19], a[92:95], v[176:191]
  s_add_u32 m0, s29, 64000
  s_nop 0
  buffer_load_dwordx4 v18, s[16:19], s31 offen lds
  s_waitcnt lgkmcnt(15)
  v_mfma_f32_32x32x16_bf16 v[192:207], a[20:23], a[88:91], v[192:207]
  buffer_load_dwordx4 a[144:147], v2, s[20:23], s30 offen offset:3072
  buffer_load_dwordx4 a[148:151], v2, s[20:23], s32 offen offset:3072
  v_mfma_f32_32x32x16_bf16 v[208:223], a[20:23], a[92:95], v[208:223]
  v_add_f32 v28, v19, v20
  v_add_f32 v28, v28, v21
  v_add_f32 v28, v28, v22
  v_add_f32 v28, v28, v23
  s_waitcnt lgkmcnt(14)
  v_mfma_f32_32x32x16_bf16 v[224:239], a[24:27], a[88:91], v[224:239]
  v_add_f32 v28, v28, v24
  v_add_f32 v28, v28, v25
  v_add_f32 v28, v28, v26
  v_mov_b32 v29, v28
  v_mfma_f32_32x32x16_bf16 v[240:255], a[24:27], a[92:95], v[240:255]
  s_waitcnt vmcnt(26)
  s_waitcnt lgkmcnt(12)
  v_mfma_f32_32x32x16_bf16 v[32:47], a[28:31], a[96:99], v[32:47]
  ds_read_b64_tr_b16 a[0:1], v3 offset:7168
  ds_read_b64_tr_b16 a[2:3], v3 offset:8960
  v_mfma_f32_32x32x16_bf16 v[48:63], a[28:31], a[100:103], v[48:63]
  ds_read_b64_tr_b16 a[4:5], v3 offset:7200
  ds_read_b64_tr_b16 a[6:7], v3 offset:8992
  s_waitcnt lgkmcnt(14)
  v_mfma_f32_32x32x16_bf16 v[64:79], a[32:35], a[96:99], v[64:79]
  ds_read_b64_tr_b16 a[8:9], v3 offset:7232
  ds_read_b64_tr_b16 a[10:11], v3 offset:9024
  v_mfma_f32_32x32x16_bf16 v[80:95], a[32:35], a[100:103], v[80:95]
  ds_read_b64_tr_b16 a[12:13], v3 offset:7264
  ds_read_b64_tr_b16 a[14:15], v3 offset:9056
  s_waitcnt lgkmcnt(15)
  v_mfma_f32_32x32x16_bf16 v[96:111], a[36:39], a[96:99], v[96:111]
  v_mfma_f32_32x32x16_bf16 v[112:127], a[36:39], a[100:103], v[112:127]
  ds_read_b64_tr_b16 a[16:17], v3 offset:7296
  ds_read_b64_tr_b16 a[18:19], v3 offset:9088
  s_waitcnt lgkmcnt(15)
  v_mfma_f32_32x32x16_bf16 v[128:143], a[40:43], a[96:99], v[128:143]
  ds_read_b64_tr_b16 a[20:21], v3 offset:7328
  ds_read_b64_tr_b16 a[22:23], v3 offset:9120
  v_mfma_f32_32x32x16_bf16 v[144:159], a[40:43], a[100:103], v[144:159]
  ds_read_b64_tr_b16 a[24:25], v3 offset:7360
  ds_read_b64_tr_b16 a[26:27], v3 offset:9152
  s_waitcnt lgkmcnt(15)
  v_mfma_f32_32x32x16_bf16 v[160:175], a[44:47], a[96:99], v[160:175]
  s_add_u32 s30, s30, 4096
  buffer_load_dwordx4 a[152:155], v2, s[20:23], s30 offen offset:0
  s_add_u32 s32, s32, 4096
  buffer_load_dwordx4 a[156:159], v2, s[20:23], s32 offen offset:0
  v_mfma_f32_32x32x16_bf16 v[176:191], a[44:47], a[100:103], v[176:191]
  v_mfma_f32_32x32x16_bf16 v[192:207], a[48:51], a[96:99], v[192:207]
  buffer_load_dwordx4 a[160:163], v2, s[20:23], s30 offen offset:1024
  buffer_load_dwordx4 a[164:167], v2, s[20:23], s32 offen offset:1024
  v_mfma_f32_32x32x16_bf16 v[208:223], a[48:51], a[100:103], v[208:223]
  s_nop 1
  v_permlane32_swap_b32 v28, v29
  v_add_f32 v28, v28, v29
  v_mul_f32 v28, 0x3d800000, v28
  s_waitcnt lgkmcnt(14)
  v_mfma_f32_32x32x16_bf16 v[224:239], a[52:55], a[96:99], v[224:239]
  v_sub_f32 v19, v19, v28
  v_sub_f32 v20, v20, v28
  v_sub_f32 v21, v21, v28
  v_sub_f32 v22, v22, v28
  v_mfma_f32_32x32x16_bf16 v[240:255], a[52:55], a[100:103], v[240:255]
  s_waitcnt vmcnt(28)
  s_waitcnt lgkmcnt(12)
  v_mfma_f32_32x32x16_bf16 v[32:47], a[0:3], a[104:107], v[32:47]
  ds_read_b64_tr_b16 a[28:29], v3 offset:10752
  ds_read_b64_tr_b16 a[30:31], v3 offset:12544
  v_mfma_f32_32x32x16_bf16 v[48:63], a[0:3], a[108:111], v[48:63]
  ds_read_b64_tr_b16 a[32:33], v3 offset:10784
  ds_read_b64_tr_b16 a[34:35], v3 offset:12576
  s_waitcnt lgkmcnt(14)
  v_mfma_f32_32x32x16_bf16 v[64:79], a[4:7], a[104:107], v[64:79]
  ds_read_b64_tr_b16 a[36:37], v3 offset:10816
  ds_read_b64_tr_b16 a[38:39], v3 offset:12608
  v_mfma_f32_32x32x16_bf16 v[80:95], a[4:7], a[108:111], v[80:95]
  ds_read_b64_tr_b16 a[40:41], v3 offset:10848
  ds_read_b64_tr_b16 a[42:43], v3 offset:12640
  s_waitcnt lgkmcnt(15)
  v_mfma_f32_32x32x16_bf16 v[96:111], a[8:11], a[104:107], v[96:111]
  ds_read_b64_tr_b16 a[44:45], v3 offset:10880
  ds_read_b64_tr_b16 a[46:47], v3 offset:12672
  v_mfma_f32_32x32x16_bf16 v[112:127], a[8:11], a[108:111], v[112:127]
  ds_read_b64_tr_b16 a[48:49], v3 offset:10912
  ds_read_b64_tr_b16 a[50:51], v3 offset:12704
  s_waitcnt lgkmcnt(15)
  v_mfma_f32_32x32x16_bf16 v[128:143], a[12:15], a[104:107], v[128:143]
  v_mfma_f32_32x32x16_bf16 v[144:159], a[12:15], a[108:111], v[144:159]
  ds_read_b64_tr_b16 a[52:53], v3 offset:10944
  ds_read_b64_tr_b16 a[54:55], v3 offset:12736
  v_mfma_f32_32x32x16_bf16 v[160:175], a[16:19], a[104:107], v[160:175]
  buffer_load_dwordx4 a[168:171], v2, s[20:23], s30 offen offset:2048
  buffer_load_dwordx4 a[172:175], v2, s[20:23], s32 offen offset:2048
  v_mfma_f32_32x32x16_bf16 v[176:191], a[16:19], a[108:111], v[176:191]
  s_add_u32 m0, s29, 86784
  s_add_u32 s31, s28, 3670016
  buffer_load_dwordx4 v12, s[16:19], s31 offen lds
  s_waitcnt lgkmcnt(15)
  v_mfma_f32_32x32x16_bf16 v[192:207], a[20:23], a[104:107], v[192:207]
  s_add_u32 m0, s29, 87808
  s_nop 0
  buffer_load_dwordx4 v13, s[16:19], s31 offen lds
  v_mfma_f32_32x32x16_bf16 v[208:223], a[20:23], a[108:111], v[208:223]
  v_sub_f32 v23, v23, v28
  v_sub_f32 v24, v24, v28
  v_sub_f32 v25, v25, v28
  v_sub_f32 v26, v26, v28
  s_waitcnt lgkmcnt(14)
  v_mfma_f32_32x32x16_bf16 v[224:239], a[24:27], a[104:107], v[224:239]
  v_mul_f32 v30, v19, v19
  v_fmac_f32 v30, v20, v20
  v_fmac_f32 v30, v21, v21
  v_fmac_f32 v30, v22, v22
  v_mfma_f32_32x32x16_bf16 v[240:255], a[24:27], a[108:111], v[240:255]
  s_waitcnt vmcnt(23)
  s_waitcnt lgkmcnt(12)
  v_mfma_f32_32x32x16_bf16 v[32:47], a[28:31], a[112:115], v[32:47]
  s_waitcnt lgkmcnt(0)
  s_barrier
  v_mfma_f32_32x32x16_bf16 v[48:63], a[28:31], a[116:119], v[48:63]
  ds_read_b64_tr_b16 a[0:1], v3 offset:28928
  ds_read_b64_tr_b16 a[2:3], v3 offset:30720
  v_mfma_f32_32x32x16_bf16 v[64:79], a[32:35], a[112:115], v[64:79]
  ds_read_b64_tr_b16 a[4:5], v3 offset:28960
  ds_read_b64_tr_b16 a[6:7], v3 offset:30752
  v_mfma_f32_32x32x16_bf16 v[80:95], a[32:35], a[116:119], v[80:95]
  ds_read_b64_tr_b16 a[8:9], v3 offset:28992
  ds_read_b64_tr_b16 a[10:11], v3 offset:30784
  v_mfma_f32_32x32x16_bf16 v[96:111], a[36:39], a[112:115], v[96:111]
  ds_read_b64_tr_b16 a[12:13], v3 offset:29024
  ds_read_b64_tr_b16 a[14:15], v3 offset:30816
  v_mfma_f32_32x32x16_bf16 v[112:127], a[36:39], a[116:119], v[112:127]
  ds_read_b64_tr_b16 a[16:17], v3 offset:29056
  ds_read_b64_tr_b16 a[18:19], v3 offset:30848
  v_mfma_f32_32x32x16_bf16 v[128:143], a[40:43], a[112:115], v[128:143]
  ds_read_b64_tr_b16 a[20:21], v3 offset:29088
  ds_read_b64_tr_b16 a[22:23], v3 offset:30880
  v_mfma_f32_32x32x16_bf16 v[144:159], a[40:43], a[116:119], v[144:159]
  ds_read_b64_tr_b16 a[24:25], v3 offset:29120
  ds_read_b64_tr_b16 a[26:27], v3 offset:30912
  v_mfma_f32_32x32x16_bf16 v[160:175], a[44:47], a[112:115], v[160:175]
  s_add_u32 m0, s29, 88832
  s_nop 0
  buffer_load_dwordx4 v14, s[16:19], s31 offen lds
  v_mfma_f32_32x32x16_bf16 v[176:191], a[44:47], a[116:119], v[176:191]
  s_add_u32 m0, s29, 89856
  s_nop 0
  buffer_load_dwordx4 v15, s[16:19], s31 offen lds
  v_mfma_f32_32x32x16_bf16 v[192:207], a[48:51], a[112:115], v[192:207]
  s_add_u32 m0, s29, 90880
  s_nop 0
  buffer_load_dwordx4 v16, s[16:19], s31 offen lds
  v_mfma_f32_32x32x16_bf16 v[208:223], a[48:51], a[116:119], v[208:223]
  s_add_u32 m0, s29, 91904
  s_nop 0
  buffer_load_dwordx4 v17, s[16:19], s31 offen lds
  v_mfma_f32_32x32x16_bf16 v[224:239], a[52:55], a[112:115], v[224:239]
  v_fmac_f32 v30, v23, v23
  v_fmac_f32 v30, v24, v24
  v_fmac_f32 v30, v25, v25
  v_fmac_f32 v30, v26, v26
  v_mfma_f32_32x32x16_bf16 v[240:255], a[52:55], a[116:119], v[240:255]
  v_accvgpr_read_b32 v19, a221
  v_accvgpr_read_b32 v20, a223
  v_accvgpr_read_b32 v21, a225
  v_accvgpr_read_b32 v22, a227
  s_waitcnt vmcnt(25)
  s_waitcnt lgkmcnt(12)
  v_mfma_f32_32x32x16_bf16 v[32:47], a[0:3], a[120:123], v[32:47]
  ds_read_b64_tr_b16 a[28:29], v3 offset:32512
  ds_read_b64_tr_b16 a[30:31], v3 offset:34304
  v_mfma_f32_32x32x16_bf16 v[48:63], a[0:3], a[124:127], v[48:63]
  ds_read_b64_tr_b16 a[32:33], v3 offset:32544
  ds_read_b64_tr_b16 a[34:35], v3 offset:34336
  s_waitcnt lgkmcnt(14)
  v_mfma_f32_32x32x16_bf16 v[64:79], a[4:7], a[120:123], v[64:79]
  ds_read_b64_tr_b16 a[36:37], v3 offset:32576
  ds_read_b64_tr_b16 a[38:39], v3 offset:34368
  v_mfma_f32_32x32x16_bf16 v[80:95], a[4:7], a[124:127], v[80:95]
  ds_read_b64_tr_b16 a[40:41], v3 offset:32608
  ds_read_b64_tr_b16 a[42:43], v3 offset:34400
  s_waitcnt lgkmcnt(15)
  v_mfma_f32_32x32x16_bf16 v[96:111], a[8:11], a[120:123], v[96:111]
  ds_read_b64_tr_b16 a[44:45], v3 offset:32640
  ds_read_b64_tr_b16 a[46:47], v3 offset:34432
  v_mfma_f32_32x32x16_bf16 v[112:127], a[8:11], a[124:127], v[112:127]
  ds_read_b64_tr_b16 a[48:49], v3 offset:32672
  ds_read_b64_tr_b16 a[50:51], v3 offset:34464
  s_waitcnt lgkmcnt(15)
  v_mfma_f32_32x32x16_bf16 v[128:143], a[12:15], a[120:123], v[128:143]
  v_mfma_f32_32x32x16_bf16 v[144:159], a[12:15], a[124:127], v[144:159]
  ds_read_b64_tr_b16 a[52:53], v3 offset:32704
  ds_read_b64_tr_b16 a[54:55], v3 offset:34496
  v_mfma_f32_32x32x16_bf16 v[160:175], a[16:19], a[120:123], v[160:175]
  s_add_u32 m0, s29, 92928
  s_nop 0
  buffer_load_dwordx4 v18, s[16:19], s31 offen lds
  v_mfma_f32_32x32x16_bf16 v[176:191], a[16:19], a[124:127], v[176:191]
  buffer_load_dwordx4 a[176:179], v2, s[20:23], s30 offen offset:3072
  buffer_load_dwordx4 a[180:183], v2, s[20:23], s32 offen offset:3072
  s_waitcnt lgkmcnt(15)
  v_mfma_f32_32x32x16_bf16 v[192:207], a[20:23], a[120:123], v[192:207]
  s_add_u32 s30, s30, 4096
  buffer_load_dwordx4 a[56:59], v2, s[20:23], s30 offen offset:0
  s_add_u32 s32, s32, 4096
  buffer_load_dwordx4 a[60:63], v2, s[20:23], s32 offen offset:0
  v_mfma_f32_32x32x16_bf16 v[208:223], a[20:23], a[124:127], v[208:223]
  v_accvgpr_read_b32 v23, a229
  v_accvgpr_read_b32 v24, a231
  v_accvgpr_read_b32 v25, a233
  v_accvgpr_read_b32 v26, a235
  s_waitcnt lgkmcnt(14)
  v_mfma_f32_32x32x16_bf16 v[224:239], a[24:27], a[120:123], v[224:239]
  v_add_f32 v29, v19, v20
  v_add_f32 v29, v29, v21
  v_add_f32 v29, v29, v22
  v_add_f32 v29, v29, v23
  v_mfma_f32_32x32x16_bf16 v[240:255], a[24:27], a[124:127], v[240:255]
  s_waitcnt vmcnt(28)
  s_waitcnt lgkmcnt(12)
  v_mfma_f32_32x32x16_bf16 v[32:47], a[28:31], a[128:131], v[32:47]
  ds_read_b64_tr_b16 a[0:1], v3 offset:36096
  ds_read_b64_tr_b16 a[2:3], v3 offset:37888
  v_mfma_f32_32x32x16_bf16 v[48:63], a[28:31], a[132:135], v[48:63]
  ds_read_b64_tr_b16 a[4:5], v3 offset:36128
  ds_read_b64_tr_b16 a[6:7], v3 offset:37920
  s_waitcnt lgkmcnt(14)
  v_mfma_f32_32x32x16_bf16 v[64:79], a[32:35], a[128:131], v[64:79]
  ds_read_b64_tr_b16 a[8:9], v3 offset:36160
  ds_read_b64_tr_b16 a[10:11], v3 offset:37952
  v_mfma_f32_32x32x16_bf16 v[80:95], a[32:35], a[132:135], v[80:95]
  ds_read_b64_tr_b16 a[12:13], v3 offset:36192
  ds_read_b64_tr_b16 a[14:15], v3 offset:37984
  s_waitcnt lgkmcnt(15)
  v_mfma_f32_32x32x16_bf16 v[96:111], a[36:39], a[128:131], v[96:111]
  v_mfma_f32_32x32x16_bf16 v[112:127], a[36:39], a[132:135], v[112:127]
  ds_read_b64_tr_b16 a[16:17], v3 offset:36224
  ds_read_b64_tr_b16 a[18:19], v3 offset:38016
  s_waitcnt lgkmcnt(15)
  v_mfma_f32_32x32x16_bf16 v[128:143], a[40:43], a[128:131], v[128:143]
  ds_read_b64_tr_b16 a[20:21], v3 offset:36256
  ds_read_b64_tr_b16 a[22:23], v3 offset:38048
  v_mfma_f32_32x32x16_bf16 v[144:159], a[40:43], a[132:135], v[144:159]
  ds_read_b64_tr_b16 a[24:25], v3 offset:36288
  ds_read_b64_tr_b16 a[26:27], v3 offset:38080
  s_waitcnt lgkmcnt(15)
  v_mfma_f32_32x32x16_bf16 v[160:175], a[44:47], a[128:131], v[160:175]
  buffer_load_dwordx4 a[64:67], v2, s[20:23], s30 offen offset:1024
  buffer_load_dwordx4 a[68:71], v2, s[20:23], s32 offen offset:1024
  v_mfma_f32_32x32x16_bf16 v[176:191], a[44:47], a[132:135], v[176:191]
  v_mfma_f32_32x32x16_bf16 v[192:207], a[48:51], a[128:131], v[192:207]
  buffer_load_dwordx4 a[72:75], v2, s[20:23], s30 offen offset:2048
  buffer_load_dwordx4 a[76:79], v2, s[20:23], s32 offen offset:2048
  v_mfma_f32_32x32x16_bf16 v[208:223], a[48:51], a[132:135], v[208:223]
  v_add_f32 v29, v29, v24
  v_add_f32 v29, v29, v25
  v_add_f32 v29, v29, v26
  v_fmac_f32 v29, 0x42800000, v30
  s_waitcnt lgkmcnt(14)
  v_mfma_f32_32x32x16_bf16 v[224:239], a[52:55], a[128:131], v[224:239]
  v_mov_b32 v30, v29
  s_nop 1
  v_permlane32_swap_b32 v29, v30
  v_add_f32 v29, v29, v30
  v_mfma_f32_32x32x16_bf16 v[240:255], a[52:55], a[132:135], v[240:255]
  s_waitcnt vmcnt(30)
  s_waitcnt lgkmcnt(12)
  v_mfma_f32_32x32x16_bf16 v[32:47], a[0:3], a[136:139], v[32:47]
  ds_read_b64_tr_b16 a[28:29], v3 offset:39680
  ds_read_b64_tr_b16 a[30:31], v3 offset:41472
  v_mfma_f32_32x32x16_bf16 v[48:63], a[0:3], a[140:143], v[48:63]
  ds_read_b64_tr_b16 a[32:33], v3 offset:39712
  ds_read_b64_tr_b16 a[34:35], v3 offset:41504
  s_waitcnt lgkmcnt(14)
  v_mfma_f32_32x32x16_bf16 v[64:79], a[4:7], a[136:139], v[64:79]
  ds_read_b64_tr_b16 a[36:37], v3 offset:39744
  ds_read_b64_tr_b16 a[38:39], v3 offset:41536
  v_mfma_f32_32x32x16_bf16 v[80:95], a[4:7], a[140:143], v[80:95]
  ds_read_b64_tr_b16 a[40:41], v3 offset:39776
  ds_read_b64_tr_b16 a[42:43], v3 offset:41568
  s_waitcnt lgkmcnt(15)
  v_mfma_f32_32x32x16_bf16 v[96:111], a[8:11], a[136:139], v[96:111]
  ds_read_b64_tr_b16 a[44:45], v3 offset:39808
  ds_read_b64_tr_b16 a[46:47], v3 offset:41600
  v_mfma_f32_32x32x16_bf16 v[112:127], a[8:11], a[140:143], v[112:127]
  ds_read_b64_tr_b16 a[48:49], v3 offset:39840
  ds_read_b64_tr_b16 a[50:51], v3 offset:41632
  s_waitcnt lgkmcnt(15)
  v_mfma_f32_32x32x16_bf16 v[128:143], a[12:15], a[136:139], v[128:143]
  ds_read_b64_tr_b16 a[52:53], v3 offset:39872
  ds_read_b64_tr_b16 a[54:55], v3 offset:41664
  v_mfma_f32_32x32x16_bf16 v[144:159], a[12:15], a[140:143], v[144:159]
  s_add_u32 m0, s29, 115712
  s_add_u32 s31, s28, 4128768
  buffer_load_dwordx4 v12, s[16:19], s31 offen lds
  v_mfma_f32_32x32x16_bf16 v[160:175], a[16:19], a[136:139], v[160:175]
  s_add_u32 m0, s29, 116736
  s_nop 0
  buffer_load_dwordx4 v13, s[16:19], s31 offen lds
  v_mfma_f32_32x32x16_bf16 v[176:191], a[16:19], a[140:143], v[176:191]
  s_add_u32 m0, s29, 117760
  s_nop 0
  buffer_load_dwordx4 v14, s[16:19], s31 offen lds
  s_waitcnt lgkmcnt(15)
  v_mfma_f32_32x32x16_bf16 v[192:207], a[20:23], a[136:139], v[192:207]
  s_add_u32 m0, s29, 118784
  s_nop 0
  buffer_load_dwordx4 v15, s[16:19], s31 offen lds
  v_mfma_f32_32x32x16_bf16 v[208:223], a[20:23], a[140:143], v[208:223]
  v_mov_b32 v30, 0x3727c5ac
  v_fmac_f32 v30, 0x3a800000, v29
  v_rcp_f32 v8, v30
  v_sqrt_f32 v29, v30
  s_waitcnt lgkmcnt(14)
  v_mfma_f32_32x32x16_bf16 v[224:239], a[24:27], a[136:139], v[224:239]
  v_sub_f32 v28, 0, v28
  v_cvt_pk_bf16_f32 v19, v28, v28
  v_and_b32 v20, 0xffff0000, v19
  v_sub_f32 v20, v28, v20
  v_mfma_f32_32x32x16_bf16 v[240:255], a[24:27], a[140:143], v[240:255]
  s_waitcnt vmcnt(25)
  s_waitcnt lgkmcnt(12)
  v_mfma_f32_32x32x16_bf16 v[32:47], a[28:31], a[144:147], v[32:47]
  s_waitcnt lgkmcnt(0)
  s_barrier
  v_mfma_f32_32x32x16_bf16 v[48:63], a[28:31], a[148:151], v[48:63]
  ds_read_b64_tr_b16 a[0:1], v3 offset:57856
  ds_read_b64_tr_b16 a[2:3], v3 offset:59648
  v_mfma_f32_32x32x16_bf16 v[64:79], a[32:35], a[144:147], v[64:79]
  ds_read_b64_tr_b16 a[4:5], v3 offset:57888
  ds_read_b64_tr_b16 a[6:7], v3 offset:59680
  v_mfma_f32_32x32x16_bf16 v[80:95], a[32:35], a[148:151], v[80:95]
  ds_read_b64_tr_b16 a[8:9], v3 offset:57920
  ds_read_b64_tr_b16 a[10:11], v3 offset:59712
  v_mfma_f32_32x32x16_bf16 v[96:111], a[36:39], a[144:147], v[96:111]
  ds_read_b64_tr_b16 a[12:13], v3 offset:57952
  ds_read_b64_tr_b16 a[14:15], v3 offset:59744
  v_mfma_f32_32x32x16_bf16 v[112:127], a[36:39], a[148:151], v[112:127]
  ds_read_b64_tr_b16 a[16:17], v3 offset:57984
  ds_read_b64_tr_b16 a[18:19], v3 offset:59776
  v_mfma_f32_32x32x16_bf16 v[128:143], a[40:43], a[144:147], v[128:143]
  ds_read_b64_tr_b16 a[20:21], v3 offset:58016
  ds_read_b64_tr_b16 a[22:23], v3 offset:59808
  v_mfma_f32_32x32x16_bf16 v[144:159], a[40:43], a[148:151], v[144:159]
  ds_read_b64_tr_b16 a[24:25], v3 offset:58048
  ds_read_b64_tr_b16 a[26:27], v3 offset:59840
  v_mfma_f32_32x32x16_bf16 v[160:175], a[44:47], a[144:147], v[160:175]
  s_add_u32 m0, s29, 119808
  s_nop 0
  buffer_load_dwordx4 v16, s[16:19], s31 offen lds
  v_mfma_f32_32x32x16_bf16 v[176:191], a[44:47], a[148:151], v[176:191]
  s_add_u32 m0, s29, 120832
  s_nop 0
  buffer_load_dwordx4 v17, s[16:19], s31 offen lds
  v_mfma_f32_32x32x16_bf16 v[192:207], a[48:51], a[144:147], v[192:207]
  s_add_u32 m0, s29, 121856
  s_nop 0
  buffer_load_dwordx4 v18, s[16:19], s31 offen lds
  v_mfma_f32_32x32x16_bf16 v[208:223], a[48:51], a[148:151], v[208:223]
  buffer_load_dwordx4 a[80:83], v2, s[20:23], s30 offen offset:3072
  buffer_load_dwordx4 a[84:87], v2, s[20:23], s32 offen offset:3072
  v_mfma_f32_32x32x16_bf16 v[224:239], a[52:55], a[144:147], v[224:239]
  v_cvt_pk_bf16_f32 v20, v20, v20
  v_cvt_pk_bf16_f32 v21, v29, v29
  v_and_b32 v22, 0xffff0000, v21
  v_sub_f32 v22, v29, v22
  v_mfma_f32_32x32x16_bf16 v[240:255], a[52:55], a[148:151], v[240:255]
  v_cvt_pk_bf16_f32 v22, v22, v22
  v_perm_b32 v23, v21, v20, s46
  v_perm_b32 v24, v22, v21, s46
  v_cmp_gt_u32 vcc, 32, v1
  s_waitcnt vmcnt(28)
  s_waitcnt lgkmcnt(12)
  v_mfma_f32_32x32x16_bf16 v[32:47], a[0:3], a[152:155], v[32:47]
  ds_read_b64_tr_b16 a[28:29], v3 offset:61440
  ds_read_b64_tr_b16 a[30:31], v3 offset:63232
  v_mfma_f32_32x32x16_bf16 v[48:63], a[0:3], a[156:159], v[48:63]
  ds_read_b64_tr_b16 a[32:33], v3 offset:61472
  ds_read_b64_tr_b16 a[34:35], v3 offset:63264
  s_waitcnt lgkmcnt(14)
  v_mfma_f32_32x32x16_bf16 v[64:79], a[4:7], a[152:155], v[64:79]
  ds_read_b64_tr_b16 a[36:37], v3 offset:61504
  ds_read_b64_tr_b16 a[38:39], v3 offset:63296
  v_mfma_f32_32x32x16_bf16 v[80:95], a[4:7], a[156:159], v[80:95]
  ds_read_b64_tr_b16 a[40:41], v3 offset:61536
  ds_read_b64_tr_b16 a[42:43], v3 offset:63328
  s_waitcnt lgkmcnt(15)
  v_mfma_f32_32x32x16_bf16 v[96:111], a[8:11], a[152:155], v[96:111]
  v_mfma_f32_32x32x16_bf16 v[112:127], a[8:11], a[156:159], v[112:127]
  ds_read_b64_tr_b16 a[44:45], v3 offset:61568
  ds_read_b64_tr_b16 a[46:47], v3 offset:63360
  s_waitcnt lgkmcnt(15)
  v_mfma_f32_32x32x16_bf16 v[128:143], a[12:15], a[152:155], v[128:143]
  ds_read_b64_tr_b16 a[48:49], v3 offset:61600
  ds_read_b64_tr_b16 a[50:51], v3 offset:63392
  v_mfma_f32_32x32x16_bf16 v[144:159], a[12:15], a[156:159], v[144:159]
  ds_read_b64_tr_b16 a[52:53], v3 offset:61632
  ds_read_b64_tr_b16 a[54:55], v3 offset:63424
  s_waitcnt lgkmcnt(15)
  v_mfma_f32_32x32x16_bf16 v[160:175], a[16:19], a[152:155], v[160:175]
  s_add_u32 s30, s30, 4096
  buffer_load_dwordx4 a[88:91], v2, s[20:23], s30 offen offset:0
  s_add_u32 s32, s32, 4096
  buffer_load_dwordx4 a[92:95], v2, s[20:23], s32 offen offset:0
  v_mfma_f32_32x32x16_bf16 v[176:191], a[16:19], a[156:159], v[176:191]
  v_mfma_f32_32x32x16_bf16 v[192:207], a[20:23], a[152:155], v[192:207]
  buffer_load_dwordx4 a[96:99], v2, s[20:23], s30 offen offset:1024
  buffer_load_dwordx4 a[100:103], v2, s[20:23], s32 offen offset:1024
  v_mfma_f32_32x32x16_bf16 v[208:223], a[20:23], a[156:159], v[208:223]
  s_nop 1
  v_cndmask_b32 v19, 0, v19, vcc
  v_cndmask_b32 v23, 0, v23, vcc
  v_cndmask_b32 v24, 0, v24, vcc
  s_waitcnt lgkmcnt(14)
  v_mfma_f32_32x32x16_bf16 v[224:239], a[24:27], a[152:155], v[224:239]
  v_accvgpr_write_b32 a212, v19
  v_accvgpr_write_b32 a213, v23
  v_accvgpr_write_b32 a214, v24
  v_accvgpr_write_b32 a215, 0
  v_mfma_f32_32x32x16_bf16 v[240:255], a[24:27], a[156:159], v[240:255]
  s_waitcnt vmcnt(30)
  s_waitcnt lgkmcnt(12)
  v_mfma_f32_32x32x16_bf16 v[32:47], a[28:31], a[160:163], v[32:47]
  ds_read_b64_tr_b16 a[0:1], v3 offset:65024
  ds_read_b64_tr_b16 a[2:3], v4 offset:1280
  v_mfma_f32_32x32x16_bf16 v[48:63], a[28:31], a[164:167], v[48:63]
  ds_read_b64_tr_b16 a[4:5], v3 offset:65056
  ds_read_b64_tr_b16 a[6:7], v4 offset:1312
  s_waitcnt lgkmcnt(14)
  v_mfma_f32_32x32x16_bf16 v[64:79], a[32:35], a[160:163], v[64:79]
  ds_read_b64_tr_b16 a[8:9], v3 offset:65088
  ds_read_b64_tr_b16 a[10:11], v4 offset:1344
  v_mfma_f32_32x32x16_bf16 v[80:95], a[32:35], a[164:167], v[80:95]
  ds_read_b64_tr_b16 a[12:13], v3 offset:65120
  ds_read_b64_tr_b16 a[14:15], v4 offset:1376
  s_waitcnt lgkmcnt(15)
  v_mfma_f32_32x32x16_bf16 v[96:111], a[36:39], a[160:163], v[96:111]
  ds_read_b64_tr_b16 a[16:17], v3 offset:65152
  ds_read_b64_tr_b16 a[18:19], v4 offset:1408
  v_mfma_f32_32x32x16_bf16 v[112:127], a[36:39], a[164:167], v[112:127]
  ds_read_b64_tr_b16 a[20:21], v3 offset:65184
  ds_read_b64_tr_b16 a[22:23], v4 offset:1440
  s_waitcnt lgkmcnt(15)
  v_mfma_f32_32x32x16_bf16 v[128:143], a[40:43], a[160:163], v[128:143]
  v_mfma_f32_32x32x16_bf16 v[144:159], a[40:43], a[164:167], v[144:159]
  ds_read_b64_tr_b16 a[24:25], v3 offset:65216
  ds_read_b64_tr_b16 a[26:27], v4 offset:1472
  v_mfma_f32_32x32x16_bf16 v[160:175], a[44:47], a[160:163], v[160:175]
  buffer_load_dwordx4 a[104:107], v2, s[20:23], s30 offen offset:2048
  buffer_load_dwordx4 a[108:111], v2, s[20:23], s32 offen offset:2048
  v_mfma_f32_32x32x16_bf16 v[176:191], a[44:47], a[164:167], v[176:191]
  s_add_u32 m0, s29, 0
  s_add_u32 s31, s28, 4587520
  buffer_load_dwordx4 v12, s[16:19], s31 offen lds
  s_waitcnt lgkmcnt(15)
  v_mfma_f32_32x32x16_bf16 v[192:207], a[48:51], a[160:163], v[192:207]
  s_add_u32 m0, s29, 1024
  s_nop 0
  buffer_load_dwordx4 v13, s[16:19], s31 offen lds
  v_mfma_f32_32x32x16_bf16 v[208:223], a[48:51], a[164:167], v[208:223]
  buffer_load_dwordx4 a[220:223], v7, s[36:39], s35 offen offset:0
  buffer_load_dwordx4 a[224:227], v7, s[36:39], s35 offen offset:16
  buffer_load_dwordx4 a[228:231], v7, s[36:39], s35 offen offset:32
  buffer_load_dwordx4 a[232:235], v7, s[36:39], s35 offen offset:48
  s_waitcnt lgkmcnt(14)
  v_mfma_f32_32x32x16_bf16 v[224:239], a[52:55], a[160:163], v[224:239]
  v_mfma_f32_32x32x16_bf16 v[240:255], a[52:55], a[164:167], v[240:255]
  s_waitcnt vmcnt(36)
  s_waitcnt lgkmcnt(12)
  v_mfma_f32_32x32x16_bf16 v[32:47], a[0:3], a[168:171], v[32:47]
  ds_read_b64_tr_b16 a[28:29], v4 offset:3072
  ds_read_b64_tr_b16 a[30:31], v4 offset:4864
  v_mfma_f32_32x32x16_bf16 v[48:63], a[0:3], a[172:175], v[48:63]
  ds_read_b64_tr_b16 a[32:33], v4 offset:3104
  ds_read_b64_tr_b16 a[34:35], v4 offset:4896
  s_waitcnt lgkmcnt(14)
  v_mfma_f32_32x32x16_bf16 v[64:79], a[4:7], a[168:171], v[64:79]
  ds_read_b64_tr_b16 a[36:37], v4 offset:3136
  ds_read_b64_tr_b16 a[38:39], v4 offset:4928
  v_mfma_f32_32x32x16_bf16 v[80:95], a[4:7], a[172:175], v[80:95]
  ds_read_b64_tr_b16 a[40:41], v4 offset:3168
  ds_read_b64_tr_b16 a[42:43], v4 offset:4960
  s_waitcnt lgkmcnt(15)
  v_mfma_f32_32x32x16_bf16 v[96:111], a[8:11], a[168:171], v[96:111]
  ds_read_b64_tr_b16 a[44:45], v4 offset:3200
  ds_read_b64_tr_b16 a[46:47], v4 offset:4992
  v_mfma_f32_32x32x16_bf16 v[112:127], a[8:11], a[172:175], v[112:127]
  ds_read_b64_tr_b16 a[48:49], v4 offset:3232
  ds_read_b64_tr_b16 a[50:51], v4 offset:5024
  s_waitcnt lgkmcnt(15)
  v_mfma_f32_32x32x16_bf16 v[128:143], a[12:15], a[168:171], v[128:143]
  ds_read_b64_tr_b16 a[52:53], v4 offset:3264
  ds_read_b64_tr_b16 a[54:55], v4 offset:5056
  v_mfma_f32_32x32x16_bf16 v[144:159], a[12:15], a[172:175], v[144:159]
  s_add_u32 m0, s29, 2048
  s_nop 0
  buffer_load_dwordx4 v14, s[16:19], s31 offen lds
  v_mfma_f32_32x32x16_bf16 v[160:175], a[16:19], a[168:171], v[160:175]
  s_add_u32 m0, s29, 3072
  s_nop 0
  buffer_load_dwordx4 v15, s[16:19], s31 offen lds
  v_mfma_f32_32x32x16_bf16 v[176:191], a[16:19], a[172:175], v[176:191]
  s_add_u32 m0, s29, 4096
  s_nop 0
  buffer_load_dwordx4 v16, s[16:19], s31 offen lds
  s_waitcnt lgkmcnt(15)
  v_mfma_f32_32x32x16_bf16 v[192:207], a[20:23], a[168:171], v[192:207]
  s_add_u32 m0, s29, 5120
  s_nop 0
  buffer_load_dwordx4 v17, s[16:19], s31 offen lds
  v_mfma_f32_32x32x16_bf16 v[208:223], a[20:23], a[172:175], v[208:223]
  s_waitcnt lgkmcnt(14)
  v_mfma_f32_32x32x16_bf16 v[224:239], a[24:27], a[168:171], v[224:239]
  v_mfma_f32_32x32x16_bf16 v[240:255], a[24:27], a[172:175], v[240:255]
  s_waitcnt vmcnt(31)
  s_waitcnt lgkmcnt(12)
  v_mfma_f32_32x32x16_bf16 v[32:47], a[28:31], a[176:179], v[32:47]
  s_waitcnt lgkmcnt(0)
  s_barrier
  v_mfma_f32_32x32x16_bf16 v[48:63], a[28:31], a[180:183], v[48:63]
  ds_read_b64_tr_b16 a[0:1], v4 offset:21248
  ds_read_b64_tr_b16 a[2:3], v4 offset:23040
  v_mfma_f32_32x32x16_bf16 v[64:79], a[32:35], a[176:179], v[64:79]
  ds_read_b64_tr_b16 a[4:5], v4 offset:21280
  ds_read_b64_tr_b16 a[6:7], v4 offset:23072
  v_mfma_f32_32x32x16_bf16 v[80:95], a[32:35], a[180:183], v[80:95]
  ds_read_b64_tr_b16 a[8:9], v4 offset:21312
  ds_read_b64_tr_b16 a[10:11], v4 offset:23104
  v_mfma_f32_32x32x16_bf16 v[96:111], a[36:39], a[176:179], v[96:111]
  ds_read_b64_tr_b16 a[12:13], v4 offset:21344
  ds_read_b64_tr_b16 a[14:15], v4 offset:23136
  v_mfma_f32_32x32x16_bf16 v[112:127], a[36:39], a[180:183], v[112:127]
  ds_read_b64_tr_b16 a[16:17], v4 offset:21376
  ds_read_b64_tr_b16 a[18:19], v4 offset:23168
  v_mfma_f32_32x32x16_bf16 v[128:143], a[40:43], a[176:179], v[128:143]
  ds_read_b64_tr_b16 a[20:21], v4 offset:21408
  ds_read_b64_tr_b16 a[22:23], v4 offset:23200
  v_mfma_f32_32x32x16_bf16 v[144:159], a[40:43], a[180:183], v[144:159]
  ds_read_b64_tr_b16 a[24:25], v4 offset:21440
  ds_read_b64_tr_b16 a[26:27], v4 offset:23232
  v_mfma_f32_32x32x16_bf16 v[160:175], a[44:47], a[176:179], v[160:175]
  s_add_u32 m0, s29, 6144
  s_nop 0
  buffer_load_dwordx4 v18, s[16:19], s31 offen lds
  v_mfma_f32_32x32x16_bf16 v[176:191], a[44:47], a[180:183], v[176:191]
  buffer_load_dwordx4 a[112:115], v2, s[20:23], s30 offen offset:3072
  buffer_load_dwordx4 a[116:119], v2, s[20:23], s32 offen offset:3072
  v_mfma_f32_32x32x16_bf16 v[192:207], a[48:51], a[176:179], v[192:207]
  s_add_u32 s30, s30, 4096
  buffer_load_dwordx4 a[120:123], v2, s[20:23], s30 offen offset:0
  s_add_u32 s32, s32, 4096
  buffer_load_dwordx4 a[124:127], v2, s[20:23], s32 offen offset:0
  v_mfma_f32_32x32x16_bf16 v[208:223], a[48:51], a[180:183], v[208:223]
  v_mfma_f32_32x32x16_bf16 v[224:239], a[52:55], a[176:179], v[224:239]
  v_mfma_f32_32x32x16_bf16 v[240:255], a[52:55], a[180:183], v[240:255]
  s_waitcnt vmcnt(34)
  s_waitcnt lgkmcnt(12)
  v_mfma_f32_32x32x16_bf16 v[32:47], a[0:3], a[56:59], v[32:47]
  ds_read_b64_tr_b16 a[28:29], v4 offset:24832
  ds_read_b64_tr_b16 a[30:31], v4 offset:26624
  v_mfma_f32_32x32x16_bf16 v[48:63], a[0:3], a[60:63], v[48:63]
  ds_read_b64_tr_b16 a[32:33], v4 offset:24864
  ds_read_b64_tr_b16 a[34:35], v4 offset:26656
  s_waitcnt lgkmcnt(14)
  v_mfma_f32_32x32x16_bf16 v[64:79], a[4:7], a[56:59], v[64:79]
  ds_read_b64_tr_b16 a[36:37], v4 offset:24896
  ds_read_b64_tr_b16 a[38:39], v4 offset:26688
  v_mfma_f32_32x32x16_bf16 v[80:95], a[4:7], a[60:63], v[80:95]
  ds_read_b64_tr_b16 a[40:41], v4 offset:24928
  ds_read_b64_tr_b16 a[42:43], v4 offset:26720
  s_waitcnt lgkmcnt(15)
  v_mfma_f32_32x32x16_bf16 v[96:111], a[8:11], a[56:59], v[96:111]
  v_mfma_f32_32x32x16_bf16 v[112:127], a[8:11], a[60:63], v[112:127]
  ds_read_b64_tr_b16 a[44:45], v4 offset:24960
  ds_read_b64_tr_b16 a[46:47], v4 offset:26752
  s_waitcnt lgkmcnt(15)
  v_mfma_f32_32x32x16_bf16 v[128:143], a[12:15], a[56:59], v[128:143]
  ds_read_b64_tr_b16 a[48:49], v4 offset:24992
  ds_read_b64_tr_b16 a[50:51], v4 offset:26784
  v_mfma_f32_32x32x16_bf16 v[144:159], a[12:15], a[60:63], v[144:159]
  ds_read_b64_tr_b16 a[52:53], v4 offset:25024
  ds_read_b64_tr_b16 a[54:55], v4 offset:26816
  s_waitcnt lgkmcnt(15)
  v_mfma_f32_32x32x16_bf16 v[160:175], a[16:19], a[56:59], v[160:175]
  buffer_load_dwordx4 a[128:131], v2, s[20:23], s30 offen offset:1024
  buffer_load_dwordx4 a[132:135], v2, s[20:23], s32 offen offset:1024
  v_mfma_f32_32x32x16_bf16 v[176:191], a[16:19], a[60:63], v[176:191]
  v_mfma_f32_32x32x16_bf16 v[192:207], a[20:23], a[56:59], v[192:207]
  buffer_load_dwordx4 a[136:139], v2, s[20:23], s30 offen offset:2048
  buffer_load_dwordx4 a[140:143], v2, s[20:23], s32 offen offset:2048
  v_mfma_f32_32x32x16_bf16 v[208:223], a[20:23], a[60:63], v[208:223]
  s_waitcnt lgkmcnt(14)
  v_mfma_f32_32x32x16_bf16 v[224:239], a[24:27], a[56:59], v[224:239]
  v_mfma_f32_32x32x16_bf16 v[240:255], a[24:27], a[60:63], v[240:255]
  s_waitcnt vmcnt(36)
  s_waitcnt lgkmcnt(12)
  v_mfma_f32_32x32x16_bf16 v[32:47], a[28:31], a[64:67], v[32:47]
  ds_read_b64_tr_b16 a[0:1], v4 offset:28416
  ds_read_b64_tr_b16 a[2:3], v4 offset:30208
  v_mfma_f32_32x32x16_bf16 v[48:63], a[28:31], a[68:71], v[48:63]
  ds_read_b64_tr_b16 a[4:5], v4 offset:28448
  ds_read_b64_tr_b16 a[6:7], v4 offset:30240
  s_waitcnt lgkmcnt(14)
  v_mfma_f32_32x32x16_bf16 v[64:79], a[32:35], a[64:67], v[64:79]
  ds_read_b64_tr_b16 a[8:9], v4 offset:28480
  ds_read_b64_tr_b16 a[10:11], v4 offset:30272
  v_mfma_f32_32x32x16_bf16 v[80:95], a[32:35], a[68:71], v[80:95]
  ds_read_b64_tr_b16 a[12:13], v4 offset:28512
  ds_read_b64_tr_b16 a[14:15], v4 offset:30304
  s_waitcnt lgkmcnt(15)
  v_mfma_f32_32x32x16_bf16 v[96:111], a[36:39], a[64:67], v[96:111]
  ds_read_b64_tr_b16 a[16:17], v4 offset:28544
  ds_read_b64_tr_b16 a[18:19], v4 offset:30336
  v_mfma_f32_32x32x16_bf16 v[112:127], a[36:39], a[68:71], v[112:127]
  ds_read_b64_tr_b16 a[20:21], v4 offset:28576
  ds_read_b64_tr_b16 a[22:23], v4 offset:30368
  s_waitcnt lgkmcnt(15)
  v_mfma_f32_32x32x16_bf16 v[128:143], a[40:43], a[64:67], v[128:143]
  ds_read_b64_tr_b16 a[24:25], v4 offset:28608
  ds_read_b64_tr_b16 a[26:27], v4 offset:30400
  v_mfma_f32_32x32x16_bf16 v[144:159], a[40:43], a[68:71], v[144:159]
  s_add_u32 m0, s29, 28928
  s_add_u32 s31, s28, 5046272
  buffer_load_dwordx4 v12, s[16:19], s31 offen lds
  v_mfma_f32_32x32x16_bf16 v[160:175], a[44:47], a[64:67], v[160:175]
  s_add_u32 m0, s29, 29952
  s_nop 0
  buffer_load_dwordx4 v13, s[16:19], s31 offen lds
  v_mfma_f32_32x32x16_bf16 v[176:191], a[44:47], a[68:71], v[176:191]
  s_add_u32 m0, s29, 30976
  s_nop 0
  buffer_load_dwordx4 v14, s[16:19], s31 offen lds
  s_waitcnt lgkmcnt(15)
  v_mfma_f32_32x32x16_bf16 v[192:207], a[48:51], a[64:67], v[192:207]
  s_add_u32 m0, s29, 32000
  s_nop 0
  buffer_load_dwordx4 v15, s[16:19], s31 offen lds
  v_mfma_f32_32x32x16_bf16 v[208:223], a[48:51], a[68:71], v[208:223]
  s_waitcnt lgkmcnt(14)
  v_mfma_f32_32x32x16_bf16 v[224:239], a[52:55], a[64:67], v[224:239]
  v_mfma_f32_32x32x16_bf16 v[240:255], a[52:55], a[68:71], v[240:255]
  s_waitcnt vmcnt(38)
  s_waitcnt lgkmcnt(12)
  v_mfma_f32_32x32x16_bf16 v[32:47], a[0:3], a[72:75], v[32:47]
  ds_read_b64_tr_b16 a[28:29], v4 offset:32000
  ds_read_b64_tr_b16 a[30:31], v4 offset:33792
  v_mfma_f32_32x32x16_bf16 v[48:63], a[0:3], a[76:79], v[48:63]
  ds_read_b64_tr_b16 a[32:33], v4 offset:32032
  ds_read_b64_tr_b16 a[34:35], v4 offset:33824
  s_waitcnt lgkmcnt(14)
  v_mfma_f32_32x32x16_bf16 v[64:79], a[4:7], a[72:75], v[64:79]
  ds_read_b64_tr_b16 a[36:37], v4 offset:32064
  ds_read_b64_tr_b16 a[38:39], v4 offset:33856
  v_mfma_f32_32x32x16_bf16 v[80:95], a[4:7], a[76:79], v[80:95]
  ds_read_b64_tr_b16 a[40:41], v4 offset:32096
  ds_read_b64_tr_b16 a[42:43], v4 offset:33888
  s_waitcnt lgkmcnt(15)
  v_mfma_f32_32x32x16_bf16 v[96:111], a[8:11], a[72:75], v[96:111]
  ds_read_b64_tr_b16 a[44:45], v4 offset:32128
  ds_read_b64_tr_b16 a[46:47], v4 offset:33920
  v_mfma_f32_32x32x16_bf16 v[112:127], a[8:11], a[76:79], v[112:127]
  ds_read_b64_tr_b16 a[48:49], v4 offset:32160
  ds_read_b64_tr_b16 a[50:51], v4 offset:33952
  s_waitcnt lgkmcnt(15)
  v_mfma_f32_32x32x16_bf16 v[128:143], a[12:15], a[72:75], v[128:143]
  ds_read_b64_tr_b16 a[52:53], v4 offset:32192
  ds_read_b64_tr_b16 a[54:55], v4 offset:33984
  v_mfma_f32_32x32x16_bf16 v[144:159], a[12:15], a[76:79], v[144:159]
  s_add_u32 m0, s29, 33024
  s_nop 0
  buffer_load_dwordx4 v16, s[16:19], s31 offen lds
  v_mfma_f32_32x32x16_bf16 v[160:175], a[16:19], a[72:75], v[160:175]
  s_add_u32 m0, s29, 34048
  s_nop 0
  buffer_load_dwordx4 v17, s[16:19], s31 offen lds
  v_mfma_f32_32x32x16_bf16 v[176:191], a[16:19], a[76:79], v[176:191]
  s_add_u32 m0, s29, 35072
  s_nop 0
  buffer_load_dwordx4 v18, s[16:19], s31 offen lds
  s_waitcnt lgkmcnt(15)
  v_mfma_f32_32x32x16_bf16 v[192:207], a[20:23], a[72:75], v[192:207]
  buffer_load_dwordx4 a[144:147], v2, s[20:23], s30 offen offset:3072
  buffer_load_dwordx4 a[148:151], v2, s[20:23], s32 offen offset:3072
  v_mfma_f32_32x32x16_bf16 v[208:223], a[20:23], a[76:79], v[208:223]
  s_waitcnt lgkmcnt(14)
  v_mfma_f32_32x32x16_bf16 v[224:239], a[24:27], a[72:75], v[224:239]
  v_mfma_f32_32x32x16_bf16 v[240:255], a[24:27], a[76:79], v[240:255]
  s_waitcnt vmcnt(34)
  s_waitcnt lgkmcnt(12)
  v_mfma_f32_32x32x16_bf16 v[32:47], a[28:31], a[80:83], v[32:47]
  s_waitcnt lgkmcnt(0)
  s_barrier
  v_mfma_f32_32x32x16_bf16 v[48:63], a[28:31], a[84:87], v[48:63]
  ds_read_b64_tr_b16 a[0:1], v4 offset:50176
  ds_read_b64_tr_b16 a[2:3], v4 offset:51968
  v_mfma_f32_32x32x16_bf16 v[64:79], a[32:35], a[80:83], v[64:79]
  ds_read_b64_tr_b16 a[4:5], v4 offset:50208
  ds_read_b64_tr_b16 a[6:7], v4 offset:52000
  v_mfma_f32_32x32x16_bf16 v[80:95], a[32:35], a[84:87], v[80:95]
  ds_read_b64_tr_b16 a[8:9], v4 offset:50240
  ds_read_b64_tr_b16 a[10:11], v4 offset:52032
  v_mfma_f32_32x32x16_bf16 v[96:111], a[36:39], a[80:83], v[96:111]
  ds_read_b64_tr_b16 a[12:13], v4 offset:50272
  ds_read_b64_tr_b16 a[14:15], v4 offset:52064
  v_mfma_f32_32x32x16_bf16 v[112:127], a[36:39], a[84:87], v[112:127]
  ds_read_b64_tr_b16 a[16:17], v4 offset:50304
  ds_read_b64_tr_b16 a[18:19], v4 offset:52096
  v_mfma_f32_32x32x16_bf16 v[128:143], a[40:43], a[80:83], v[128:143]
  ds_read_b64_tr_b16 a[20:21], v4 offset:50336
  ds_read_b64_tr_b16 a[22:23], v4 offset:52128
  v_mfma_f32_32x32x16_bf16 v[144:159], a[40:43], a[84:87], v[144:159]
  v_mfma_f32_32x32x16_bf16 v[160:175], a[44:47], a[80:83], v[160:175]
  ds_read_b64_tr_b16 a[24:25], v4 offset:50368
  ds_read_b64_tr_b16 a[26:27], v4 offset:52160
  v_mfma_f32_32x32x16_bf16 v[176:191], a[44:47], a[84:87], v[176:191]
  s_add_u32 s30, s30, 4096
  buffer_load_dwordx4 a[152:155], v2, s[20:23], s30 offen offset:0
  s_add_u32 s32, s32, 4096
  buffer_load_dwordx4 a[156:159], v2, s[20:23], s32 offen offset:0
  v_mfma_f32_32x32x16_bf16 v[192:207], a[48:51], a[80:83], v[192:207]
  buffer_load_dwordx4 a[160:163], v2, s[20:23], s30 offen offset:1024
  buffer_load_dwordx4 a[164:167], v2, s[20:23], s32 offen offset:1024
  v_mfma_f32_32x32x16_bf16 v[208:223], a[48:51], a[84:87], v[208:223]
  v_mfma_f32_32x32x16_bf16 v[224:239], a[52:55], a[80:83], v[224:239]
  v_mfma_f32_32x32x16_bf16 v[240:255], a[52:55], a[84:87], v[240:255]
  s_waitcnt vmcnt(36)
  s_waitcnt lgkmcnt(12)
  v_mfma_f32_32x32x16_bf16 v[32:47], a[0:3], a[88:91], v[32:47]
  ds_read_b64_tr_b16 a[28:29], v4 offset:53760
  ds_read_b64_tr_b16 a[30:31], v4 offset:55552
  v_mfma_f32_32x32x16_bf16 v[48:63], a[0:3], a[92:95], v[48:63]
  ds_read_b64_tr_b16 a[32:33], v4 offset:53792
  ds_read_b64_tr_b16 a[34:35], v4 offset:55584
  s_waitcnt lgkmcnt(14)
  v_mfma_f32_32x32x16_bf16 v[64:79], a[4:7], a[88:91], v[64:79]
  ds_read_b64_tr_b16 a[36:37], v4 offset:53824
  ds_read_b64_tr_b16 a[38:39], v4 offset:55616
  v_mfma_f32_32x32x16_bf16 v[80:95], a[4:7], a[92:95], v[80:95]
  ds_read_b64_tr_b16 a[40:41], v4 offset:53856
  ds_read_b64_tr_b16 a[42:43], v4 offset:55648
  s_waitcnt lgkmcnt(15)
  v_mfma_f32_32x32x16_bf16 v[96:111], a[8:11], a[88:91], v[96:111]
  ds_read_b64_tr_b16 a[44:45], v4 offset:53888
  ds_read_b64_tr_b16 a[46:47], v4 offset:55680
  v_mfma_f32_32x32x16_bf16 v[112:127], a[8:11], a[92:95], v[112:127]
  ds_read_b64_tr_b16 a[48:49], v4 offset:53920
  ds_read_b64_tr_b16 a[50:51], v4 offset:55712
  s_waitcnt lgkmcnt(15)
  v_mfma_f32_32x32x16_bf16 v[128:143], a[12:15], a[88:91], v[128:143]
  v_mfma_f32_32x32x16_bf16 v[144:159], a[12:15], a[92:95], v[144:159]
  ds_read_b64_tr_b16 a[52:53], v4 offset:53952
  ds_read_b64_tr_b16 a[54:55], v4 offset:55744
  v_mfma_f32_32x32x16_bf16 v[160:175], a[16:19], a[88:91], v[160:175]
  buffer_load_dwordx4 a[168:171], v2, s[20:23], s30 offen offset:2048
  buffer_load_dwordx4 a[172:175], v2, s[20:23], s32 offen offset:2048
  v_mfma_f32_32x32x16_bf16 v[176:191], a[16:19], a[92:95], v[176:191]
  s_add_u32 m0, s29, 57856
  s_add_u32 s31, s28, 5505024
  buffer_load_dwordx4 v12, s[16:19], s31 offen lds
  s_waitcnt lgkmcnt(15)
  v_mfma_f32_32x32x16_bf16 v[192:207], a[20:23], a[88:91], v[192:207]
  s_add_u32 m0, s29, 58880
  s_nop 0
  buffer_load_dwordx4 v13, s[16:19], s31 offen lds
  v_mfma_f32_32x32x16_bf16 v[208:223], a[20:23], a[92:95], v[208:223]
  s_waitcnt lgkmcnt(14)
  v_mfma_f32_32x32x16_bf16 v[224:239], a[24:27], a[88:91], v[224:239]
  v_mfma_f32_32x32x16_bf16 v[240:255], a[24:27], a[92:95], v[240:255]
  s_waitcnt vmcnt(38)
  s_waitcnt lgkmcnt(12)
  v_mfma_f32_32x32x16_bf16 v[32:47], a[28:31], a[96:99], v[32:47]
  ds_read_b64_tr_b16 a[0:1], v4 offset:57344
  ds_read_b64_tr_b16 a[2:3], v4 offset:59136
  v_mfma_f32_32x32x16_bf16 v[48:63], a[28:31], a[100:103], v[48:63]
  ds_read_b64_tr_b16 a[4:5], v4 offset:57376
  ds_read_b64_tr_b16 a[6:7], v4 offset:59168
  s_waitcnt lgkmcnt(14)
  v_mfma_f32_32x32x16_bf16 v[64:79], a[32:35], a[96:99], v[64:79]
  ds_read_b64_tr_b16 a[8:9], v4 offset:57408
  ds_read_b64_tr_b16 a[10:11], v4 offset:59200
  v_mfma_f32_32x32x16_bf16 v[80:95], a[32:35], a[100:103], v[80:95]
  ds_read_b64_tr_b16 a[12:13], v4 offset:57440
  ds_read_b64_tr_b16 a[14:15], v4 offset:59232
  s_waitcnt lgkmcnt(15)
  v_mfma_f32_32x32x16_bf16 v[96:111], a[36:39], a[96:99], v[96:111]
  ds_read_b64_tr_b16 a[16:17], v4 offset:57472
  ds_read_b64_tr_b16 a[18:19], v4 offset:59264
  v_mfma_f32_32x32x16_bf16 v[112:127], a[36:39], a[100:103], v[112:127]
  ds_read_b64_tr_b16 a[20:21], v4 offset:57504
  ds_read_b64_tr_b16 a[22:23], v4 offset:59296
  s_waitcnt lgkmcnt(15)
  v_mfma_f32_32x32x16_bf16 v[128:143], a[40:43], a[96:99], v[128:143]
  ds_read_b64_tr_b16 a[24:25], v4 offset:57536
  ds_read_b64_tr_b16 a[26:27], v4 offset:59328
  v_mfma_f32_32x32x16_bf16 v[144:159], a[40:43], a[100:103], v[144:159]
  s_add_u32 m0, s29, 59904
  s_nop 0
  buffer_load_dwordx4 v14, s[16:19], s31 offen lds
  v_mfma_f32_32x32x16_bf16 v[160:175], a[44:47], a[96:99], v[160:175]
  s_add_u32 m0, s29, 60928
  s_nop 0
  buffer_load_dwordx4 v15, s[16:19], s31 offen lds
  v_mfma_f32_32x32x16_bf16 v[176:191], a[44:47], a[100:103], v[176:191]
  s_add_u32 m0, s29, 61952
  s_nop 0
  buffer_load_dwordx4 v16, s[16:19], s31 offen lds
  s_waitcnt lgkmcnt(15)
  v_mfma_f32_32x32x16_bf16 v[192:207], a[48:51], a[96:99], v[192:207]
  s_add_u32 m0, s29, 62976
  s_nop 0
  buffer_load_dwordx4 v17, s[16:19], s31 offen lds
  v_mfma_f32_32x32x16_bf16 v[208:223], a[48:51], a[100:103], v[208:223]
  s_waitcnt lgkmcnt(14)
  v_mfma_f32_32x32x16_bf16 v[224:239], a[52:55], a[96:99], v[224:239]
  s_waitcnt vmcnt(34)
  v_mfma_f32_32x32x16_bf16 v[240:255], a[52:55], a[100:103], v[240:255]
  s_waitcnt lgkmcnt(12)
  v_mfma_f32_32x32x16_bf16 v[32:47], a[0:3], a[104:107], v[32:47]
  ds_read_b64_tr_b16 a[28:29], v4 offset:60928
  ds_read_b64_tr_b16 a[30:31], v4 offset:62720
  v_mfma_f32_32x32x16_bf16 v[48:63], a[0:3], a[108:111], v[48:63]
  ds_read_b64_tr_b16 a[32:33], v4 offset:60960
  ds_read_b64_tr_b16 a[34:35], v4 offset:62752
  s_waitcnt lgkmcnt(14)
  v_mfma_f32_32x32x16_bf16 v[64:79], a[4:7], a[104:107], v[64:79]
  ds_read_b64_tr_b16 a[36:37], v4 offset:60992
  ds_read_b64_tr_b16 a[38:39], v4 offset:62784
  v_mfma_f32_32x32x16_bf16 v[80:95], a[4:7], a[108:111], v[80:95]
  ds_read_b64_tr_b16 a[40:41], v4 offset:61024
  ds_read_b64_tr_b16 a[42:43], v4 offset:62816
  s_waitcnt lgkmcnt(15)
  v_mfma_f32_32x32x16_bf16 v[96:111], a[8:11], a[104:107], v[96:111]
  ds_read_b64_tr_b16 a[44:45], v4 offset:61056
  ds_read_b64_tr_b16 a[46:47], v4 offset:62848
  v_mfma_f32_32x32x16_bf16 v[112:127], a[8:11], a[108:111], v[112:127]
  ds_read_b64_tr_b16 a[48:49], v4 offset:61088
  ds_read_b64_tr_b16 a[50:51], v4 offset:62880
  s_waitcnt lgkmcnt(15)
  v_mfma_f32_32x32x16_bf16 v[128:143], a[12:15], a[104:107], v[128:143]
  v_mfma_f32_32x32x16_bf16 v[144:159], a[12:15], a[108:111], v[144:159]
  ds_read_b64_tr_b16 a[52:53], v4 offset:61120
  ds_read_b64_tr_b16 a[54:55], v4 offset:62912
  v_mfma_f32_32x32x16_bf16 v[160:175], a[16:19], a[104:107], v[160:175]
  s_add_u32 m0, s29, 64000
  s_nop 0
  buffer_load_dwordx4 v18, s[16:19], s31 offen lds
  v_mfma_f32_32x32x16_bf16 v[176:191], a[16:19], a[108:111], v[176:191]
  buffer_load_dwordx4 a[176:179], v2, s[20:23], s30 offen offset:3072
  buffer_load_dwordx4 a[180:183], v2, s[20:23], s32 offen offset:3072
  s_waitcnt lgkmcnt(15)
  v_mfma_f32_32x32x16_bf16 v[192:207], a[20:23], a[104:107], v[192:207]
  s_add_u32 s30, s30, 4096
  buffer_load_dwordx4 a[56:59], v2, s[20:23], s30 offen offset:0
  s_add_u32 s32, s32, 4096
  buffer_load_dwordx4 a[60:63], v2, s[20:23], s32 offen offset:0
  v_mfma_f32_32x32x16_bf16 v[208:223], a[20:23], a[108:111], v[208:223]
  v_accvgpr_read_b32 v19, a220
  v_accvgpr_read_b32 v20, a222
  v_accvgpr_read_b32 v21, a224
  v_accvgpr_read_b32 v22, a226
  s_waitcnt lgkmcnt(14)
  v_mfma_f32_32x32x16_bf16 v[224:239], a[24:27], a[104:107], v[224:239]
  v_accvgpr_read_b32 v23, a228
  v_accvgpr_read_b32 v24, a230
  v_accvgpr_read_b32 v25, a232
  v_accvgpr_read_b32 v26, a234
  v_mfma_f32_32x32x16_bf16 v[240:255], a[24:27], a[108:111], v[240:255]
  s_waitcnt vmcnt(32)
  s_waitcnt lgkmcnt(12)
  v_mfma_f32_32x32x16_bf16 v[32:47], a[28:31], a[112:115], v[32:47]
  s_waitcnt lgkmcnt(0)
  s_barrier
  v_mfma_f32_32x32x16_bf16 v[48:63], a[28:31], a[116:119], v[48:63]
  ds_read_b64_tr_b16 a[0:1], v3 offset:0
  ds_read_b64_tr_b16 a[2:3], v3 offset:1792
  v_mfma_f32_32x32x16_bf16 v[64:79], a[32:35], a[112:115], v[64:79]
  ds_read_b64_tr_b16 a[4:5], v3 offset:32
  ds_read_b64_tr_b16 a[6:7], v3 offset:1824
  v_mfma_f32_32x32x16_bf16 v[80:95], a[32:35], a[116:119], v[80:95]
  ds_read_b64_tr_b16 a[8:9], v3 offset:64
  ds_read_b64_tr_b16 a[10:11], v3 offset:1856
  v_mfma_f32_32x32x16_bf16 v[96:111], a[36:39], a[112:115], v[96:111]
  ds_read_b64_tr_b16 a[12:13], v3 offset:96
  ds_read_b64_tr_b16 a[14:15], v3 offset:1888
  v_mfma_f32_32x32x16_bf16 v[112:127], a[36:39], a[116:119], v[112:127]
  ds_read_b64_tr_b16 a[16:17], v3 offset:128
  ds_read_b64_tr_b16 a[18:19], v3 offset:1920
  v_mfma_f32_32x32x16_bf16 v[128:143], a[40:43], a[112:115], v[128:143]
  ds_read_b64_tr_b16 a[20:21], v3 offset:160
  ds_read_b64_tr_b16 a[22:23], v3 offset:1952
  v_mfma_f32_32x32x16_bf16 v[144:159], a[40:43], a[116:119], v[144:159]
  v_mfma_f32_32x32x16_bf16 v[160:175], a[44:47], a[112:115], v[160:175]
  ds_read_b64_tr_b16 a[24:25], v3 offset:192
  ds_read_b64_tr_b16 a[26:27], v3 offset:1984
  v_mfma_f32_32x32x16_bf16 v[176:191], a[44:47], a[116:119], v[176:191]
  buffer_load_dwordx4 a[64:67], v2, s[20:23], s30 offen offset:1024
  buffer_load_dwordx4 a[68:71], v2, s[20:23], s32 offen offset:1024
  v_mfma_f32_32x32x16_bf16 v[192:207], a[48:51], a[112:115], v[192:207]
  buffer_load_dwordx4 a[72:75], v2, s[20:23], s30 offen offset:2048
  buffer_load_dwordx4 a[76:79], v2, s[20:23], s32 offen offset:2048
  v_mfma_f32_32x32x16_bf16 v[208:223], a[48:51], a[116:119], v[208:223]
  v_add_f32 v28, v19, v20
  v_add_f32 v28, v28, v21
  v_add_f32 v28, v28, v22
  v_add_f32 v28, v28, v23
  v_mfma_f32_32x32x16_bf16 v[224:239], a[52:55], a[112:115], v[224:239]
  v_add_f32 v28, v28, v24
  v_add_f32 v28, v28, v25
  v_add_f32 v28, v28, v26
  v_mov_b32 v29, v28
  v_mfma_f32_32x32x16_bf16 v[240:255], a[52:55], a[116:119], v[240:255]
  s_waitcnt vmcnt(34)
  s_waitcnt lgkmcnt(12)
  v_mfma_f32_32x32x16_bf16 v[32:47], a[0:3], a[120:123], v[32:47]
  ds_read_b64_tr_b16 a[28:29], v3 offset:3584
  ds_read_b64_tr_b16 a[30:31], v3 offset:5376
  v_mfma_f32_32x32x16_bf16 v[48:63], a[0:3], a[124:127], v[48:63]
  ds_read_b64_tr_b16 a[32:33], v3 offset:3616
  ds_read_b64_tr_b16 a[34:35], v3 offset:5408
  s_waitcnt lgkmcnt(14)
  v_mfma_f32_32x32x16_bf16 v[64:79], a[4:7], a[120:123], v[64:79]
  ds_read_b64_tr_b16 a[36:37], v3 offset:3648
  ds_read_b64_tr_b16 a[38:39], v3 offset:5440
  v_mfma_f32_32x32x16_bf16 v[80:95], a[4:7], a[124:127], v[80:95]
  ds_read_b64_tr_b16 a[40:41], v3 offset:3680
  ds_read_b64_tr_b16 a[42:43], v3 offset:5472
  s_waitcnt lgkmcnt(15)
  v_mfma_f32_32x32x16_bf16 v[96:111], a[8:11], a[120:123], v[96:111]
  ds_read_b64_tr_b16 a[44:45], v3 offset:3712
  ds_read_b64_tr_b16 a[46:47], v3 offset:5504
  v_mfma_f32_32x32x16_bf16 v[112:127], a[8:11], a[124:127], v[112:127]
  ds_read_b64_tr_b16 a[48:49], v3 offset:3744
  ds_read_b64_tr_b16 a[50:51], v3 offset:5536
  s_waitcnt lgkmcnt(15)
  v_mfma_f32_32x32x16_bf16 v[128:143], a[12:15], a[120:123], v[128:143]
  ds_read_b64_tr_b16 a[52:53], v3 offset:3776
  ds_read_b64_tr_b16 a[54:55], v3 offset:5568
  v_mfma_f32_32x32x16_bf16 v[144:159], a[12:15], a[124:127], v[144:159]
  s_add_u32 m0, s29, 86784
  s_add_u32 s31, s28, 5963776
  buffer_load_dwordx4 v12, s[16:19], s31 offen lds
  v_mfma_f32_32x32x16_bf16 v[160:175], a[16:19], a[120:123], v[160:175]
  s_add_u32 m0, s29, 87808
  s_nop 0
  buffer_load_dwordx4 v13, s[16:19], s31 offen lds
  v_mfma_f32_32x32x16_bf16 v[176:191], a[16:19], a[124:127], v[176:191]
  s_add_u32 m0, s29, 88832
  s_nop 0
  buffer_load_dwordx4 v14, s[16:19], s31 offen lds
  s_waitcnt lgkmcnt(15)
  v_mfma_f32_32x32x16_bf16 v[192:207], a[20:23], a[120:123], v[192:207]
  s_add_u32 m0, s29, 89856
  s_nop 0
  buffer_load_dwordx4 v15, s[16:19], s31 offen lds
  v_mfma_f32_32x32x16_bf16 v[208:223], a[20:23], a[124:127], v[208:223]
  s_nop 1
  v_permlane32_swap_b32 v28, v29
  v_add_f32 v28, v28, v29
  v_mul_f32 v28, 0x3d800000, v28
  s_waitcnt lgkmcnt(14)
  v_mfma_f32_32x32x16_bf16 v[224:239], a[24:27], a[120:123], v[224:239]
  v_sub_f32 v19, v19, v28
  v_sub_f32 v20, v20, v28
  v_sub_f32 v21, v21, v28
  v_sub_f32 v22, v22, v28
  v_mfma_f32_32x32x16_bf16 v[240:255], a[24:27], a[124:127], v[240:255]
  s_waitcnt vmcnt(36)
  s_waitcnt lgkmcnt(12)
  v_mfma_f32_32x32x16_bf16 v[32:47], a[28:31], a[128:131], v[32:47]
  ds_read_b64_tr_b16 a[0:1], v3 offset:7168
  ds_read_b64_tr_b16 a[2:3], v3 offset:8960
  v_mfma_f32_32x32x16_bf16 v[48:63], a[28:31], a[132:135], v[48:63]
  ds_read_b64_tr_b16 a[4:5], v3 offset:7200
  ds_read_b64_tr_b16 a[6:7], v3 offset:8992
  s_waitcnt lgkmcnt(14)
  v_mfma_f32_32x32x16_bf16 v[64:79], a[32:35], a[128:131], v[64:79]
  ds_read_b64_tr_b16 a[8:9], v3 offset:7232
  ds_read_b64_tr_b16 a[10:11], v3 offset:9024
  v_mfma_f32_32x32x16_bf16 v[80:95], a[32:35], a[132:135], v[80:95]
  ds_read_b64_tr_b16 a[12:13], v3 offset:7264
  ds_read_b64_tr_b16 a[14:15], v3 offset:9056
  s_waitcnt lgkmcnt(15)
  v_mfma_f32_32x32x16_bf16 v[96:111], a[36:39], a[128:131], v[96:111]
  ds_read_b64_tr_b16 a[16:17], v3 offset:7296
  ds_read_b64_tr_b16 a[18:19], v3 offset:9088
  v_mfma_f32_32x32x16_bf16 v[112:127], a[36:39], a[132:135], v[112:127]
  ds_read_b64_tr_b16 a[20:21], v3 offset:7328
  ds_read_b64_tr_b16 a[22:23], v3 offset:9120
  s_waitcnt lgkmcnt(15)
  v_mfma_f32_32x32x16_bf16 v[128:143], a[40:43], a[128:131], v[128:143]
  ds_read_b64_tr_b16 a[24:25], v3 offset:7360
  ds_read_b64_tr_b16 a[26:27], v3 offset:9152
  v_mfma_f32_32x32x16_bf16 v[144:159], a[40:43], a[132:135], v[144:159]
  s_add_u32 m0, s29, 90880
  s_nop 0
  buffer_load_dwordx4 v16, s[16:19], s31 offen lds
  v_mfma_f32_32x32x16_bf16 v[160:175], a[44:47], a[128:131], v[160:175]
  s_add_u32 m0, s29, 91904
  s_nop 0
  buffer_load_dwordx4 v17, s[16:19], s31 offen lds
  v_mfma_f32_32x32x16_bf16 v[176:191], a[44:47], a[132:135], v[176:191]
  s_add_u32 m0, s29, 92928
  s_nop 0
  buffer_load_dwordx4 v18, s[16:19], s31 offen lds
  s_waitcnt lgkmcnt(15)
  v_mfma_f32_32x32x16_bf16 v[192:207], a[48:51], a[128:131], v[192:207]
  buffer_load_dwordx4 a[80:83], v2, s[20:23], s30 offen offset:3072
  buffer_load_dwordx4 a[84:87], v2, s[20:23], s32 offen offset:3072
  v_mfma_f32_32x32x16_bf16 v[208:223], a[48:51], a[132:135], v[208:223]
  v_sub_f32 v23, v23, v28
  v_sub_f32 v24, v24, v28
  v_sub_f32 v25, v25, v28
  v_sub_f32 v26, v26, v28
  s_waitcnt lgkmcnt(14)
  v_mfma_f32_32x32x16_bf16 v[224:239], a[52:55], a[128:131], v[224:239]
  v_mul_f32 v30, v19, v19
  v_fmac_f32 v30, v20, v20
  v_fmac_f32 v30, v21, v21
  v_fmac_f32 v30, v22, v22
  v_mfma_f32_32x32x16_bf16 v[240:255], a[52:55], a[132:135], v[240:255]
  s_waitcnt vmcnt(39)
  s_waitcnt lgkmcnt(12)
  v_mfma_f32_32x32x16_bf16 v[32:47], a[0:3], a[136:139], v[32:47]
  ds_read_b64_tr_b16 a[28:29], v3 offset:10752
  ds_read_b64_tr_b16 a[30:31], v3 offset:12544
  v_mfma_f32_32x32x16_bf16 v[48:63], a[0:3], a[140:143], v[48:63]
  ds_read_b64_tr_b16 a[32:33], v3 offset:10784
  ds_read_b64_tr_b16 a[34:35], v3 offset:12576
  s_waitcnt lgkmcnt(14)
  v_mfma_f32_32x32x16_bf16 v[64:79], a[4:7], a[136:139], v[64:79]
  ds_read_b64_tr_b16 a[36:37], v3 offset:10816
  ds_read_b64_tr_b16 a[38:39], v3 offset:12608
  v_mfma_f32_32x32x16_bf16 v[80:95], a[4:7], a[140:143], v[80:95]
  ds_read_b64_tr_b16 a[40:41], v3 offset:10848
  ds_read_b64_tr_b16 a[42:43], v3 offset:12640
  s_waitcnt lgkmcnt(15)
  v_mfma_f32_32x32x16_bf16 v[96:111], a[8:11], a[136:139], v[96:111]
  v_mfma_f32_32x32x16_bf16 v[112:127], a[8:11], a[140:143], v[112:127]
  ds_read_b64_tr_b16 a[44:45], v3 offset:10880
  ds_read_b64_tr_b16 a[46:47], v3 offset:12672
  s_waitcnt lgkmcnt(15)
  v_mfma_f32_32x32x16_bf16 v[128:143], a[12:15], a[136:139], v[128:143]
  ds_read_b64_tr_b16 a[48:49], v3 offset:10912
  ds_read_b64_tr_b16 a[50:51], v3 offset:12704
  v_mfma_f32_32x32x16_bf16 v[144:159], a[12:15], a[140:143], v[144:159]
  ds_read_b64_tr_b16 a[52:53], v3 offset:10944
  ds_read_b64_tr_b16 a[54:55], v3 offset:12736
  s_waitcnt lgkmcnt(15)
  v_mfma_f32_32x32x16_bf16 v[160:175], a[16:19], a[136:139], v[160:175]
  s_add_u32 s30, s30, 4096
  buffer_load_dwordx4 a[88:91], v2, s[20:23], s30 offen offset:0
  s_add_u32 s32, s32, 4096
  buffer_load_dwordx4 a[92:95], v2, s[20:23], s32 offen offset:0
  v_mfma_f32_32x32x16_bf16 v[176:191], a[16:19], a[140:143], v[176:191]
  v_mfma_f32_32x32x16_bf16 v[192:207], a[20:23], a[136:139], v[192:207]
  buffer_load_dwordx4 a[96:99], v2, s[20:23], s30 offen offset:1024
  buffer_load_dwordx4 a[100:103], v2, s[20:23], s32 offen offset:1024
  v_mfma_f32_32x32x16_bf16 v[208:223], a[20:23], a[140:143], v[208:223]
  v_fmac_f32 v30, v23, v23
  v_fmac_f32 v30, v24, v24
  v_fmac_f32 v30, v25, v25
  v_fmac_f32 v30, v26, v26
  s_waitcnt lgkmcnt(14)
  v_mfma_f32_32x32x16_bf16 v[224:239], a[24:27], a[136:139], v[224:239]
  v_accvgpr_read_b32 v19, a221
  v_accvgpr_read_b32 v20, a223
  v_accvgpr_read_b32 v21, a225
  v_accvgpr_read_b32 v22, a227
  v_mfma_f32_32x32x16_bf16 v[240:255], a[24:27], a[140:143], v[240:255]
  s_waitcnt vmcnt(34)
  s_waitcnt lgkmcnt(12)
  v_mfma_f32_32x32x16_bf16 v[32:47], a[28:31], a[144:147], v[32:47]
  s_waitcnt lgkmcnt(0)
  s_barrier
  v_mfma_f32_32x32x16_bf16 v[48:63], a[28:31], a[148:151], v[48:63]
  ds_read_b64_tr_b16 a[0:1], v3 offset:28928
  ds_read_b64_tr_b16 a[2:3], v3 offset:30720
  v_mfma_f32_32x32x16_bf16 v[64:79], a[32:35], a[144:147], v[64:79]
  ds_read_b64_tr_b16 a[4:5], v3 offset:28960
  ds_read_b64_tr_b16 a[6:7], v3 offset:30752
  v_mfma_f32_32x32x16_bf16 v[80:95], a[32:35], a[148:151], v[80:95]
  ds_read_b64_tr_b16 a[8:9], v3 offset:28992
  ds_read_b64_tr_b16 a[10:11], v3 offset:30784
  v_mfma_f32_32x32x16_bf16 v[96:111], a[36:39], a[144:147], v[96:111]
  ds_read_b64_tr_b16 a[12:13], v3 offset:29024
  ds_read_b64_tr_b16 a[14:15], v3 offset:30816
  v_mfma_f32_32x32x16_bf16 v[112:127], a[36:39], a[148:151], v[112:127]
  ds_read_b64_tr_b16 a[16:17], v3 offset:29056
  ds_read_b64_tr_b16 a[18:19], v3 offset:30848
  v_mfma_f32_32x32x16_bf16 v[128:143], a[40:43], a[144:147], v[128:143]
  ds_read_b64_tr_b16 a[20:21], v3 offset:29088
  ds_read_b64_tr_b16 a[22:23], v3 offset:30880
  v_mfma_f32_32x32x16_bf16 v[144:159], a[40:43], a[148:151], v[144:159]
  ds_read_b64_tr_b16 a[24:25], v3 offset:29120
  ds_read_b64_tr_b16 a[26:27], v3 offset:30912
  v_mfma_f32_32x32x16_bf16 v[160:175], a[44:47], a[144:147], v[160:175]
  buffer_load_dwordx4 a[104:107], v2, s[20:23], s30 offen offset:2048
  buffer_load_dwordx4 a[108:111], v2, s[20:23], s32 offen offset:2048
  v_mfma_f32_32x32x16_bf16 v[176:191], a[44:47], a[148:151], v[176:191]
  s_add_u32 m0, s29, 115712
  s_add_u32 s31, s28, 6422528
  buffer_load_dwordx4 v12, s[16:19], s31 offen lds
  v_mfma_f32_32x32x16_bf16 v[192:207], a[48:51], a[144:147], v[192:207]
  s_add_u32 m0, s29, 116736
  s_nop 0
  buffer_load_dwordx4 v13, s[16:19], s31 offen lds
  v_mfma_f32_32x32x16_bf16 v[208:223], a[48:51], a[148:151], v[208:223]
  v_accvgpr_read_b32 v23, a229
  v_accvgpr_read_b32 v24, a231
  v_accvgpr_read_b32 v25, a233
  v_accvgpr_read_b32 v26, a235
  v_mfma_f32_32x32x16_bf16 v[224:239], a[52:55], a[144:147], v[224:239]
  v_add_f32 v29, v19, v20
  v_add_f32 v29, v29, v21
  v_add_f32 v29, v29, v22
  v_add_f32 v29, v29, v23
  v_mfma_f32_32x32x16_bf16 v[240:255], a[52:55], a[148:151], v[240:255]
  s_waitcnt vmcnt(36)
  s_waitcnt lgkmcnt(12)
  v_mfma_f32_32x32x16_bf16 v[32:47], a[0:3], a[152:155], v[32:47]
  ds_read_b64_tr_b16 a[28:29], v3 offset:32512
  ds_read_b64_tr_b16 a[30:31], v3 offset:34304
  v_mfma_f32_32x32x16_bf16 v[48:63], a[0:3], a[156:159], v[48:63]
  ds_read_b64_tr_b16 a[32:33], v3 offset:32544
  ds_read_b64_tr_b16 a[34:35], v3 offset:34336
  s_waitcnt lgkmcnt(14)
  v_mfma_f32_32x32x16_bf16 v[64:79], a[4:7], a[152:155], v[64:79]
  ds_read_b64_tr_b16 a[36:37], v3 offset:32576
  ds_read_b64_tr_b16 a[38:39], v3 offset:34368
  v_mfma_f32_32x32x16_bf16 v[80:95], a[4:7], a[156:159], v[80:95]
  ds_read_b64_tr_b16 a[40:41], v3 offset:32608
  ds_read_b64_tr_b16 a[42:43], v3 offset:34400
  s_waitcnt lgkmcnt(15)
  v_mfma_f32_32x32x16_bf16 v[96:111], a[8:11], a[152:155], v[96:111]
  ds_read_b64_tr_b16 a[44:45], v3 offset:32640
  ds_read_b64_tr_b16 a[46:47], v3 offset:34432
  v_mfma_f32_32x32x16_bf16 v[112:127], a[8:11], a[156:159], v[112:127]
  ds_read_b64_tr_b16 a[48:49], v3 offset:32672
  ds_read_b64_tr_b16 a[50:51], v3 offset:34464
  s_waitcnt lgkmcnt(15)
  v_mfma_f32_32x32x16_bf16 v[128:143], a[12:15], a[152:155], v[128:143]
  ds_read_b64_tr_b16 a[52:53], v3 offset:32704
  ds_read_b64_tr_b16 a[54:55], v3 offset:34496
  v_mfma_f32_32x32x16_bf16 v[144:159], a[12:15], a[156:159], v[144:159]
  s_add_u32 m0, s29, 117760
  s_nop 0
  buffer_load_dwordx4 v14, s[16:19], s31 offen lds
  v_mfma_f32_32x32x16_bf16 v[160:175], a[16:19], a[152:155], v[160:175]
  s_add_u32 m0, s29, 118784
  s_nop 0
  buffer_load_dwordx4 v15, s[16:19], s31 offen lds
  v_mfma_f32_32x32x16_bf16 v[176:191], a[16:19], a[156:159], v[176:191]
  s_add_u32 m0, s29, 119808
  s_nop 0
  buffer_load_dwordx4 v16, s[16:19], s31 offen lds
  s_waitcnt lgkmcnt(15)
  v_mfma_f32_32x32x16_bf16 v[192:207], a[20:23], a[152:155], v[192:207]
  s_add_u32 m0, s29, 120832
  s_nop 0
  buffer_load_dwordx4 v17, s[16:19], s31 offen lds
  v_mfma_f32_32x32x16_bf16 v[208:223], a[20:23], a[156:159], v[208:223]
  v_add_f32 v29, v29, v24
  v_add_f32 v29, v29, v25
  v_add_f32 v29, v29, v26
  v_fmac_f32 v29, 0x42800000, v30
  s_waitcnt lgkmcnt(14)
  v_mfma_f32_32x32x16_bf16 v[224:239], a[24:27], a[152:155], v[224:239]
  v_mov_b32 v30, v29
  s_nop 1
  v_permlane32_swap_b32 v29, v30
  v_add_f32 v29, v29, v30
  v_mfma_f32_32x32x16_bf16 v[240:255], a[24:27], a[156:159], v[240:255]
  s_waitcnt vmcnt(38)
  s_waitcnt lgkmcnt(12)
  v_mfma_f32_32x32x16_bf16 v[32:47], a[28:31], a[160:163], v[32:47]
  ds_read_b64_tr_b16 a[0:1], v3 offset:36096
  ds_read_b64_tr_b16 a[2:3], v3 offset:37888
  v_mfma_f32_32x32x16_bf16 v[48:63], a[28:31], a[164:167], v[48:63]
  ds_read_b64_tr_b16 a[4:5], v3 offset:36128
  ds_read_b64_tr_b16 a[6:7], v3 offset:37920
  s_waitcnt lgkmcnt(14)
  v_mfma_f32_32x32x16_bf16 v[64:79], a[32:35], a[160:163], v[64:79]
  ds_read_b64_tr_b16 a[8:9], v3 offset:36160
  ds_read_b64_tr_b16 a[10:11], v3 offset:37952
  v_mfma_f32_32x32x16_bf16 v[80:95], a[32:35], a[164:167], v[80:95]
  ds_read_b64_tr_b16 a[12:13], v3 offset:36192
  ds_read_b64_tr_b16 a[14:15], v3 offset:37984
  s_waitcnt lgkmcnt(15)
  v_mfma_f32_32x32x16_bf16 v[96:111], a[36:39], a[160:163], v[96:111]
  ds_read_b64_tr_b16 a[16:17], v3 offset:36224
  ds_read_b64_tr_b16 a[18:19], v3 offset:38016
  v_mfma_f32_32x32x16_bf16 v[112:127], a[36:39], a[164:167], v[112:127]
  ds_read_b64_tr_b16 a[20:21], v3 offset:36256
  ds_read_b64_tr_b16 a[22:23], v3 offset:38048
  s_waitcnt lgkmcnt(15)
  v_mfma_f32_32x32x16_bf16 v[128:143], a[40:43], a[160:163], v[128:143]
  v_mfma_f32_32x32x16_bf16 v[144:159], a[40:43], a[164:167], v[144:159]
  ds_read_b64_tr_b16 a[24:25], v3 offset:36288
  ds_read_b64_tr_b16 a[26:27], v3 offset:38080
  v_mfma_f32_32x32x16_bf16 v[160:175], a[44:47], a[160:163], v[160:175]
  s_add_u32 m0, s29, 121856
  s_nop 0
  buffer_load_dwordx4 v18, s[16:19], s31 offen lds
  v_mfma_f32_32x32x16_bf16 v[176:191], a[44:47], a[164:167], v[176:191]
  buffer_load_dwordx4 a[112:115], v2, s[20:23], s30 offen offset:3072
  buffer_load_dwordx4 a[116:119], v2, s[20:23], s32 offen offset:3072
  s_waitcnt lgkmcnt(15)
  v_mfma_f32_32x32x16_bf16 v[192:207], a[48:51], a[160:163], v[192:207]
  s_add_u32 s30, s30, 4096
  buffer_load_dwordx4 a[120:123], v2, s[20:23], s30 offen offset:0
  s_add_u32 s32, s32, 4096
  buffer_load_dwordx4 a[124:127], v2, s[20:23], s32 offen offset:0
  v_mfma_f32_32x32x16_bf16 v[208:223], a[48:51], a[164:167], v[208:223]
  v_mov_b32 v30, 0x3727c5ac
  v_fmac_f32 v30, 0x3a800000, v29
  v_rcp_f32 v9, v30
  v_sqrt_f32 v29, v30
  s_waitcnt lgkmcnt(14)
  v_mfma_f32_32x32x16_bf16 v[224:239], a[52:55], a[160:163], v[224:239]
  v_sub_f32 v28, 0, v28
  v_cvt_pk_bf16_f32 v19, v28, v28
  v_and_b32 v20, 0xffff0000, v19
  v_sub_f32 v20, v28, v20
  v_mfma_f32_32x32x16_bf16 v[240:255], a[52:55], a[164:167], v[240:255]
  s_waitcnt vmcnt(41)
  s_waitcnt lgkmcnt(12)
  v_mfma_f32_32x32x16_bf16 v[32:47], a[0:3], a[168:171], v[32:47]
  ds_read_b64_tr_b16 a[28:29], v3 offset:39680
  ds_read_b64_tr_b16 a[30:31], v3 offset:41472
  v_mfma_f32_32x32x16_bf16 v[48:63], a[0:3], a[172:175], v[48:63]
  ds_read_b64_tr_b16 a[32:33], v3 offset:39712
  ds_read_b64_tr_b16 a[34:35], v3 offset:41504
  s_waitcnt lgkmcnt(14)
  v_mfma_f32_32x32x16_bf16 v[64:79], a[4:7], a[168:171], v[64:79]
  ds_read_b64_tr_b16 a[36:37], v3 offset:39744
  ds_read_b64_tr_b16 a[38:39], v3 offset:41536
  v_mfma_f32_32x32x16_bf16 v[80:95], a[4:7], a[172:175], v[80:95]
  ds_read_b64_tr_b16 a[40:41], v3 offset:39776
  ds_read_b64_tr_b16 a[42:43], v3 offset:41568
  s_waitcnt lgkmcnt(15)
  v_mfma_f32_32x32x16_bf16 v[96:111], a[8:11], a[168:171], v[96:111]
  v_mfma_f32_32x32x16_bf16 v[112:127], a[8:11], a[172:175], v[112:127]
  ds_read_b64_tr_b16 a[44:45], v3 offset:39808
  ds_read_b64_tr_b16 a[46:47], v3 offset:41600
  s_waitcnt lgkmcnt(15)
  v_mfma_f32_32x32x16_bf16 v[128:143], a[12:15], a[168:171], v[128:143]
  ds_read_b64_tr_b16 a[48:49], v3 offset:39840
  ds_read_b64_tr_b16 a[50:51], v3 offset:41632
  v_mfma_f32_32x32x16_bf16 v[144:159], a[12:15], a[172:175], v[144:159]
  ds_read_b64_tr_b16 a[52:53], v3 offset:39872
  ds_read_b64_tr_b16 a[54:55], v3 offset:41664
  s_waitcnt lgkmcnt(15)
  v_mfma_f32_32x32x16_bf16 v[160:175], a[16:19], a[168:171], v[160:175]
  buffer_load_dwordx4 a[128:131], v2, s[20:23], s30 offen offset:1024
  buffer_load_dwordx4 a[132:135], v2, s[20:23], s32 offen offset:1024
  v_mfma_f32_32x32x16_bf16 v[176:191], a[16:19], a[172:175], v[176:191]
  v_mfma_f32_32x32x16_bf16 v[192:207], a[20:23], a[168:171], v[192:207]
  buffer_load_dwordx4 a[136:139], v2, s[20:23], s30 offen offset:2048
  buffer_load_dwordx4 a[140:143], v2, s[20:23], s32 offen offset:2048
  v_mfma_f32_32x32x16_bf16 v[208:223], a[20:23], a[172:175], v[208:223]
  v_cvt_pk_bf16_f32 v20, v20, v20
  v_cvt_pk_bf16_f32 v21, v29, v29
  v_and_b32 v22, 0xffff0000, v21
  v_sub_f32 v22, v29, v22
  s_waitcnt lgkmcnt(14)
  v_mfma_f32_32x32x16_bf16 v[224:239], a[24:27], a[168:171], v[224:239]
  v_cvt_pk_bf16_f32 v22, v22, v22
  v_perm_b32 v23, v21, v20, s46
  v_perm_b32 v24, v22, v21, s46
  v_cmp_gt_u32 vcc, 32, v1
  v_mfma_f32_32x32x16_bf16 v[240:255], a[24:27], a[172:175], v[240:255]
  s_waitcnt vmcnt(36)
  s_waitcnt lgkmcnt(12)
  v_mfma_f32_32x32x16_bf16 v[32:47], a[28:31], a[176:179], v[32:47]
  s_waitcnt lgkmcnt(0)
  s_barrier
  v_mfma_f32_32x32x16_bf16 v[48:63], a[28:31], a[180:183], v[48:63]
  ds_read_b64_tr_b16 a[0:1], v3 offset:57856
  ds_read_b64_tr_b16 a[2:3], v3 offset:59648
  v_mfma_f32_32x32x16_bf16 v[64:79], a[32:35], a[176:179], v[64:79]
  ds_read_b64_tr_b16 a[4:5], v3 offset:57888
  ds_read_b64_tr_b16 a[6:7], v3 offset:59680
  v_mfma_f32_32x32x16_bf16 v[80:95], a[32:35], a[180:183], v[80:95]
  ds_read_b64_tr_b16 a[8:9], v3 offset:57920
  ds_read_b64_tr_b16 a[10:11], v3 offset:59712
  v_mfma_f32_32x32x16_bf16 v[96:111], a[36:39], a[176:179], v[96:111]
  ds_read_b64_tr_b16 a[12:13], v3 offset:57952
  ds_read_b64_tr_b16 a[14:15], v3 offset:59744
  v_mfma_f32_32x32x16_bf16 v[112:127], a[36:39], a[180:183], v[112:127]
  ds_read_b64_tr_b16 a[16:17], v3 offset:57984
  ds_read_b64_tr_b16 a[18:19], v3 offset:59776
  v_mfma_f32_32x32x16_bf16 v[128:143], a[40:43], a[176:179], v[128:143]
  ds_read_b64_tr_b16 a[20:21], v3 offset:58016
  ds_read_b64_tr_b16 a[22:23], v3 offset:59808
  v_mfma_f32_32x32x16_bf16 v[144:159], a[40:43], a[180:183], v[144:159]
  ds_read_b64_tr_b16 a[24:25], v3 offset:58048
  ds_read_b64_tr_b16 a[26:27], v3 offset:59840
  v_mfma_f32_32x32x16_bf16 v[160:175], a[44:47], a[176:179], v[160:175]
  s_add_u32 m0, s29, 0
  s_add_u32 s31, s28, 6881280
  buffer_load_dwordx4 v12, s[16:19], s31 offen lds
  v_mfma_f32_32x32x16_bf16 v[176:191], a[44:47], a[180:183], v[176:191]
  s_add_u32 m0, s29, 1024
  s_nop 0
  buffer_load_dwordx4 v13, s[16:19], s31 offen lds
  v_mfma_f32_32x32x16_bf16 v[192:207], a[48:51], a[176:179], v[192:207]
  s_add_u32 m0, s29, 2048
  s_nop 0
  buffer_load_dwordx4 v14, s[16:19], s31 offen lds
  v_mfma_f32_32x32x16_bf16 v[208:223], a[48:51], a[180:183], v[208:223]
  s_add_u32 m0, s29, 3072
  s_nop 0
  buffer_load_dwordx4 v15, s[16:19], s31 offen lds
  v_mfma_f32_32x32x16_bf16 v[224:239], a[52:55], a[176:179], v[224:239]
  s_nop 1
  v_cndmask_b32 v19, 0, v19, vcc
  v_cndmask_b32 v23, 0, v23, vcc
  v_cndmask_b32 v24, 0, v24, vcc
  v_mfma_f32_32x32x16_bf16 v[240:255], a[52:55], a[180:183], v[240:255]
  v_accvgpr_write_b32 a216, v19
  v_accvgpr_write_b32 a217, v23
  v_accvgpr_write_b32 a218, v24
  v_accvgpr_write_b32 a219, 0
  s_waitcnt vmcnt(38)
  s_waitcnt lgkmcnt(12)
  v_mfma_f32_32x32x16_bf16 v[32:47], a[0:3], a[56:59], v[32:47]
  ds_read_b64_tr_b16 a[28:29], v3 offset:61440
  ds_read_b64_tr_b16 a[30:31], v3 offset:63232
  v_mfma_f32_32x32x16_bf16 v[48:63], a[0:3], a[60:63], v[48:63]
  ds_read_b64_tr_b16 a[32:33], v3 offset:61472
  ds_read_b64_tr_b16 a[34:35], v3 offset:63264
  s_waitcnt lgkmcnt(14)
  v_mfma_f32_32x32x16_bf16 v[64:79], a[4:7], a[56:59], v[64:79]
  ds_read_b64_tr_b16 a[36:37], v3 offset:61504
  ds_read_b64_tr_b16 a[38:39], v3 offset:63296
  v_mfma_f32_32x32x16_bf16 v[80:95], a[4:7], a[60:63], v[80:95]
  ds_read_b64_tr_b16 a[40:41], v3 offset:61536
  ds_read_b64_tr_b16 a[42:43], v3 offset:63328
  s_waitcnt lgkmcnt(15)
  v_mfma_f32_32x32x16_bf16 v[96:111], a[8:11], a[56:59], v[96:111]
  v_mfma_f32_32x32x16_bf16 v[112:127], a[8:11], a[60:63], v[112:127]
  ds_read_b64_tr_b16 a[44:45], v3 offset:61568
  ds_read_b64_tr_b16 a[46:47], v3 offset:63360
  s_waitcnt lgkmcnt(15)
  v_mfma_f32_32x32x16_bf16 v[128:143], a[12:15], a[56:59], v[128:143]
  ds_read_b64_tr_b16 a[48:49], v3 offset:61600
  ds_read_b64_tr_b16 a[50:51], v3 offset:63392
  v_mfma_f32_32x32x16_bf16 v[144:159], a[12:15], a[60:63], v[144:159]
  ds_read_b64_tr_b16 a[52:53], v3 offset:61632
  ds_read_b64_tr_b16 a[54:55], v3 offset:63424
  s_waitcnt lgkmcnt(15)
  v_mfma_f32_32x32x16_bf16 v[160:175], a[16:19], a[56:59], v[160:175]
  s_add_u32 m0, s29, 4096
  s_nop 0
  buffer_load_dwordx4 v16, s[16:19], s31 offen lds
  v_mfma_f32_32x32x16_bf16 v[176:191], a[16:19], a[60:63], v[176:191]
  v_mfma_f32_32x32x16_bf16 v[192:207], a[20:23], a[56:59], v[192:207]
  s_add_u32 m0, s29, 5120
  s_nop 0
  buffer_load_dwordx4 v17, s[16:19], s31 offen lds
  v_mfma_f32_32x32x16_bf16 v[208:223], a[20:23], a[60:63], v[208:223]
  s_add_u32 m0, s29, 6144
  s_nop 0
  buffer_load_dwordx4 v18, s[16:19], s31 offen lds
  s_waitcnt lgkmcnt(14)
  v_mfma_f32_32x32x16_bf16 v[224:239], a[24:27], a[56:59], v[224:239]
  buffer_load_dwordx4 a[144:147], v2, s[20:23], s30 offen offset:3072
  buffer_load_dwordx4 a[148:151], v2, s[20:23], s32 offen offset:3072
  v_mfma_f32_32x32x16_bf16 v[240:255], a[24:27], a[60:63], v[240:255]
  s_waitcnt vmcnt(41)
  s_waitcnt lgkmcnt(12)
  v_mfma_f32_32x32x16_bf16 v[32:47], a[28:31], a[64:67], v[32:47]
  ds_read_b64_tr_b16 a[0:1], v3 offset:65024
  ds_read_b64_tr_b16 a[2:3], v4 offset:1280
  v_mfma_f32_32x32x16_bf16 v[48:63], a[28:31], a[68:71], v[48:63]
  ds_read_b64_tr_b16 a[4:5], v3 offset:65056
  ds_read_b64_tr_b16 a[6:7], v4 offset:1312
  s_waitcnt lgkmcnt(14)
  v_mfma_f32_32x32x16_bf16 v[64:79], a[32:35], a[64:67], v[64:79]
  v_mfma_f32_32x32x16_bf16 v[80:95], a[32:35], a[68:71], v[80:95]
  ds_read_b64_tr_b16 a[8:9], v3 offset:65088
  ds_read_b64_tr_b16 a[10:11], v4 offset:1344
  s_waitcnt lgkmcnt(14)
  v_mfma_f32_32x32x16_bf16 v[96:111], a[36:39], a[64:67], v[96:111]
  ds_read_b64_tr_b16 a[12:13], v3 offset:65120
  ds_read_b64_tr_b16 a[14:15], v4 offset:1376
  v_mfma_f32_32x32x16_bf16 v[112:127], a[36:39], a[68:71], v[112:127]
  s_waitcnt lgkmcnt(14)
  v_mfma_f32_32x32x16_bf16 v[128:143], a[40:43], a[64:67], v[128:143]
  ds_read_b64_tr_b16 a[16:17], v3 offset:65152
  ds_read_b64_tr_b16 a[18:19], v4 offset:1408
  v_mfma_f32_32x32x16_bf16 v[144:159], a[40:43], a[68:71], v[144:159]
  ds_read_b64_tr_b16 a[20:21], v3 offset:65184
  ds_read_b64_tr_b16 a[22:23], v4 offset:1440
  s_waitcnt lgkmcnt(15)
  v_mfma_f32_32x32x16_bf16 v[160:175], a[44:47], a[64:67], v[160:175]
  v_mfma_f32_32x32x16_bf16 v[176:191], a[44:47], a[68:71], v[176:191]
  ds_read_b64_tr_b16 a[24:25], v3 offset:65216
  ds_read_b64_tr_b16 a[26:27], v4 offset:1472
  s_waitcnt lgkmcnt(15)
  v_mfma_f32_32x32x16_bf16 v[192:207], a[48:51], a[64:67], v[192:207]
  s_add_u32 s30, s30, 4096
  buffer_load_dwordx4 a[152:155], v2, s[20:23], s30 offen offset:0
  s_add_u32 s32, s32, 4096
  buffer_load_dwordx4 a[156:159], v2, s[20:23], s32 offen offset:0
  v_mfma_f32_32x32x16_bf16 v[208:223], a[48:51], a[68:71], v[208:223]
  s_waitcnt lgkmcnt(14)
  v_mfma_f32_32x32x16_bf16 v[224:239], a[52:55], a[64:67], v[224:239]
  buffer_load_dwordx4 a[160:163], v2, s[20:23], s30 offen offset:1024
  buffer_load_dwordx4 a[164:167], v2, s[20:23], s32 offen offset:1024
  v_mfma_f32_32x32x16_bf16 v[240:255], a[52:55], a[68:71], v[240:255]
  s_waitcnt vmcnt(43)
  s_waitcnt lgkmcnt(12)
  v_mfma_f32_32x32x16_bf16 v[32:47], a[0:3], a[72:75], v[32:47]
  ds_read_b64_tr_b16 a[28:29], v4 offset:3072
  ds_read_b64_tr_b16 a[30:31], v4 offset:4864
  v_mfma_f32_32x32x16_bf16 v[48:63], a[0:3], a[76:79], v[48:63]
  ds_read_b64_tr_b16 a[32:33], v4 offset:3104
  ds_read_b64_tr_b16 a[34:35], v4 offset:4896
  s_waitcnt lgkmcnt(14)
  v_mfma_f32_32x32x16_bf16 v[64:79], a[4:7], a[72:75], v[64:79]
  v_mfma_f32_32x32x16_bf16 v[80:95], a[4:7], a[76:79], v[80:95]
  ds_read_b64_tr_b16 a[36:37], v4 offset:3136
  ds_read_b64_tr_b16 a[38:39], v4 offset:4928
  s_waitcnt lgkmcnt(14)
  v_mfma_f32_32x32x16_bf16 v[96:111], a[8:11], a[72:75], v[96:111]
  ds_read_b64_tr_b16 a[40:41], v4 offset:3168
  ds_read_b64_tr_b16 a[42:43], v4 offset:4960
  v_mfma_f32_32x32x16_bf16 v[112:127], a[8:11], a[76:79], v[112:127]
  s_waitcnt lgkmcnt(14)
  v_mfma_f32_32x32x16_bf16 v[128:143], a[12:15], a[72:75], v[128:143]
  ds_read_b64_tr_b16 a[44:45], v4 offset:3200
  ds_read_b64_tr_b16 a[46:47], v4 offset:4992
  v_mfma_f32_32x32x16_bf16 v[144:159], a[12:15], a[76:79], v[144:159]
  ds_read_b64_tr_b16 a[48:49], v4 offset:3232
  ds_read_b64_tr_b16 a[50:51], v4 offset:5024
  s_waitcnt lgkmcnt(15)
  v_mfma_f32_32x32x16_bf16 v[160:175], a[16:19], a[72:75], v[160:175]
  v_mfma_f32_32x32x16_bf16 v[176:191], a[16:19], a[76:79], v[176:191]
  ds_read_b64_tr_b16 a[52:53], v4 offset:3264
  ds_read_b64_tr_b16 a[54:55], v4 offset:5056
  s_waitcnt lgkmcnt(15)
  v_mfma_f32_32x32x16_bf16 v[192:207], a[20:23], a[72:75], v[192:207]
  buffer_load_dwordx4 a[168:171], v2, s[20:23], s30 offen offset:2048
  buffer_load_dwordx4 a[172:175], v2, s[20:23], s32 offen offset:2048
  v_mfma_f32_32x32x16_bf16 v[208:223], a[20:23], a[76:79], v[208:223]
  s_waitcnt lgkmcnt(14)
  v_mfma_f32_32x32x16_bf16 v[224:239], a[24:27], a[72:75], v[224:239]
  buffer_load_dwordx4 a[176:179], v2, s[20:23], s30 offen offset:3072
  buffer_load_dwordx4 a[180:183], v2, s[20:23], s32 offen offset:3072
  v_mfma_f32_32x32x16_bf16 v[240:255], a[24:27], a[76:79], v[240:255]
  s_waitcnt vmcnt(38)
  s_waitcnt lgkmcnt(12)
  v_mfma_f32_32x32x16_bf16 v[32:47], a[28:31], a[80:83], v[32:47]
  v_mfma_f32_32x32x16_bf16 v[48:63], a[28:31], a[84:87], v[48:63]
  s_waitcnt lgkmcnt(10)
  v_mfma_f32_32x32x16_bf16 v[64:79], a[32:35], a[80:83], v[64:79]
  v_mfma_f32_32x32x16_bf16 v[80:95], a[32:35], a[84:87], v[80:95]
  s_waitcnt lgkmcnt(8)
  v_mfma_f32_32x32x16_bf16 v[96:111], a[36:39], a[80:83], v[96:111]
  v_mfma_f32_32x32x16_bf16 v[112:127], a[36:39], a[84:87], v[112:127]
  s_waitcnt lgkmcnt(6)
  v_mfma_f32_32x32x16_bf16 v[128:143], a[40:43], a[80:83], v[128:143]
  v_mfma_f32_32x32x16_bf16 v[144:159], a[40:43], a[84:87], v[144:159]
  s_waitcnt lgkmcnt(4)
  v_mfma_f32_32x32x16_bf16 v[160:175], a[44:47], a[80:83], v[160:175]
  v_mfma_f32_32x32x16_bf16 v[176:191], a[44:47], a[84:87], v[176:191]
  s_waitcnt lgkmcnt(2)
  v_mfma_f32_32x32x16_bf16 v[192:207], a[48:51], a[80:83], v[192:207]
  v_mfma_f32_32x32x16_bf16 v[208:223], a[48:51], a[84:87], v[208:223]
  s_waitcnt lgkmcnt(0)
  v_mfma_f32_32x32x16_bf16 v[224:239], a[52:55], a[80:83], v[224:239]
  v_mfma_f32_32x32x16_bf16 v[240:255], a[52:55], a[84:87], v[240:255]
  s_add_u32 s20, s4, 50331648
  s_addc_u32 s21, s5, 0
  s_and_b32 s21, s21, 0xffff
  s_mov_b32 s22, 14680064
  s_mov_b32 s23, 0x00020000
  s_add_u32 s16, s4, 65536000
  s_addc_u32 s17, s5, 0
  s_and_b32 s17, s17, 0xffff
  s_mov_b32 s18, 8192
  s_mov_b32 s19, 0x00020000
  s_mul_i32 s36, s9, 7168
  s_mul_i32 s37, s33, 229376
  s_add_u32 s36, s36, s37
  s_add_u32 s37, s36, 229376
  s_lshl_b32 s34, s33, 7
  s_cmp_lg_u32 s9, 0
  s_cselect_b32 s34, 0x7ff00000, s34
  v_lshlrev_b32 v7, 2, v1
  v_cmp_gt_u32 vcc, 32, v1
  s_nop 1
  v_cndmask_b32 v19, v9, v8, vcc
  buffer_store_dword v19, v7, s[16:19], s34 offen sc1
  s_waitcnt vmcnt(11)
  s_barrier
  ds_read_b64_tr_b16 a[0:1], v4 offset:21248
  ds_read_b64_tr_b16 a[2:3], v4 offset:23040
  ds_read_b64_tr_b16 a[4:5], v4 offset:24832
  ds_read_b64_tr_b16 a[6:7], v4 offset:26624
  ds_read_b64_tr_b16 a[8:9], v4 offset:28416
  ds_read_b64_tr_b16 a[10:11], v4 offset:30208
  ds_read_b64_tr_b16 a[12:13], v4 offset:32000
  ds_read_b64_tr_b16 a[14:15], v4 offset:33792
  ds_read_b64_tr_b16 a[16:17], v4 offset:50176
  ds_read_b64_tr_b16 a[18:19], v4 offset:51968
  ds_read_b64_tr_b16 a[20:21], v4 offset:53760
  ds_read_b64_tr_b16 a[22:23], v4 offset:55552
  s_waitcnt lgkmcnt(10)
  v_mfma_f32_32x32x16_bf16 v[32:47], a[0:3], a[88:91], v[32:47]
  ds_read_b64_tr_b16 a[24:25], v4 offset:57344
  ds_read_b64_tr_b16 a[26:27], v4 offset:59136
  v_mfma_f32_32x32x16_bf16 v[48:63], a[0:3], a[92:95], v[48:63]
  s_waitcnt lgkmcnt(10)
  v_mfma_f32_32x32x16_bf16 v[32:47], a[4:7], a[96:99], v[32:47]
  ds_read_b64_tr_b16 a[28:29], v4 offset:60928
  ds_read_b64_tr_b16 a[30:31], v4 offset:62720
  v_mfma_f32_32x32x16_bf16 v[48:63], a[4:7], a[100:103], v[48:63]
  s_waitcnt lgkmcnt(10)
  v_mfma_f32_32x32x16_bf16 v[32:47], a[8:11], a[104:107], v[32:47]
  ds_read_b64_tr_b16 a[32:33], v3 offset:0
  ds_read_b64_tr_b16 a[34:35], v3 offset:1792
  v_mfma_f32_32x32x16_bf16 v[48:63], a[8:11], a[108:111], v[48:63]
  s_waitcnt lgkmcnt(10)
  v_mfma_f32_32x32x16_bf16 v[32:47], a[12:15], a[112:115], v[32:47]
  ds_read_b64_tr_b16 a[36:37], v3 offset:3584
  ds_read_b64_tr_b16 a[38:39], v3 offset:5376
  v_mfma_f32_32x32x16_bf16 v[48:63], a[12:15], a[116:119], v[48:63]
  s_waitcnt lgkmcnt(10)
  v_mfma_f32_32x32x16_bf16 v[32:47], a[16:19], a[120:123], v[32:47]
  ds_read_b64_tr_b16 a[40:41], v3 offset:7168
  ds_read_b64_tr_b16 a[42:43], v3 offset:8960
  v_mfma_f32_32x32x16_bf16 v[48:63], a[16:19], a[124:127], v[48:63]
  s_waitcnt lgkmcnt(10)
  v_mfma_f32_32x32x16_bf16 v[32:47], a[20:23], a[128:131], v[32:47]
  ds_read_b64_tr_b16 a[44:45], v3 offset:10752
  ds_read_b64_tr_b16 a[46:47], v3 offset:12544
  v_mfma_f32_32x32x16_bf16 v[48:63], a[20:23], a[132:135], v[48:63]
  s_waitcnt lgkmcnt(10)
  v_mfma_f32_32x32x16_bf16 v[32:47], a[24:27], a[136:139], v[32:47]
  ds_read_b64_tr_b16 a[48:49], v4 offset:21280
  ds_read_b64_tr_b16 a[50:51], v4 offset:23072
  v_mfma_f32_32x32x16_bf16 v[48:63], a[24:27], a[140:143], v[48:63]
  s_waitcnt lgkmcnt(10)
  s_waitcnt vmcnt(9)
  v_mfma_f32_32x32x16_bf16 v[32:47], a[28:31], a[144:147], v[32:47]
  ds_read_b64_tr_b16 a[52:53], v4 offset:24864
  ds_read_b64_tr_b16 a[54:55], v4 offset:26656
  v_mfma_f32_32x32x16_bf16 v[48:63], a[28:31], a[148:151], v[48:63]
  s_waitcnt lgkmcnt(10)
  s_waitcnt vmcnt(7)
  v_mfma_f32_32x32x16_bf16 v[32:47], a[32:35], a[152:155], v[32:47]
  ds_read_b64_tr_b16 a[0:1], v4 offset:28448
  ds_read_b64_tr_b16 a[2:3], v4 offset:30240
  v_mfma_f32_32x32x16_bf16 v[48:63], a[32:35], a[156:159], v[48:63]
  s_waitcnt lgkmcnt(10)
  s_waitcnt vmcnt(5)
  v_mfma_f32_32x32x16_bf16 v[32:47], a[36:39], a[160:163], v[32:47]
  ds_read_b64_tr_b16 a[4:5], v4 offset:32032
  ds_read_b64_tr_b16 a[6:7], v4 offset:33824
  v_mfma_f32_32x32x16_bf16 v[48:63], a[36:39], a[164:167], v[48:63]
  s_waitcnt lgkmcnt(10)
  s_waitcnt vmcnt(3)
  v_mfma_f32_32x32x16_bf16 v[32:47], a[40:43], a[168:171], v[32:47]
  ds_read_b64_tr_b16 a[8:9], v4 offset:50208
  ds_read_b64_tr_b16 a[10:11], v4 offset:52000
  v_mfma_f32_32x32x16_bf16 v[48:63], a[40:43], a[172:175], v[48:63]
  s_waitcnt lgkmcnt(10)
  s_waitcnt vmcnt(1)
  v_mfma_f32_32x32x16_bf16 v[32:47], a[44:47], a[176:179], v[32:47]
  ds_read_b64_tr_b16 a[12:13], v4 offset:53792
  ds_read_b64_tr_b16 a[14:15], v4 offset:55584
  v_mfma_f32_32x32x16_bf16 v[48:63], a[44:47], a[180:183], v[48:63]
  v_mfma_f32_32x32x16_bf16 v[32:47], a[184:187], a[212:215], v[32:47]
  v_mfma_f32_32x32x16_bf16 v[48:63], a[184:187], a[216:219], v[48:63]
  s_waitcnt lgkmcnt(10)
  v_mfma_f32_32x32x16_bf16 v[64:79], a[48:51], a[88:91], v[64:79]
  ds_read_b64_tr_b16 a[16:17], v4 offset:57376
  ds_read_b64_tr_b16 a[18:19], v4 offset:59168
  v_mfma_f32_32x32x16_bf16 v[80:95], a[48:51], a[92:95], v[80:95]
  s_waitcnt lgkmcnt(10)
  v_mfma_f32_32x32x16_bf16 v[64:79], a[52:55], a[96:99], v[64:79]
  ds_read_b64_tr_b16 a[20:21], v4 offset:60960
  ds_read_b64_tr_b16 a[22:23], v4 offset:62752
  v_mfma_f32_32x32x16_bf16 v[80:95], a[52:55], a[100:103], v[80:95]
  s_waitcnt lgkmcnt(10)
  v_mfma_f32_32x32x16_bf16 v[64:79], a[0:3], a[104:107], v[64:79]
  ds_read_b64_tr_b16 a[24:25], v3 offset:32
  ds_read_b64_tr_b16 a[26:27], v3 offset:1824
  v_max_f32 v32, 0, v32
  v_max_f32 v33, 0, v33
  v_max_f32 v34, 0, v34
  v_mfma_f32_32x32x16_bf16 v[80:95], a[0:3], a[108:111], v[80:95]
  v_max_f32 v35, 0, v35
  v_max_f32 v36, 0, v36
  v_max_f32 v37, 0, v37
  s_waitcnt lgkmcnt(10)
  v_mfma_f32_32x32x16_bf16 v[64:79], a[4:7], a[112:115], v[64:79]
  ds_read_b64_tr_b16 a[28:29], v3 offset:3616
  ds_read_b64_tr_b16 a[30:31], v3 offset:5408
  v_max_f32 v38, 0, v38
  v_max_f32 v39, 0, v39
  v_mul_f32 v32, v32, v40
  v_mfma_f32_32x32x16_bf16 v[80:95], a[4:7], a[116:119], v[80:95]
  v_mul_f32 v33, v33, v41
  v_mul_f32 v34, v34, v42
  v_mul_f32 v35, v35, v43
  s_waitcnt lgkmcnt(10)
  v_mfma_f32_32x32x16_bf16 v[64:79], a[8:11], a[120:123], v[64:79]
  ds_read_b64_tr_b16 a[32:33], v3 offset:7200
  ds_read_b64_tr_b16 a[34:35], v3 offset:8992
  v_mul_f32 v36, v36, v44
  v_mul_f32 v37, v37, v45
  v_mul_f32 v38, v38, v46
  v_mfma_f32_32x32x16_bf16 v[80:95], a[8:11], a[124:127], v[80:95]
  v_mul_f32 v39, v39, v47
  v_cvt_pk_bf16_f32 v40, v32, v33
  v_cvt_pk_bf16_f32 v41, v34, v35
  s_waitcnt lgkmcnt(10)
  v_mfma_f32_32x32x16_bf16 v[64:79], a[12:15], a[128:131], v[64:79]
  ds_read_b64_tr_b16 a[36:37], v3 offset:10784
  ds_read_b64_tr_b16 a[38:39], v3 offset:12576
  v_cvt_pk_bf16_f32 v42, v36, v37
  v_cvt_pk_bf16_f32 v43, v38, v39
  buffer_store_dwordx4 v[40:43], v2, s[20:23], s36 offen offset:0 sc1
  v_mfma_f32_32x32x16_bf16 v[80:95], a[12:15], a[132:135], v[80:95]
  v_max_f32 v48, 0, v48
  v_max_f32 v49, 0, v49
  v_max_f32 v50, 0, v50
  s_waitcnt lgkmcnt(10)
  v_mfma_f32_32x32x16_bf16 v[64:79], a[16:19], a[136:139], v[64:79]
  ds_read_b64_tr_b16 a[40:41], v4 offset:21312
  ds_read_b64_tr_b16 a[42:43], v4 offset:23104
  v_max_f32 v51, 0, v51
  v_max_f32 v52, 0, v52
  v_max_f32 v53, 0, v53
  v_mfma_f32_32x32x16_bf16 v[80:95], a[16:19], a[140:143], v[80:95]
  v_max_f32 v54, 0, v54
  v_max_f32 v55, 0, v55
  v_mul_f32 v48, v48, v56
  s_waitcnt lgkmcnt(10)
  v_mfma_f32_32x32x16_bf16 v[64:79], a[20:23], a[144:147], v[64:79]
  ds_read_b64_tr_b16 a[44:45], v4 offset:24896
  ds_read_b64_tr_b16 a[46:47], v4 offset:26688
  v_mul_f32 v49, v49, v57
  v_mul_f32 v50, v50, v58
  v_mul_f32 v51, v51, v59
  v_mfma_f32_32x32x16_bf16 v[80:95], a[20:23], a[148:151], v[80:95]
  v_mul_f32 v52, v52, v60
  v_mul_f32 v53, v53, v61
  v_mul_f32 v54, v54, v62
  s_waitcnt lgkmcnt(10)
  v_mfma_f32_32x32x16_bf16 v[64:79], a[24:27], a[152:155], v[64:79]
  ds_read_b64_tr_b16 a[48:49], v4 offset:28480
  ds_read_b64_tr_b16 a[50:51], v4 offset:30272
  v_mul_f32 v55, v55, v63
  v_cvt_pk_bf16_f32 v56, v48, v49
  v_cvt_pk_bf16_f32 v57, v50, v51
  v_mfma_f32_32x32x16_bf16 v[80:95], a[24:27], a[156:159], v[80:95]
  v_cvt_pk_bf16_f32 v58, v52, v53
  v_cvt_pk_bf16_f32 v59, v54, v55
  buffer_store_dwordx4 v[56:59], v2, s[20:23], s37 offen offset:0 sc1
  s_waitcnt lgkmcnt(10)
  v_mfma_f32_32x32x16_bf16 v[64:79], a[28:31], a[160:163], v[64:79]
  ds_read_b64_tr_b16 a[52:53], v4 offset:32064
  ds_read_b64_tr_b16 a[54:55], v4 offset:33856
  v_mfma_f32_32x32x16_bf16 v[80:95], a[28:31], a[164:167], v[80:95]
  s_waitcnt lgkmcnt(10)
  v_mfma_f32_32x32x16_bf16 v[64:79], a[32:35], a[168:171], v[64:79]
  ds_read_b64_tr_b16 a[0:1], v4 offset:50240
  ds_read_b64_tr_b16 a[2:3], v4 offset:52032
  v_mfma_f32_32x32x16_bf16 v[80:95], a[32:35], a[172:175], v[80:95]
  s_waitcnt lgkmcnt(10)
  v_mfma_f32_32x32x16_bf16 v[64:79], a[36:39], a[176:179], v[64:79]
  ds_read_b64_tr_b16 a[4:5], v4 offset:53824
  ds_read_b64_tr_b16 a[6:7], v4 offset:55616
  v_mfma_f32_32x32x16_bf16 v[80:95], a[36:39], a[180:183], v[80:95]
  v_mfma_f32_32x32x16_bf16 v[64:79], a[188:191], a[212:215], v[64:79]
  v_mfma_f32_32x32x16_bf16 v[80:95], a[188:191], a[216:219], v[80:95]
  s_waitcnt lgkmcnt(10)
  v_mfma_f32_32x32x16_bf16 v[96:111], a[40:43], a[88:91], v[96:111]
  ds_read_b64_tr_b16 a[8:9], v4 offset:57408
  ds_read_b64_tr_b16 a[10:11], v4 offset:59200
  v_mfma_f32_32x32x16_bf16 v[112:127], a[40:43], a[92:95], v[112:127]
  s_waitcnt lgkmcnt(10)
  v_mfma_f32_32x32x16_bf16 v[96:111], a[44:47], a[96:99], v[96:111]
  ds_read_b64_tr_b16 a[12:13], v4 offset:60992
  ds_read_b64_tr_b16 a[14:15], v4 offset:62784
  v_mfma_f32_32x32x16_bf16 v[112:127], a[44:47], a[100:103], v[112:127]
  s_waitcnt lgkmcnt(10)
  v_mfma_f32_32x32x16_bf16 v[96:111], a[48:51], a[104:107], v[96:111]
  ds_read_b64_tr_b16 a[16:17], v3 offset:64
  ds_read_b64_tr_b16 a[18:19], v3 offset:1856
  v_max_f32 v64, 0, v64
  v_max_f32 v65, 0, v65
  v_max_f32 v66, 0, v66
  v_mfma_f32_32x32x16_bf16 v[112:127], a[48:51], a[108:111], v[112:127]
  v_max_f32 v67, 0, v67
  v_max_f32 v68, 0, v68
  v_max_f32 v69, 0, v69
  s_waitcnt lgkmcnt(10)
  v_mfma_f32_32x32x16_bf16 v[96:111], a[52:55], a[112:115], v[96:111]
  ds_read_b64_tr_b16 a[20:21], v3 offset:3648
  ds_read_b64_tr_b16 a[22:23], v3 offset:5440
  v_max_f32 v70, 0, v70
  v_max_f32 v71, 0, v71
  v_mul_f32 v64, v64, v72
  v_mfma_f32_32x32x16_bf16 v[112:127], a[52:55], a[116:119], v[112:127]
  v_mul_f32 v65, v65, v73
  v_mul_f32 v66, v66, v74
  v_mul_f32 v67, v67, v75
  s_waitcnt lgkmcnt(10)
  v_mfma_f32_32x32x16_bf16 v[96:111], a[0:3], a[120:123], v[96:111]
  ds_read_b64_tr_b16 a[24:25], v3 offset:7232
  ds_read_b64_tr_b16 a[26:27], v3 offset:9024
  v_mul_f32 v68, v68, v76
  v_mul_f32 v69, v69, v77
  v_mul_f32 v70, v70, v78
  v_mfma_f32_32x32x16_bf16 v[112:127], a[0:3], a[124:127], v[112:127]
  v_mul_f32 v71, v71, v79
  v_cvt_pk_bf16_f32 v72, v64, v65
  v_cvt_pk_bf16_f32 v73, v66, v67
  s_waitcnt lgkmcnt(10)
  v_mfma_f32_32x32x16_bf16 v[96:111], a[4:7], a[128:131], v[96:111]
  ds_read_b64_tr_b16 a[28:29], v3 offset:10816
  ds_read_b64_tr_b16 a[30:31], v3 offset:12608
  v_cvt_pk_bf16_f32 v74, v68, v69
  v_cvt_pk_bf16_f32 v75, v70, v71
  buffer_store_dwordx4 v[72:75], v2, s[20:23], s36 offen offset:1024 sc1
  v_mfma_f32_32x32x16_bf16 v[112:127], a[4:7], a[132:135], v[112:127]
  v_max_f32 v80, 0, v80
  v_max_f32 v81, 0, v81
  v_max_f32 v82, 0, v82
  s_waitcnt lgkmcnt(10)
  v_mfma_f32_32x32x16_bf16 v[96:111], a[8:11], a[136:139], v[96:111]
  ds_read_b64_tr_b16 a[32:33], v4 offset:21344
  ds_read_b64_tr_b16 a[34:35], v4 offset:23136
  v_max_f32 v83, 0, v83
  v_max_f32 v84, 0, v84
  v_max_f32 v85, 0, v85
  v_mfma_f32_32x32x16_bf16 v[112:127], a[8:11], a[140:143], v[112:127]
  v_max_f32 v86, 0, v86
  v_max_f32 v87, 0, v87
  v_mul_f32 v80, v80, v88
  s_waitcnt lgkmcnt(10)
  v_mfma_f32_32x32x16_bf16 v[96:111], a[12:15], a[144:147], v[96:111]
  ds_read_b64_tr_b16 a[36:37], v4 offset:24928
  ds_read_b64_tr_b16 a[38:39], v4 offset:26720
  v_mul_f32 v81, v81, v89
  v_mul_f32 v82, v82, v90
  v_mul_f32 v83, v83, v91
  v_mfma_f32_32x32x16_bf16 v[112:127], a[12:15], a[148:151], v[112:127]
  v_mul_f32 v84, v84, v92
  v_mul_f32 v85, v85, v93
  v_mul_f32 v86, v86, v94
  s_waitcnt lgkmcnt(10)
  v_mfma_f32_32x32x16_bf16 v[96:111], a[16:19], a[152:155], v[96:111]
  ds_read_b64_tr_b16 a[40:41], v4 offset:28512
  ds_read_b64_tr_b16 a[42:43], v4 offset:30304
  v_mul_f32 v87, v87, v95
  v_cvt_pk_bf16_f32 v88, v80, v81
  v_cvt_pk_bf16_f32 v89, v82, v83
  v_mfma_f32_32x32x16_bf16 v[112:127], a[16:19], a[156:159], v[112:127]
  v_cvt_pk_bf16_f32 v90, v84, v85
  v_cvt_pk_bf16_f32 v91, v86, v87
  buffer_store_dwordx4 v[88:91], v2, s[20:23], s37 offen offset:1024 sc1
  s_waitcnt lgkmcnt(10)
  v_mfma_f32_32x32x16_bf16 v[96:111], a[20:23], a[160:163], v[96:111]
  ds_read_b64_tr_b16 a[44:45], v4 offset:32096
  ds_read_b64_tr_b16 a[46:47], v4 offset:33888
  v_mfma_f32_32x32x16_bf16 v[112:127], a[20:23], a[164:167], v[112:127]
  s_waitcnt lgkmcnt(10)
  v_mfma_f32_32x32x16_bf16 v[96:111], a[24:27], a[168:171], v[96:111]
  ds_read_b64_tr_b16 a[48:49], v4 offset:50272
  ds_read_b64_tr_b16 a[50:51], v4 offset:52064
  v_mfma_f32_32x32x16_bf16 v[112:127], a[24:27], a[172:175], v[112:127]
  s_waitcnt lgkmcnt(10)
  v_mfma_f32_32x32x16_bf16 v[96:111], a[28:31], a[176:179], v[96:111]
  ds_read_b64_tr_b16 a[52:53], v4 offset:53856
  ds_read_b64_tr_b16 a[54:55], v4 offset:55648
  v_mfma_f32_32x32x16_bf16 v[112:127], a[28:31], a[180:183], v[112:127]
  v_mfma_f32_32x32x16_bf16 v[96:111], a[192:195], a[212:215], v[96:111]
  v_mfma_f32_32x32x16_bf16 v[112:127], a[192:195], a[216:219], v[112:127]
  s_waitcnt lgkmcnt(10)
  v_mfma_f32_32x32x16_bf16 v[128:143], a[32:35], a[88:91], v[128:143]
  ds_read_b64_tr_b16 a[0:1], v4 offset:57440
  ds_read_b64_tr_b16 a[2:3], v4 offset:59232
  v_mfma_f32_32x32x16_bf16 v[144:159], a[32:35], a[92:95], v[144:159]
  s_waitcnt lgkmcnt(10)
  v_mfma_f32_32x32x16_bf16 v[128:143], a[36:39], a[96:99], v[128:143]
  ds_read_b64_tr_b16 a[4:5], v4 offset:61024
  ds_read_b64_tr_b16 a[6:7], v4 offset:62816
  v_mfma_f32_32x32x16_bf16 v[144:159], a[36:39], a[100:103], v[144:159]
  s_waitcnt lgkmcnt(10)
  v_mfma_f32_32x32x16_bf16 v[128:143], a[40:43], a[104:107], v[128:143]
  ds_read_b64_tr_b16 a[8:9], v3 offset:96
  ds_read_b64_tr_b16 a[10:11], v3 offset:1888
  v_max_f32 v96, 0, v96
  v_max_f32 v97, 0, v97
  v_max_f32 v98, 0, v98
  v_mfma_f32_32x32x16_bf16 v[144:159], a[40:43], a[108:111], v[144:159]
  v_max_f32 v99, 0, v99
  v_max_f32 v100, 0, v100
  v_max_f32 v101, 0, v101
  s_waitcnt lgkmcnt(10)
  v_mfma_f32_32x32x16_bf16 v[128:143], a[44:47], a[112:115], v[128:143]
  ds_read_b64_tr_b16 a[12:13], v3 offset:3680
  ds_read_b64_tr_b16 a[14:15], v3 offset:5472
  v_max_f32 v102, 0, v102
  v_max_f32 v103, 0, v103
  v_mul_f32 v96, v96, v104
  v_mfma_f32_32x32x16_bf16 v[144:159], a[44:47], a[116:119], v[144:159]
  v_mul_f32 v97, v97, v105
  v_mul_f32 v98, v98, v106
  v_mul_f32 v99, v99, v107
  s_waitcnt lgkmcnt(10)
  v_mfma_f32_32x32x16_bf16 v[128:143], a[48:51], a[120:123], v[128:143]
  ds_read_b64_tr_b16 a[16:17], v3 offset:7264
  ds_read_b64_tr_b16 a[18:19], v3 offset:9056
  v_mul_f32 v100, v100, v108
  v_mul_f32 v101, v101, v109
  v_mul_f32 v102, v102, v110
  v_mfma_f32_32x32x16_bf16 v[144:159], a[48:51], a[124:127], v[144:159]
  v_mul_f32 v103, v103, v111
  v_cvt_pk_bf16_f32 v104, v96, v97
  v_cvt_pk_bf16_f32 v105, v98, v99
  s_waitcnt lgkmcnt(10)
  v_mfma_f32_32x32x16_bf16 v[128:143], a[52:55], a[128:131], v[128:143]
  ds_read_b64_tr_b16 a[20:21], v3 offset:10848
  ds_read_b64_tr_b16 a[22:23], v3 offset:12640
  v_cvt_pk_bf16_f32 v106, v100, v101
  v_cvt_pk_bf16_f32 v107, v102, v103
  buffer_store_dwordx4 v[104:107], v2, s[20:23], s36 offen offset:2048 sc1
  v_mfma_f32_32x32x16_bf16 v[144:159], a[52:55], a[132:135], v[144:159]
  v_max_f32 v112, 0, v112
  v_max_f32 v113, 0, v113
  v_max_f32 v114, 0, v114
  s_waitcnt lgkmcnt(10)
  v_mfma_f32_32x32x16_bf16 v[128:143], a[0:3], a[136:139], v[128:143]
  ds_read_b64_tr_b16 a[24:25], v4 offset:21376
  ds_read_b64_tr_b16 a[26:27], v4 offset:23168
  v_max_f32 v115, 0, v115
  v_max_f32 v116, 0, v116
  v_max_f32 v117, 0, v117
  v_mfma_f32_32x32x16_bf16 v[144:159], a[0:3], a[140:143], v[144:159]
  v_max_f32 v118, 0, v118
  v_max_f32 v119, 0, v119
  v_mul_f32 v112, v112, v120
  s_waitcnt lgkmcnt(10)
  v_mfma_f32_32x32x16_bf16 v[128:143], a[4:7], a[144:147], v[128:143]
  ds_read_b64_tr_b16 a[28:29], v4 offset:24960
  ds_read_b64_tr_b16 a[30:31], v4 offset:26752
  v_mul_f32 v113, v113, v121
  v_mul_f32 v114, v114, v122
  v_mul_f32 v115, v115, v123
  v_mfma_f32_32x32x16_bf16 v[144:159], a[4:7], a[148:151], v[144:159]
  v_mul_f32 v116, v116, v124
  v_mul_f32 v117, v117, v125
  v_mul_f32 v118, v118, v126
  s_waitcnt lgkmcnt(10)
  v_mfma_f32_32x32x16_bf16 v[128:143], a[8:11], a[152:155], v[128:143]
  ds_read_b64_tr_b16 a[32:33], v4 offset:28544
  ds_read_b64_tr_b16 a[34:35], v4 offset:30336
  v_mul_f32 v119, v119, v127
  v_cvt_pk_bf16_f32 v120, v112, v113
  v_cvt_pk_bf16_f32 v121, v114, v115
  v_mfma_f32_32x32x16_bf16 v[144:159], a[8:11], a[156:159], v[144:159]
  v_cvt_pk_bf16_f32 v122, v116, v117
  v_cvt_pk_bf16_f32 v123, v118, v119
  buffer_store_dwordx4 v[120:123], v2, s[20:23], s37 offen offset:2048 sc1
  s_waitcnt lgkmcnt(10)
  v_mfma_f32_32x32x16_bf16 v[128:143], a[12:15], a[160:163], v[128:143]
  ds_read_b64_tr_b16 a[36:37], v4 offset:32128
  ds_read_b64_tr_b16 a[38:39], v4 offset:33920
  v_mfma_f32_32x32x16_bf16 v[144:159], a[12:15], a[164:167], v[144:159]
  s_waitcnt lgkmcnt(10)
  v_mfma_f32_32x32x16_bf16 v[128:143], a[16:19], a[168:171], v[128:143]
  ds_read_b64_tr_b16 a[40:41], v4 offset:50304
  ds_read_b64_tr_b16 a[42:43], v4 offset:52096
  v_mfma_f32_32x32x16_bf16 v[144:159], a[16:19], a[172:175], v[144:159]
  s_waitcnt lgkmcnt(10)
  v_mfma_f32_32x32x16_bf16 v[128:143], a[20:23], a[176:179], v[128:143]
  ds_read_b64_tr_b16 a[44:45], v4 offset:53888
  ds_read_b64_tr_b16 a[46:47], v4 offset:55680
  v_mfma_f32_32x32x16_bf16 v[144:159], a[20:23], a[180:183], v[144:159]
  v_mfma_f32_32x32x16_bf16 v[128:143], a[196:199], a[212:215], v[128:143]
  v_mfma_f32_32x32x16_bf16 v[144:159], a[196:199], a[216:219], v[144:159]
  s_waitcnt lgkmcnt(10)
  v_mfma_f32_32x32x16_bf16 v[160:175], a[24:27], a[88:91], v[160:175]
  ds_read_b64_tr_b16 a[48:49], v4 offset:57472
  ds_read_b64_tr_b16 a[50:51], v4 offset:59264
  v_mfma_f32_32x32x16_bf16 v[176:191], a[24:27], a[92:95], v[176:191]
  s_waitcnt lgkmcnt(10)
  v_mfma_f32_32x32x16_bf16 v[160:175], a[28:31], a[96:99], v[160:175]
  ds_read_b64_tr_b16 a[52:53], v4 offset:61056
  ds_read_b64_tr_b16 a[54:55], v4 offset:62848
  v_mfma_f32_32x32x16_bf16 v[176:191], a[28:31], a[100:103], v[176:191]
  s_waitcnt lgkmcnt(10)
  v_mfma_f32_32x32x16_bf16 v[160:175], a[32:35], a[104:107], v[160:175]
  ds_read_b64_tr_b16 a[0:1], v3 offset:128
  ds_read_b64_tr_b16 a[2:3], v3 offset:1920
  v_max_f32 v128, 0, v128
  v_max_f32 v129, 0, v129
  v_max_f32 v130, 0, v130
  v_mfma_f32_32x32x16_bf16 v[176:191], a[32:35], a[108:111], v[176:191]
  v_max_f32 v131, 0, v131
  v_max_f32 v132, 0, v132
  v_max_f32 v133, 0, v133
  s_waitcnt lgkmcnt(10)
  v_mfma_f32_32x32x16_bf16 v[160:175], a[36:39], a[112:115], v[160:175]
  ds_read_b64_tr_b16 a[4:5], v3 offset:3712
  ds_read_b64_tr_b16 a[6:7], v3 offset:5504
  v_max_f32 v134, 0, v134
  v_max_f32 v135, 0, v135
  v_mul_f32 v128, v128, v136
  v_mfma_f32_32x32x16_bf16 v[176:191], a[36:39], a[116:119], v[176:191]
  v_mul_f32 v129, v129, v137
  v_mul_f32 v130, v130, v138
  v_mul_f32 v131, v131, v139
  s_waitcnt lgkmcnt(10)
  v_mfma_f32_32x32x16_bf16 v[160:175], a[40:43], a[120:123], v[160:175]
  ds_read_b64_tr_b16 a[8:9], v3 offset:7296
  ds_read_b64_tr_b16 a[10:11], v3 offset:9088
  v_mul_f32 v132, v132, v140
  v_mul_f32 v133, v133, v141
  v_mul_f32 v134, v134, v142
  v_mfma_f32_32x32x16_bf16 v[176:191], a[40:43], a[124:127], v[176:191]
  v_mul_f32 v135, v135, v143
  v_cvt_pk_bf16_f32 v136, v128, v129
  v_cvt_pk_bf16_f32 v137, v130, v131
  s_waitcnt lgkmcnt(10)
  v_mfma_f32_32x32x16_bf16 v[160:175], a[44:47], a[128:131], v[160:175]
  ds_read_b64_tr_b16 a[12:13], v3 offset:10880
  ds_read_b64_tr_b16 a[14:15], v3 offset:12672
  v_cvt_pk_bf16_f32 v138, v132, v133
  v_cvt_pk_bf16_f32 v139, v134, v135
  buffer_store_dwordx4 v[136:139], v2, s[20:23], s36 offen offset:3072 sc1
  v_mfma_f32_32x32x16_bf16 v[176:191], a[44:47], a[132:135], v[176:191]
  v_max_f32 v144, 0, v144
  v_max_f32 v145, 0, v145
  v_max_f32 v146, 0, v146
  s_waitcnt lgkmcnt(10)
  v_mfma_f32_32x32x16_bf16 v[160:175], a[48:51], a[136:139], v[160:175]
  ds_read_b64_tr_b16 a[16:17], v4 offset:21408
  ds_read_b64_tr_b16 a[18:19], v4 offset:23200
  v_max_f32 v147, 0, v147
  v_max_f32 v148, 0, v148
  v_max_f32 v149, 0, v149
  v_mfma_f32_32x32x16_bf16 v[176:191], a[48:51], a[140:143], v[176:191]
  v_max_f32 v150, 0, v150
  v_max_f32 v151, 0, v151
  v_mul_f32 v144, v144, v152
  s_waitcnt lgkmcnt(10)
  v_mfma_f32_32x32x16_bf16 v[160:175], a[52:55], a[144:147], v[160:175]
  ds_read_b64_tr_b16 a[20:21], v4 offset:24992
  ds_read_b64_tr_b16 a[22:23], v4 offset:26784
  v_mul_f32 v145, v145, v153
  v_mul_f32 v146, v146, v154
  v_mul_f32 v147, v147, v155
  v_mfma_f32_32x32x16_bf16 v[176:191], a[52:55], a[148:151], v[176:191]
  v_mul_f32 v148, v148, v156
  v_mul_f32 v149, v149, v157
  v_mul_f32 v150, v150, v158
  s_waitcnt lgkmcnt(10)
  v_mfma_f32_32x32x16_bf16 v[160:175], a[0:3], a[152:155], v[160:175]
  ds_read_b64_tr_b16 a[24:25], v4 offset:28576
  ds_read_b64_tr_b16 a[26:27], v4 offset:30368
  v_mul_f32 v151, v151, v159
  v_cvt_pk_bf16_f32 v152, v144, v145
  v_cvt_pk_bf16_f32 v153, v146, v147
  v_mfma_f32_32x32x16_bf16 v[176:191], a[0:3], a[156:159], v[176:191]
  v_cvt_pk_bf16_f32 v154, v148, v149
  v_cvt_pk_bf16_f32 v155, v150, v151
  buffer_store_dwordx4 v[152:155], v2, s[20:23], s37 offen offset:3072 sc1
  s_waitcnt lgkmcnt(10)
  v_mfma_f32_32x32x16_bf16 v[160:175], a[4:7], a[160:163], v[160:175]
  ds_read_b64_tr_b16 a[28:29], v4 offset:32160
  ds_read_b64_tr_b16 a[30:31], v4 offset:33952
  s_add_u32 s36, s36, 4096
  s_add_u32 s37, s37, 4096
  v_mfma_f32_32x32x16_bf16 v[176:191], a[4:7], a[164:167], v[176:191]
  s_waitcnt lgkmcnt(10)
  v_mfma_f32_32x32x16_bf16 v[160:175], a[8:11], a[168:171], v[160:175]
  ds_read_b64_tr_b16 a[32:33], v4 offset:50336
  ds_read_b64_tr_b16 a[34:35], v4 offset:52128
  v_mfma_f32_32x32x16_bf16 v[176:191], a[8:11], a[172:175], v[176:191]
  s_waitcnt lgkmcnt(10)
  v_mfma_f32_32x32x16_bf16 v[160:175], a[12:15], a[176:179], v[160:175]
  ds_read_b64_tr_b16 a[36:37], v4 offset:53920
  ds_read_b64_tr_b16 a[38:39], v4 offset:55712
  v_mfma_f32_32x32x16_bf16 v[176:191], a[12:15], a[180:183], v[176:191]
  v_mfma_f32_32x32x16_bf16 v[160:175], a[200:203], a[212:215], v[160:175]
  v_mfma_f32_32x32x16_bf16 v[176:191], a[200:203], a[216:219], v[176:191]
  s_waitcnt lgkmcnt(10)
  v_mfma_f32_32x32x16_bf16 v[192:207], a[16:19], a[88:91], v[192:207]
  ds_read_b64_tr_b16 a[40:41], v4 offset:57504
  ds_read_b64_tr_b16 a[42:43], v4 offset:59296
  v_mfma_f32_32x32x16_bf16 v[208:223], a[16:19], a[92:95], v[208:223]
  s_waitcnt lgkmcnt(10)
  v_mfma_f32_32x32x16_bf16 v[192:207], a[20:23], a[96:99], v[192:207]
  ds_read_b64_tr_b16 a[44:45], v4 offset:61088
  ds_read_b64_tr_b16 a[46:47], v4 offset:62880
  v_mfma_f32_32x32x16_bf16 v[208:223], a[20:23], a[100:103], v[208:223]
  s_waitcnt lgkmcnt(10)
  v_mfma_f32_32x32x16_bf16 v[192:207], a[24:27], a[104:107], v[192:207]
  ds_read_b64_tr_b16 a[48:49], v3 offset:160
  ds_read_b64_tr_b16 a[50:51], v3 offset:1952
  v_max_f32 v160, 0, v160
  v_max_f32 v161, 0, v161
  v_max_f32 v162, 0, v162
  v_mfma_f32_32x32x16_bf16 v[208:223], a[24:27], a[108:111], v[208:223]
  v_max_f32 v163, 0, v163
  v_max_f32 v164, 0, v164
  v_max_f32 v165, 0, v165
  s_waitcnt lgkmcnt(10)
  v_mfma_f32_32x32x16_bf16 v[192:207], a[28:31], a[112:115], v[192:207]
  ds_read_b64_tr_b16 a[52:53], v3 offset:3744
  ds_read_b64_tr_b16 a[54:55], v3 offset:5536
  v_max_f32 v166, 0, v166
  v_max_f32 v167, 0, v167
  v_mul_f32 v160, v160, v168
  v_mfma_f32_32x32x16_bf16 v[208:223], a[28:31], a[116:119], v[208:223]
  v_mul_f32 v161, v161, v169
  v_mul_f32 v162, v162, v170
  v_mul_f32 v163, v163, v171
  s_waitcnt lgkmcnt(10)
  v_mfma_f32_32x32x16_bf16 v[192:207], a[32:35], a[120:123], v[192:207]
  ds_read_b64_tr_b16 a[0:1], v3 offset:7328
  ds_read_b64_tr_b16 a[2:3], v3 offset:9120
  v_mul_f32 v164, v164, v172
  v_mul_f32 v165, v165, v173
  v_mul_f32 v166, v166, v174
  v_mfma_f32_32x32x16_bf16 v[208:223], a[32:35], a[124:127], v[208:223]
  v_mul_f32 v167, v167, v175
  v_cvt_pk_bf16_f32 v168, v160, v161
  v_cvt_pk_bf16_f32 v169, v162, v163
  s_waitcnt lgkmcnt(10)
  v_mfma_f32_32x32x16_bf16 v[192:207], a[36:39], a[128:131], v[192:207]
  ds_read_b64_tr_b16 a[4:5], v3 offset:10912
  ds_read_b64_tr_b16 a[6:7], v3 offset:12704
  v_cvt_pk_bf16_f32 v170, v164, v165
  v_cvt_pk_bf16_f32 v171, v166, v167
  buffer_store_dwordx4 v[168:171], v2, s[20:23], s36 offen offset:0 sc1
  v_mfma_f32_32x32x16_bf16 v[208:223], a[36:39], a[132:135], v[208:223]
  v_max_f32 v176, 0, v176
  v_max_f32 v177, 0, v177
  v_max_f32 v178, 0, v178
  s_waitcnt lgkmcnt(10)
  v_mfma_f32_32x32x16_bf16 v[192:207], a[40:43], a[136:139], v[192:207]
  ds_read_b64_tr_b16 a[8:9], v4 offset:21440
  ds_read_b64_tr_b16 a[10:11], v4 offset:23232
  v_max_f32 v179, 0, v179
  v_max_f32 v180, 0, v180
  v_max_f32 v181, 0, v181
  v_mfma_f32_32x32x16_bf16 v[208:223], a[40:43], a[140:143], v[208:223]
  v_max_f32 v182, 0, v182
  v_max_f32 v183, 0, v183
  v_mul_f32 v176, v176, v184
  s_waitcnt lgkmcnt(10)
  v_mfma_f32_32x32x16_bf16 v[192:207], a[44:47], a[144:147], v[192:207]
  ds_read_b64_tr_b16 a[12:13], v4 offset:25024
  ds_read_b64_tr_b16 a[14:15], v4 offset:26816
  v_mul_f32 v177, v177, v185
  v_mul_f32 v178, v178, v186
  v_mul_f32 v179, v179, v187
  v_mfma_f32_32x32x16_bf16 v[208:223], a[44:47], a[148:151], v[208:223]
  v_mul_f32 v180, v180, v188
  v_mul_f32 v181, v181, v189
  v_mul_f32 v182, v182, v190
  s_waitcnt lgkmcnt(10)
  v_mfma_f32_32x32x16_bf16 v[192:207], a[48:51], a[152:155], v[192:207]
  ds_read_b64_tr_b16 a[16:17], v4 offset:28608
  ds_read_b64_tr_b16 a[18:19], v4 offset:30400
  v_mul_f32 v183, v183, v191
  v_cvt_pk_bf16_f32 v184, v176, v177
  v_cvt_pk_bf16_f32 v185, v178, v179
  v_mfma_f32_32x32x16_bf16 v[208:223], a[48:51], a[156:159], v[208:223]
  v_cvt_pk_bf16_f32 v186, v180, v181
  v_cvt_pk_bf16_f32 v187, v182, v183
  buffer_store_dwordx4 v[184:187], v2, s[20:23], s37 offen offset:0 sc1
  s_waitcnt lgkmcnt(10)
  v_mfma_f32_32x32x16_bf16 v[192:207], a[52:55], a[160:163], v[192:207]
  ds_read_b64_tr_b16 a[20:21], v4 offset:32192
  ds_read_b64_tr_b16 a[22:23], v4 offset:33984
  v_mfma_f32_32x32x16_bf16 v[208:223], a[52:55], a[164:167], v[208:223]
  s_waitcnt lgkmcnt(10)
  v_mfma_f32_32x32x16_bf16 v[192:207], a[0:3], a[168:171], v[192:207]
  ds_read_b64_tr_b16 a[24:25], v4 offset:50368
  ds_read_b64_tr_b16 a[26:27], v4 offset:52160
  v_mfma_f32_32x32x16_bf16 v[208:223], a[0:3], a[172:175], v[208:223]
  s_waitcnt lgkmcnt(10)
  v_mfma_f32_32x32x16_bf16 v[192:207], a[4:7], a[176:179], v[192:207]
  ds_read_b64_tr_b16 a[28:29], v4 offset:53952
  ds_read_b64_tr_b16 a[30:31], v4 offset:55744
  v_mfma_f32_32x32x16_bf16 v[208:223], a[4:7], a[180:183], v[208:223]
  v_mfma_f32_32x32x16_bf16 v[192:207], a[204:207], a[212:215], v[192:207]
  v_mfma_f32_32x32x16_bf16 v[208:223], a[204:207], a[216:219], v[208:223]
  s_waitcnt lgkmcnt(10)
  v_mfma_f32_32x32x16_bf16 v[224:239], a[8:11], a[88:91], v[224:239]
  ds_read_b64_tr_b16 a[32:33], v4 offset:57536
  ds_read_b64_tr_b16 a[34:35], v4 offset:59328
  v_mfma_f32_32x32x16_bf16 v[240:255], a[8:11], a[92:95], v[240:255]
  s_waitcnt lgkmcnt(10)
  v_mfma_f32_32x32x16_bf16 v[224:239], a[12:15], a[96:99], v[224:239]
  ds_read_b64_tr_b16 a[36:37], v4 offset:61120
  ds_read_b64_tr_b16 a[38:39], v4 offset:62912
  v_mfma_f32_32x32x16_bf16 v[240:255], a[12:15], a[100:103], v[240:255]
  s_waitcnt lgkmcnt(10)
  v_mfma_f32_32x32x16_bf16 v[224:239], a[16:19], a[104:107], v[224:239]
  ds_read_b64_tr_b16 a[40:41], v3 offset:192
  ds_read_b64_tr_b16 a[42:43], v3 offset:1984
  v_max_f32 v192, 0, v192
  v_max_f32 v193, 0, v193
  v_max_f32 v194, 0, v194
  v_mfma_f32_32x32x16_bf16 v[240:255], a[16:19], a[108:111], v[240:255]
  v_max_f32 v195, 0, v195
  v_max_f32 v196, 0, v196
  v_max_f32 v197, 0, v197
  s_waitcnt lgkmcnt(10)
  v_mfma_f32_32x32x16_bf16 v[224:239], a[20:23], a[112:115], v[224:239]
  ds_read_b64_tr_b16 a[44:45], v3 offset:3776
  ds_read_b64_tr_b16 a[46:47], v3 offset:5568
  v_max_f32 v198, 0, v198
  v_max_f32 v199, 0, v199
  v_mul_f32 v192, v192, v200
  v_mfma_f32_32x32x16_bf16 v[240:255], a[20:23], a[116:119], v[240:255]
  v_mul_f32 v193, v193, v201
  v_mul_f32 v194, v194, v202
  v_mul_f32 v195, v195, v203
  s_waitcnt lgkmcnt(10)
  v_mfma_f32_32x32x16_bf16 v[224:239], a[24:27], a[120:123], v[224:239]
  ds_read_b64_tr_b16 a[48:49], v3 offset:7360
  ds_read_b64_tr_b16 a[50:51], v3 offset:9152
  v_mul_f32 v196, v196, v204
  v_mul_f32 v197, v197, v205
  v_mul_f32 v198, v198, v206
  v_mfma_f32_32x32x16_bf16 v[240:255], a[24:27], a[124:127], v[240:255]
  v_mul_f32 v199, v199, v207
  v_cvt_pk_bf16_f32 v200, v192, v193
  v_cvt_pk_bf16_f32 v201, v194, v195
  s_waitcnt lgkmcnt(10)
  v_mfma_f32_32x32x16_bf16 v[224:239], a[28:31], a[128:131], v[224:239]
  ds_read_b64_tr_b16 a[52:53], v3 offset:10944
  ds_read_b64_tr_b16 a[54:55], v3 offset:12736
  v_cvt_pk_bf16_f32 v202, v196, v197
  v_cvt_pk_bf16_f32 v203, v198, v199
  buffer_store_dwordx4 v[200:203], v2, s[20:23], s36 offen offset:1024 sc1
  v_mfma_f32_32x32x16_bf16 v[240:255], a[28:31], a[132:135], v[240:255]
  v_max_f32 v208, 0, v208
  v_max_f32 v209, 0, v209
  v_max_f32 v210, 0, v210
  s_waitcnt lgkmcnt(10)
  v_mfma_f32_32x32x16_bf16 v[224:239], a[32:35], a[136:139], v[224:239]
  v_max_f32 v211, 0, v211
  v_max_f32 v212, 0, v212
  v_max_f32 v213, 0, v213
  v_mfma_f32_32x32x16_bf16 v[240:255], a[32:35], a[140:143], v[240:255]
  v_max_f32 v214, 0, v214
  v_max_f32 v215, 0, v215
  v_mul_f32 v208, v208, v216
  s_waitcnt lgkmcnt(8)
  v_mfma_f32_32x32x16_bf16 v[224:239], a[36:39], a[144:147], v[224:239]
  v_mul_f32 v209, v209, v217
  v_mul_f32 v210, v210, v218
  v_mul_f32 v211, v211, v219
  v_mfma_f32_32x32x16_bf16 v[240:255], a[36:39], a[148:151], v[240:255]
  v_mul_f32 v212, v212, v220
  v_mul_f32 v213, v213, v221
  v_mul_f32 v214, v214, v222
  s_waitcnt lgkmcnt(6)
  v_mfma_f32_32x32x16_bf16 v[224:239], a[40:43], a[152:155], v[224:239]
  v_mul_f32 v215, v215, v223
  v_cvt_pk_bf16_f32 v216, v208, v209
  v_cvt_pk_bf16_f32 v217, v210, v211
  v_mfma_f32_32x32x16_bf16 v[240:255], a[40:43], a[156:159], v[240:255]
  v_cvt_pk_bf16_f32 v218, v212, v213
  v_cvt_pk_bf16_f32 v219, v214, v215
  buffer_store_dwordx4 v[216:219], v2, s[20:23], s37 offen offset:1024 sc1
  s_waitcnt lgkmcnt(4)
  v_mfma_f32_32x32x16_bf16 v[224:239], a[44:47], a[160:163], v[224:239]
  v_mfma_f32_32x32x16_bf16 v[240:255], a[44:47], a[164:167], v[240:255]
  s_waitcnt lgkmcnt(2)
  v_mfma_f32_32x32x16_bf16 v[224:239], a[48:51], a[168:171], v[224:239]
  v_mfma_f32_32x32x16_bf16 v[240:255], a[48:51], a[172:175], v[240:255]
  s_waitcnt lgkmcnt(0)
  v_mfma_f32_32x32x16_bf16 v[224:239], a[52:55], a[176:179], v[224:239]
  v_mfma_f32_32x32x16_bf16 v[240:255], a[52:55], a[180:183], v[240:255]
  v_mfma_f32_32x32x16_bf16 v[224:239], a[208:211], a[212:215], v[224:239]
  v_mfma_f32_32x32x16_bf16 v[240:255], a[208:211], a[216:219], v[240:255]
  s_nop 10
  v_max_f32 v224, 0, v224
  v_max_f32 v225, 0, v225
  v_max_f32 v226, 0, v226
  v_max_f32 v227, 0, v227
  v_max_f32 v228, 0, v228
  v_max_f32 v229, 0, v229
  v_max_f32 v230, 0, v230
  v_max_f32 v231, 0, v231
  v_mul_f32 v224, v224, v232
  v_mul_f32 v225, v225, v233
  v_mul_f32 v226, v226, v234
  v_mul_f32 v227, v227, v235
  v_mul_f32 v228, v228, v236
  v_mul_f32 v229, v229, v237
  v_mul_f32 v230, v230, v238
  v_mul_f32 v231, v231, v239
  v_cvt_pk_bf16_f32 v232, v224, v225
  v_cvt_pk_bf16_f32 v233, v226, v227
  v_cvt_pk_bf16_f32 v234, v228, v229
  v_cvt_pk_bf16_f32 v235, v230, v231
  buffer_store_dwordx4 v[232:235], v2, s[20:23], s36 offen offset:2048 sc1
  v_max_f32 v240, 0, v240
  v_max_f32 v241, 0, v241
  v_max_f32 v242, 0, v242
  v_max_f32 v243, 0, v243
  v_max_f32 v244, 0, v244
  v_max_f32 v245, 0, v245
  v_max_f32 v246, 0, v246
  v_max_f32 v247, 0, v247
  v_mul_f32 v240, v240, v248
  v_mul_f32 v241, v241, v249
  v_mul_f32 v242, v242, v250
  v_mul_f32 v243, v243, v251
  v_mul_f32 v244, v244, v252
  v_mul_f32 v245, v245, v253
  v_mul_f32 v246, v246, v254
  v_mul_f32 v247, v247, v255
  v_cvt_pk_bf16_f32 v248, v240, v241
  v_cvt_pk_bf16_f32 v249, v242, v243
  v_cvt_pk_bf16_f32 v250, v244, v245
  v_cvt_pk_bf16_f32 v251, v246, v247
  buffer_store_dwordx4 v[248:251], v2, s[20:23], s37 offen offset:2048 sc1
k5_end:
  s_endpgm
.globl k6_kernel
.p2align 8
.type k6_kernel,@function
k6_kernel:
  s_cmp_ge_u32 s2, 256
  s_cbranch_scc1 k6_end
  s_load_dwordx2 s[4:5], s[0:1], 104
  s_load_dwordx2 s[12:13], s[0:1], 88
  s_load_dwordx2 s[14:15], s[0:1], 64
  v_and_b32 v1, 63, v0
  v_lshlrev_b32 v2, 4, v1
  v_lshrrev_b32 v10, 6, v0
  s_nop 0
  v_readfirstlane_b32 s3, v10
  s_and_b32 s6, s2, 7
  s_lshr_b32 s7, s2, 3
  s_lshr_b32 s8, s6, 1
  s_lshl_b32 s8, s8, 2
  s_and_b32 s10, s7, 3
  s_add_u32 s8, s8, s10
  s_and_b32 s9, s6, 1
  s_lshl_b32 s9, s9, 3
  s_lshr_b32 s10, s7, 2
  s_add_u32 s9, s9, s10
  s_waitcnt lgkmcnt(0)
  s_mov_b32 s16, s14
  s_and_b32 s17, s15, 0xffff
  s_mov_b32 s18, 7340032
  s_mov_b32 s19, 0x00020000
  s_add_u32 s20, s4, 50331648
  s_addc_u32 s21, s5, 0
  s_and_b32 s21, s21, 0xffff
  s_mov_b32 s22, 14680064
  s_mov_b32 s23, 0x00020000
  v_lshrrev_b32 v10, 3, v1
  v_lshlrev_b32 v15, 11, v10
  v_and_b32 v10, 7, v1
  v_bfe_u32 v12, v1, 4, 1
  v_lshlrev_b32 v12, 2, v12
  v_xor_b32 v10, v10, v12
  v_lshl_add_u32 v15, v10, 4, v15
  v_bfe_u32 v10, v1, 2, 2
  v_lshrrev_b32 v12, 5, v1
  v_lshl_add_u32 v12, v12, 2, v10
  v_lshlrev_b32 v3, 7, v12
  v_and_b32 v12, 3, v1
  v_lshl_add_u32 v3, v12, 3, v3
  v_bfe_u32 v12, v1, 4, 1
  v_lshl_add_u32 v3, v12, 5, v3
  v_lshrrev_b32 v10, 1, v10
  v_lshlrev_b32 v10, 6, v10
  v_xor_b32 v13, 64, v10
  v_add_u32 v13, v13, v3
  v_add_u32 v3, v3, v10
  v_add_u32 v12, 0x10000, v3
  v_add_u32 v14, 0x10000, v13
  s_lshl_b32 s29, s3, 12
  s_lshl_b32 s28, s3, 16
  s_lshl_b32 s30, s9, 7
  s_add_u32 s28, s28, s30
  s_lshl_b32 s30, s8, 2
  s_add_u32 s33, s30, s3
  s_mul_i32 s30, s33, 229376
  s_add_u32 m0, s29, 0
  s_add_u32 s31, s28, 0
  buffer_load_dwordx4 v15, s[16:19], s31 offen lds
  s_add_u32 m0, s29, 1024
  s_add_u32 s31, s28, 16384
  buffer_load_dwordx4 v15, s[16:19], s31 offen lds
  s_add_u32 m0, s29, 2048
  s_add_u32 s31, s28, 32768
  buffer_load_dwordx4 v15, s[16:19], s31 offen lds
  s_add_u32 m0, s29, 3072
  s_add_u32 s31, s28, 49152
  buffer_load_dwordx4 v15, s[16:19], s31 offen lds
  buffer_load_dwordx4 v[80:83], v2, s[20:23], s30 offen offset:0
  buffer_load_dwordx4 v[84:87], v2, s[20:23], s30 offen offset:1024
  buffer_load_dwordx4 v[88:91], v2, s[20:23], s30 offen offset:2048
  buffer_load_dwordx4 v[92:95], v2, s[20:23], s30 offen offset:3072
  s_add_u32 s30, s30, 4096
  buffer_load_dwordx4 v[96:99], v2, s[20:23], s30 offen offset:0
  buffer_load_dwordx4 v[100:103], v2, s[20:23], s30 offen offset:1024
  buffer_load_dwordx4 v[104:107], v2, s[20:23], s30 offen offset:2048
  buffer_load_dwordx4 v[108:111], v2, s[20:23], s30 offen offset:3072
  s_add_u32 s30, s30, 4096
  buffer_load_dwordx4 v[112:115], v2, s[20:23], s30 offen offset:0
  buffer_load_dwordx4 v[116:119], v2, s[20:23], s30 offen offset:1024
  buffer_load_dwordx4 v[120:123], v2, s[20:23], s30 offen offset:2048
  buffer_load_dwordx4 v[124:127], v2, s[20:23], s30 offen offset:3072
  s_add_u32 s30, s30, 4096
  buffer_load_dwordx4 v[128:131], v2, s[20:23], s30 offen offset:0
  buffer_load_dwordx4 v[132:135], v2, s[20:23], s30 offen offset:1024
  buffer_load_dwordx4 v[136:139], v2, s[20:23], s30 offen offset:2048
  buffer_load_dwordx4 v[140:143], v2, s[20:23], s30 offen offset:3072
  s_add_u32 m0, s29, 16384
  s_add_u32 s31, s28, 262144
  buffer_load_dwordx4 v15, s[16:19], s31 offen lds
  s_add_u32 m0, s29, 17408
  s_add_u32 s31, s28, 278528
  buffer_load_dwordx4 v15, s[16:19], s31 offen lds
  s_add_u32 m0, s29, 18432
  s_add_u32 s31, s28, 294912
  buffer_load_dwordx4 v15, s[16:19], s31 offen lds
  s_add_u32 m0, s29, 19456
  s_add_u32 s31, s28, 311296
  buffer_load_dwordx4 v15, s[16:19], s31 offen lds
  s_add_u32 s36, s4, 19922944
  s_addc_u32 s37, s5, 0
  s_and_b32 s37, s37, 0xffff
  s_mov_b32 s38, 4194304
  s_mov_b32 s39, 0x00020000
  s_mov_b32 s40, s4
  s_and_b32 s41, s5, 0xffff
  s_mov_b32 s42, 24576
  s_mov_b32 s43, 0x00020000
  s_add_u32 s44, s4, 65536000
  s_addc_u32 s45, s5, 0
  s_and_b32 s45, s45, 0xffff
  s_mov_b32 s46, 8192
  s_mov_b32 s47, 0x00020000
  v_and_b32 v5, 31, v1
  v_lshlrev_b32 v4, 2, v5
  s_lshl_b32 s49, s33, 7
  v_lshrrev_b32 v6, 5, v1
  v_lshlrev_b32 v9, 4, v1
  v_cmp_gt_u32 vcc, 16, v1
  v_mov_b32 v10, 0x7ff00000
  s_nop 0
  v_cndmask_b32 v9, v10, v9, vcc
  v_lshlrev_b32 v10, 4, v6
  v_add_u32 v10, 81920, v10
  s_lshl_b32 s48, s9, 8
  s_add_u32 s48, s48, 20480
  s_lshl_b32 s34, s33, 16
  s_lshl_b32 s35, s9, 12
  s_add_u32 s34, s34, s35
  s_waitcnt vmcnt(20)
  s_barrier
  ds_read_b64_tr_b16 v[48:49], v3 offset:0
  ds_read_b64_tr_b16 v[50:51], v3 offset:1024
  ds_read_b64_tr_b16 v[52:53], v13 offset:0
  ds_read_b64_tr_b16 v[54:55], v13 offset:1024
  ds_read_b64_tr_b16 v[56:57], v3 offset:2048
  ds_read_b64_tr_b16 v[58:59], v3 offset:3072
  ds_read_b64_tr_b16 v[60:61], v13 offset:2048
  ds_read_b64_tr_b16 v[62:63], v13 offset:3072
  ds_read_b64_tr_b16 v[64:65], v3 offset:4096
  ds_read_b64_tr_b16 v[66:67], v3 offset:5120
  ds_read_b64_tr_b16 v[68:69], v13 offset:4096
  ds_read_b64_tr_b16 v[70:71], v13 offset:5120
  s_waitcnt vmcnt(19)
  s_waitcnt lgkmcnt(10)
  v_mfma_f32_32x32x16_bf16 v[16:31], v[48:51], v[80:83], 0
  ds_read_b64_tr_b16 v[72:73], v3 offset:6144
  ds_read_b64_tr_b16 v[74:75], v3 offset:7168
  ds_read_b64_tr_b16 v[76:77], v13 offset:6144
  ds_read_b64_tr_b16 v[78:79], v13 offset:7168
  s_waitcnt lgkmcnt(12)
  v_mfma_f32_32x32x16_bf16 v[32:47], v[52:55], v[80:83], 0
  s_add_u32 m0, s29, 32768
  s_add_u32 s31, s28, 524288
  buffer_load_dwordx4 v15, s[16:19], s31 offen lds
  s_add_u32 m0, s29, 33792
  s_add_u32 s31, s28, 540672
  buffer_load_dwordx4 v15, s[16:19], s31 offen lds
  s_waitcnt vmcnt(20)
  s_waitcnt lgkmcnt(10)
  v_mfma_f32_32x32x16_bf16 v[16:31], v[56:59], v[84:87], v[16:31]
  ds_read_b64_tr_b16 v[48:49], v3 offset:8192
  ds_read_b64_tr_b16 v[50:51], v3 offset:9216
  ds_read_b64_tr_b16 v[52:53], v13 offset:8192
  ds_read_b64_tr_b16 v[54:55], v13 offset:9216
  s_waitcnt lgkmcnt(12)
  v_mfma_f32_32x32x16_bf16 v[32:47], v[60:63], v[84:87], v[32:47]
  s_add_u32 m0, s29, 34816
  s_add_u32 s31, s28, 557056
  buffer_load_dwordx4 v15, s[16:19], s31 offen lds
  s_add_u32 m0, s29, 35840
  s_add_u32 s31, s28, 573440
  buffer_load_dwordx4 v15, s[16:19], s31 offen lds
  s_waitcnt vmcnt(21)
  s_waitcnt lgkmcnt(10)
  v_mfma_f32_32x32x16_bf16 v[16:31], v[64:67], v[88:91], v[16:31]
  ds_read_b64_tr_b16 v[56:57], v3 offset:10240
  ds_read_b64_tr_b16 v[58:59], v3 offset:11264
  ds_read_b64_tr_b16 v[60:61], v13 offset:10240
  ds_read_b64_tr_b16 v[62:63], v13 offset:11264
  s_waitcnt lgkmcnt(12)
  v_mfma_f32_32x32x16_bf16 v[32:47], v[68:71], v[88:91], v[32:47]
  s_add_u32 s30, s30, 4096
  buffer_load_dwordx4 v[144:147], v2, s[20:23], s30 offen offset:0
  buffer_load_dwordx4 v[148:151], v2, s[20:23], s30 offen offset:1024
  s_waitcnt vmcnt(22)
  s_waitcnt lgkmcnt(10)
  v_mfma_f32_32x32x16_bf16 v[16:31], v[72:75], v[92:95], v[16:31]
  ds_read_b64_tr_b16 v[64:65], v3 offset:12288
  ds_read_b64_tr_b16 v[66:67], v3 offset:13312
  ds_read_b64_tr_b16 v[68:69], v13 offset:12288
  ds_read_b64_tr_b16 v[70:71], v13 offset:13312
  s_waitcnt lgkmcnt(12)
  v_mfma_f32_32x32x16_bf16 v[32:47], v[76:79], v[92:95], v[32:47]
  buffer_load_dwordx4 v[152:155], v2, s[20:23], s30 offen offset:2048
  buffer_load_dwordx4 v[156:159], v2, s[20:23], s30 offen offset:3072
  s_waitcnt vmcnt(23)
  s_waitcnt lgkmcnt(10)
  v_mfma_f32_32x32x16_bf16 v[16:31], v[48:51], v[96:99], v[16:31]
  ds_read_b64_tr_b16 v[72:73], v3 offset:14336
  ds_read_b64_tr_b16 v[74:75], v3 offset:15360
  ds_read_b64_tr_b16 v[76:77], v13 offset:14336
  ds_read_b64_tr_b16 v[78:79], v13 offset:15360
  s_waitcnt lgkmcnt(12)
  v_mfma_f32_32x32x16_bf16 v[32:47], v[52:55], v[96:99], v[32:47]
  s_add_u32 s30, s30, 4096
  buffer_load_dwordx4 v[160:163], v2, s[20:23], s30 offen offset:0
  s_add_u32 m0, s29, 49152
  s_add_u32 s31, s28, 786432
  buffer_load_dwordx4 v15, s[16:19], s31 offen lds
  s_waitcnt vmcnt(24)
  s_waitcnt lgkmcnt(10)
  v_mfma_f32_32x32x16_bf16 v[16:31], v[56:59], v[100:103], v[16:31]
  s_waitcnt vmcnt(10)
  s_barrier
  s_waitcnt lgkmcnt(8)
  v_mfma_f32_32x32x16_bf16 v[32:47], v[60:63], v[100:103], v[32:47]
  ds_read_b64_tr_b16 v[48:49], v3 offset:16384
  ds_read_b64_tr_b16 v[50:51], v3 offset:17408
  ds_read_b64_tr_b16 v[52:53], v13 offset:16384
  ds_read_b64_tr_b16 v[54:55], v13 offset:17408
  s_add_u32 m0, s29, 50176
  s_add_u32 s31, s28, 802816
  buffer_load_dwordx4 v15, s[16:19], s31 offen lds
  s_add_u32 m0, s29, 51200
  s_add_u32 s31, s28, 819200
  buffer_load_dwordx4 v15, s[16:19], s31 offen lds
  s_waitcnt lgkmcnt(10)
  v_mfma_f32_32x32x16_bf16 v[16:31], v[64:67], v[104:107], v[16:31]
  ds_read_b64_tr_b16 v[56:57], v3 offset:18432
  ds_read_b64_tr_b16 v[58:59], v3 offset:19456
  ds_read_b64_tr_b16 v[60:61], v13 offset:18432
  ds_read_b64_tr_b16 v[62:63], v13 offset:19456
  s_waitcnt lgkmcnt(12)
  v_mfma_f32_32x32x16_bf16 v[32:47], v[68:71], v[104:107], v[32:47]
  s_add_u32 m0, s29, 52224
  s_add_u32 s31, s28, 835584
  buffer_load_dwordx4 v15, s[16:19], s31 offen lds
  buffer_load_dwordx4 v[164:167], v2, s[20:23], s30 offen offset:1024
  s_waitcnt lgkmcnt(10)
  v_mfma_f32_32x32x16_bf16 v[16:31], v[72:75], v[108:111], v[16:31]
  ds_read_b64_tr_b16 v[64:65], v3 offset:20480
  ds_read_b64_tr_b16 v[66:67], v3 offset:21504
  ds_read_b64_tr_b16 v[68:69], v13 offset:20480
  ds_read_b64_tr_b16 v[70:71], v13 offset:21504
  s_waitcnt lgkmcnt(12)
  v_mfma_f32_32x32x16_bf16 v[32:47], v[76:79], v[108:111], v[32:47]
  buffer_load_dwordx4 v[168:171], v2, s[20:23], s30 offen offset:2048
  buffer_load_dwordx4 v[172:175], v2, s[20:23], s30 offen offset:3072
  s_waitcnt lgkmcnt(10)
  v_mfma_f32_32x32x16_bf16 v[16:31], v[48:51], v[112:115], v[16:31]
  ds_read_b64_tr_b16 v[72:73], v3 offset:22528
  ds_read_b64_tr_b16 v[74:75], v3 offset:23552
  ds_read_b64_tr_b16 v[76:77], v13 offset:22528
  ds_read_b64_tr_b16 v[78:79], v13 offset:23552
  s_waitcnt lgkmcnt(12)
  v_mfma_f32_32x32x16_bf16 v[32:47], v[52:55], v[112:115], v[32:47]
  s_add_u32 s30, s30, 4096
  buffer_load_dwordx4 v[80:83], v2, s[20:23], s30 offen offset:0
  buffer_load_dwordx4 v[84:87], v2, s[20:23], s30 offen offset:1024
  s_waitcnt lgkmcnt(10)
  v_mfma_f32_32x32x16_bf16 v[16:31], v[56:59], v[116:119], v[16:31]
  ds_read_b64_tr_b16 v[48:49], v3 offset:24576
  ds_read_b64_tr_b16 v[50:51], v3 offset:25600
  ds_read_b64_tr_b16 v[52:53], v13 offset:24576
  ds_read_b64_tr_b16 v[54:55], v13 offset:25600
  s_waitcnt lgkmcnt(12)
  v_mfma_f32_32x32x16_bf16 v[32:47], v[60:63], v[116:119], v[32:47]
  buffer_load_dwordx4 v[88:91], v2, s[20:23], s30 offen offset:2048
  buffer_load_dwordx4 v[92:95], v2, s[20:23], s30 offen offset:3072
  s_waitcnt lgkmcnt(10)
  v_mfma_f32_32x32x16_bf16 v[16:31], v[64:67], v[120:123], v[16:31]
  ds_read_b64_tr_b16 v[56:57], v3 offset:26624
  ds_read_b64_tr_b16 v[58:59], v3 offset:27648
  ds_read_b64_tr_b16 v[60:61], v13 offset:26624
  ds_read_b64_tr_b16 v[62:63], v13 offset:27648
  s_waitcnt lgkmcnt(12)
  v_mfma_f32_32x32x16_bf16 v[32:47], v[68:71], v[120:123], v[32:47]
  s_add_u32 s30, s30, 4096
  buffer_load_dwordx4 v[96:99], v2, s[20:23], s30 offen offset:0
  s_add_u32 m0, s29, 65536
  s_add_u32 s31, s28, 1048576
  buffer_load_dwordx4 v15, s[16:19], s31 offen lds
  s_waitcnt lgkmcnt(10)
  v_mfma_f32_32x32x16_bf16 v[16:31], v[72:75], v[124:127], v[16:31]
  ds_read_b64_tr_b16 v[64:65], v3 offset:28672
  ds_read_b64_tr_b16 v[66:67], v3 offset:29696
  ds_read_b64_tr_b16 v[68:69], v13 offset:28672
  ds_read_b64_tr_b16 v[70:71], v13 offset:29696
  s_waitcnt lgkmcnt(12)
  v_mfma_f32_32x32x16_bf16 v[32:47], v[76:79], v[124:127], v[32:47]
  s_add_u32 m0, s29, 66560
  s_add_u32 s31, s28, 1064960
  buffer_load_dwordx4 v15, s[16:19], s31 offen lds
  s_add_u32 m0, s29, 67584
  s_add_u32 s31, s28, 1081344
  buffer_load_dwordx4 v15, s[16:19], s31 offen lds
  s_waitcnt lgkmcnt(10)
  v_mfma_f32_32x32x16_bf16 v[16:31], v[48:51], v[128:131], v[16:31]
  ds_read_b64_tr_b16 v[72:73], v3 offset:30720
  ds_read_b64_tr_b16 v[74:75], v3 offset:31744
  ds_read_b64_tr_b16 v[76:77], v13 offset:30720
  ds_read_b64_tr_b16 v[78:79], v13 offset:31744
  s_waitcnt lgkmcnt(12)
  v_mfma_f32_32x32x16_bf16 v[32:47], v[52:55], v[128:131], v[32:47]
  s_add_u32 m0, s29, 68608
  s_add_u32 s31, s28, 1097728
  buffer_load_dwordx4 v15, s[16:19], s31 offen lds
  buffer_load_dwordx4 v[100:103], v2, s[20:23], s30 offen offset:1024
  s_waitcnt lgkmcnt(10)
  v_mfma_f32_32x32x16_bf16 v[16:31], v[56:59], v[132:135], v[16:31]
  s_waitcnt vmcnt(22)
  s_barrier
  s_waitcnt lgkmcnt(8)
  v_mfma_f32_32x32x16_bf16 v[32:47], v[60:63], v[132:135], v[32:47]
  ds_read_b64_tr_b16 v[48:49], v3 offset:32768
  ds_read_b64_tr_b16 v[50:51], v3 offset:33792
  ds_read_b64_tr_b16 v[52:53], v13 offset:32768
  ds_read_b64_tr_b16 v[54:55], v13 offset:33792
  buffer_load_dwordx4 v[104:107], v2, s[20:23], s30 offen offset:2048
  buffer_load_dwordx4 v[108:111], v2, s[20:23], s30 offen offset:3072
  s_waitcnt lgkmcnt(10)
  v_mfma_f32_32x32x16_bf16 v[16:31], v[64:67], v[136:139], v[16:31]
  ds_read_b64_tr_b16 v[56:57], v3 offset:34816
  ds_read_b64_tr_b16 v[58:59], v3 offset:35840
  ds_read_b64_tr_b16 v[60:61], v13 offset:34816
  ds_read_b64_tr_b16 v[62:63], v13 offset:35840
  s_waitcnt lgkmcnt(12)
  v_mfma_f32_32x32x16_bf16 v[32:47], v[68:71], v[136:139], v[32:47]
  s_add_u32 s30, s30, 4096
  buffer_load_dwordx4 v[112:115], v2, s[20:23], s30 offen offset:0
  buffer_load_dwordx4 v[116:119], v2, s[20:23], s30 offen offset:1024
  s_waitcnt lgkmcnt(10)
  v_mfma_f32_32x32x16_bf16 v[16:31], v[72:75], v[140:143], v[16:31]
  ds_read_b64_tr_b16 v[64:65], v3 offset:36864
  ds_read_b64_tr_b16 v[66:67], v3 offset:37888
  ds_read_b64_tr_b16 v[68:69], v13 offset:36864
  ds_read_b64_tr_b16 v[70:71], v13 offset:37888
  s_waitcnt lgkmcnt(12)
  v_mfma_f32_32x32x16_bf16 v[32:47], v[76:79], v[140:143], v[32:47]
  buffer_load_dwordx4 v[120:123], v2, s[20:23], s30 offen offset:2048
  buffer_load_dwordx4 v[124:127], v2, s[20:23], s30 offen offset:3072
  s_waitcnt vmcnt(27)
  s_waitcnt lgkmcnt(10)
  v_mfma_f32_32x32x16_bf16 v[16:31], v[48:51], v[144:147], v[16:31]
  ds_read_b64_tr_b16 v[72:73], v3 offset:38912
  ds_read_b64_tr_b16 v[74:75], v3 offset:39936
  ds_read_b64_tr_b16 v[76:77], v13 offset:38912
  ds_read_b64_tr_b16 v[78:79], v13 offset:39936
  s_waitcnt lgkmcnt(12)
  v_mfma_f32_32x32x16_bf16 v[32:47], v[52:55], v[144:147], v[32:47]
  s_add_u32 s30, s30, 4096
  buffer_load_dwordx4 v[128:131], v2, s[20:23], s30 offen offset:0
  s_add_u32 m0, s29, 0
  s_add_u32 s31, s28, 1310720
  buffer_load_dwordx4 v15, s[16:19], s31 offen lds
  s_waitcnt vmcnt(28)
  s_waitcnt lgkmcnt(10)
  v_mfma_f32_32x32x16_bf16 v[16:31], v[56:59], v[148:151], v[16:31]
  ds_read_b64_tr_b16 v[48:49], v3 offset:40960
  ds_read_b64_tr_b16 v[50:51], v3 offset:41984
  ds_read_b64_tr_b16 v[52:53], v13 offset:40960
  ds_read_b64_tr_b16 v[54:55], v13 offset:41984
  s_waitcnt lgkmcnt(12)
  v_mfma_f32_32x32x16_bf16 v[32:47], v[60:63], v[148:151], v[32:47]
  s_add_u32 m0, s29, 1024
  s_add_u32 s31, s28, 1327104
  buffer_load_dwordx4 v15, s[16:19], s31 offen lds
  s_add_u32 m0, s29, 2048
  s_add_u32 s31, s28, 1343488
  buffer_load_dwordx4 v15, s[16:19], s31 offen lds
  s_waitcnt vmcnt(29)
  s_waitcnt lgkmcnt(10)
  v_mfma_f32_32x32x16_bf16 v[16:31], v[64:67], v[152:155], v[16:31]
  ds_read_b64_tr_b16 v[56:57], v3 offset:43008
  ds_read_b64_tr_b16 v[58:59], v3 offset:44032
  ds_read_b64_tr_b16 v[60:61], v13 offset:43008
  ds_read_b64_tr_b16 v[62:63], v13 offset:44032
  s_waitcnt lgkmcnt(12)
  v_mfma_f32_32x32x16_bf16 v[32:47], v[68:71], v[152:155], v[32:47]
  s_add_u32 m0, s29, 3072
  s_add_u32 s31, s28, 1359872
  buffer_load_dwordx4 v15, s[16:19], s31 offen lds
  buffer_load_dwordx4 v[132:135], v2, s[20:23], s30 offen offset:1024
  s_waitcnt vmcnt(30)
  s_waitcnt lgkmcnt(10)
  v_mfma_f32_32x32x16_bf16 v[16:31], v[72:75], v[156:159], v[16:31]
  ds_read_b64_tr_b16 v[64:65], v3 offset:45056
  ds_read_b64_tr_b16 v[66:67], v3 offset:46080
  ds_read_b64_tr_b16 v[68:69], v13 offset:45056
  ds_read_b64_tr_b16 v[70:71], v13 offset:46080
  s_waitcnt lgkmcnt(12)
  v_mfma_f32_32x32x16_bf16 v[32:47], v[76:79], v[156:159], v[32:47]
  buffer_load_dwordx4 v[136:139], v2, s[20:23], s30 offen offset:2048
  buffer_load_dwordx4 v[140:143], v2, s[20:23], s30 offen offset:3072
  s_waitcnt vmcnt(31)
  s_waitcnt lgkmcnt(10)
  v_mfma_f32_32x32x16_bf16 v[16:31], v[48:51], v[160:163], v[16:31]
  ds_read_b64_tr_b16 v[72:73], v3 offset:47104
  ds_read_b64_tr_b16 v[74:75], v3 offset:48128
  ds_read_b64_tr_b16 v[76:77], v13 offset:47104
  ds_read_b64_tr_b16 v[78:79], v13 offset:48128
  s_waitcnt lgkmcnt(12)
  v_mfma_f32_32x32x16_bf16 v[32:47], v[52:55], v[160:163], v[32:47]
  s_add_u32 s30, s30, 4096
  buffer_load_dwordx4 v[144:147], v2, s[20:23], s30 offen offset:0
  buffer_load_dwordx4 v[148:151], v2, s[20:23], s30 offen offset:1024
  s_waitcnt vmcnt(28)
  s_waitcnt lgkmcnt(10)
  v_mfma_f32_32x32x16_bf16 v[16:31], v[56:59], v[164:167], v[16:31]
  s_barrier
  s_waitcnt lgkmcnt(8)
  v_mfma_f32_32x32x16_bf16 v[32:47], v[60:63], v[164:167], v[32:47]
  ds_read_b64_tr_b16 v[48:49], v3 offset:49152
  ds_read_b64_tr_b16 v[50:51], v3 offset:50176
  ds_read_b64_tr_b16 v[52:53], v13 offset:49152
  ds_read_b64_tr_b16 v[54:55], v13 offset:50176
  buffer_load_dwordx4 v[152:155], v2, s[20:23], s30 offen offset:2048
  buffer_load_dwordx4 v[156:159], v2, s[20:23], s30 offen offset:3072
  s_waitcnt vmcnt(29)
  s_waitcnt lgkmcnt(10)
  v_mfma_f32_32x32x16_bf16 v[16:31], v[64:67], v[168:171], v[16:31]
  ds_read_b64_tr_b16 v[56:57], v3 offset:51200
  ds_read_b64_tr_b16 v[58:59], v3 offset:52224
  ds_read_b64_tr_b16 v[60:61], v13 offset:51200
  ds_read_b64_tr_b16 v[62:63], v13 offset:52224
  s_waitcnt lgkmcnt(12)
  v_mfma_f32_32x32x16_bf16 v[32:47], v[68:71], v[168:171], v[32:47]
  s_add_u32 s30, s30, 4096
  buffer_load_dwordx4 v[160:163], v2, s[20:23], s30 offen offset:0
  s_add_u32 m0, s29, 16384
  s_add_u32 s31, s28, 1572864
  buffer_load_dwordx4 v15, s[16:19], s31 offen lds
  s_waitcnt vmcnt(30)
  s_waitcnt lgkmcnt(10)
  v_mfma_f32_32x32x16_bf16 v[16:31], v[72:75], v[172:175], v[16:31]
  ds_read_b64_tr_b16 v[64:65], v3 offset:53248
  ds_read_b64_tr_b16 v[66:67], v3 offset:54272
  ds_read_b64_tr_b16 v[68:69], v13 offset:53248
  ds_read_b64_tr_b16 v[70:71], v13 offset:54272
  s_waitcnt lgkmcnt(12)
  v_mfma_f32_32x32x16_bf16 v[32:47], v[76:79], v[172:175], v[32:47]
  s_add_u32 m0, s29, 17408
  s_add_u32 s31, s28, 1589248
  buffer_load_dwordx4 v15, s[16:19], s31 offen lds
  s_add_u32 m0, s29, 18432
  s_add_u32 s31, s28, 1605632
  buffer_load_dwordx4 v15, s[16:19], s31 offen lds
  s_waitcnt vmcnt(31)
  s_waitcnt lgkmcnt(10)
  v_mfma_f32_32x32x16_bf16 v[16:31], v[48:51], v[80:83], v[16:31]
  ds_read_b64_tr_b16 v[72:73], v3 offset:55296
  ds_read_b64_tr_b16 v[74:75], v3 offset:56320
  ds_read_b64_tr_b16 v[76:77], v13 offset:55296
  ds_read_b64_tr_b16 v[78:79], v13 offset:56320
  s_waitcnt lgkmcnt(12)
  v_mfma_f32_32x32x16_bf16 v[32:47], v[52:55], v[80:83], v[32:47]
  s_add_u32 m0, s29, 19456
  s_add_u32 s31, s28, 1622016
  buffer_load_dwordx4 v15, s[16:19], s31 offen lds
  buffer_load_dwordx4 v[164:167], v2, s[20:23], s30 offen offset:1024
  s_waitcnt vmcnt(32)
  s_waitcnt lgkmcnt(10)
  v_mfma_f32_32x32x16_bf16 v[16:31], v[56:59], v[84:87], v[16:31]
  ds_read_b64_tr_b16 v[48:49], v3 offset:57344
  ds_read_b64_tr_b16 v[50:51], v3 offset:58368
  ds_read_b64_tr_b16 v[52:53], v13 offset:57344
  ds_read_b64_tr_b16 v[54:55], v13 offset:58368
  s_waitcnt lgkmcnt(12)
  v_mfma_f32_32x32x16_bf16 v[32:47], v[60:63], v[84:87], v[32:47]
  buffer_load_dwordx4 v[168:171], v2, s[20:23], s30 offen offset:2048
  buffer_load_dwordx4 v[172:175], v2, s[20:23], s30 offen offset:3072
  s_waitcnt vmcnt(33)
  s_waitcnt lgkmcnt(10)
  v_mfma_f32_32x32x16_bf16 v[16:31], v[64:67], v[88:91], v[16:31]
  ds_read_b64_tr_b16 v[56:57], v3 offset:59392
  ds_read_b64_tr_b16 v[58:59], v3 offset:60416
  ds_read_b64_tr_b16 v[60:61], v13 offset:59392
  ds_read_b64_tr_b16 v[62:63], v13 offset:60416
  s_waitcnt lgkmcnt(12)
  v_mfma_f32_32x32x16_bf16 v[32:47], v[68:71], v[88:91], v[32:47]
  s_add_u32 s30, s30, 4096
  buffer_load_dwordx4 v[80:83], v2, s[20:23], s30 offen offset:0
  buffer_load_dwordx4 v[84:87], v2, s[20:23], s30 offen offset:1024
  s_waitcnt vmcnt(34)
  s_waitcnt lgkmcnt(10)
  v_mfma_f32_32x32x16_bf16 v[16:31], v[72:75], v[92:95], v[16:31]
  ds_read_b64_tr_b16 v[64:65], v3 offset:61440
  ds_read_b64_tr_b16 v[66:67], v3 offset:62464
  ds_read_b64_tr_b16 v[68:69], v13 offset:61440
  ds_read_b64_tr_b16 v[70:71], v13 offset:62464
  s_waitcnt lgkmcnt(12)
  v_mfma_f32_32x32x16_bf16 v[32:47], v[76:79], v[92:95], v[32:47]
  buffer_load_dwordx4 v[88:91], v2, s[20:23], s30 offen offset:2048
  s_waitcnt vmcnt(34)
  s_waitcnt lgkmcnt(10)
  v_mfma_f32_32x32x16_bf16 v[16:31], v[48:51], v[96:99], v[16:31]
  ds_read_b64_tr_b16 v[72:73], v3 offset:63488
  ds_read_b64_tr_b16 v[74:75], v3 offset:64512
  ds_read_b64_tr_b16 v[76:77], v13 offset:63488
  ds_read_b64_tr_b16 v[78:79], v13 offset:64512
  s_waitcnt lgkmcnt(12)
  v_mfma_f32_32x32x16_bf16 v[32:47], v[52:55], v[96:99], v[32:47]
  buffer_load_dwordx4 v[92:95], v2, s[20:23], s30 offen offset:3072
  s_waitcnt vmcnt(30)
  s_waitcnt lgkmcnt(10)
  v_mfma_f32_32x32x16_bf16 v[16:31], v[56:59], v[100:103], v[16:31]
  s_barrier
  s_waitcnt lgkmcnt(8)
  v_mfma_f32_32x32x16_bf16 v[32:47], v[60:63], v[100:103], v[32:47]
  ds_read_b64_tr_b16 v[48:49], v12 offset:0
  ds_read_b64_tr_b16 v[50:51], v12 offset:1024
  ds_read_b64_tr_b16 v[52:53], v14 offset:0
  ds_read_b64_tr_b16 v[54:55], v14 offset:1024
  s_add_u32 s30, s30, 4096
  buffer_load_dwordx4 v[96:99], v2, s[20:23], s30 offen offset:0
  s_add_u32 m0, s29, 32768
  s_add_u32 s31, s28, 1835008
  buffer_load_dwordx4 v15, s[16:19], s31 offen lds
  s_waitcnt vmcnt(31)
  s_waitcnt lgkmcnt(10)
  v_mfma_f32_32x32x16_bf16 v[16:31], v[64:67], v[104:107], v[16:31]
  ds_read_b64_tr_b16 v[56:57], v12 offset:2048
  ds_read_b64_tr_b16 v[58:59], v12 offset:3072
  ds_read_b64_tr_b16 v[60:61], v14 offset:2048
  ds_read_b64_tr_b16 v[62:63], v14 offset:3072
  s_waitcnt lgkmcnt(12)
  v_mfma_f32_32x32x16_bf16 v[32:47], v[68:71], v[104:107], v[32:47]
  s_add_u32 m0, s29, 33792
  s_add_u32 s31, s28, 1851392
  buffer_load_dwordx4 v15, s[16:19], s31 offen lds
  s_add_u32 m0, s29, 34816
  s_add_u32 s31, s28, 1867776
  buffer_load_dwordx4 v15, s[16:19], s31 offen lds
  s_waitcnt vmcnt(32)
  s_waitcnt lgkmcnt(10)
  v_mfma_f32_32x32x16_bf16 v[16:31], v[72:75], v[108:111], v[16:31]
  ds_read_b64_tr_b16 v[64:65], v12 offset:4096
  ds_read_b64_tr_b16 v[66:67], v12 offset:5120
  ds_read_b64_tr_b16 v[68:69], v14 offset:4096
  ds_read_b64_tr_b16 v[70:71], v14 offset:5120
  s_waitcnt lgkmcnt(12)
  v_mfma_f32_32x32x16_bf16 v[32:47], v[76:79], v[108:111], v[32:47]
  s_add_u32 m0, s29, 35840
  s_add_u32 s31, s28, 1884160
  buffer_load_dwordx4 v15, s[16:19], s31 offen lds
  buffer_load_dwordx4 v[100:103], v2, s[20:23], s30 offen offset:1024
  s_waitcnt vmcnt(33)
  s_waitcnt lgkmcnt(10)
  v_mfma_f32_32x32x16_bf16 v[16:31], v[48:51], v[112:115], v[16:31]
  ds_read_b64_tr_b16 v[72:73], v12 offset:6144
  ds_read_b64_tr_b16 v[74:75], v12 offset:7168
  ds_read_b64_tr_b16 v[76:77], v14 offset:6144
  ds_read_b64_tr_b16 v[78:79], v14 offset:7168
  s_waitcnt lgkmcnt(12)
  v_mfma_f32_32x32x16_bf16 v[32:47], v[52:55], v[112:115], v[32:47]
  buffer_load_dwordx4 v[104:107], v2, s[20:23], s30 offen offset:2048
  buffer_load_dwordx4 v[108:111], v2, s[20:23], s30 offen offset:3072
  s_waitcnt vmcnt(34)
  s_waitcnt lgkmcnt(10)
  v_mfma_f32_32x32x16_bf16 v[16:31], v[56:59], v[116:119], v[16:31]
  ds_read_b64_tr_b16 v[48:49], v12 offset:8192
  ds_read_b64_tr_b16 v[50:51], v12 offset:9216
  ds_read_b64_tr_b16 v[52:53], v14 offset:8192
  ds_read_b64_tr_b16 v[54:55], v14 offset:9216
  s_waitcnt lgkmcnt(12)
  v_mfma_f32_32x32x16_bf16 v[32:47], v[60:63], v[116:119], v[32:47]
  s_add_u32 s30, s30, 4096
  buffer_load_dwordx4 v[112:115], v2, s[20:23], s30 offen offset:0
  s_waitcnt vmcnt(34)
  s_waitcnt lgkmcnt(10)
  v_mfma_f32_32x32x16_bf16 v[16:31], v[64:67], v[120:123], v[16:31]
  ds_read_b64_tr_b16 v[56:57], v12 offset:10240
  ds_read_b64_tr_b16 v[58:59], v12 offset:11264
  ds_read_b64_tr_b16 v[60:61], v14 offset:10240
  ds_read_b64_tr_b16 v[62:63], v14 offset:11264
  s_waitcnt lgkmcnt(12)
  v_mfma_f32_32x32x16_bf16 v[32:47], v[68:71], v[120:123], v[32:47]
  buffer_load_dwordx4 v[116:119], v2, s[20:23], s30 offen offset:1024
  s_waitcnt vmcnt(34)
  s_waitcnt lgkmcnt(10)
  v_mfma_f32_32x32x16_bf16 v[16:31], v[72:75], v[124:127], v[16:31]
  ds_read_b64_tr_b16 v[64:65], v12 offset:12288
  ds_read_b64_tr_b16 v[66:67], v12 offset:13312
  ds_read_b64_tr_b16 v[68:69], v14 offset:12288
  ds_read_b64_tr_b16 v[70:71], v14 offset:13312
  s_waitcnt lgkmcnt(12)
  v_mfma_f32_32x32x16_bf16 v[32:47], v[76:79], v[124:127], v[32:47]
  buffer_load_dwordx4 v[120:123], v2, s[20:23], s30 offen offset:2048
  s_waitcnt vmcnt(34)
  s_waitcnt lgkmcnt(10)
  v_mfma_f32_32x32x16_bf16 v[16:31], v[48:51], v[128:131], v[16:31]
  ds_read_b64_tr_b16 v[72:73], v12 offset:14336
  ds_read_b64_tr_b16 v[74:75], v12 offset:15360
  ds_read_b64_tr_b16 v[76:77], v14 offset:14336
  ds_read_b64_tr_b16 v[78:79], v14 offset:15360
  s_waitcnt lgkmcnt(12)
  v_mfma_f32_32x32x16_bf16 v[32:47], v[52:55], v[128:131], v[32:47]
  buffer_load_dwordx4 v[124:127], v2, s[20:23], s30 offen offset:3072
  s_waitcnt vmcnt(30)
  s_waitcnt lgkmcnt(10)
  v_mfma_f32_32x32x16_bf16 v[16:31], v[56:59], v[132:135], v[16:31]
  s_barrier
  s_waitcnt lgkmcnt(8)
  v_mfma_f32_32x32x16_bf16 v[32:47], v[60:63], v[132:135], v[32:47]
  ds_read_b64_tr_b16 v[48:49], v3 offset:0
  ds_read_b64_tr_b16 v[50:51], v3 offset:1024
  ds_read_b64_tr_b16 v[52:53], v13 offset:0
  ds_read_b64_tr_b16 v[54:55], v13 offset:1024
  s_add_u32 s30, s30, 4096
  buffer_load_dwordx4 v[128:131], v2, s[20:23], s30 offen offset:0
  s_add_u32 m0, s29, 49152
  s_add_u32 s31, s28, 2097152
  buffer_load_dwordx4 v15, s[16:19], s31 offen lds
  s_waitcnt vmcnt(31)
  s_waitcnt lgkmcnt(10)
  v_mfma_f32_32x32x16_bf16 v[16:31], v[64:67], v[136:139], v[16:31]
  ds_read_b64_tr_b16 v[56:57], v3 offset:2048
  ds_read_b64_tr_b16 v[58:59], v3 offset:3072
  ds_read_b64_tr_b16 v[60:61], v13 offset:2048
  ds_read_b64_tr_b16 v[62:63], v13 offset:3072
  s_waitcnt lgkmcnt(12)
  v_mfma_f32_32x32x16_bf16 v[32:47], v[68:71], v[136:139], v[32:47]
  s_add_u32 m0, s29, 50176
  s_add_u32 s31, s28, 2113536
  buffer_load_dwordx4 v15, s[16:19], s31 offen lds
  s_add_u32 m0, s29, 51200
  s_add_u32 s31, s28, 2129920
  buffer_load_dwordx4 v15, s[16:19], s31 offen lds
  s_waitcnt vmcnt(32)
  s_waitcnt lgkmcnt(10)
  v_mfma_f32_32x32x16_bf16 v[16:31], v[72:75], v[140:143], v[16:31]
  ds_read_b64_tr_b16 v[64:65], v3 offset:4096
  ds_read_b64_tr_b16 v[66:67], v3 offset:5120
  ds_read_b64_tr_b16 v[68:69], v13 offset:4096
  ds_read_b64_tr_b16 v[70:71], v13 offset:5120
  s_waitcnt lgkmcnt(12)
  v_mfma_f32_32x32x16_bf16 v[32:47], v[76:79], v[140:143], v[32:47]
  s_add_u32 m0, s29, 52224
  s_add_u32 s31, s28, 2146304
  buffer_load_dwordx4 v15, s[16:19], s31 offen lds
  buffer_load_dwordx4 v[132:135], v2, s[20:23], s30 offen offset:1024
  s_waitcnt vmcnt(33)
  s_waitcnt lgkmcnt(10)
  v_mfma_f32_32x32x16_bf16 v[16:31], v[48:51], v[144:147], v[16:31]
  ds_read_b64_tr_b16 v[72:73], v3 offset:6144
  ds_read_b64_tr_b16 v[74:75], v3 offset:7168
  ds_read_b64_tr_b16 v[76:77], v13 offset:6144
  ds_read_b64_tr_b16 v[78:79], v13 offset:7168
  s_waitcnt lgkmcnt(12)
  v_mfma_f32_32x32x16_bf16 v[32:47], v[52:55], v[144:147], v[32:47]
  buffer_load_dwordx4 v[136:139], v2, s[20:23], s30 offen offset:2048
  buffer_load_dwordx4 v[140:143], v2, s[20:23], s30 offen offset:3072
  s_waitcnt vmcnt(34)
  s_waitcnt lgkmcnt(10)
  v_mfma_f32_32x32x16_bf16 v[16:31], v[56:59], v[148:151], v[16:31]
  ds_read_b64_tr_b16 v[48:49], v3 offset:8192
  ds_read_b64_tr_b16 v[50:51], v3 offset:9216
  ds_read_b64_tr_b16 v[52:53], v13 offset:8192
  ds_read_b64_tr_b16 v[54:55], v13 offset:9216
  s_waitcnt lgkmcnt(12)
  v_mfma_f32_32x32x16_bf16 v[32:47], v[60:63], v[148:151], v[32:47]
  s_add_u32 s30, s30, 4096
  buffer_load_dwordx4 v[144:147], v2, s[20:23], s30 offen offset:0
  s_waitcnt vmcnt(34)
  s_waitcnt lgkmcnt(10)
  v_mfma_f32_32x32x16_bf16 v[16:31], v[64:67], v[152:155], v[16:31]
  ds_read_b64_tr_b16 v[56:57], v3 offset:10240
  ds_read_b64_tr_b16 v[58:59], v3 offset:11264
  ds_read_b64_tr_b16 v[60:61], v13 offset:10240
  ds_read_b64_tr_b16 v[62:63], v13 offset:11264
  s_waitcnt lgkmcnt(12)
  v_mfma_f32_32x32x16_bf16 v[32:47], v[68:71], v[152:155], v[32:47]
  buffer_load_dwordx4 v[148:151], v2, s[20:23], s30 offen offset:1024
  s_waitcnt vmcnt(34)
  s_waitcnt lgkmcnt(10)
  v_mfma_f32_32x32x16_bf16 v[16:31], v[72:75], v[156:159], v[16:31]
  ds_read_b64_tr_b16 v[64:65], v3 offset:12288
  ds_read_b64_tr_b16 v[66:67], v3 offset:13312
  ds_read_b64_tr_b16 v[68:69], v13 offset:12288
  ds_read_b64_tr_b16 v[70:71], v13 offset:13312
  s_waitcnt lgkmcnt(12)
  v_mfma_f32_32x32x16_bf16 v[32:47], v[76:79], v[156:159], v[32:47]
  buffer_load_dwordx4 v[152:155], v2, s[20:23], s30 offen offset:2048
  s_waitcnt vmcnt(34)
  s_waitcnt lgkmcnt(10)
  v_mfma_f32_32x32x16_bf16 v[16:31], v[48:51], v[160:163], v[16:31]
  ds_read_b64_tr_b16 v[72:73], v3 offset:14336
  ds_read_b64_tr_b16 v[74:75], v3 offset:15360
  ds_read_b64_tr_b16 v[76:77], v13 offset:14336
  ds_read_b64_tr_b16 v[78:79], v13 offset:15360
  s_waitcnt lgkmcnt(12)
  v_mfma_f32_32x32x16_bf16 v[32:47], v[52:55], v[160:163], v[32:47]
  buffer_load_dwordx4 v[156:159], v2, s[20:23], s30 offen offset:3072
  s_waitcnt vmcnt(30)
  s_waitcnt lgkmcnt(10)
  v_mfma_f32_32x32x16_bf16 v[16:31], v[56:59], v[164:167], v[16:31]
  s_barrier
  s_waitcnt lgkmcnt(8)
  v_mfma_f32_32x32x16_bf16 v[32:47], v[60:63], v[164:167], v[32:47]
  ds_read_b64_tr_b16 v[48:49], v3 offset:16384
  ds_read_b64_tr_b16 v[50:51], v3 offset:17408
  ds_read_b64_tr_b16 v[52:53], v13 offset:16384
  ds_read_b64_tr_b16 v[54:55], v13 offset:17408
  s_add_u32 s30, s30, 4096
  buffer_load_dwordx4 v[160:163], v2, s[20:23], s30 offen offset:0
  s_add_u32 m0, s29, 65536
  s_add_u32 s31, s28, 2359296
  buffer_load_dwordx4 v15, s[16:19], s31 offen lds
  s_waitcnt vmcnt(31)
  s_waitcnt lgkmcnt(10)
  v_mfma_f32_32x32x16_bf16 v[16:31], v[64:67], v[168:171], v[16:31]
  ds_read_b64_tr_b16 v[56:57], v3 offset:18432
  ds_read_b64_tr_b16 v[58:59], v3 offset:19456
  ds_read_b64_tr_b16 v[60:61], v13 offset:18432
  ds_read_b64_tr_b16 v[62:63], v13 offset:19456
  s_waitcnt lgkmcnt(12)
  v_mfma_f32_32x32x16_bf16 v[32:47], v[68:71], v[168:171], v[32:47]
  s_add_u32 m0, s29, 66560
  s_add_u32 s31, s28, 2375680
  buffer_load_dwordx4 v15, s[16:19], s31 offen lds
  s_add_u32 m0, s29, 67584
  s_add_u32 s31, s28, 2392064
  buffer_load_dwordx4 v15, s[16:19], s31 offen lds
  s_waitcnt vmcnt(32)
  s_waitcnt lgkmcnt(10)
  v_mfma_f32_32x32x16_bf16 v[16:31], v[72:75], v[172:175], v[16:31]
  ds_read_b64_tr_b16 v[64:65], v3 offset:20480
  ds_read_b64_tr_b16 v[66:67], v3 offset:21504
  ds_read_b64_tr_b16 v[68:69], v13 offset:20480
  ds_read_b64_tr_b16 v[70:71], v13 offset:21504
  s_waitcnt lgkmcnt(12)
  v_mfma_f32_32x32x16_bf16 v[32:47], v[76:79], v[172:175], v[32:47]
  s_add_u32 m0, s29, 68608
  s_add_u32 s31, s28, 2408448
  buffer_load_dwordx4 v15, s[16:19], s31 offen lds
  buffer_load_dwordx4 v[164:167], v2, s[20:23], s30 offen offset:1024
  s_waitcnt vmcnt(33)
  s_waitcnt lgkmcnt(10)
  v_mfma_f32_32x32x16_bf16 v[16:31], v[48:51], v[80:83], v[16:31]
  ds_read_b64_tr_b16 v[72:73], v3 offset:22528
  ds_read_b64_tr_b16 v[74:75], v3 offset:23552
  ds_read_b64_tr_b16 v[76:77], v13 offset:22528
  ds_read_b64_tr_b16 v[78:79], v13 offset:23552
  s_waitcnt lgkmcnt(12)
  v_mfma_f32_32x32x16_bf16 v[32:47], v[52:55], v[80:83], v[32:47]
  buffer_load_dwordx4 v[168:171], v2, s[20:23], s30 offen offset:2048
  buffer_load_dwordx4 v[172:175], v2, s[20:23], s30 offen offset:3072
  s_waitcnt vmcnt(34)
  s_waitcnt lgkmcnt(10)
  v_mfma_f32_32x32x16_bf16 v[16:31], v[56:59], v[84:87], v[16:31]
  ds_read_b64_tr_b16 v[48:49], v3 offset:24576
  ds_read_b64_tr_b16 v[50:51], v3 offset:25600
  ds_read_b64_tr_b16 v[52:53], v13 offset:24576
  ds_read_b64_tr_b16 v[54:55], v13 offset:25600
  s_waitcnt lgkmcnt(12)
  v_mfma_f32_32x32x16_bf16 v[32:47], v[60:63], v[84:87], v[32:47]
  s_add_u32 s30, s30, 4096
  buffer_load_dwordx4 v[80:83], v2, s[20:23], s30 offen offset:0
  s_waitcnt vmcnt(34)
  s_waitcnt lgkmcnt(10)
  v_mfma_f32_32x32x16_bf16 v[16:31], v[64:67], v[88:91], v[16:31]
  ds_read_b64_tr_b16 v[56:57], v3 offset:26624
  ds_read_b64_tr_b16 v[58:59], v3 offset:27648
  ds_read_b64_tr_b16 v[60:61], v13 offset:26624
  ds_read_b64_tr_b16 v[62:63], v13 offset:27648
  s_waitcnt lgkmcnt(12)
  v_mfma_f32_32x32x16_bf16 v[32:47], v[68:71], v[88:91], v[32:47]
  buffer_load_dwordx4 v[84:87], v2, s[20:23], s30 offen offset:1024
  s_waitcnt vmcnt(34)
  s_waitcnt lgkmcnt(10)
  v_mfma_f32_32x32x16_bf16 v[16:31], v[72:75], v[92:95], v[16:31]
  ds_read_b64_tr_b16 v[64:65], v3 offset:28672
  ds_read_b64_tr_b16 v[66:67], v3 offset:29696
  ds_read_b64_tr_b16 v[68:69], v13 offset:28672
  ds_read_b64_tr_b16 v[70:71], v13 offset:29696
  s_waitcnt lgkmcnt(12)
  v_mfma_f32_32x32x16_bf16 v[32:47], v[76:79], v[92:95], v[32:47]
  buffer_load_dwordx4 v[88:91], v2, s[20:23], s30 offen offset:2048
  s_waitcnt vmcnt(34)
  s_waitcnt lgkmcnt(10)
  v_mfma_f32_32x32x16_bf16 v[16:31], v[48:51], v[96:99], v[16:31]
  ds_read_b64_tr_b16 v[72:73], v3 offset:30720
  ds_read_b64_tr_b16 v[74:75], v3 offset:31744
  ds_read_b64_tr_b16 v[76:77], v13 offset:30720
  ds_read_b64_tr_b16 v[78:79], v13 offset:31744
  s_waitcnt lgkmcnt(12)
  v_mfma_f32_32x32x16_bf16 v[32:47], v[52:55], v[96:99], v[32:47]
  buffer_load_dwordx4 v[92:95], v2, s[20:23], s30 offen offset:3072
  s_waitcnt vmcnt(30)
  s_waitcnt lgkmcnt(10)
  v_mfma_f32_32x32x16_bf16 v[16:31], v[56:59], v[100:103], v[16:31]
  s_barrier
  s_waitcnt lgkmcnt(8)
  v_mfma_f32_32x32x16_bf16 v[32:47], v[60:63], v[100:103], v[32:47]
  ds_read_b64_tr_b16 v[48:49], v3 offset:32768
  ds_read_b64_tr_b16 v[50:51], v3 offset:33792
  ds_read_b64_tr_b16 v[52:53], v13 offset:32768
  ds_read_b64_tr_b16 v[54:55], v13 offset:33792
  s_add_u32 s30, s30, 4096
  buffer_load_dwordx4 v[96:99], v2, s[20:23], s30 offen offset:0
  s_add_u32 m0, s29, 0
  s_add_u32 s31, s28, 2621440
  buffer_load_dwordx4 v15, s[16:19], s31 offen lds
  s_waitcnt vmcnt(31)
  s_waitcnt lgkmcnt(10)
  v_mfma_f32_32x32x16_bf16 v[16:31], v[64:67], v[104:107], v[16:31]
  ds_read_b64_tr_b16 v[56:57], v3 offset:34816
  ds_read_b64_tr_b16 v[58:59], v3 offset:35840
  ds_read_b64_tr_b16 v[60:61], v13 offset:34816
  ds_read_b64_tr_b16 v[62:63], v13 offset:35840
  s_waitcnt lgkmcnt(12)
  v_mfma_f32_32x32x16_bf16 v[32:47], v[68:71], v[104:107], v[32:47]
  s_add_u32 m0, s29, 1024
  s_add_u32 s31, s28, 2637824
  buffer_load_dwordx4 v15, s[16:19], s31 offen lds
  s_add_u32 m0, s29, 2048
  s_add_u32 s31, s28, 2654208
  buffer_load_dwordx4 v15, s[16:19], s31 offen lds
  s_waitcnt vmcnt(32)
  s_waitcnt lgkmcnt(10)
  v_mfma_f32_32x32x16_bf16 v[16:31], v[72:75], v[108:111], v[16:31]
  ds_read_b64_tr_b16 v[64:65], v3 offset:36864
  ds_read_b64_tr_b16 v[66:67], v3 offset:37888
  ds_read_b64_tr_b16 v[68:69], v13 offset:36864
  ds_read_b64_tr_b16 v[70:71], v13 offset:37888
  s_waitcnt lgkmcnt(12)
  v_mfma_f32_32x32x16_bf16 v[32:47], v[76:79], v[108:111], v[32:47]
  s_add_u32 m0, s29, 3072
  s_add_u32 s31, s28, 2670592
  buffer_load_dwordx4 v15, s[16:19], s31 offen lds
  buffer_load_dwordx4 v[100:103], v2, s[20:23], s30 offen offset:1024
  s_waitcnt vmcnt(33)
  s_waitcnt lgkmcnt(10)
  v_mfma_f32_32x32x16_bf16 v[16:31], v[48:51], v[112:115], v[16:31]
  ds_read_b64_tr_b16 v[72:73], v3 offset:38912
  ds_read_b64_tr_b16 v[74:75], v3 offset:39936
  ds_read_b64_tr_b16 v[76:77], v13 offset:38912
  ds_read_b64_tr_b16 v[78:79], v13 offset:39936
  s_waitcnt lgkmcnt(12)
  v_mfma_f32_32x32x16_bf16 v[32:47], v[52:55], v[112:115], v[32:47]
  buffer_load_dwordx4 v[104:107], v2, s[20:23], s30 offen offset:2048
  buffer_load_dwordx4 v[108:111], v2, s[20:23], s30 offen offset:3072
  s_waitcnt vmcnt(34)
  s_waitcnt lgkmcnt(10)
  v_mfma_f32_32x32x16_bf16 v[16:31], v[56:59], v[116:119], v[16:31]
  ds_read_b64_tr_b16 v[48:49], v3 offset:40960
  ds_read_b64_tr_b16 v[50:51], v3 offset:41984
  ds_read_b64_tr_b16 v[52:53], v13 offset:40960
  ds_read_b64_tr_b16 v[54:55], v13 offset:41984
  s_waitcnt lgkmcnt(12)
  v_mfma_f32_32x32x16_bf16 v[32:47], v[60:63], v[116:119], v[32:47]
  s_add_u32 s30, s30, 4096
  buffer_load_dwordx4 v[112:115], v2, s[20:23], s30 offen offset:0
  s_waitcnt vmcnt(34)
  s_waitcnt lgkmcnt(10)
  v_mfma_f32_32x32x16_bf16 v[16:31], v[64:67], v[120:123], v[16:31]
  ds_read_b64_tr_b16 v[56:57], v3 offset:43008
  ds_read_b64_tr_b16 v[58:59], v3 offset:44032
  ds_read_b64_tr_b16 v[60:61], v13 offset:43008
  ds_read_b64_tr_b16 v[62:63], v13 offset:44032
  s_waitcnt lgkmcnt(12)
  v_mfma_f32_32x32x16_bf16 v[32:47], v[68:71], v[120:123], v[32:47]
  buffer_load_dwordx4 v[116:119], v2, s[20:23], s30 offen offset:1024
  s_waitcnt vmcnt(34)
  s_waitcnt lgkmcnt(10)
  v_mfma_f32_32x32x16_bf16 v[16:31], v[72:75], v[124:127], v[16:31]
  ds_read_b64_tr_b16 v[64:65], v3 offset:45056
  ds_read_b64_tr_b16 v[66:67], v3 offset:46080
  ds_read_b64_tr_b16 v[68:69], v13 offset:45056
  ds_read_b64_tr_b16 v[70:71], v13 offset:46080
  s_waitcnt lgkmcnt(12)
  v_mfma_f32_32x32x16_bf16 v[32:47], v[76:79], v[124:127], v[32:47]
  buffer_load_dwordx4 v[120:123], v2, s[20:23], s30 offen offset:2048
  s_waitcnt vmcnt(34)
  s_waitcnt lgkmcnt(10)
  v_mfma_f32_32x32x16_bf16 v[16:31], v[48:51], v[128:131], v[16:31]
  ds_read_b64_tr_b16 v[72:73], v3 offset:47104
  ds_read_b64_tr_b16 v[74:75], v3 offset:48128
  ds_read_b64_tr_b16 v[76:77], v13 offset:47104
  ds_read_b64_tr_b16 v[78:79], v13 offset:48128
  s_waitcnt lgkmcnt(12)
  v_mfma_f32_32x32x16_bf16 v[32:47], v[52:55], v[128:131], v[32:47]
  buffer_load_dwordx4 v[124:127], v2, s[20:23], s30 offen offset:3072
  s_waitcnt vmcnt(30)
  s_waitcnt lgkmcnt(10)
  v_mfma_f32_32x32x16_bf16 v[16:31], v[56:59], v[132:135], v[16:31]
  s_barrier
  s_waitcnt lgkmcnt(8)
  v_mfma_f32_32x32x16_bf16 v[32:47], v[60:63], v[132:135], v[32:47]
  ds_read_b64_tr_b16 v[48:49], v3 offset:49152
  ds_read_b64_tr_b16 v[50:51], v3 offset:50176
  ds_read_b64_tr_b16 v[52:53], v13 offset:49152
  ds_read_b64_tr_b16 v[54:55], v13 offset:50176
  s_add_u32 s30, s30, 4096
  buffer_load_dwordx4 v[128:131], v2, s[20:23], s30 offen offset:0
  s_add_u32 m0, s29, 16384
  s_add_u32 s31, s28, 2883584
  buffer_load_dwordx4 v15, s[16:19], s31 offen lds
  s_waitcnt vmcnt(31)
  s_waitcnt lgkmcnt(10)
  v_mfma_f32_32x32x16_bf16 v[16:31], v[64:67], v[136:139], v[16:31]
  ds_read_b64_tr_b16 v[56:57], v3 offset:51200
  ds_read_b64_tr_b16 v[58:59], v3 offset:52224
  ds_read_b64_tr_b16 v[60:61], v13 offset:51200
  ds_read_b64_tr_b16 v[62:63], v13 offset:52224
  s_waitcnt lgkmcnt(12)
  v_mfma_f32_32x32x16_bf16 v[32:47], v[68:71], v[136:139], v[32:47]
  s_add_u32 m0, s29, 17408
  s_add_u32 s31, s28, 2899968
  buffer_load_dwordx4 v15, s[16:19], s31 offen lds
  s_add_u32 m0, s29, 18432
  s_add_u32 s31, s28, 2916352
  buffer_load_dwordx4 v15, s[16:19], s31 offen lds
  s_waitcnt vmcnt(32)
  s_waitcnt lgkmcnt(10)
  v_mfma_f32_32x32x16_bf16 v[16:31], v[72:75], v[140:143], v[16:31]
  ds_read_b64_tr_b16 v[64:65], v3 offset:53248
  ds_read_b64_tr_b16 v[66:67], v3 offset:54272
  ds_read_b64_tr_b16 v[68:69], v13 offset:53248
  ds_read_b64_tr_b16 v[70:71], v13 offset:54272
  s_waitcnt lgkmcnt(12)
  v_mfma_f32_32x32x16_bf16 v[32:47], v[76:79], v[140:143], v[32:47]
  s_add_u32 m0, s29, 19456
  s_add_u32 s31, s28, 2932736
  buffer_load_dwordx4 v15, s[16:19], s31 offen lds
  buffer_load_dwordx4 v[132:135], v2, s[20:23], s30 offen offset:1024
  s_waitcnt vmcnt(33)
  s_waitcnt lgkmcnt(10)
  v_mfma_f32_32x32x16_bf16 v[16:31], v[48:51], v[144:147], v[16:31]
  ds_read_b64_tr_b16 v[72:73], v3 offset:55296
  ds_read_b64_tr_b16 v[74:75], v3 offset:56320
  ds_read_b64_tr_b16 v[76:77], v13 offset:55296
  ds_read_b64_tr_b16 v[78:79], v13 offset:56320
  s_waitcnt lgkmcnt(12)
  v_mfma_f32_32x32x16_bf16 v[32:47], v[52:55], v[144:147], v[32:47]
  buffer_load_dwordx4 v[136:139], v2, s[20:23], s30 offen offset:2048
  buffer_load_dwordx4 v[140:143], v2, s[20:23], s30 offen offset:3072
  s_waitcnt vmcnt(34)
  s_waitcnt lgkmcnt(10)
  v_mfma_f32_32x32x16_bf16 v[16:31], v[56:59], v[148:151], v[16:31]
  ds_read_b64_tr_b16 v[48:49], v3 offset:57344
  ds_read_b64_tr_b16 v[50:51], v3 offset:58368
  ds_read_b64_tr_b16 v[52:53], v13 offset:57344
  ds_read_b64_tr_b16 v[54:55], v13 offset:58368
  s_waitcnt lgkmcnt(12)
  v_mfma_f32_32x32x16_bf16 v[32:47], v[60:63], v[148:151], v[32:47]
  s_add_u32 s30, s30, 4096
  buffer_load_dwordx4 v[144:147], v2, s[20:23], s30 offen offset:0
  s_waitcnt vmcnt(34)
  s_waitcnt lgkmcnt(10)
  v_mfma_f32_32x32x16_bf16 v[16:31], v[64:67], v[152:155], v[16:31]
  ds_read_b64_tr_b16 v[56:57], v3 offset:59392
  ds_read_b64_tr_b16 v[58:59], v3 offset:60416
  ds_read_b64_tr_b16 v[60:61], v13 offset:59392
  ds_read_b64_tr_b16 v[62:63], v13 offset:60416
  s_waitcnt lgkmcnt(12)
  v_mfma_f32_32x32x16_bf16 v[32:47], v[68:71], v[152:155], v[32:47]
  buffer_load_dwordx4 v[148:151], v2, s[20:23], s30 offen offset:1024
  s_waitcnt vmcnt(34)
  s_waitcnt lgkmcnt(10)
  v_mfma_f32_32x32x16_bf16 v[16:31], v[72:75], v[156:159], v[16:31]
  ds_read_b64_tr_b16 v[64:65], v3 offset:61440
  ds_read_b64_tr_b16 v[66:67], v3 offset:62464
  ds_read_b64_tr_b16 v[68:69], v13 offset:61440
  ds_read_b64_tr_b16 v[70:71], v13 offset:62464
  s_waitcnt lgkmcnt(12)
  v_mfma_f32_32x32x16_bf16 v[32:47], v[76:79], v[156:159], v[32:47]
  buffer_load_dwordx4 v[152:155], v2, s[20:23], s30 offen offset:2048
  s_waitcnt vmcnt(34)
  s_waitcnt lgkmcnt(10)
  v_mfma_f32_32x32x16_bf16 v[16:31], v[48:51], v[160:163], v[16:31]
  ds_read_b64_tr_b16 v[72:73], v3 offset:63488
  ds_read_b64_tr_b16 v[74:75], v3 offset:64512
  ds_read_b64_tr_b16 v[76:77], v13 offset:63488
  ds_read_b64_tr_b16 v[78:79], v13 offset:64512
  s_waitcnt lgkmcnt(12)
  v_mfma_f32_32x32x16_bf16 v[32:47], v[52:55], v[160:163], v[32:47]
  buffer_load_dwordx4 v[156:159], v2, s[20:23], s30 offen offset:3072
  s_waitcnt vmcnt(30)
  s_waitcnt lgkmcnt(10)
  v_mfma_f32_32x32x16_bf16 v[16:31], v[56:59], v[164:167], v[16:31]
  s_barrier
  s_waitcnt lgkmcnt(8)
  v_mfma_f32_32x32x16_bf16 v[32:47], v[60:63], v[164:167], v[32:47]
  ds_read_b64_tr_b16 v[48:49], v12 offset:0
  ds_read_b64_tr_b16 v[50:51], v12 offset:1024
  ds_read_b64_tr_b16 v[52:53], v14 offset:0
  ds_read_b64_tr_b16 v[54:55], v14 offset:1024
  s_add_u32 s30, s30, 4096
  buffer_load_dwordx4 v[160:163], v2, s[20:23], s30 offen offset:0
  s_add_u32 m0, s29, 32768
  s_add_u32 s31, s28, 3145728
  buffer_load_dwordx4 v15, s[16:19], s31 offen lds
  s_waitcnt vmcnt(31)
  s_waitcnt lgkmcnt(10)
  v_mfma_f32_32x32x16_bf16 v[16:31], v[64:67], v[168:171], v[16:31]
  ds_read_b64_tr_b16 v[56:57], v12 offset:2048
  ds_read_b64_tr_b16 v[58:59], v12 offset:3072
  ds_read_b64_tr_b16 v[60:61], v14 offset:2048
  ds_read_b64_tr_b16 v[62:63], v14 offset:3072
  s_waitcnt lgkmcnt(12)
  v_mfma_f32_32x32x16_bf16 v[32:47], v[68:71], v[168:171], v[32:47]
  s_add_u32 m0, s29, 33792
  s_add_u32 s31, s28, 3162112
  buffer_load_dwordx4 v15, s[16:19], s31 offen lds
  s_add_u32 m0, s29, 34816
  s_add_u32 s31, s28, 3178496
  buffer_load_dwordx4 v15, s[16:19], s31 offen lds
  s_waitcnt vmcnt(32)
  s_waitcnt lgkmcnt(10)
  v_mfma_f32_32x32x16_bf16 v[16:31], v[72:75], v[172:175], v[16:31]
  ds_read_b64_tr_b16 v[64:65], v12 offset:4096
  ds_read_b64_tr_b16 v[66:67], v12 offset:5120
  ds_read_b64_tr_b16 v[68:69], v14 offset:4096
  ds_read_b64_tr_b16 v[70:71], v14 offset:5120
  s_waitcnt lgkmcnt(12)
  v_mfma_f32_32x32x16_bf16 v[32:47], v[76:79], v[172:175], v[32:47]
  s_add_u32 m0, s29, 35840
  s_add_u32 s31, s28, 3194880
  buffer_load_dwordx4 v15, s[16:19], s31 offen lds
  buffer_load_dwordx4 v[164:167], v2, s[20:23], s30 offen offset:1024
  s_waitcnt vmcnt(33)
  s_waitcnt lgkmcnt(10)
  v_mfma_f32_32x32x16_bf16 v[16:31], v[48:51], v[80:83], v[16:31]
  ds_read_b64_tr_b16 v[72:73], v12 offset:6144
  ds_read_b64_tr_b16 v[74:75], v12 offset:7168
  ds_read_b64_tr_b16 v[76:77], v14 offset:6144
  ds_read_b64_tr_b16 v[78:79], v14 offset:7168
  s_waitcnt lgkmcnt(12)
  v_mfma_f32_32x32x16_bf16 v[32:47], v[52:55], v[80:83], v[32:47]
  buffer_load_dwordx4 v[168:171], v2, s[20:23], s30 offen offset:2048
  buffer_load_dwordx4 v[172:175], v2, s[20:23], s30 offen offset:3072
  s_waitcnt vmcnt(34)
  s_waitcnt lgkmcnt(10)
  v_mfma_f32_32x32x16_bf16 v[16:31], v[56:59], v[84:87], v[16:31]
  ds_read_b64_tr_b16 v[48:49], v12 offset:8192
  ds_read_b64_tr_b16 v[50:51], v12 offset:9216
  ds_read_b64_tr_b16 v[52:53], v14 offset:8192
  ds_read_b64_tr_b16 v[54:55], v14 offset:9216
  s_waitcnt lgkmcnt(12)
  v_mfma_f32_32x32x16_bf16 v[32:47], v[60:63], v[84:87], v[32:47]
  s_add_u32 s30, s30, 4096
  buffer_load_dwordx4 v[80:83], v2, s[20:23], s30 offen offset:0
  s_waitcnt vmcnt(34)
  s_waitcnt lgkmcnt(10)
  v_mfma_f32_32x32x16_bf16 v[16:31], v[64:67], v[88:91], v[16:31]
  ds_read_b64_tr_b16 v[56:57], v12 offset:10240
  ds_read_b64_tr_b16 v[58:59], v12 offset:11264
  ds_read_b64_tr_b16 v[60:61], v14 offset:10240
  ds_read_b64_tr_b16 v[62:63], v14 offset:11264
  s_waitcnt lgkmcnt(12)
  v_mfma_f32_32x32x16_bf16 v[32:47], v[68:71], v[88:91], v[32:47]
  buffer_load_dwordx4 v[84:87], v2, s[20:23], s30 offen offset:1024
  s_waitcnt vmcnt(34)
  s_waitcnt lgkmcnt(10)
  v_mfma_f32_32x32x16_bf16 v[16:31], v[72:75], v[92:95], v[16:31]
  ds_read_b64_tr_b16 v[64:65], v12 offset:12288
  ds_read_b64_tr_b16 v[66:67], v12 offset:13312
  ds_read_b64_tr_b16 v[68:69], v14 offset:12288
  ds_read_b64_tr_b16 v[70:71], v14 offset:13312
  s_waitcnt lgkmcnt(12)
  v_mfma_f32_32x32x16_bf16 v[32:47], v[76:79], v[92:95], v[32:47]
  buffer_load_dwordx4 v[88:91], v2, s[20:23], s30 offen offset:2048
  s_waitcnt vmcnt(34)
  s_waitcnt lgkmcnt(10)
  v_mfma_f32_32x32x16_bf16 v[16:31], v[48:51], v[96:99], v[16:31]
  ds_read_b64_tr_b16 v[72:73], v12 offset:14336
  ds_read_b64_tr_b16 v[74:75], v12 offset:15360
  ds_read_b64_tr_b16 v[76:77], v14 offset:14336
  ds_read_b64_tr_b16 v[78:79], v14 offset:15360
  s_waitcnt lgkmcnt(12)
  v_mfma_f32_32x32x16_bf16 v[32:47], v[52:55], v[96:99], v[32:47]
  buffer_load_dwordx4 v[92:95], v2, s[20:23], s30 offen offset:3072
  s_waitcnt vmcnt(30)
  s_waitcnt lgkmcnt(10)
  v_mfma_f32_32x32x16_bf16 v[16:31], v[56:59], v[100:103], v[16:31]
  s_barrier
  s_waitcnt lgkmcnt(8)
  v_mfma_f32_32x32x16_bf16 v[32:47], v[60:63], v[100:103], v[32:47]
  ds_read_b64_tr_b16 v[48:49], v3 offset:0
  ds_read_b64_tr_b16 v[50:51], v3 offset:1024
  ds_read_b64_tr_b16 v[52:53], v13 offset:0
  ds_read_b64_tr_b16 v[54:55], v13 offset:1024
  s_add_u32 s30, s30, 4096
  buffer_load_dwordx4 v[96:99], v2, s[20:23], s30 offen offset:0
  s_add_u32 m0, s29, 49152
  s_add_u32 s31, s28, 3407872
  buffer_load_dwordx4 v15, s[16:19], s31 offen lds
  s_waitcnt vmcnt(31)
  s_waitcnt lgkmcnt(10)
  v_mfma_f32_32x32x16_bf16 v[16:31], v[64:67], v[104:107], v[16:31]
  ds_read_b64_tr_b16 v[56:57], v3 offset:2048
  ds_read_b64_tr_b16 v[58:59], v3 offset:3072
  ds_read_b64_tr_b16 v[60:61], v13 offset:2048
  ds_read_b64_tr_b16 v[62:63], v13 offset:3072
  s_waitcnt lgkmcnt(12)
  v_mfma_f32_32x32x16_bf16 v[32:47], v[68:71], v[104:107], v[32:47]
  s_add_u32 m0, s29, 50176
  s_add_u32 s31, s28, 3424256
  buffer_load_dwordx4 v15, s[16:19], s31 offen lds
  s_add_u32 m0, s29, 51200
  s_add_u32 s31, s28, 3440640
  buffer_load_dwordx4 v15, s[16:19], s31 offen lds
  s_waitcnt vmcnt(32)
  s_waitcnt lgkmcnt(10)
  v_mfma_f32_32x32x16_bf16 v[16:31], v[72:75], v[108:111], v[16:31]
  ds_read_b64_tr_b16 v[64:65], v3 offset:4096
  ds_read_b64_tr_b16 v[66:67], v3 offset:5120
  ds_read_b64_tr_b16 v[68:69], v13 offset:4096
  ds_read_b64_tr_b16 v[70:71], v13 offset:5120
  s_waitcnt lgkmcnt(12)
  v_mfma_f32_32x32x16_bf16 v[32:47], v[76:79], v[108:111], v[32:47]
  s_add_u32 m0, s29, 52224
  s_add_u32 s31, s28, 3457024
  buffer_load_dwordx4 v15, s[16:19], s31 offen lds
  buffer_load_dwordx4 v[100:103], v2, s[20:23], s30 offen offset:1024
  s_waitcnt vmcnt(33)
  s_waitcnt lgkmcnt(10)
  v_mfma_f32_32x32x16_bf16 v[16:31], v[48:51], v[112:115], v[16:31]
  ds_read_b64_tr_b16 v[72:73], v3 offset:6144
  ds_read_b64_tr_b16 v[74:75], v3 offset:7168
  ds_read_b64_tr_b16 v[76:77], v13 offset:6144
  ds_read_b64_tr_b16 v[78:79], v13 offset:7168
  s_waitcnt lgkmcnt(12)
  v_mfma_f32_32x32x16_bf16 v[32:47], v[52:55], v[112:115], v[32:47]
  buffer_load_dwordx4 v[104:107], v2, s[20:23], s30 offen offset:2048
  buffer_load_dwordx4 v[108:111], v2, s[20:23], s30 offen offset:3072
  s_waitcnt vmcnt(34)
  s_waitcnt lgkmcnt(10)
  v_mfma_f32_32x32x16_bf16 v[16:31], v[56:59], v[116:119], v[16:31]
  ds_read_b64_tr_b16 v[48:49], v3 offset:8192
  ds_read_b64_tr_b16 v[50:51], v3 offset:9216
  ds_read_b64_tr_b16 v[52:53], v13 offset:8192
  ds_read_b64_tr_b16 v[54:55], v13 offset:9216
  s_waitcnt lgkmcnt(12)
  v_mfma_f32_32x32x16_bf16 v[32:47], v[60:63], v[116:119], v[32:47]
  s_add_u32 s30, s30, 4096
  buffer_load_dwordx4 v[112:115], v2, s[20:23], s30 offen offset:0
  s_waitcnt vmcnt(34)
  s_waitcnt lgkmcnt(10)
  v_mfma_f32_32x32x16_bf16 v[16:31], v[64:67], v[120:123], v[16:31]
  ds_read_b64_tr_b16 v[56:57], v3 offset:10240
  ds_read_b64_tr_b16 v[58:59], v3 offset:11264
  ds_read_b64_tr_b16 v[60:61], v13 offset:10240
  ds_read_b64_tr_b16 v[62:63], v13 offset:11264
  s_waitcnt lgkmcnt(12)
  v_mfma_f32_32x32x16_bf16 v[32:47], v[68:71], v[120:123], v[32:47]
  buffer_load_dwordx4 v[116:119], v2, s[20:23], s30 offen offset:1024
  s_waitcnt vmcnt(34)
  s_waitcnt lgkmcnt(10)
  v_mfma_f32_32x32x16_bf16 v[16:31], v[72:75], v[124:127], v[16:31]
  ds_read_b64_tr_b16 v[64:65], v3 offset:12288
  ds_read_b64_tr_b16 v[66:67], v3 offset:13312
  ds_read_b64_tr_b16 v[68:69], v13 offset:12288
  ds_read_b64_tr_b16 v[70:71], v13 offset:13312
  s_waitcnt lgkmcnt(12)
  v_mfma_f32_32x32x16_bf16 v[32:47], v[76:79], v[124:127], v[32:47]
  buffer_load_dwordx4 v[120:123], v2, s[20:23], s30 offen offset:2048
  s_waitcnt vmcnt(34)
  s_waitcnt lgkmcnt(10)
  v_mfma_f32_32x32x16_bf16 v[16:31], v[48:51], v[128:131], v[16:31]
  ds_read_b64_tr_b16 v[72:73], v3 offset:14336
  ds_read_b64_tr_b16 v[74:75], v3 offset:15360
  ds_read_b64_tr_b16 v[76:77], v13 offset:14336
  ds_read_b64_tr_b16 v[78:79], v13 offset:15360
  s_waitcnt lgkmcnt(12)
  v_mfma_f32_32x32x16_bf16 v[32:47], v[52:55], v[128:131], v[32:47]
  buffer_load_dwordx4 v[124:127], v2, s[20:23], s30 offen offset:3072
  s_waitcnt vmcnt(30)
  s_waitcnt lgkmcnt(10)
  v_mfma_f32_32x32x16_bf16 v[16:31], v[56:59], v[132:135], v[16:31]
  s_barrier
  s_waitcnt lgkmcnt(8)
  v_mfma_f32_32x32x16_bf16 v[32:47], v[60:63], v[132:135], v[32:47]
  ds_read_b64_tr_b16 v[48:49], v3 offset:16384
  ds_read_b64_tr_b16 v[50:51], v3 offset:17408
  ds_read_b64_tr_b16 v[52:53], v13 offset:16384
  ds_read_b64_tr_b16 v[54:55], v13 offset:17408
  s_add_u32 s30, s30, 4096
  buffer_load_dwordx4 v[128:131], v2, s[20:23], s30 offen offset:0
  s_add_u32 m0, s29, 65536
  s_add_u32 s31, s28, 3670016
  buffer_load_dwordx4 v15, s[16:19], s31 offen lds
  s_waitcnt vmcnt(31)
  s_waitcnt lgkmcnt(10)
  v_mfma_f32_32x32x16_bf16 v[16:31], v[64:67], v[136:139], v[16:31]
  ds_read_b64_tr_b16 v[56:57], v3 offset:18432
  ds_read_b64_tr_b16 v[58:59], v3 offset:19456
  ds_read_b64_tr_b16 v[60:61], v13 offset:18432
  ds_read_b64_tr_b16 v[62:63], v13 offset:19456
  s_waitcnt lgkmcnt(12)
  v_mfma_f32_32x32x16_bf16 v[32:47], v[68:71], v[136:139], v[32:47]
  s_add_u32 m0, s29, 66560
  s_add_u32 s31, s28, 3686400
  buffer_load_dwordx4 v15, s[16:19], s31 offen lds
  s_add_u32 m0, s29, 67584
  s_add_u32 s31, s28, 3702784
  buffer_load_dwordx4 v15, s[16:19], s31 offen lds
  s_waitcnt vmcnt(32)
  s_waitcnt lgkmcnt(10)
  v_mfma_f32_32x32x16_bf16 v[16:31], v[72:75], v[140:143], v[16:31]
  ds_read_b64_tr_b16 v[64:65], v3 offset:20480
  ds_read_b64_tr_b16 v[66:67], v3 offset:21504
  ds_read_b64_tr_b16 v[68:69], v13 offset:20480
  ds_read_b64_tr_b16 v[70:71], v13 offset:21504
  s_waitcnt lgkmcnt(12)
  v_mfma_f32_32x32x16_bf16 v[32:47], v[76:79], v[140:143], v[32:47]
  s_add_u32 m0, s29, 68608
  s_add_u32 s31, s28, 3719168
  buffer_load_dwordx4 v15, s[16:19], s31 offen lds
  buffer_load_dwordx4 v[132:135], v2, s[20:23], s30 offen offset:1024
  s_waitcnt vmcnt(33)
  s_waitcnt lgkmcnt(10)
  v_mfma_f32_32x32x16_bf16 v[16:31], v[48:51], v[144:147], v[16:31]
  ds_read_b64_tr_b16 v[72:73], v3 offset:22528
  ds_read_b64_tr_b16 v[74:75], v3 offset:23552
  ds_read_b64_tr_b16 v[76:77], v13 offset:22528
  ds_read_b64_tr_b16 v[78:79], v13 offset:23552
  s_waitcnt lgkmcnt(12)
  v_mfma_f32_32x32x16_bf16 v[32:47], v[52:55], v[144:147], v[32:47]
  buffer_load_dwordx4 v[136:139], v2, s[20:23], s30 offen offset:2048
  buffer_load_dwordx4 v[140:143], v2, s[20:23], s30 offen offset:3072
  s_waitcnt vmcnt(34)
  s_waitcnt lgkmcnt(10)
  v_mfma_f32_32x32x16_bf16 v[16:31], v[56:59], v[148:151], v[16:31]
  ds_read_b64_tr_b16 v[48:49], v3 offset:24576
  ds_read_b64_tr_b16 v[50:51], v3 offset:25600
  ds_read_b64_tr_b16 v[52:53], v13 offset:24576
  ds_read_b64_tr_b16 v[54:55], v13 offset:25600
  s_waitcnt lgkmcnt(12)
  v_mfma_f32_32x32x16_bf16 v[32:47], v[60:63], v[148:151], v[32:47]
  s_add_u32 s30, s30, 4096
  buffer_load_dwordx4 v[144:147], v2, s[20:23], s30 offen offset:0
  s_waitcnt vmcnt(34)
  s_waitcnt lgkmcnt(10)
  v_mfma_f32_32x32x16_bf16 v[16:31], v[64:67], v[152:155], v[16:31]
  ds_read_b64_tr_b16 v[56:57], v3 offset:26624
  ds_read_b64_tr_b16 v[58:59], v3 offset:27648
  ds_read_b64_tr_b16 v[60:61], v13 offset:26624
  ds_read_b64_tr_b16 v[62:63], v13 offset:27648
  s_waitcnt lgkmcnt(12)
  v_mfma_f32_32x32x16_bf16 v[32:47], v[68:71], v[152:155], v[32:47]
  buffer_load_dwordx4 v[148:151], v2, s[20:23], s30 offen offset:1024
  s_waitcnt vmcnt(34)
  s_waitcnt lgkmcnt(10)
  v_mfma_f32_32x32x16_bf16 v[16:31], v[72:75], v[156:159], v[16:31]
  ds_read_b64_tr_b16 v[64:65], v3 offset:28672
  ds_read_b64_tr_b16 v[66:67], v3 offset:29696
  ds_read_b64_tr_b16 v[68:69], v13 offset:28672
  ds_read_b64_tr_b16 v[70:71], v13 offset:29696
  s_waitcnt lgkmcnt(12)
  v_mfma_f32_32x32x16_bf16 v[32:47], v[76:79], v[156:159], v[32:47]
  buffer_load_dwordx4 v[152:155], v2, s[20:23], s30 offen offset:2048
  s_waitcnt vmcnt(34)
  s_waitcnt lgkmcnt(10)
  v_mfma_f32_32x32x16_bf16 v[16:31], v[48:51], v[160:163], v[16:31]
  ds_read_b64_tr_b16 v[72:73], v3 offset:30720
  ds_read_b64_tr_b16 v[74:75], v3 offset:31744
  ds_read_b64_tr_b16 v[76:77], v13 offset:30720
  ds_read_b64_tr_b16 v[78:79], v13 offset:31744
  s_waitcnt lgkmcnt(12)
  v_mfma_f32_32x32x16_bf16 v[32:47], v[52:55], v[160:163], v[32:47]
  buffer_load_dwordx4 v[156:159], v2, s[20:23], s30 offen offset:3072
  s_waitcnt vmcnt(30)
  s_waitcnt lgkmcnt(10)
  v_mfma_f32_32x32x16_bf16 v[16:31], v[56:59], v[164:167], v[16:31]
  s_barrier
  s_waitcnt lgkmcnt(8)
  v_mfma_f32_32x32x16_bf16 v[32:47], v[60:63], v[164:167], v[32:47]
  ds_read_b64_tr_b16 v[48:49], v3 offset:32768
  ds_read_b64_tr_b16 v[50:51], v3 offset:33792
  ds_read_b64_tr_b16 v[52:53], v13 offset:32768
  ds_read_b64_tr_b16 v[54:55], v13 offset:33792
  s_add_u32 s30, s30, 4096
  buffer_load_dwordx4 v[160:163], v2, s[20:23], s30 offen offset:0
  s_add_u32 m0, s29, 0
  s_add_u32 s31, s28, 3932160
  buffer_load_dwordx4 v15, s[16:19], s31 offen lds
  s_waitcnt vmcnt(31)
  s_waitcnt lgkmcnt(10)
  v_mfma_f32_32x32x16_bf16 v[16:31], v[64:67], v[168:171], v[16:31]
  ds_read_b64_tr_b16 v[56:57], v3 offset:34816
  ds_read_b64_tr_b16 v[58:59], v3 offset:35840
  ds_read_b64_tr_b16 v[60:61], v13 offset:34816
  ds_read_b64_tr_b16 v[62:63], v13 offset:35840
  s_waitcnt lgkmcnt(12)
  v_mfma_f32_32x32x16_bf16 v[32:47], v[68:71], v[168:171], v[32:47]
  s_add_u32 m0, s29, 1024
  s_add_u32 s31, s28, 3948544
  buffer_load_dwordx4 v15, s[16:19], s31 offen lds
  s_add_u32 m0, s29, 2048
  s_add_u32 s31, s28, 3964928
  buffer_load_dwordx4 v15, s[16:19], s31 offen lds
  s_waitcnt vmcnt(32)
  s_waitcnt lgkmcnt(10)
  v_mfma_f32_32x32x16_bf16 v[16:31], v[72:75], v[172:175], v[16:31]
  ds_read_b64_tr_b16 v[64:65], v3 offset:36864
  ds_read_b64_tr_b16 v[66:67], v3 offset:37888
  ds_read_b64_tr_b16 v[68:69], v13 offset:36864
  ds_read_b64_tr_b16 v[70:71], v13 offset:37888
  s_waitcnt lgkmcnt(12)
  v_mfma_f32_32x32x16_bf16 v[32:47], v[76:79], v[172:175], v[32:47]
  s_add_u32 m0, s29, 3072
  s_add_u32 s31, s28, 3981312
  buffer_load_dwordx4 v15, s[16:19], s31 offen lds
  buffer_load_dwordx4 v[164:167], v2, s[20:23], s30 offen offset:1024
  s_waitcnt vmcnt(33)
  s_waitcnt lgkmcnt(10)
  v_mfma_f32_32x32x16_bf16 v[16:31], v[48:51], v[80:83], v[16:31]
  ds_read_b64_tr_b16 v[72:73], v3 offset:38912
  ds_read_b64_tr_b16 v[74:75], v3 offset:39936
  ds_read_b64_tr_b16 v[76:77], v13 offset:38912
  ds_read_b64_tr_b16 v[78:79], v13 offset:39936
  s_waitcnt lgkmcnt(12)
  v_mfma_f32_32x32x16_bf16 v[32:47], v[52:55], v[80:83], v[32:47]
  buffer_load_dwordx4 v[168:171], v2, s[20:23], s30 offen offset:2048
  buffer_load_dwordx4 v[172:175], v2, s[20:23], s30 offen offset:3072
  s_waitcnt vmcnt(34)
  s_waitcnt lgkmcnt(10)
  v_mfma_f32_32x32x16_bf16 v[16:31], v[56:59], v[84:87], v[16:31]
  ds_read_b64_tr_b16 v[48:49], v3 offset:40960
  ds_read_b64_tr_b16 v[50:51], v3 offset:41984
  ds_read_b64_tr_b16 v[52:53], v13 offset:40960
  ds_read_b64_tr_b16 v[54:55], v13 offset:41984
  s_waitcnt lgkmcnt(12)
  v_mfma_f32_32x32x16_bf16 v[32:47], v[60:63], v[84:87], v[32:47]
  s_add_u32 s30, s30, 4096
  buffer_load_dwordx4 v[80:83], v2, s[20:23], s30 offen offset:0
  s_waitcnt vmcnt(34)
  s_waitcnt lgkmcnt(10)
  v_mfma_f32_32x32x16_bf16 v[16:31], v[64:67], v[88:91], v[16:31]
  ds_read_b64_tr_b16 v[56:57], v3 offset:43008
  ds_read_b64_tr_b16 v[58:59], v3 offset:44032
  ds_read_b64_tr_b16 v[60:61], v13 offset:43008
  ds_read_b64_tr_b16 v[62:63], v13 offset:44032
  s_waitcnt lgkmcnt(12)
  v_mfma_f32_32x32x16_bf16 v[32:47], v[68:71], v[88:91], v[32:47]
  buffer_load_dwordx4 v[84:87], v2, s[20:23], s30 offen offset:1024
  s_waitcnt vmcnt(34)
  s_waitcnt lgkmcnt(10)
  v_mfma_f32_32x32x16_bf16 v[16:31], v[72:75], v[92:95], v[16:31]
  ds_read_b64_tr_b16 v[64:65], v3 offset:45056
  ds_read_b64_tr_b16 v[66:67], v3 offset:46080
  ds_read_b64_tr_b16 v[68:69], v13 offset:45056
  ds_read_b64_tr_b16 v[70:71], v13 offset:46080
  s_waitcnt lgkmcnt(12)
  v_mfma_f32_32x32x16_bf16 v[32:47], v[76:79], v[92:95], v[32:47]
  buffer_load_dwordx4 v[88:91], v2, s[20:23], s30 offen offset:2048
  s_waitcnt vmcnt(34)
  s_waitcnt lgkmcnt(10)
  v_mfma_f32_32x32x16_bf16 v[16:31], v[48:51], v[96:99], v[16:31]
  ds_read_b64_tr_b16 v[72:73], v3 offset:47104
  ds_read_b64_tr_b16 v[74:75], v3 offset:48128
  ds_read_b64_tr_b16 v[76:77], v13 offset:47104
  ds_read_b64_tr_b16 v[78:79], v13 offset:48128
  s_waitcnt lgkmcnt(12)
  v_mfma_f32_32x32x16_bf16 v[32:47], v[52:55], v[96:99], v[32:47]
  buffer_load_dwordx4 v[92:95], v2, s[20:23], s30 offen offset:3072
  s_waitcnt vmcnt(30)
  s_waitcnt lgkmcnt(10)
  v_mfma_f32_32x32x16_bf16 v[16:31], v[56:59], v[100:103], v[16:31]
  s_barrier
  s_waitcnt lgkmcnt(8)
  v_mfma_f32_32x32x16_bf16 v[32:47], v[60:63], v[100:103], v[32:47]
  ds_read_b64_tr_b16 v[48:49], v3 offset:49152
  ds_read_b64_tr_b16 v[50:51], v3 offset:50176
  ds_read_b64_tr_b16 v[52:53], v13 offset:49152
  ds_read_b64_tr_b16 v[54:55], v13 offset:50176
  s_add_u32 s30, s30, 4096
  buffer_load_dwordx4 v[96:99], v2, s[20:23], s30 offen offset:0
  s_add_u32 m0, s29, 16384
  s_add_u32 s31, s28, 4194304
  buffer_load_dwordx4 v15, s[16:19], s31 offen lds
  s_waitcnt vmcnt(31)
  s_waitcnt lgkmcnt(10)
  v_mfma_f32_32x32x16_bf16 v[16:31], v[64:67], v[104:107], v[16:31]
  ds_read_b64_tr_b16 v[56:57], v3 offset:51200
  ds_read_b64_tr_b16 v[58:59], v3 offset:52224
  ds_read_b64_tr_b16 v[60:61], v13 offset:51200
  ds_read_b64_tr_b16 v[62:63], v13 offset:52224
  s_waitcnt lgkmcnt(12)
  v_mfma_f32_32x32x16_bf16 v[32:47], v[68:71], v[104:107], v[32:47]
  s_add_u32 m0, s29, 17408
  s_add_u32 s31, s28, 4210688
  buffer_load_dwordx4 v15, s[16:19], s31 offen lds
  s_add_u32 m0, s29, 18432
  s_add_u32 s31, s28, 4227072
  buffer_load_dwordx4 v15, s[16:19], s31 offen lds
  s_waitcnt vmcnt(32)
  s_waitcnt lgkmcnt(10)
  v_mfma_f32_32x32x16_bf16 v[16:31], v[72:75], v[108:111], v[16:31]
  ds_read_b64_tr_b16 v[64:65], v3 offset:53248
  ds_read_b64_tr_b16 v[66:67], v3 offset:54272
  ds_read_b64_tr_b16 v[68:69], v13 offset:53248
  ds_read_b64_tr_b16 v[70:71], v13 offset:54272
  s_waitcnt lgkmcnt(12)
  v_mfma_f32_32x32x16_bf16 v[32:47], v[76:79], v[108:111], v[32:47]
  s_add_u32 m0, s29, 19456
  s_add_u32 s31, s28, 4243456
  buffer_load_dwordx4 v15, s[16:19], s31 offen lds
  buffer_load_dwordx4 v[100:103], v2, s[20:23], s30 offen offset:1024
  s_waitcnt vmcnt(33)
  s_waitcnt lgkmcnt(10)
  v_mfma_f32_32x32x16_bf16 v[16:31], v[48:51], v[112:115], v[16:31]
  ds_read_b64_tr_b16 v[72:73], v3 offset:55296
  ds_read_b64_tr_b16 v[74:75], v3 offset:56320
  ds_read_b64_tr_b16 v[76:77], v13 offset:55296
  ds_read_b64_tr_b16 v[78:79], v13 offset:56320
  s_waitcnt lgkmcnt(12)
  v_mfma_f32_32x32x16_bf16 v[32:47], v[52:55], v[112:115], v[32:47]
  buffer_load_dwordx4 v[104:107], v2, s[20:23], s30 offen offset:2048
  buffer_load_dwordx4 v[108:111], v2, s[20:23], s30 offen offset:3072
  s_waitcnt vmcnt(34)
  s_waitcnt lgkmcnt(10)
  v_mfma_f32_32x32x16_bf16 v[16:31], v[56:59], v[116:119], v[16:31]
  ds_read_b64_tr_b16 v[48:49], v3 offset:57344
  ds_read_b64_tr_b16 v[50:51], v3 offset:58368
  ds_read_b64_tr_b16 v[52:53], v13 offset:57344
  ds_read_b64_tr_b16 v[54:55], v13 offset:58368
  s_waitcnt lgkmcnt(12)
  v_mfma_f32_32x32x16_bf16 v[32:47], v[60:63], v[116:119], v[32:47]
  s_add_u32 s30, s30, 4096
  buffer_load_dwordx4 v[112:115], v2, s[20:23], s30 offen offset:0
  s_waitcnt vmcnt(34)
  s_waitcnt lgkmcnt(10)
  v_mfma_f32_32x32x16_bf16 v[16:31], v[64:67], v[120:123], v[16:31]
  ds_read_b64_tr_b16 v[56:57], v3 offset:59392
  ds_read_b64_tr_b16 v[58:59], v3 offset:60416
  ds_read_b64_tr_b16 v[60:61], v13 offset:59392
  ds_read_b64_tr_b16 v[62:63], v13 offset:60416
  s_waitcnt lgkmcnt(12)
  v_mfma_f32_32x32x16_bf16 v[32:47], v[68:71], v[120:123], v[32:47]
  buffer_load_dwordx4 v[116:119], v2, s[20:23], s30 offen offset:1024
  s_waitcnt vmcnt(34)
  s_waitcnt lgkmcnt(10)
  v_mfma_f32_32x32x16_bf16 v[16:31], v[72:75], v[124:127], v[16:31]
  ds_read_b64_tr_b16 v[64:65], v3 offset:61440
  ds_read_b64_tr_b16 v[66:67], v3 offset:62464
  ds_read_b64_tr_b16 v[68:69], v13 offset:61440
  ds_read_b64_tr_b16 v[70:71], v13 offset:62464
  s_waitcnt lgkmcnt(12)
  v_mfma_f32_32x32x16_bf16 v[32:47], v[76:79], v[124:127], v[32:47]
  buffer_load_dwordx4 v[120:123], v2, s[20:23], s30 offen offset:2048
  s_waitcnt vmcnt(34)
  s_waitcnt lgkmcnt(10)
  v_mfma_f32_32x32x16_bf16 v[16:31], v[48:51], v[128:131], v[16:31]
  ds_read_b64_tr_b16 v[72:73], v3 offset:63488
  ds_read_b64_tr_b16 v[74:75], v3 offset:64512
  ds_read_b64_tr_b16 v[76:77], v13 offset:63488
  ds_read_b64_tr_b16 v[78:79], v13 offset:64512
  s_waitcnt lgkmcnt(12)
  v_mfma_f32_32x32x16_bf16 v[32:47], v[52:55], v[128:131], v[32:47]
  buffer_load_dwordx4 v[124:127], v2, s[20:23], s30 offen offset:3072
  s_waitcnt vmcnt(30)
  s_waitcnt lgkmcnt(10)
  v_mfma_f32_32x32x16_bf16 v[16:31], v[56:59], v[132:135], v[16:31]
  s_barrier
  s_waitcnt lgkmcnt(8)
  v_mfma_f32_32x32x16_bf16 v[32:47], v[60:63], v[132:135], v[32:47]
  ds_read_b64_tr_b16 v[48:49], v12 offset:0
  ds_read_b64_tr_b16 v[50:51], v12 offset:1024
  ds_read_b64_tr_b16 v[52:53], v14 offset:0
  ds_read_b64_tr_b16 v[54:55], v14 offset:1024
  s_add_u32 s30, s30, 4096
  buffer_load_dwordx4 v[128:131], v2, s[20:23], s30 offen offset:0
  s_add_u32 m0, s29, 32768
  s_add_u32 s31, s28, 4456448
  buffer_load_dwordx4 v15, s[16:19], s31 offen lds
  s_waitcnt vmcnt(31)
  s_waitcnt lgkmcnt(10)
  v_mfma_f32_32x32x16_bf16 v[16:31], v[64:67], v[136:139], v[16:31]
  ds_read_b64_tr_b16 v[56:57], v12 offset:2048
  ds_read_b64_tr_b16 v[58:59], v12 offset:3072
  ds_read_b64_tr_b16 v[60:61], v14 offset:2048
  ds_read_b64_tr_b16 v[62:63], v14 offset:3072
  s_waitcnt lgkmcnt(12)
  v_mfma_f32_32x32x16_bf16 v[32:47], v[68:71], v[136:139], v[32:47]
  s_add_u32 m0, s29, 33792
  s_add_u32 s31, s28, 4472832
  buffer_load_dwordx4 v15, s[16:19], s31 offen lds
  s_add_u32 m0, s29, 34816
  s_add_u32 s31, s28, 4489216
  buffer_load_dwordx4 v15, s[16:19], s31 offen lds
  s_waitcnt vmcnt(32)
  s_waitcnt lgkmcnt(10)
  v_mfma_f32_32x32x16_bf16 v[16:31], v[72:75], v[140:143], v[16:31]
  ds_read_b64_tr_b16 v[64:65], v12 offset:4096
  ds_read_b64_tr_b16 v[66:67], v12 offset:5120
  ds_read_b64_tr_b16 v[68:69], v14 offset:4096
  ds_read_b64_tr_b16 v[70:71], v14 offset:5120
  s_waitcnt lgkmcnt(12)
  v_mfma_f32_32x32x16_bf16 v[32:47], v[76:79], v[140:143], v[32:47]
  s_add_u32 m0, s29, 35840
  s_add_u32 s31, s28, 4505600
  buffer_load_dwordx4 v15, s[16:19], s31 offen lds
  buffer_load_dwordx4 v[132:135], v2, s[20:23], s30 offen offset:1024
  s_waitcnt vmcnt(33)
  s_waitcnt lgkmcnt(10)
  v_mfma_f32_32x32x16_bf16 v[16:31], v[48:51], v[144:147], v[16:31]
  ds_read_b64_tr_b16 v[72:73], v12 offset:6144
  ds_read_b64_tr_b16 v[74:75], v12 offset:7168
  ds_read_b64_tr_b16 v[76:77], v14 offset:6144
  ds_read_b64_tr_b16 v[78:79], v14 offset:7168
  s_waitcnt lgkmcnt(12)
  v_mfma_f32_32x32x16_bf16 v[32:47], v[52:55], v[144:147], v[32:47]
  buffer_load_dwordx4 v[136:139], v2, s[20:23], s30 offen offset:2048
  buffer_load_dwordx4 v[140:143], v2, s[20:23], s30 offen offset:3072
  s_waitcnt vmcnt(34)
  s_waitcnt lgkmcnt(10)
  v_mfma_f32_32x32x16_bf16 v[16:31], v[56:59], v[148:151], v[16:31]
  ds_read_b64_tr_b16 v[48:49], v12 offset:8192
  ds_read_b64_tr_b16 v[50:51], v12 offset:9216
  ds_read_b64_tr_b16 v[52:53], v14 offset:8192
  ds_read_b64_tr_b16 v[54:55], v14 offset:9216
  s_waitcnt lgkmcnt(12)
  v_mfma_f32_32x32x16_bf16 v[32:47], v[60:63], v[148:151], v[32:47]
  s_add_u32 s30, s30, 4096
  buffer_load_dwordx4 v[144:147], v2, s[20:23], s30 offen offset:0
  s_waitcnt vmcnt(34)
  s_waitcnt lgkmcnt(10)
  v_mfma_f32_32x32x16_bf16 v[16:31], v[64:67], v[152:155], v[16:31]
  ds_read_b64_tr_b16 v[56:57], v12 offset:10240
  ds_read_b64_tr_b16 v[58:59], v12 offset:11264
  ds_read_b64_tr_b16 v[60:61], v14 offset:10240
  ds_read_b64_tr_b16 v[62:63], v14 offset:11264
  s_waitcnt lgkmcnt(12)
  v_mfma_f32_32x32x16_bf16 v[32:47], v[68:71], v[152:155], v[32:47]
  buffer_load_dwordx4 v[148:151], v2, s[20:23], s30 offen offset:1024
  s_waitcnt vmcnt(34)
  s_waitcnt lgkmcnt(10)
  v_mfma_f32_32x32x16_bf16 v[16:31], v[72:75], v[156:159], v[16:31]
  ds_read_b64_tr_b16 v[64:65], v12 offset:12288
  ds_read_b64_tr_b16 v[66:67], v12 offset:13312
  ds_read_b64_tr_b16 v[68:69], v14 offset:12288
  ds_read_b64_tr_b16 v[70:71], v14 offset:13312
  s_waitcnt lgkmcnt(12)
  v_mfma_f32_32x32x16_bf16 v[32:47], v[76:79], v[156:159], v[32:47]
  buffer_load_dwordx4 v[152:155], v2, s[20:23], s30 offen offset:2048
  s_waitcnt vmcnt(34)
  s_waitcnt lgkmcnt(10)
  v_mfma_f32_32x32x16_bf16 v[16:31], v[48:51], v[160:163], v[16:31]
  ds_read_b64_tr_b16 v[72:73], v12 offset:14336
  ds_read_b64_tr_b16 v[74:75], v12 offset:15360
  ds_read_b64_tr_b16 v[76:77], v14 offset:14336
  ds_read_b64_tr_b16 v[78:79], v14 offset:15360
  s_waitcnt lgkmcnt(12)
  v_mfma_f32_32x32x16_bf16 v[32:47], v[52:55], v[160:163], v[32:47]
  buffer_load_dwordx4 v[156:159], v2, s[20:23], s30 offen offset:3072
  s_waitcnt vmcnt(30)
  s_waitcnt lgkmcnt(10)
  v_mfma_f32_32x32x16_bf16 v[16:31], v[56:59], v[164:167], v[16:31]
  s_barrier
  s_waitcnt lgkmcnt(8)
  v_mfma_f32_32x32x16_bf16 v[32:47], v[60:63], v[164:167], v[32:47]
  ds_read_b64_tr_b16 v[48:49], v3 offset:0
  ds_read_b64_tr_b16 v[50:51], v3 offset:1024
  ds_read_b64_tr_b16 v[52:53], v13 offset:0
  ds_read_b64_tr_b16 v[54:55], v13 offset:1024
  s_add_u32 s30, s30, 4096
  buffer_load_dwordx4 v[160:163], v2, s[20:23], s30 offen offset:0
  s_add_u32 m0, s29, 49152
  s_add_u32 s31, s28, 4718592
  buffer_load_dwordx4 v15, s[16:19], s31 offen lds
  s_waitcnt vmcnt(31)
  s_waitcnt lgkmcnt(10)
  v_mfma_f32_32x32x16_bf16 v[16:31], v[64:67], v[168:171], v[16:31]
  ds_read_b64_tr_b16 v[56:57], v3 offset:2048
  ds_read_b64_tr_b16 v[58:59], v3 offset:3072
  ds_read_b64_tr_b16 v[60:61], v13 offset:2048
  ds_read_b64_tr_b16 v[62:63], v13 offset:3072
  s_waitcnt lgkmcnt(12)
  v_mfma_f32_32x32x16_bf16 v[32:47], v[68:71], v[168:171], v[32:47]
  s_add_u32 m0, s29, 50176
  s_add_u32 s31, s28, 4734976
  buffer_load_dwordx4 v15, s[16:19], s31 offen lds
  s_add_u32 m0, s29, 51200
  s_add_u32 s31, s28, 4751360
  buffer_load_dwordx4 v15, s[16:19], s31 offen lds
  s_waitcnt vmcnt(32)
  s_waitcnt lgkmcnt(10)
  v_mfma_f32_32x32x16_bf16 v[16:31], v[72:75], v[172:175], v[16:31]
  ds_read_b64_tr_b16 v[64:65], v3 offset:4096
  ds_read_b64_tr_b16 v[66:67], v3 offset:5120
  ds_read_b64_tr_b16 v[68:69], v13 offset:4096
  ds_read_b64_tr_b16 v[70:71], v13 offset:5120
  s_waitcnt lgkmcnt(12)
  v_mfma_f32_32x32x16_bf16 v[32:47], v[76:79], v[172:175], v[32:47]
  s_add_u32 m0, s29, 52224
  s_add_u32 s31, s28, 4767744
  buffer_load_dwordx4 v15, s[16:19], s31 offen lds
  buffer_load_dwordx4 v[164:167], v2, s[20:23], s30 offen offset:1024
  s_waitcnt vmcnt(33)
  s_waitcnt lgkmcnt(10)
  v_mfma_f32_32x32x16_bf16 v[16:31], v[48:51], v[80:83], v[16:31]
  ds_read_b64_tr_b16 v[72:73], v3 offset:6144
  ds_read_b64_tr_b16 v[74:75], v3 offset:7168
  ds_read_b64_tr_b16 v[76:77], v13 offset:6144
  ds_read_b64_tr_b16 v[78:79], v13 offset:7168
  s_waitcnt lgkmcnt(12)
  v_mfma_f32_32x32x16_bf16 v[32:47], v[52:55], v[80:83], v[32:47]
  buffer_load_dwordx4 v[168:171], v2, s[20:23], s30 offen offset:2048
  buffer_load_dwordx4 v[172:175], v2, s[20:23], s30 offen offset:3072
  s_waitcnt vmcnt(34)
  s_waitcnt lgkmcnt(10)
  v_mfma_f32_32x32x16_bf16 v[16:31], v[56:59], v[84:87], v[16:31]
  ds_read_b64_tr_b16 v[48:49], v3 offset:8192
  ds_read_b64_tr_b16 v[50:51], v3 offset:9216
  ds_read_b64_tr_b16 v[52:53], v13 offset:8192
  ds_read_b64_tr_b16 v[54:55], v13 offset:9216
  s_waitcnt lgkmcnt(12)
  v_mfma_f32_32x32x16_bf16 v[32:47], v[60:63], v[84:87], v[32:47]
  s_add_u32 s30, s30, 4096
  buffer_load_dwordx4 v[80:83], v2, s[20:23], s30 offen offset:0
  s_waitcnt vmcnt(34)
  s_waitcnt lgkmcnt(10)
  v_mfma_f32_32x32x16_bf16 v[16:31], v[64:67], v[88:91], v[16:31]
  ds_read_b64_tr_b16 v[56:57], v3 offset:10240
  ds_read_b64_tr_b16 v[58:59], v3 offset:11264
  ds_read_b64_tr_b16 v[60:61], v13 offset:10240
  ds_read_b64_tr_b16 v[62:63], v13 offset:11264
  s_waitcnt lgkmcnt(12)
  v_mfma_f32_32x32x16_bf16 v[32:47], v[68:71], v[88:91], v[32:47]
  buffer_load_dwordx4 v[84:87], v2, s[20:23], s30 offen offset:1024
  s_waitcnt vmcnt(34)
  s_waitcnt lgkmcnt(10)
  v_mfma_f32_32x32x16_bf16 v[16:31], v[72:75], v[92:95], v[16:31]
  ds_read_b64_tr_b16 v[64:65], v3 offset:12288
  ds_read_b64_tr_b16 v[66:67], v3 offset:13312
  ds_read_b64_tr_b16 v[68:69], v13 offset:12288
  ds_read_b64_tr_b16 v[70:71], v13 offset:13312
  s_waitcnt lgkmcnt(12)
  v_mfma_f32_32x32x16_bf16 v[32:47], v[76:79], v[92:95], v[32:47]
  buffer_load_dwordx4 v[88:91], v2, s[20:23], s30 offen offset:2048
  s_waitcnt vmcnt(34)
  s_waitcnt lgkmcnt(10)
  v_mfma_f32_32x32x16_bf16 v[16:31], v[48:51], v[96:99], v[16:31]
  ds_read_b64_tr_b16 v[72:73], v3 offset:14336
  ds_read_b64_tr_b16 v[74:75], v3 offset:15360
  ds_read_b64_tr_b16 v[76:77], v13 offset:14336
  ds_read_b64_tr_b16 v[78:79], v13 offset:15360
  s_waitcnt lgkmcnt(12)
  v_mfma_f32_32x32x16_bf16 v[32:47], v[52:55], v[96:99], v[32:47]
  buffer_load_dwordx4 v[92:95], v2, s[20:23], s30 offen offset:3072
  s_waitcnt vmcnt(30)
  s_waitcnt lgkmcnt(10)
  v_mfma_f32_32x32x16_bf16 v[16:31], v[56:59], v[100:103], v[16:31]
  s_barrier
  s_waitcnt lgkmcnt(8)
  v_mfma_f32_32x32x16_bf16 v[32:47], v[60:63], v[100:103], v[32:47]
  ds_read_b64_tr_b16 v[48:49], v3 offset:16384
  ds_read_b64_tr_b16 v[50:51], v3 offset:17408
  ds_read_b64_tr_b16 v[52:53], v13 offset:16384
  ds_read_b64_tr_b16 v[54:55], v13 offset:17408
  s_add_u32 s30, s30, 4096
  buffer_load_dwordx4 v[96:99], v2, s[20:23], s30 offen offset:0
  s_add_u32 m0, s29, 65536
  s_add_u32 s31, s28, 4980736
  buffer_load_dwordx4 v15, s[16:19], s31 offen lds
  s_waitcnt vmcnt(31)
  s_waitcnt lgkmcnt(10)
  v_mfma_f32_32x32x16_bf16 v[16:31], v[64:67], v[104:107], v[16:31]
  ds_read_b64_tr_b16 v[56:57], v3 offset:18432
  ds_read_b64_tr_b16 v[58:59], v3 offset:19456
  ds_read_b64_tr_b16 v[60:61], v13 offset:18432
  ds_read_b64_tr_b16 v[62:63], v13 offset:19456
  s_waitcnt lgkmcnt(12)
  v_mfma_f32_32x32x16_bf16 v[32:47], v[68:71], v[104:107], v[32:47]
  s_add_u32 m0, s29, 66560
  s_add_u32 s31, s28, 4997120
  buffer_load_dwordx4 v15, s[16:19], s31 offen lds
  s_add_u32 m0, s29, 67584
  s_add_u32 s31, s28, 5013504
  buffer_load_dwordx4 v15, s[16:19], s31 offen lds
  s_waitcnt vmcnt(32)
  s_waitcnt lgkmcnt(10)
  v_mfma_f32_32x32x16_bf16 v[16:31], v[72:75], v[108:111], v[16:31]
  ds_read_b64_tr_b16 v[64:65], v3 offset:20480
  ds_read_b64_tr_b16 v[66:67], v3 offset:21504
  ds_read_b64_tr_b16 v[68:69], v13 offset:20480
  ds_read_b64_tr_b16 v[70:71], v13 offset:21504
  s_waitcnt lgkmcnt(12)
  v_mfma_f32_32x32x16_bf16 v[32:47], v[76:79], v[108:111], v[32:47]
  s_add_u32 m0, s29, 68608
  s_add_u32 s31, s28, 5029888
  buffer_load_dwordx4 v15, s[16:19], s31 offen lds
  buffer_load_dwordx4 v[100:103], v2, s[20:23], s30 offen offset:1024
  s_waitcnt vmcnt(33)
  s_waitcnt lgkmcnt(10)
  v_mfma_f32_32x32x16_bf16 v[16:31], v[48:51], v[112:115], v[16:31]
  ds_read_b64_tr_b16 v[72:73], v3 offset:22528
  ds_read_b64_tr_b16 v[74:75], v3 offset:23552
  ds_read_b64_tr_b16 v[76:77], v13 offset:22528
  ds_read_b64_tr_b16 v[78:79], v13 offset:23552
  s_waitcnt lgkmcnt(12)
  v_mfma_f32_32x32x16_bf16 v[32:47], v[52:55], v[112:115], v[32:47]
  buffer_load_dwordx4 v[104:107], v2, s[20:23], s30 offen offset:2048
  buffer_load_dwordx4 v[108:111], v2, s[20:23], s30 offen offset:3072
  s_waitcnt vmcnt(34)
  s_waitcnt lgkmcnt(10)
  v_mfma_f32_32x32x16_bf16 v[16:31], v[56:59], v[116:119], v[16:31]
  ds_read_b64_tr_b16 v[48:49], v3 offset:24576
  ds_read_b64_tr_b16 v[50:51], v3 offset:25600
  ds_read_b64_tr_b16 v[52:53], v13 offset:24576
  ds_read_b64_tr_b16 v[54:55], v13 offset:25600
  s_waitcnt lgkmcnt(12)
  v_mfma_f32_32x32x16_bf16 v[32:47], v[60:63], v[116:119], v[32:47]
  s_add_u32 s30, s30, 4096
  buffer_load_dwordx4 v[112:115], v2, s[20:23], s30 offen offset:0
  s_waitcnt vmcnt(34)
  s_waitcnt lgkmcnt(10)
  v_mfma_f32_32x32x16_bf16 v[16:31], v[64:67], v[120:123], v[16:31]
  ds_read_b64_tr_b16 v[56:57], v3 offset:26624
  ds_read_b64_tr_b16 v[58:59], v3 offset:27648
  ds_read_b64_tr_b16 v[60:61], v13 offset:26624
  ds_read_b64_tr_b16 v[62:63], v13 offset:27648
  s_waitcnt lgkmcnt(12)
  v_mfma_f32_32x32x16_bf16 v[32:47], v[68:71], v[120:123], v[32:47]
  buffer_load_dwordx4 v[116:119], v2, s[20:23], s30 offen offset:1024
  s_waitcnt vmcnt(34)
  s_waitcnt lgkmcnt(10)
  v_mfma_f32_32x32x16_bf16 v[16:31], v[72:75], v[124:127], v[16:31]
  ds_read_b64_tr_b16 v[64:65], v3 offset:28672
  ds_read_b64_tr_b16 v[66:67], v3 offset:29696
  ds_read_b64_tr_b16 v[68:69], v13 offset:28672
  ds_read_b64_tr_b16 v[70:71], v13 offset:29696
  s_waitcnt lgkmcnt(12)
  v_mfma_f32_32x32x16_bf16 v[32:47], v[76:79], v[124:127], v[32:47]
  buffer_load_dwordx4 v[120:123], v2, s[20:23], s30 offen offset:2048
  s_waitcnt vmcnt(34)
  s_waitcnt lgkmcnt(10)
  v_mfma_f32_32x32x16_bf16 v[16:31], v[48:51], v[128:131], v[16:31]
  ds_read_b64_tr_b16 v[72:73], v3 offset:30720
  ds_read_b64_tr_b16 v[74:75], v3 offset:31744
  ds_read_b64_tr_b16 v[76:77], v13 offset:30720
  ds_read_b64_tr_b16 v[78:79], v13 offset:31744
  s_waitcnt lgkmcnt(12)
  v_mfma_f32_32x32x16_bf16 v[32:47], v[52:55], v[128:131], v[32:47]
  buffer_load_dwordx4 v[124:127], v2, s[20:23], s30 offen offset:3072
  s_waitcnt vmcnt(30)
  s_waitcnt lgkmcnt(10)
  v_mfma_f32_32x32x16_bf16 v[16:31], v[56:59], v[132:135], v[16:31]
  s_barrier
  s_waitcnt lgkmcnt(8)
  v_mfma_f32_32x32x16_bf16 v[32:47], v[60:63], v[132:135], v[32:47]
  ds_read_b64_tr_b16 v[48:49], v3 offset:32768
  ds_read_b64_tr_b16 v[50:51], v3 offset:33792
  ds_read_b64_tr_b16 v[52:53], v13 offset:32768
  ds_read_b64_tr_b16 v[54:55], v13 offset:33792
  s_add_u32 s30, s30, 4096
  buffer_load_dwordx4 v[128:131], v2, s[20:23], s30 offen offset:0
  s_add_u32 m0, s29, 0
  s_add_u32 s31, s28, 5242880
  buffer_load_dwordx4 v15, s[16:19], s31 offen lds
  s_waitcnt vmcnt(31)
  s_waitcnt lgkmcnt(10)
  v_mfma_f32_32x32x16_bf16 v[16:31], v[64:67], v[136:139], v[16:31]
  ds_read_b64_tr_b16 v[56:57], v3 offset:34816
  ds_read_b64_tr_b16 v[58:59], v3 offset:35840
  ds_read_b64_tr_b16 v[60:61], v13 offset:34816
  ds_read_b64_tr_b16 v[62:63], v13 offset:35840
  s_waitcnt lgkmcnt(12)
  v_mfma_f32_32x32x16_bf16 v[32:47], v[68:71], v[136:139], v[32:47]
  s_add_u32 m0, s29, 1024
  s_add_u32 s31, s28, 5259264
  buffer_load_dwordx4 v15, s[16:19], s31 offen lds
  s_add_u32 m0, s29, 2048
  s_add_u32 s31, s28, 5275648
  buffer_load_dwordx4 v15, s[16:19], s31 offen lds
  s_waitcnt vmcnt(32)
  s_waitcnt lgkmcnt(10)
  v_mfma_f32_32x32x16_bf16 v[16:31], v[72:75], v[140:143], v[16:31]
  ds_read_b64_tr_b16 v[64:65], v3 offset:36864
  ds_read_b64_tr_b16 v[66:67], v3 offset:37888
  ds_read_b64_tr_b16 v[68:69], v13 offset:36864
  ds_read_b64_tr_b16 v[70:71], v13 offset:37888
  s_waitcnt lgkmcnt(12)
  v_mfma_f32_32x32x16_bf16 v[32:47], v[76:79], v[140:143], v[32:47]
  s_add_u32 m0, s29, 3072
  s_add_u32 s31, s28, 5292032
  buffer_load_dwordx4 v15, s[16:19], s31 offen lds
  buffer_load_dwordx4 v[132:135], v2, s[20:23], s30 offen offset:1024
  s_waitcnt vmcnt(33)
  s_waitcnt lgkmcnt(10)
  v_mfma_f32_32x32x16_bf16 v[16:31], v[48:51], v[144:147], v[16:31]
  ds_read_b64_tr_b16 v[72:73], v3 offset:38912
  ds_read_b64_tr_b16 v[74:75], v3 offset:39936
  ds_read_b64_tr_b16 v[76:77], v13 offset:38912
  ds_read_b64_tr_b16 v[78:79], v13 offset:39936
  s_waitcnt lgkmcnt(12)
  v_mfma_f32_32x32x16_bf16 v[32:47], v[52:55], v[144:147], v[32:47]
  buffer_load_dwordx4 v[136:139], v2, s[20:23], s30 offen offset:2048
  buffer_load_dwordx4 v[140:143], v2, s[20:23], s30 offen offset:3072
  s_waitcnt vmcnt(34)
  s_waitcnt lgkmcnt(10)
  v_mfma_f32_32x32x16_bf16 v[16:31], v[56:59], v[148:151], v[16:31]
  ds_read_b64_tr_b16 v[48:49], v3 offset:40960
  ds_read_b64_tr_b16 v[50:51], v3 offset:41984
  ds_read_b64_tr_b16 v[52:53], v13 offset:40960
  ds_read_b64_tr_b16 v[54:55], v13 offset:41984
  s_waitcnt lgkmcnt(12)
  v_mfma_f32_32x32x16_bf16 v[32:47], v[60:63], v[148:151], v[32:47]
  s_add_u32 s30, s30, 4096
  buffer_load_dwordx4 v[144:147], v2, s[20:23], s30 offen offset:0
  s_waitcnt vmcnt(34)
  s_waitcnt lgkmcnt(10)
  v_mfma_f32_32x32x16_bf16 v[16:31], v[64:67], v[152:155], v[16:31]
  ds_read_b64_tr_b16 v[56:57], v3 offset:43008
  ds_read_b64_tr_b16 v[58:59], v3 offset:44032
  ds_read_b64_tr_b16 v[60:61], v13 offset:43008
  ds_read_b64_tr_b16 v[62:63], v13 offset:44032
  s_waitcnt lgkmcnt(12)
  v_mfma_f32_32x32x16_bf16 v[32:47], v[68:71], v[152:155], v[32:47]
  buffer_load_dwordx4 v[148:151], v2, s[20:23], s30 offen offset:1024
  s_waitcnt vmcnt(34)
  s_waitcnt lgkmcnt(10)
  v_mfma_f32_32x32x16_bf16 v[16:31], v[72:75], v[156:159], v[16:31]
  ds_read_b64_tr_b16 v[64:65], v3 offset:45056
  ds_read_b64_tr_b16 v[66:67], v3 offset:46080
  ds_read_b64_tr_b16 v[68:69], v13 offset:45056
  ds_read_b64_tr_b16 v[70:71], v13 offset:46080
  s_waitcnt lgkmcnt(12)
  v_mfma_f32_32x32x16_bf16 v[32:47], v[76:79], v[156:159], v[32:47]
  buffer_load_dwordx4 v[152:155], v2, s[20:23], s30 offen offset:2048
  s_waitcnt vmcnt(34)
  s_waitcnt lgkmcnt(10)
  v_mfma_f32_32x32x16_bf16 v[16:31], v[48:51], v[160:163], v[16:31]
  ds_read_b64_tr_b16 v[72:73], v3 offset:47104
  ds_read_b64_tr_b16 v[74:75], v3 offset:48128
  ds_read_b64_tr_b16 v[76:77], v13 offset:47104
  ds_read_b64_tr_b16 v[78:79], v13 offset:48128
  s_waitcnt lgkmcnt(12)
  v_mfma_f32_32x32x16_bf16 v[32:47], v[52:55], v[160:163], v[32:47]
  buffer_load_dwordx4 v[156:159], v2, s[20:23], s30 offen offset:3072
  s_waitcnt vmcnt(30)
  s_waitcnt lgkmcnt(10)
  v_mfma_f32_32x32x16_bf16 v[16:31], v[56:59], v[164:167], v[16:31]
  s_barrier
  s_waitcnt lgkmcnt(8)
  v_mfma_f32_32x32x16_bf16 v[32:47], v[60:63], v[164:167], v[32:47]
  ds_read_b64_tr_b16 v[48:49], v3 offset:49152
  ds_read_b64_tr_b16 v[50:51], v3 offset:50176
  ds_read_b64_tr_b16 v[52:53], v13 offset:49152
  ds_read_b64_tr_b16 v[54:55], v13 offset:50176
  s_add_u32 s30, s30, 4096
  buffer_load_dwordx4 v[160:163], v2, s[20:23], s30 offen offset:0
  s_add_u32 m0, s29, 16384
  s_add_u32 s31, s28, 5505024
  buffer_load_dwordx4 v15, s[16:19], s31 offen lds
  s_waitcnt vmcnt(31)
  s_waitcnt lgkmcnt(10)
  v_mfma_f32_32x32x16_bf16 v[16:31], v[64:67], v[168:171], v[16:31]
  ds_read_b64_tr_b16 v[56:57], v3 offset:51200
  ds_read_b64_tr_b16 v[58:59], v3 offset:52224
  ds_read_b64_tr_b16 v[60:61], v13 offset:51200
  ds_read_b64_tr_b16 v[62:63], v13 offset:52224
  s_waitcnt lgkmcnt(12)
  v_mfma_f32_32x32x16_bf16 v[32:47], v[68:71], v[168:171], v[32:47]
  s_add_u32 m0, s29, 17408
  s_add_u32 s31, s28, 5521408
  buffer_load_dwordx4 v15, s[16:19], s31 offen lds
  s_add_u32 m0, s29, 18432
  s_add_u32 s31, s28, 5537792
  buffer_load_dwordx4 v15, s[16:19], s31 offen lds
  s_waitcnt vmcnt(32)
  s_waitcnt lgkmcnt(10)
  v_mfma_f32_32x32x16_bf16 v[16:31], v[72:75], v[172:175], v[16:31]
  ds_read_b64_tr_b16 v[64:65], v3 offset:53248
  ds_read_b64_tr_b16 v[66:67], v3 offset:54272
  ds_read_b64_tr_b16 v[68:69], v13 offset:53248
  ds_read_b64_tr_b16 v[70:71], v13 offset:54272
  s_waitcnt lgkmcnt(12)
  v_mfma_f32_32x32x16_bf16 v[32:47], v[76:79], v[172:175], v[32:47]
  s_add_u32 m0, s29, 19456
  s_add_u32 s31, s28, 5554176
  buffer_load_dwordx4 v15, s[16:19], s31 offen lds
  buffer_load_dwordx4 v[164:167], v2, s[20:23], s30 offen offset:1024
  s_waitcnt vmcnt(33)
  s_waitcnt lgkmcnt(10)
  v_mfma_f32_32x32x16_bf16 v[16:31], v[48:51], v[80:83], v[16:31]
  ds_read_b64_tr_b16 v[72:73], v3 offset:55296
  ds_read_b64_tr_b16 v[74:75], v3 offset:56320
  ds_read_b64_tr_b16 v[76:77], v13 offset:55296
  ds_read_b64_tr_b16 v[78:79], v13 offset:56320
  s_waitcnt lgkmcnt(12)
  v_mfma_f32_32x32x16_bf16 v[32:47], v[52:55], v[80:83], v[32:47]
  buffer_load_dwordx4 v[168:171], v2, s[20:23], s30 offen offset:2048
  buffer_load_dwordx4 v[172:175], v2, s[20:23], s30 offen offset:3072
  s_waitcnt vmcnt(34)
  s_waitcnt lgkmcnt(10)
  v_mfma_f32_32x32x16_bf16 v[16:31], v[56:59], v[84:87], v[16:31]
  ds_read_b64_tr_b16 v[48:49], v3 offset:57344
  ds_read_b64_tr_b16 v[50:51], v3 offset:58368
  ds_read_b64_tr_b16 v[52:53], v13 offset:57344
  ds_read_b64_tr_b16 v[54:55], v13 offset:58368
  s_waitcnt lgkmcnt(12)
  v_mfma_f32_32x32x16_bf16 v[32:47], v[60:63], v[84:87], v[32:47]
  s_add_u32 s30, s30, 4096
  buffer_load_dwordx4 v[80:83], v2, s[20:23], s30 offen offset:0
  s_waitcnt vmcnt(34)
  s_waitcnt lgkmcnt(10)
  v_mfma_f32_32x32x16_bf16 v[16:31], v[64:67], v[88:91], v[16:31]
  ds_read_b64_tr_b16 v[56:57], v3 offset:59392
  ds_read_b64_tr_b16 v[58:59], v3 offset:60416
  ds_read_b64_tr_b16 v[60:61], v13 offset:59392
  ds_read_b64_tr_b16 v[62:63], v13 offset:60416
  s_waitcnt lgkmcnt(12)
  v_mfma_f32_32x32x16_bf16 v[32:47], v[68:71], v[88:91], v[32:47]
  buffer_load_dwordx4 v[84:87], v2, s[20:23], s30 offen offset:1024
  s_waitcnt vmcnt(34)
  s_waitcnt lgkmcnt(10)
  v_mfma_f32_32x32x16_bf16 v[16:31], v[72:75], v[92:95], v[16:31]
  ds_read_b64_tr_b16 v[64:65], v3 offset:61440
  ds_read_b64_tr_b16 v[66:67], v3 offset:62464
  ds_read_b64_tr_b16 v[68:69], v13 offset:61440
  ds_read_b64_tr_b16 v[70:71], v13 offset:62464
  s_waitcnt lgkmcnt(12)
  v_mfma_f32_32x32x16_bf16 v[32:47], v[76:79], v[92:95], v[32:47]
  buffer_load_dwordx4 v[88:91], v2, s[20:23], s30 offen offset:2048
  s_waitcnt vmcnt(34)
  s_waitcnt lgkmcnt(10)
  v_mfma_f32_32x32x16_bf16 v[16:31], v[48:51], v[96:99], v[16:31]
  ds_read_b64_tr_b16 v[72:73], v3 offset:63488
  ds_read_b64_tr_b16 v[74:75], v3 offset:64512
  ds_read_b64_tr_b16 v[76:77], v13 offset:63488
  ds_read_b64_tr_b16 v[78:79], v13 offset:64512
  s_waitcnt lgkmcnt(12)
  v_mfma_f32_32x32x16_bf16 v[32:47], v[52:55], v[96:99], v[32:47]
  buffer_load_dwordx4 v[92:95], v2, s[20:23], s30 offen offset:3072
  s_waitcnt vmcnt(30)
  s_waitcnt lgkmcnt(10)
  v_mfma_f32_32x32x16_bf16 v[16:31], v[56:59], v[100:103], v[16:31]
  s_barrier
  s_waitcnt lgkmcnt(8)
  v_mfma_f32_32x32x16_bf16 v[32:47], v[60:63], v[100:103], v[32:47]
  ds_read_b64_tr_b16 v[48:49], v12 offset:0
  ds_read_b64_tr_b16 v[50:51], v12 offset:1024
  ds_read_b64_tr_b16 v[52:53], v14 offset:0
  ds_read_b64_tr_b16 v[54:55], v14 offset:1024
  s_add_u32 s30, s30, 4096
  buffer_load_dwordx4 v[96:99], v2, s[20:23], s30 offen offset:0
  s_add_u32 m0, s29, 32768
  s_add_u32 s31, s28, 5767168
  buffer_load_dwordx4 v15, s[16:19], s31 offen lds
  s_waitcnt vmcnt(31)
  s_waitcnt lgkmcnt(10)
  v_mfma_f32_32x32x16_bf16 v[16:31], v[64:67], v[104:107], v[16:31]
  ds_read_b64_tr_b16 v[56:57], v12 offset:2048
  ds_read_b64_tr_b16 v[58:59], v12 offset:3072
  ds_read_b64_tr_b16 v[60:61], v14 offset:2048
  ds_read_b64_tr_b16 v[62:63], v14 offset:3072
  s_add_u32 m0, s29, 33792
  s_add_u32 s31, s28, 5783552
  buffer_load_dwordx4 v15, s[16:19], s31 offen lds
  s_waitcnt lgkmcnt(12)
  v_mfma_f32_32x32x16_bf16 v[32:47], v[68:71], v[104:107], v[32:47]
  s_add_u32 m0, s29, 34816
  s_add_u32 s31, s28, 5799936
  buffer_load_dwordx4 v15, s[16:19], s31 offen lds
  buffer_load_dwordx4 v[176:179], v2, s[36:39], s34 offen offset:0
  s_waitcnt vmcnt(33)
  s_waitcnt lgkmcnt(10)
  v_mfma_f32_32x32x16_bf16 v[16:31], v[72:75], v[108:111], v[16:31]
  ds_read_b64_tr_b16 v[64:65], v12 offset:4096
  ds_read_b64_tr_b16 v[66:67], v12 offset:5120
  ds_read_b64_tr_b16 v[68:69], v14 offset:4096
  ds_read_b64_tr_b16 v[70:71], v14 offset:5120
  s_add_u32 m0, s29, 35840
  s_add_u32 s31, s28, 5816320
  buffer_load_dwordx4 v15, s[16:19], s31 offen lds
  s_waitcnt lgkmcnt(12)
  v_mfma_f32_32x32x16_bf16 v[32:47], v[76:79], v[108:111], v[32:47]
  buffer_load_dwordx4 v[100:103], v2, s[20:23], s30 offen offset:1024
  buffer_load_dwordx4 v[180:183], v2, s[36:39], s34 offen offset:1024
  s_waitcnt vmcnt(35)
  s_waitcnt lgkmcnt(10)
  v_mfma_f32_32x32x16_bf16 v[16:31], v[48:51], v[112:115], v[16:31]
  ds_read_b64_tr_b16 v[72:73], v12 offset:6144
  ds_read_b64_tr_b16 v[74:75], v12 offset:7168
  ds_read_b64_tr_b16 v[76:77], v14 offset:6144
  ds_read_b64_tr_b16 v[78:79], v14 offset:7168
  buffer_load_dwordx4 v[104:107], v2, s[20:23], s30 offen offset:2048
  s_waitcnt lgkmcnt(12)
  v_mfma_f32_32x32x16_bf16 v[32:47], v[52:55], v[112:115], v[32:47]
  buffer_load_dwordx4 v[108:111], v2, s[20:23], s30 offen offset:3072
  buffer_load_dwordx4 v[184:187], v2, s[36:39], s34 offen offset:2048
  s_waitcnt vmcnt(37)
  s_waitcnt lgkmcnt(10)
  v_mfma_f32_32x32x16_bf16 v[16:31], v[56:59], v[116:119], v[16:31]
  ds_read_b64_tr_b16 v[48:49], v12 offset:8192
  ds_read_b64_tr_b16 v[50:51], v12 offset:9216
  ds_read_b64_tr_b16 v[52:53], v14 offset:8192
  ds_read_b64_tr_b16 v[54:55], v14 offset:9216
  s_waitcnt lgkmcnt(12)
  v_mfma_f32_32x32x16_bf16 v[32:47], v[60:63], v[116:119], v[32:47]
  s_add_u32 s30, s30, 4096
  buffer_load_dwordx4 v[112:115], v2, s[20:23], s30 offen offset:0
  buffer_load_dwordx4 v[188:191], v2, s[36:39], s34 offen offset:3072
  s_waitcnt vmcnt(38)
  s_waitcnt lgkmcnt(10)
  v_mfma_f32_32x32x16_bf16 v[16:31], v[64:67], v[120:123], v[16:31]
  ds_read_b64_tr_b16 v[56:57], v12 offset:10240
  ds_read_b64_tr_b16 v[58:59], v12 offset:11264
  ds_read_b64_tr_b16 v[60:61], v14 offset:10240
  ds_read_b64_tr_b16 v[62:63], v14 offset:11264
  s_waitcnt lgkmcnt(12)
  v_mfma_f32_32x32x16_bf16 v[32:47], v[68:71], v[120:123], v[32:47]
  buffer_load_dwordx4 v[116:119], v2, s[20:23], s30 offen offset:1024
  s_mov_b32 m0, 81920
  s_nop 0
  buffer_load_dwordx4 v9, s[40:43], s48 offen lds
  s_waitcnt vmcnt(39)
  s_waitcnt lgkmcnt(10)
  v_mfma_f32_32x32x16_bf16 v[16:31], v[72:75], v[124:127], v[16:31]
  ds_read_b64_tr_b16 v[64:65], v12 offset:12288
  ds_read_b64_tr_b16 v[66:67], v12 offset:13312
  ds_read_b64_tr_b16 v[68:69], v14 offset:12288
  ds_read_b64_tr_b16 v[70:71], v14 offset:13312
  s_waitcnt lgkmcnt(12)
  v_mfma_f32_32x32x16_bf16 v[32:47], v[76:79], v[124:127], v[32:47]
  buffer_load_dwordx4 v[120:123], v2, s[20:23], s30 offen offset:2048
  buffer_load_dword v11, v4, s[44:47], s49 offen sc1
  s_waitcnt vmcnt(40)
  s_waitcnt lgkmcnt(10)
  v_mfma_f32_32x32x16_bf16 v[16:31], v[48:51], v[128:131], v[16:31]
  ds_read_b64_tr_b16 v[72:73], v12 offset:14336
  ds_read_b64_tr_b16 v[74:75], v12 offset:15360
  ds_read_b64_tr_b16 v[76:77], v14 offset:14336
  ds_read_b64_tr_b16 v[78:79], v14 offset:15360
  s_waitcnt lgkmcnt(12)
  v_mfma_f32_32x32x16_bf16 v[32:47], v[52:55], v[128:131], v[32:47]
  buffer_load_dwordx4 v[124:127], v2, s[20:23], s30 offen offset:3072
  s_waitcnt vmcnt(36)
  s_waitcnt lgkmcnt(10)
  v_mfma_f32_32x32x16_bf16 v[16:31], v[56:59], v[132:135], v[16:31]
  s_barrier
  s_waitcnt lgkmcnt(8)
  v_mfma_f32_32x32x16_bf16 v[32:47], v[60:63], v[132:135], v[32:47]
  ds_read_b64_tr_b16 v[48:49], v3 offset:0
  ds_read_b64_tr_b16 v[50:51], v3 offset:1024
  ds_read_b64_tr_b16 v[52:53], v13 offset:0
  ds_read_b64_tr_b16 v[54:55], v13 offset:1024
  s_add_u32 s30, s30, 4096
  buffer_load_dwordx4 v[128:131], v2, s[20:23], s30 offen offset:0
  s_add_u32 m0, s29, 49152
  s_add_u32 s31, s28, 6029312
  buffer_load_dwordx4 v15, s[16:19], s31 offen lds
  s_waitcnt vmcnt(37)
  s_waitcnt lgkmcnt(10)
  v_mfma_f32_32x32x16_bf16 v[16:31], v[64:67], v[136:139], v[16:31]
  ds_read_b64_tr_b16 v[56:57], v3 offset:2048
  ds_read_b64_tr_b16 v[58:59], v3 offset:3072
  ds_read_b64_tr_b16 v[60:61], v13 offset:2048
  ds_read_b64_tr_b16 v[62:63], v13 offset:3072
  s_waitcnt lgkmcnt(12)
  v_mfma_f32_32x32x16_bf16 v[32:47], v[68:71], v[136:139], v[32:47]
  s_add_u32 m0, s29, 50176
  s_add_u32 s31, s28, 6045696
  buffer_load_dwordx4 v15, s[16:19], s31 offen lds
  s_add_u32 m0, s29, 51200
  s_add_u32 s31, s28, 6062080
  buffer_load_dwordx4 v15, s[16:19], s31 offen lds
  s_waitcnt vmcnt(38)
  s_waitcnt lgkmcnt(10)
  v_mfma_f32_32x32x16_bf16 v[16:31], v[72:75], v[140:143], v[16:31]
  ds_read_b64_tr_b16 v[64:65], v3 offset:4096
  ds_read_b64_tr_b16 v[66:67], v3 offset:5120
  ds_read_b64_tr_b16 v[68:69], v13 offset:4096
  ds_read_b64_tr_b16 v[70:71], v13 offset:5120
  s_waitcnt lgkmcnt(12)
  v_mfma_f32_32x32x16_bf16 v[32:47], v[76:79], v[140:143], v[32:47]
  s_add_u32 m0, s29, 52224
  s_add_u32 s31, s28, 6078464
  buffer_load_dwordx4 v15, s[16:19], s31 offen lds
  buffer_load_dwordx4 v[132:135], v2, s[20:23], s30 offen offset:1024
  s_waitcnt vmcnt(39)
  s_waitcnt lgkmcnt(10)
  v_mfma_f32_32x32x16_bf16 v[16:31], v[48:51], v[144:147], v[16:31]
  ds_read_b64_tr_b16 v[72:73], v3 offset:6144
  ds_read_b64_tr_b16 v[74:75], v3 offset:7168
  ds_read_b64_tr_b16 v[76:77], v13 offset:6144
  ds_read_b64_tr_b16 v[78:79], v13 offset:7168
  s_waitcnt lgkmcnt(12)
  v_mfma_f32_32x32x16_bf16 v[32:47], v[52:55], v[144:147], v[32:47]
  buffer_load_dwordx4 v[136:139], v2, s[20:23], s30 offen offset:2048
  buffer_load_dwordx4 v[140:143], v2, s[20:23], s30 offen offset:3072
  s_waitcnt vmcnt(40)
  s_waitcnt lgkmcnt(10)
  v_mfma_f32_32x32x16_bf16 v[16:31], v[56:59], v[148:151], v[16:31]
  ds_read_b64_tr_b16 v[48:49], v3 offset:8192
  ds_read_b64_tr_b16 v[50:51], v3 offset:9216
  ds_read_b64_tr_b16 v[52:53], v13 offset:8192
  ds_read_b64_tr_b16 v[54:55], v13 offset:9216
  s_waitcnt lgkmcnt(12)
  v_mfma_f32_32x32x16_bf16 v[32:47], v[60:63], v[148:151], v[32:47]
  s_add_u32 s30, s30, 4096
  buffer_load_dwordx4 v[144:147], v2, s[20:23], s30 offen offset:0
  s_waitcnt vmcnt(40)
  s_waitcnt lgkmcnt(10)
  v_mfma_f32_32x32x16_bf16 v[16:31], v[64:67], v[152:155], v[16:31]
  ds_read_b64_tr_b16 v[56:57], v3 offset:10240
  ds_read_b64_tr_b16 v[58:59], v3 offset:11264
  ds_read_b64_tr_b16 v[60:61], v13 offset:10240
  ds_read_b64_tr_b16 v[62:63], v13 offset:11264
  s_waitcnt lgkmcnt(12)
  v_mfma_f32_32x32x16_bf16 v[32:47], v[68:71], v[152:155], v[32:47]
  buffer_load_dwordx4 v[148:151], v2, s[20:23], s30 offen offset:1024
  s_waitcnt vmcnt(40)
  s_waitcnt lgkmcnt(10)
  v_mfma_f32_32x32x16_bf16 v[16:31], v[72:75], v[156:159], v[16:31]
  ds_read_b64_tr_b16 v[64:65], v3 offset:12288
  ds_read_b64_tr_b16 v[66:67], v3 offset:13312
  ds_read_b64_tr_b16 v[68:69], v13 offset:12288
  ds_read_b64_tr_b16 v[70:71], v13 offset:13312
  s_waitcnt lgkmcnt(12)
  v_mfma_f32_32x32x16_bf16 v[32:47], v[76:79], v[156:159], v[32:47]
  buffer_load_dwordx4 v[152:155], v2, s[20:23], s30 offen offset:2048
  s_waitcnt vmcnt(40)
  s_waitcnt lgkmcnt(10)
  v_mfma_f32_32x32x16_bf16 v[16:31], v[48:51], v[160:163], v[16:31]
  ds_read_b64_tr_b16 v[72:73], v3 offset:14336
  ds_read_b64_tr_b16 v[74:75], v3 offset:15360
  ds_read_b64_tr_b16 v[76:77], v13 offset:14336
  ds_read_b64_tr_b16 v[78:79], v13 offset:15360
  s_waitcnt lgkmcnt(12)
  v_mfma_f32_32x32x16_bf16 v[32:47], v[52:55], v[160:163], v[32:47]
  buffer_load_dwordx4 v[156:159], v2, s[20:23], s30 offen offset:3072
  s_waitcnt vmcnt(36)
  s_waitcnt lgkmcnt(10)
  v_mfma_f32_32x32x16_bf16 v[16:31], v[56:59], v[164:167], v[16:31]
  s_barrier
  s_waitcnt lgkmcnt(8)
  v_mfma_f32_32x32x16_bf16 v[32:47], v[60:63], v[164:167], v[32:47]
  ds_read_b64_tr_b16 v[48:49], v3 offset:16384
  ds_read_b64_tr_b16 v[50:51], v3 offset:17408
  ds_read_b64_tr_b16 v[52:53], v13 offset:16384
  ds_read_b64_tr_b16 v[54:55], v13 offset:17408
  s_add_u32 s30, s30, 4096
  buffer_load_dwordx4 v[160:163], v2, s[20:23], s30 offen offset:0
  s_add_u32 m0, s29, 65536
  s_add_u32 s31, s28, 6291456
  buffer_load_dwordx4 v15, s[16:19], s31 offen lds
  s_waitcnt vmcnt(37)
  s_waitcnt lgkmcnt(10)
  v_mfma_f32_32x32x16_bf16 v[16:31], v[64:67], v[168:171], v[16:31]
  ds_read_b64_tr_b16 v[56:57], v3 offset:18432
  ds_read_b64_tr_b16 v[58:59], v3 offset:19456
  ds_read_b64_tr_b16 v[60:61], v13 offset:18432
  ds_read_b64_tr_b16 v[62:63], v13 offset:19456
  s_waitcnt lgkmcnt(12)
  v_mfma_f32_32x32x16_bf16 v[32:47], v[68:71], v[168:171], v[32:47]
  s_add_u32 m0, s29, 66560
  s_add_u32 s31, s28, 6307840
  buffer_load_dwordx4 v15, s[16:19], s31 offen lds
  s_add_u32 m0, s29, 67584
  s_add_u32 s31, s28, 6324224
  buffer_load_dwordx4 v15, s[16:19], s31 offen lds
  s_waitcnt vmcnt(38)
  s_waitcnt lgkmcnt(10)
  v_mfma_f32_32x32x16_bf16 v[16:31], v[72:75], v[172:175], v[16:31]
  ds_read_b64_tr_b16 v[64:65], v3 offset:20480
  ds_read_b64_tr_b16 v[66:67], v3 offset:21504
  ds_read_b64_tr_b16 v[68:69], v13 offset:20480
  ds_read_b64_tr_b16 v[70:71], v13 offset:21504
  s_waitcnt lgkmcnt(12)
  v_mfma_f32_32x32x16_bf16 v[32:47], v[76:79], v[172:175], v[32:47]
  s_add_u32 m0, s29, 68608
  s_add_u32 s31, s28, 6340608
  buffer_load_dwordx4 v15, s[16:19], s31 offen lds
  buffer_load_dwordx4 v[164:167], v2, s[20:23], s30 offen offset:1024
  s_waitcnt vmcnt(39)
  s_waitcnt lgkmcnt(10)
  v_mfma_f32_32x32x16_bf16 v[16:31], v[48:51], v[80:83], v[16:31]
  ds_read_b64_tr_b16 v[72:73], v3 offset:22528
  ds_read_b64_tr_b16 v[74:75], v3 offset:23552
  ds_read_b64_tr_b16 v[76:77], v13 offset:22528
  ds_read_b64_tr_b16 v[78:79], v13 offset:23552
  s_waitcnt lgkmcnt(12)
  v_mfma_f32_32x32x16_bf16 v[32:47], v[52:55], v[80:83], v[32:47]
  buffer_load_dwordx4 v[168:171], v2, s[20:23], s30 offen offset:2048
  buffer_load_dwordx4 v[172:175], v2, s[20:23], s30 offen offset:3072
  s_waitcnt vmcnt(40)
  s_waitcnt lgkmcnt(10)
  v_mfma_f32_32x32x16_bf16 v[16:31], v[56:59], v[84:87], v[16:31]
  ds_read_b64_tr_b16 v[48:49], v3 offset:24576
  ds_read_b64_tr_b16 v[50:51], v3 offset:25600
  ds_read_b64_tr_b16 v[52:53], v13 offset:24576
  ds_read_b64_tr_b16 v[54:55], v13 offset:25600
  s_waitcnt lgkmcnt(12)
  v_mfma_f32_32x32x16_bf16 v[32:47], v[60:63], v[84:87], v[32:47]
  s_add_u32 s30, s30, 4096
  buffer_load_dwordx4 v[80:83], v2, s[20:23], s30 offen offset:0
  s_waitcnt vmcnt(40)
  s_waitcnt lgkmcnt(10)
  v_mfma_f32_32x32x16_bf16 v[16:31], v[64:67], v[88:91], v[16:31]
  ds_read_b64_tr_b16 v[56:57], v3 offset:26624
  ds_read_b64_tr_b16 v[58:59], v3 offset:27648
  ds_read_b64_tr_b16 v[60:61], v13 offset:26624
  ds_read_b64_tr_b16 v[62:63], v13 offset:27648
  s_waitcnt lgkmcnt(12)
  v_mfma_f32_32x32x16_bf16 v[32:47], v[68:71], v[88:91], v[32:47]
  buffer_load_dwordx4 v[84:87], v2, s[20:23], s30 offen offset:1024
  s_waitcnt vmcnt(40)
  s_waitcnt lgkmcnt(10)
  v_mfma_f32_32x32x16_bf16 v[16:31], v[72:75], v[92:95], v[16:31]
  ds_read_b64_tr_b16 v[64:65], v3 offset:28672
  ds_read_b64_tr_b16 v[66:67], v3 offset:29696
  ds_read_b64_tr_b16 v[68:69], v13 offset:28672
  ds_read_b64_tr_b16 v[70:71], v13 offset:29696
  s_waitcnt lgkmcnt(12)
  v_mfma_f32_32x32x16_bf16 v[32:47], v[76:79], v[92:95], v[32:47]
  buffer_load_dwordx4 v[88:91], v2, s[20:23], s30 offen offset:2048
  s_waitcnt vmcnt(40)
  s_waitcnt lgkmcnt(10)
  v_mfma_f32_32x32x16_bf16 v[16:31], v[48:51], v[96:99], v[16:31]
  ds_read_b64_tr_b16 v[72:73], v3 offset:30720
  ds_read_b64_tr_b16 v[74:75], v3 offset:31744
  ds_read_b64_tr_b16 v[76:77], v13 offset:30720
  ds_read_b64_tr_b16 v[78:79], v13 offset:31744
  s_waitcnt lgkmcnt(12)
  v_mfma_f32_32x32x16_bf16 v[32:47], v[52:55], v[96:99], v[32:47]
  buffer_load_dwordx4 v[92:95], v2, s[20:23], s30 offen offset:3072
  s_waitcnt vmcnt(35)
  s_waitcnt lgkmcnt(10)
  v_mfma_f32_32x32x16_bf16 v[16:31], v[56:59], v[100:103], v[16:31]
  s_barrier
  s_waitcnt lgkmcnt(8)
  v_mfma_f32_32x32x16_bf16 v[32:47], v[60:63], v[100:103], v[32:47]
  ds_read_b64_tr_b16 v[48:49], v3 offset:32768
  ds_read_b64_tr_b16 v[50:51], v3 offset:33792
  ds_read_b64_tr_b16 v[52:53], v13 offset:32768
  ds_read_b64_tr_b16 v[54:55], v13 offset:33792
  s_add_u32 s30, s30, 4096
  buffer_load_dwordx4 v[96:99], v2, s[20:23], s30 offen offset:0
  s_add_u32 m0, s29, 0
  s_add_u32 s31, s28, 6553600
  buffer_load_dwordx4 v15, s[16:19], s31 offen lds
  s_waitcnt vmcnt(35)
  s_waitcnt lgkmcnt(10)
  v_mfma_f32_32x32x16_bf16 v[16:31], v[64:67], v[104:107], v[16:31]
  ds_read_b64_tr_b16 v[56:57], v3 offset:34816
  ds_read_b64_tr_b16 v[58:59], v3 offset:35840
  ds_read_b64_tr_b16 v[60:61], v13 offset:34816
  ds_read_b64_tr_b16 v[62:63], v13 offset:35840
  s_waitcnt lgkmcnt(12)
  v_mfma_f32_32x32x16_bf16 v[32:47], v[68:71], v[104:107], v[32:47]
  s_add_u32 m0, s29, 1024
  s_add_u32 s31, s28, 6569984
  buffer_load_dwordx4 v15, s[16:19], s31 offen lds
  s_add_u32 m0, s29, 2048
  s_add_u32 s31, s28, 6586368
  buffer_load_dwordx4 v15, s[16:19], s31 offen lds
  s_waitcnt vmcnt(36)
  s_waitcnt lgkmcnt(10)
  v_mfma_f32_32x32x16_bf16 v[16:31], v[72:75], v[108:111], v[16:31]
  ds_read_b64_tr_b16 v[64:65], v3 offset:36864
  ds_read_b64_tr_b16 v[66:67], v3 offset:37888
  ds_read_b64_tr_b16 v[68:69], v13 offset:36864
  ds_read_b64_tr_b16 v[70:71], v13 offset:37888
  s_waitcnt lgkmcnt(12)
  v_mfma_f32_32x32x16_bf16 v[32:47], v[76:79], v[108:111], v[32:47]
  s_add_u32 m0, s29, 3072
  s_add_u32 s31, s28, 6602752
  buffer_load_dwordx4 v15, s[16:19], s31 offen lds
  buffer_load_dwordx4 v[100:103], v2, s[20:23], s30 offen offset:1024
  s_waitcnt vmcnt(36)
  s_waitcnt lgkmcnt(10)
  v_mfma_f32_32x32x16_bf16 v[16:31], v[48:51], v[112:115], v[16:31]
  ds_read_b64_tr_b16 v[72:73], v3 offset:38912
  ds_read_b64_tr_b16 v[74:75], v3 offset:39936
  ds_read_b64_tr_b16 v[76:77], v13 offset:38912
  ds_read_b64_tr_b16 v[78:79], v13 offset:39936
  s_waitcnt lgkmcnt(12)
  v_mfma_f32_32x32x16_bf16 v[32:47], v[52:55], v[112:115], v[32:47]
  buffer_load_dwordx4 v[104:107], v2, s[20:23], s30 offen offset:2048
  buffer_load_dwordx4 v[108:111], v2, s[20:23], s30 offen offset:3072
  s_waitcnt vmcnt(36)
  s_waitcnt lgkmcnt(10)
  v_mfma_f32_32x32x16_bf16 v[16:31], v[56:59], v[116:119], v[16:31]
  ds_read_b64_tr_b16 v[48:49], v3 offset:40960
  ds_read_b64_tr_b16 v[50:51], v3 offset:41984
  ds_read_b64_tr_b16 v[52:53], v13 offset:40960
  ds_read_b64_tr_b16 v[54:55], v13 offset:41984
  s_waitcnt lgkmcnt(12)
  v_mfma_f32_32x32x16_bf16 v[32:47], v[60:63], v[116:119], v[32:47]
  s_add_u32 s30, s30, 4096
  buffer_load_dwordx4 v[112:115], v2, s[20:23], s30 offen offset:0
  s_waitcnt vmcnt(35)
  s_waitcnt lgkmcnt(10)
  v_mfma_f32_32x32x16_bf16 v[16:31], v[64:67], v[120:123], v[16:31]
  ds_read_b64_tr_b16 v[56:57], v3 offset:43008
  ds_read_b64_tr_b16 v[58:59], v3 offset:44032
  ds_read_b64_tr_b16 v[60:61], v13 offset:43008
  ds_read_b64_tr_b16 v[62:63], v13 offset:44032
  s_waitcnt lgkmcnt(12)
  v_mfma_f32_32x32x16_bf16 v[32:47], v[68:71], v[120:123], v[32:47]
  buffer_load_dwordx4 v[116:119], v2, s[20:23], s30 offen offset:1024
  s_waitcnt vmcnt(34)
  s_waitcnt lgkmcnt(10)
  v_mfma_f32_32x32x16_bf16 v[16:31], v[72:75], v[124:127], v[16:31]
  ds_read_b64_tr_b16 v[64:65], v3 offset:45056
  ds_read_b64_tr_b16 v[66:67], v3 offset:46080
  ds_read_b64_tr_b16 v[68:69], v13 offset:45056
  ds_read_b64_tr_b16 v[70:71], v13 offset:46080
  s_waitcnt lgkmcnt(12)
  v_mfma_f32_32x32x16_bf16 v[32:47], v[76:79], v[124:127], v[32:47]
  buffer_load_dwordx4 v[120:123], v2, s[20:23], s30 offen offset:2048
  s_waitcnt vmcnt(34)
  s_waitcnt lgkmcnt(10)
  v_mfma_f32_32x32x16_bf16 v[16:31], v[48:51], v[128:131], v[16:31]
  ds_read_b64_tr_b16 v[72:73], v3 offset:47104
  ds_read_b64_tr_b16 v[74:75], v3 offset:48128
  ds_read_b64_tr_b16 v[76:77], v13 offset:47104
  ds_read_b64_tr_b16 v[78:79], v13 offset:48128
  s_waitcnt lgkmcnt(12)
  v_mfma_f32_32x32x16_bf16 v[32:47], v[52:55], v[128:131], v[32:47]
  buffer_load_dwordx4 v[124:127], v2, s[20:23], s30 offen offset:3072
  s_waitcnt vmcnt(30)
  s_waitcnt lgkmcnt(10)
  v_mfma_f32_32x32x16_bf16 v[16:31], v[56:59], v[132:135], v[16:31]
  s_barrier
  s_waitcnt lgkmcnt(8)
  v_mfma_f32_32x32x16_bf16 v[32:47], v[60:63], v[132:135], v[32:47]
  ds_read_b64_tr_b16 v[48:49], v3 offset:49152
  ds_read_b64_tr_b16 v[50:51], v3 offset:50176
  ds_read_b64_tr_b16 v[52:53], v13 offset:49152
  ds_read_b64_tr_b16 v[54:55], v13 offset:50176
  s_add_u32 s30, s30, 4096
  buffer_load_dwordx4 v[128:131], v2, s[20:23], s30 offen offset:0
  s_add_u32 m0, s29, 16384
  s_add_u32 s31, s28, 6815744
  buffer_load_dwordx4 v15, s[16:19], s31 offen lds
  s_waitcnt vmcnt(31)
  s_waitcnt lgkmcnt(10)
  v_mfma_f32_32x32x16_bf16 v[16:31], v[64:67], v[136:139], v[16:31]
  ds_read_b64_tr_b16 v[56:57], v3 offset:51200
  ds_read_b64_tr_b16 v[58:59], v3 offset:52224
  ds_read_b64_tr_b16 v[60:61], v13 offset:51200
  ds_read_b64_tr_b16 v[62:63], v13 offset:52224
  s_waitcnt lgkmcnt(12)
  v_mfma_f32_32x32x16_bf16 v[32:47], v[68:71], v[136:139], v[32:47]
  s_add_u32 m0, s29, 17408
  s_add_u32 s31, s28, 6832128
  buffer_load_dwordx4 v15, s[16:19], s31 offen lds
  s_add_u32 m0, s29, 18432
  s_add_u32 s31, s28, 6848512
  buffer_load_dwordx4 v15, s[16:19], s31 offen lds
  s_waitcnt vmcnt(32)
  s_waitcnt lgkmcnt(10)
  v_mfma_f32_32x32x16_bf16 v[16:31], v[72:75], v[140:143], v[16:31]
  ds_read_b64_tr_b16 v[64:65], v3 offset:53248
  ds_read_b64_tr_b16 v[66:67], v3 offset:54272
  ds_read_b64_tr_b16 v[68:69], v13 offset:53248
  ds_read_b64_tr_b16 v[70:71], v13 offset:54272
  s_waitcnt lgkmcnt(12)
  v_mfma_f32_32x32x16_bf16 v[32:47], v[76:79], v[140:143], v[32:47]
  s_add_u32 m0, s29, 19456
  s_add_u32 s31, s28, 6864896
  buffer_load_dwordx4 v15, s[16:19], s31 offen lds
  buffer_load_dwordx4 v[132:135], v2, s[20:23], s30 offen offset:1024
  s_waitcnt vmcnt(33)
  s_waitcnt lgkmcnt(10)
  v_mfma_f32_32x32x16_bf16 v[16:31], v[48:51], v[144:147], v[16:31]
  ds_read_b64_tr_b16 v[72:73], v3 offset:55296
  ds_read_b64_tr_b16 v[74:75], v3 offset:56320
  ds_read_b64_tr_b16 v[76:77], v13 offset:55296
  ds_read_b64_tr_b16 v[78:79], v13 offset:56320
  s_waitcnt lgkmcnt(12)
  v_mfma_f32_32x32x16_bf16 v[32:47], v[52:55], v[144:147], v[32:47]
  buffer_load_dwordx4 v[136:139], v2, s[20:23], s30 offen offset:2048
  buffer_load_dwordx4 v[140:143], v2, s[20:23], s30 offen offset:3072
  s_waitcnt vmcnt(34)
  s_waitcnt lgkmcnt(10)
  v_mfma_f32_32x32x16_bf16 v[16:31], v[56:59], v[148:151], v[16:31]
  ds_read_b64_tr_b16 v[48:49], v3 offset:57344
  ds_read_b64_tr_b16 v[50:51], v3 offset:58368
  ds_read_b64_tr_b16 v[52:53], v13 offset:57344
  ds_read_b64_tr_b16 v[54:55], v13 offset:58368
  s_waitcnt lgkmcnt(12)
  v_mfma_f32_32x32x16_bf16 v[32:47], v[60:63], v[148:151], v[32:47]
  s_add_u32 s30, s30, 4096
  buffer_load_dwordx4 v[144:147], v2, s[20:23], s30 offen offset:0
  s_waitcnt vmcnt(34)
  s_waitcnt lgkmcnt(10)
  v_mfma_f32_32x32x16_bf16 v[16:31], v[64:67], v[152:155], v[16:31]
  ds_read_b64_tr_b16 v[56:57], v3 offset:59392
  ds_read_b64_tr_b16 v[58:59], v3 offset:60416
  ds_read_b64_tr_b16 v[60:61], v13 offset:59392
  ds_read_b64_tr_b16 v[62:63], v13 offset:60416
  s_waitcnt lgkmcnt(12)
  v_mfma_f32_32x32x16_bf16 v[32:47], v[68:71], v[152:155], v[32:47]
  buffer_load_dwordx4 v[148:151], v2, s[20:23], s30 offen offset:1024
  s_waitcnt vmcnt(34)
  s_waitcnt lgkmcnt(10)
  v_mfma_f32_32x32x16_bf16 v[16:31], v[72:75], v[156:159], v[16:31]
  ds_read_b64_tr_b16 v[64:65], v3 offset:61440
  ds_read_b64_tr_b16 v[66:67], v3 offset:62464
  ds_read_b64_tr_b16 v[68:69], v13 offset:61440
  ds_read_b64_tr_b16 v[70:71], v13 offset:62464
  s_waitcnt lgkmcnt(12)
  v_mfma_f32_32x32x16_bf16 v[32:47], v[76:79], v[156:159], v[32:47]
  buffer_load_dwordx4 v[152:155], v2, s[20:23], s30 offen offset:2048
  s_waitcnt vmcnt(34)
  s_waitcnt lgkmcnt(10)
  v_mfma_f32_32x32x16_bf16 v[16:31], v[48:51], v[160:163], v[16:31]
  ds_read_b64_tr_b16 v[72:73], v3 offset:63488
  ds_read_b64_tr_b16 v[74:75], v3 offset:64512
  ds_read_b64_tr_b16 v[76:77], v13 offset:63488
  ds_read_b64_tr_b16 v[78:79], v13 offset:64512
  s_waitcnt lgkmcnt(12)
  v_mfma_f32_32x32x16_bf16 v[32:47], v[52:55], v[160:163], v[32:47]
  buffer_load_dwordx4 v[156:159], v2, s[20:23], s30 offen offset:3072
  s_waitcnt vmcnt(30)
  s_waitcnt lgkmcnt(10)
  v_mfma_f32_32x32x16_bf16 v[16:31], v[56:59], v[164:167], v[16:31]
  s_barrier
  s_waitcnt lgkmcnt(8)
  v_mfma_f32_32x32x16_bf16 v[32:47], v[60:63], v[164:167], v[32:47]
  ds_read_b64_tr_b16 v[48:49], v12 offset:0
  ds_read_b64_tr_b16 v[50:51], v12 offset:1024
  ds_read_b64_tr_b16 v[52:53], v14 offset:0
  ds_read_b64_tr_b16 v[54:55], v14 offset:1024
  s_add_u32 s30, s30, 4096
  buffer_load_dwordx4 v[160:163], v2, s[20:23], s30 offen offset:0
  s_add_u32 m0, s29, 32768
  s_add_u32 s31, s28, 7077888
  buffer_load_dwordx4 v15, s[16:19], s31 offen lds
  s_waitcnt vmcnt(31)
  s_waitcnt lgkmcnt(10)
  v_mfma_f32_32x32x16_bf16 v[16:31], v[64:67], v[168:171], v[16:31]
  ds_read_b64_tr_b16 v[56:57], v12 offset:2048
  ds_read_b64_tr_b16 v[58:59], v12 offset:3072
  ds_read_b64_tr_b16 v[60:61], v14 offset:2048
  ds_read_b64_tr_b16 v[62:63], v14 offset:3072
  s_waitcnt lgkmcnt(12)
  v_mfma_f32_32x32x16_bf16 v[32:47], v[68:71], v[168:171], v[32:47]
  s_add_u32 m0, s29, 33792
  s_add_u32 s31, s28, 7094272
  buffer_load_dwordx4 v15, s[16:19], s31 offen lds
  s_add_u32 m0, s29, 34816
  s_add_u32 s31, s28, 7110656
  buffer_load_dwordx4 v15, s[16:19], s31 offen lds
  s_waitcnt vmcnt(32)
  s_waitcnt lgkmcnt(10)
  v_mfma_f32_32x32x16_bf16 v[16:31], v[72:75], v[172:175], v[16:31]
  ds_read_b64_tr_b16 v[64:65], v12 offset:4096
  ds_read_b64_tr_b16 v[66:67], v12 offset:5120
  ds_read_b64_tr_b16 v[68:69], v14 offset:4096
  ds_read_b64_tr_b16 v[70:71], v14 offset:5120
  s_waitcnt lgkmcnt(12)
  v_mfma_f32_32x32x16_bf16 v[32:47], v[76:79], v[172:175], v[32:47]
  s_add_u32 m0, s29, 35840
  s_add_u32 s31, s28, 7127040
  buffer_load_dwordx4 v15, s[16:19], s31 offen lds
  buffer_load_dwordx4 v[164:167], v2, s[20:23], s30 offen offset:1024
  s_waitcnt vmcnt(33)
  s_waitcnt lgkmcnt(10)
  v_mfma_f32_32x32x16_bf16 v[16:31], v[48:51], v[80:83], v[16:31]
  ds_read_b64_tr_b16 v[72:73], v12 offset:6144
  ds_read_b64_tr_b16 v[74:75], v12 offset:7168
  ds_read_b64_tr_b16 v[76:77], v14 offset:6144
  ds_read_b64_tr_b16 v[78:79], v14 offset:7168
  s_waitcnt lgkmcnt(12)
  v_mfma_f32_32x32x16_bf16 v[32:47], v[52:55], v[80:83], v[32:47]
  buffer_load_dwordx4 v[168:171], v2, s[20:23], s30 offen offset:2048
  buffer_load_dwordx4 v[172:175], v2, s[20:23], s30 offen offset:3072
  s_waitcnt vmcnt(34)
  s_waitcnt lgkmcnt(10)
  v_mfma_f32_32x32x16_bf16 v[16:31], v[56:59], v[84:87], v[16:31]
  ds_read_b64_tr_b16 v[48:49], v12 offset:8192
  ds_read_b64_tr_b16 v[50:51], v12 offset:9216
  ds_read_b64_tr_b16 v[52:53], v14 offset:8192
  ds_read_b64_tr_b16 v[54:55], v14 offset:9216
  s_waitcnt lgkmcnt(12)
  v_mfma_f32_32x32x16_bf16 v[32:47], v[60:63], v[84:87], v[32:47]
  s_add_u32 s30, s30, 4096
  buffer_load_dwordx4 v[80:83], v2, s[20:23], s30 offen offset:0
  s_waitcnt vmcnt(34)
  s_waitcnt lgkmcnt(10)
  v_mfma_f32_32x32x16_bf16 v[16:31], v[64:67], v[88:91], v[16:31]
  ds_read_b64_tr_b16 v[56:57], v12 offset:10240
  ds_read_b64_tr_b16 v[58:59], v12 offset:11264
  ds_read_b64_tr_b16 v[60:61], v14 offset:10240
  ds_read_b64_tr_b16 v[62:63], v14 offset:11264
  s_waitcnt lgkmcnt(12)
  v_mfma_f32_32x32x16_bf16 v[32:47], v[68:71], v[88:91], v[32:47]
  buffer_load_dwordx4 v[84:87], v2, s[20:23], s30 offen offset:1024
  s_waitcnt vmcnt(34)
  s_waitcnt lgkmcnt(10)
  v_mfma_f32_32x32x16_bf16 v[16:31], v[72:75], v[92:95], v[16:31]
  ds_read_b64_tr_b16 v[64:65], v12 offset:12288
  ds_read_b64_tr_b16 v[66:67], v12 offset:13312
  ds_read_b64_tr_b16 v[68:69], v14 offset:12288
  ds_read_b64_tr_b16 v[70:71], v14 offset:13312
  s_waitcnt lgkmcnt(12)
  v_mfma_f32_32x32x16_bf16 v[32:47], v[76:79], v[92:95], v[32:47]
  buffer_load_dwordx4 v[88:91], v2, s[20:23], s30 offen offset:2048
  s_waitcnt vmcnt(34)
  s_waitcnt lgkmcnt(10)
  v_mfma_f32_32x32x16_bf16 v[16:31], v[48:51], v[96:99], v[16:31]
  ds_read_b64_tr_b16 v[72:73], v12 offset:14336
  ds_read_b64_tr_b16 v[74:75], v12 offset:15360
  ds_read_b64_tr_b16 v[76:77], v14 offset:14336
  ds_read_b64_tr_b16 v[78:79], v14 offset:15360
  s_waitcnt lgkmcnt(12)
  v_mfma_f32_32x32x16_bf16 v[32:47], v[52:55], v[96:99], v[32:47]
  buffer_load_dwordx4 v[92:95], v2, s[20:23], s30 offen offset:3072
  s_waitcnt vmcnt(30)
  s_waitcnt lgkmcnt(10)
  v_mfma_f32_32x32x16_bf16 v[16:31], v[56:59], v[100:103], v[16:31]
  s_barrier
  s_waitcnt lgkmcnt(8)
  v_mfma_f32_32x32x16_bf16 v[32:47], v[60:63], v[100:103], v[32:47]
  ds_read_b64_tr_b16 v[48:49], v3 offset:0
  ds_read_b64_tr_b16 v[50:51], v3 offset:1024
  ds_read_b64_tr_b16 v[52:53], v13 offset:0
  ds_read_b64_tr_b16 v[54:55], v13 offset:1024
  s_add_u32 s30, s30, 4096
  buffer_load_dwordx4 v[96:99], v2, s[20:23], s30 offen offset:0
  s_waitcnt vmcnt(30)
  s_waitcnt lgkmcnt(10)
  v_mfma_f32_32x32x16_bf16 v[16:31], v[64:67], v[104:107], v[16:31]
  ds_read_b64_tr_b16 v[56:57], v3 offset:2048
  ds_read_b64_tr_b16 v[58:59], v3 offset:3072
  ds_read_b64_tr_b16 v[60:61], v13 offset:2048
  ds_read_b64_tr_b16 v[62:63], v13 offset:3072
  s_waitcnt lgkmcnt(12)
  v_mfma_f32_32x32x16_bf16 v[32:47], v[68:71], v[104:107], v[32:47]
  buffer_load_dwordx4 v[100:103], v2, s[20:23], s30 offen offset:1024
  s_waitcnt vmcnt(30)
  s_waitcnt lgkmcnt(10)
  v_mfma_f32_32x32x16_bf16 v[16:31], v[72:75], v[108:111], v[16:31]
  ds_read_b64_tr_b16 v[64:65], v3 offset:4096
  ds_read_b64_tr_b16 v[66:67], v3 offset:5120
  ds_read_b64_tr_b16 v[68:69], v13 offset:4096
  ds_read_b64_tr_b16 v[70:71], v13 offset:5120
  s_waitcnt lgkmcnt(12)
  v_mfma_f32_32x32x16_bf16 v[32:47], v[76:79], v[108:111], v[32:47]
  buffer_load_dwordx4 v[104:107], v2, s[20:23], s30 offen offset:2048
  s_waitcnt vmcnt(30)
  s_waitcnt lgkmcnt(10)
  v_mfma_f32_32x32x16_bf16 v[16:31], v[48:51], v[112:115], v[16:31]
  ds_read_b64_tr_b16 v[72:73], v3 offset:6144
  ds_read_b64_tr_b16 v[74:75], v3 offset:7168
  ds_read_b64_tr_b16 v[76:77], v13 offset:6144
  ds_read_b64_tr_b16 v[78:79], v13 offset:7168
  s_waitcnt lgkmcnt(12)
  v_mfma_f32_32x32x16_bf16 v[32:47], v[52:55], v[112:115], v[32:47]
  buffer_load_dwordx4 v[108:111], v2, s[20:23], s30 offen offset:3072
  s_waitcnt vmcnt(30)
  s_waitcnt lgkmcnt(10)
  v_mfma_f32_32x32x16_bf16 v[16:31], v[56:59], v[116:119], v[16:31]
  ds_read_b64_tr_b16 v[48:49], v3 offset:8192
  ds_read_b64_tr_b16 v[50:51], v3 offset:9216
  s_waitcnt lgkmcnt(10)
  v_mfma_f32_32x32x16_bf16 v[32:47], v[60:63], v[116:119], v[32:47]
  ds_read_b64_tr_b16 v[52:53], v13 offset:8192
  ds_read_b64_tr_b16 v[54:55], v13 offset:9216
  s_waitcnt vmcnt(29)
  s_waitcnt lgkmcnt(10)
  v_mfma_f32_32x32x16_bf16 v[16:31], v[64:67], v[120:123], v[16:31]
  ds_read_b64_tr_b16 v[56:57], v3 offset:10240
  ds_read_b64_tr_b16 v[58:59], v3 offset:11264
  s_waitcnt lgkmcnt(10)
  v_mfma_f32_32x32x16_bf16 v[32:47], v[68:71], v[120:123], v[32:47]
  ds_read_b64_tr_b16 v[60:61], v13 offset:10240
  ds_read_b64_tr_b16 v[62:63], v13 offset:11264
  s_waitcnt vmcnt(28)
  s_waitcnt lgkmcnt(10)
  v_mfma_f32_32x32x16_bf16 v[16:31], v[72:75], v[124:127], v[16:31]
  ds_read_b64_tr_b16 v[64:65], v3 offset:12288
  ds_read_b64_tr_b16 v[66:67], v3 offset:13312
  s_waitcnt lgkmcnt(10)
  v_mfma_f32_32x32x16_bf16 v[32:47], v[76:79], v[124:127], v[32:47]
  ds_read_b64_tr_b16 v[68:69], v13 offset:12288
  ds_read_b64_tr_b16 v[70:71], v13 offset:13312
  s_waitcnt vmcnt(27)
  s_waitcnt lgkmcnt(10)
  v_mfma_f32_32x32x16_bf16 v[16:31], v[48:51], v[128:131], v[16:31]
  ds_read_b64_tr_b16 v[72:73], v3 offset:14336
  ds_read_b64_tr_b16 v[74:75], v3 offset:15360
  s_waitcnt lgkmcnt(10)
  v_mfma_f32_32x32x16_bf16 v[32:47], v[52:55], v[128:131], v[32:47]
  ds_read_b64_tr_b16 v[76:77], v13 offset:14336
  ds_read_b64_tr_b16 v[78:79], v13 offset:15360
  s_waitcnt vmcnt(22)
  s_waitcnt lgkmcnt(10)
  v_mfma_f32_32x32x16_bf16 v[16:31], v[56:59], v[132:135], v[16:31]
  s_barrier
  s_waitcnt lgkmcnt(8)
  v_mfma_f32_32x32x16_bf16 v[32:47], v[60:63], v[132:135], v[32:47]
  ds_read_b64_tr_b16 v[48:49], v3 offset:16384
  ds_read_b64_tr_b16 v[50:51], v3 offset:17408
  ds_read_b64_tr_b16 v[52:53], v13 offset:16384
  ds_read_b64_tr_b16 v[54:55], v13 offset:17408
  s_waitcnt vmcnt(21)
  s_waitcnt lgkmcnt(10)
  v_mfma_f32_32x32x16_bf16 v[16:31], v[64:67], v[136:139], v[16:31]
  ds_read_b64_tr_b16 v[56:57], v3 offset:18432
  ds_read_b64_tr_b16 v[58:59], v3 offset:19456
  s_waitcnt lgkmcnt(10)
  v_mfma_f32_32x32x16_bf16 v[32:47], v[68:71], v[136:139], v[32:47]
  ds_read_b64_tr_b16 v[60:61], v13 offset:18432
  ds_read_b64_tr_b16 v[62:63], v13 offset:19456
  s_waitcnt vmcnt(20)
  s_waitcnt lgkmcnt(10)
  v_mfma_f32_32x32x16_bf16 v[16:31], v[72:75], v[140:143], v[16:31]
  ds_read_b64_tr_b16 v[64:65], v3 offset:20480
  ds_read_b64_tr_b16 v[66:67], v3 offset:21504
  s_waitcnt lgkmcnt(10)
  v_mfma_f32_32x32x16_bf16 v[32:47], v[76:79], v[140:143], v[32:47]
  ds_read_b64_tr_b16 v[68:69], v13 offset:20480
  ds_read_b64_tr_b16 v[70:71], v13 offset:21504
  s_waitcnt vmcnt(19)
  s_waitcnt lgkmcnt(10)
  v_mfma_f32_32x32x16_bf16 v[16:31], v[48:51], v[144:147], v[16:31]
  ds_read_b64_tr_b16 v[72:73], v3 offset:22528
  ds_read_b64_tr_b16 v[74:75], v3 offset:23552
  s_waitcnt lgkmcnt(10)
  v_mfma_f32_32x32x16_bf16 v[32:47], v[52:55], v[144:147], v[32:47]
  ds_read_b64_tr_b16 v[76:77], v13 offset:22528
  ds_read_b64_tr_b16 v[78:79], v13 offset:23552
  s_waitcnt vmcnt(18)
  s_waitcnt lgkmcnt(10)
  v_mfma_f32_32x32x16_bf16 v[16:31], v[56:59], v[148:151], v[16:31]
  ds_read_b64_tr_b16 v[48:49], v3 offset:24576
  ds_read_b64_tr_b16 v[50:51], v3 offset:25600
  s_waitcnt lgkmcnt(10)
  v_mfma_f32_32x32x16_bf16 v[32:47], v[60:63], v[148:151], v[32:47]
  ds_read_b64_tr_b16 v[52:53], v13 offset:24576
  ds_read_b64_tr_b16 v[54:55], v13 offset:25600
  s_waitcnt vmcnt(17)
  s_waitcnt lgkmcnt(10)
  v_mfma_f32_32x32x16_bf16 v[16:31], v[64:67], v[152:155], v[16:31]
  ds_read_b64_tr_b16 v[56:57], v3 offset:26624
  ds_read_b64_tr_b16 v[58:59], v3 offset:27648
  s_waitcnt lgkmcnt(10)
  v_mfma_f32_32x32x16_bf16 v[32:47], v[68:71], v[152:155], v[32:47]
  ds_read_b64_tr_b16 v[60:61], v13 offset:26624
  ds_read_b64_tr_b16 v[62:63], v13 offset:27648
  s_waitcnt vmcnt(16)
  s_waitcnt lgkmcnt(10)
  v_mfma_f32_32x32x16_bf16 v[16:31], v[72:75], v[156:159], v[16:31]
  ds_read_b64_tr_b16 v[64:65], v3 offset:28672
  ds_read_b64_tr_b16 v[66:67], v3 offset:29696
  s_waitcnt lgkmcnt(10)
  v_mfma_f32_32x32x16_bf16 v[32:47], v[76:79], v[156:159], v[32:47]
  ds_read_b64_tr_b16 v[68:69], v13 offset:28672
  ds_read_b64_tr_b16 v[70:71], v13 offset:29696
  s_waitcnt vmcnt(15)
  s_waitcnt lgkmcnt(10)
  v_mfma_f32_32x32x16_bf16 v[16:31], v[48:51], v[160:163], v[16:31]
  ds_read_b64_tr_b16 v[72:73], v3 offset:30720
  ds_read_b64_tr_b16 v[74:75], v3 offset:31744
  s_waitcnt lgkmcnt(10)
  v_mfma_f32_32x32x16_bf16 v[32:47], v[52:55], v[160:163], v[32:47]
  ds_read_b64_tr_b16 v[76:77], v13 offset:30720
  ds_read_b64_tr_b16 v[78:79], v13 offset:31744
  s_waitcnt vmcnt(10)
  s_waitcnt lgkmcnt(10)
  v_mfma_f32_32x32x16_bf16 v[16:31], v[56:59], v[164:167], v[16:31]
  s_barrier
  s_waitcnt lgkmcnt(8)
  v_mfma_f32_32x32x16_bf16 v[32:47], v[60:63], v[164:167], v[32:47]
  ds_read_b64_tr_b16 v[48:49], v3 offset:32768
  ds_read_b64_tr_b16 v[50:51], v3 offset:33792
  ds_read_b64_tr_b16 v[52:53], v13 offset:32768
  ds_read_b64_tr_b16 v[54:55], v13 offset:33792
  s_waitcnt vmcnt(9)
  s_waitcnt lgkmcnt(10)
  v_mfma_f32_32x32x16_bf16 v[16:31], v[64:67], v[168:171], v[16:31]
  ds_read_b64_tr_b16 v[56:57], v3 offset:34816
  ds_read_b64_tr_b16 v[58:59], v3 offset:35840
  s_waitcnt lgkmcnt(10)
  v_mfma_f32_32x32x16_bf16 v[32:47], v[68:71], v[168:171], v[32:47]
  ds_read_b64_tr_b16 v[60:61], v13 offset:34816
  ds_read_b64_tr_b16 v[62:63], v13 offset:35840
  s_waitcnt vmcnt(8)
  s_waitcnt lgkmcnt(10)
  v_mfma_f32_32x32x16_bf16 v[16:31], v[72:75], v[172:175], v[16:31]
  ds_read_b64_tr_b16 v[64:65], v3 offset:36864
  ds_read_b64_tr_b16 v[66:67], v3 offset:37888
  s_waitcnt lgkmcnt(10)
  v_mfma_f32_32x32x16_bf16 v[32:47], v[76:79], v[172:175], v[32:47]
  ds_read_b64_tr_b16 v[68:69], v13 offset:36864
  ds_read_b64_tr_b16 v[70:71], v13 offset:37888
  s_waitcnt vmcnt(7)
  s_waitcnt lgkmcnt(10)
  v_mfma_f32_32x32x16_bf16 v[16:31], v[48:51], v[80:83], v[16:31]
  ds_read_b64_tr_b16 v[72:73], v3 offset:38912
  ds_read_b64_tr_b16 v[74:75], v3 offset:39936
  s_waitcnt lgkmcnt(10)
  v_mfma_f32_32x32x16_bf16 v[32:47], v[52:55], v[80:83], v[32:47]
  ds_read_b64_tr_b16 v[76:77], v13 offset:38912
  ds_read_b64_tr_b16 v[78:79], v13 offset:39936
  s_waitcnt vmcnt(6)
  s_waitcnt lgkmcnt(10)
  v_mfma_f32_32x32x16_bf16 v[16:31], v[56:59], v[84:87], v[16:31]
  ds_read_b64_tr_b16 v[48:49], v3 offset:40960
  ds_read_b64_tr_b16 v[50:51], v3 offset:41984
  s_waitcnt lgkmcnt(10)
  v_mfma_f32_32x32x16_bf16 v[32:47], v[60:63], v[84:87], v[32:47]
  ds_read_b64_tr_b16 v[52:53], v13 offset:40960
  ds_read_b64_tr_b16 v[54:55], v13 offset:41984
  s_waitcnt vmcnt(5)
  s_waitcnt lgkmcnt(10)
  v_mfma_f32_32x32x16_bf16 v[16:31], v[64:67], v[88:91], v[16:31]
  ds_read_b64_tr_b16 v[56:57], v3 offset:43008
  ds_read_b64_tr_b16 v[58:59], v3 offset:44032
  s_waitcnt lgkmcnt(10)
  v_mfma_f32_32x32x16_bf16 v[32:47], v[68:71], v[88:91], v[32:47]
  ds_read_b64_tr_b16 v[60:61], v13 offset:43008
  ds_read_b64_tr_b16 v[62:63], v13 offset:44032
  s_waitcnt vmcnt(4)
  s_waitcnt lgkmcnt(10)
  v_mfma_f32_32x32x16_bf16 v[16:31], v[72:75], v[92:95], v[16:31]
  ds_read_b64_tr_b16 v[64:65], v3 offset:45056
  ds_read_b64_tr_b16 v[66:67], v3 offset:46080
  s_waitcnt lgkmcnt(10)
  v_mfma_f32_32x32x16_bf16 v[32:47], v[76:79], v[92:95], v[32:47]
  ds_read_b64_tr_b16 v[68:69], v13 offset:45056
  ds_read_b64_tr_b16 v[70:71], v13 offset:46080
  s_waitcnt vmcnt(3)
  s_waitcnt lgkmcnt(10)
  v_mfma_f32_32x32x16_bf16 v[16:31], v[48:51], v[96:99], v[16:31]
  ds_read_b64_tr_b16 v[72:73], v3 offset:47104
  ds_read_b64_tr_b16 v[74:75], v3 offset:48128
  s_waitcnt lgkmcnt(10)
  v_mfma_f32_32x32x16_bf16 v[32:47], v[52:55], v[96:99], v[32:47]
  ds_read_b64_tr_b16 v[76:77], v13 offset:47104
  ds_read_b64_tr_b16 v[78:79], v13 offset:48128
  s_waitcnt vmcnt(2)
  s_waitcnt lgkmcnt(10)
  v_mfma_f32_32x32x16_bf16 v[16:31], v[56:59], v[100:103], v[16:31]
  s_waitcnt lgkmcnt(8)
  v_mfma_f32_32x32x16_bf16 v[32:47], v[60:63], v[100:103], v[32:47]
  s_waitcnt vmcnt(1)
  s_waitcnt lgkmcnt(6)
  v_mfma_f32_32x32x16_bf16 v[16:31], v[64:67], v[104:107], v[16:31]
  s_waitcnt lgkmcnt(4)
  v_mfma_f32_32x32x16_bf16 v[32:47], v[68:71], v[104:107], v[32:47]
  s_waitcnt vmcnt(0)
  s_waitcnt lgkmcnt(2)
  v_mfma_f32_32x32x16_bf16 v[16:31], v[72:75], v[108:111], v[16:31]
  s_waitcnt lgkmcnt(0)
  v_mfma_f32_32x32x16_bf16 v[32:47], v[76:79], v[108:111], v[32:47]
  s_mov_b32 s16, s12
  s_and_b32 s17, s13, 0xffff
  s_mov_b32 s18, 4194304
  s_mov_b32 s19, 0x00020000
  ds_read_b128 v[192:195], v10 offset:0
  ds_read_b128 v[196:199], v10 offset:32
  ds_read_b128 v[200:203], v10 offset:64
  ds_read_b128 v[204:207], v10 offset:96
  ds_read_b128 v[208:211], v10 offset:128
  ds_read_b128 v[212:215], v10 offset:160
  ds_read_b128 v[216:219], v10 offset:192
  ds_read_b128 v[220:223], v10 offset:224
  s_waitcnt lgkmcnt(0)
  v_lshlrev_b32 v48, 16, v176
  v_and_b32 v49, 0xffff0000, v176
  v_lshlrev_b32 v50, 16, v177
  v_and_b32 v51, 0xffff0000, v177
  v_lshlrev_b32 v52, 16, v178
  v_and_b32 v53, 0xffff0000, v178
  v_lshlrev_b32 v54, 16, v179
  v_and_b32 v55, 0xffff0000, v179
  v_lshlrev_b32 v56, 16, v180
  v_and_b32 v57, 0xffff0000, v180
  v_lshlrev_b32 v58, 16, v181
  v_and_b32 v59, 0xffff0000, v181
  v_lshlrev_b32 v60, 16, v182
  v_and_b32 v61, 0xffff0000, v182
  v_lshlrev_b32 v62, 16, v183
  v_and_b32 v63, 0xffff0000, v183
  v_mul_f32 v16, v11, v16
  v_mul_f32 v17, v11, v17
  v_mul_f32 v18, v11, v18
  v_mul_f32 v19, v11, v19
  v_mul_f32 v20, v11, v20
  v_mul_f32 v21, v11, v21
  v_mul_f32 v22, v11, v22
  v_mul_f32 v23, v11, v23
  v_mul_f32 v24, v11, v24
  v_mul_f32 v25, v11, v25
  v_mul_f32 v26, v11, v26
  v_mul_f32 v27, v11, v27
  v_mul_f32 v28, v11, v28
  v_mul_f32 v29, v11, v29
  v_mul_f32 v30, v11, v30
  v_mul_f32 v31, v11, v31
  v_fmac_f32 v48, v192, v16
  v_fmac_f32 v49, v193, v17
  v_fmac_f32 v50, v194, v18
  v_fmac_f32 v51, v195, v19
  v_fmac_f32 v52, v196, v20
  v_fmac_f32 v53, v197, v21
  v_fmac_f32 v54, v198, v22
  v_fmac_f32 v55, v199, v23
  v_fmac_f32 v56, v200, v24
  v_fmac_f32 v57, v201, v25
  v_fmac_f32 v58, v202, v26
  v_fmac_f32 v59, v203, v27
  v_fmac_f32 v60, v204, v28
  v_fmac_f32 v61, v205, v29
  v_fmac_f32 v62, v206, v30
  v_fmac_f32 v63, v207, v31
  v_cvt_pk_bf16_f32 v16, v48, v49
  v_cvt_pk_bf16_f32 v17, v50, v51
  v_cvt_pk_bf16_f32 v18, v52, v53
  v_cvt_pk_bf16_f32 v19, v54, v55
  v_cvt_pk_bf16_f32 v20, v56, v57
  v_cvt_pk_bf16_f32 v21, v58, v59
  v_cvt_pk_bf16_f32 v22, v60, v61
  v_cvt_pk_bf16_f32 v23, v62, v63
  v_lshlrev_b32 v64, 16, v184
  v_and_b32 v65, 0xffff0000, v184
  v_lshlrev_b32 v66, 16, v185
  v_and_b32 v67, 0xffff0000, v185
  v_lshlrev_b32 v68, 16, v186
  v_and_b32 v69, 0xffff0000, v186
  v_lshlrev_b32 v70, 16, v187
  v_and_b32 v71, 0xffff0000, v187
  v_lshlrev_b32 v72, 16, v188
  v_and_b32 v73, 0xffff0000, v188
  v_lshlrev_b32 v74, 16, v189
  v_and_b32 v75, 0xffff0000, v189
  v_lshlrev_b32 v76, 16, v190
  v_and_b32 v77, 0xffff0000, v190
  v_lshlrev_b32 v78, 16, v191
  v_and_b32 v79, 0xffff0000, v191
  v_mul_f32 v32, v11, v32
  v_mul_f32 v33, v11, v33
  v_mul_f32 v34, v11, v34
  v_mul_f32 v35, v11, v35
  v_mul_f32 v36, v11, v36
  v_mul_f32 v37, v11, v37
  v_mul_f32 v38, v11, v38
  v_mul_f32 v39, v11, v39
  v_mul_f32 v40, v11, v40
  v_mul_f32 v41, v11, v41
  v_mul_f32 v42, v11, v42
  v_mul_f32 v43, v11, v43
  v_mul_f32 v44, v11, v44
  v_mul_f32 v45, v11, v45
  v_mul_f32 v46, v11, v46
  v_mul_f32 v47, v11, v47
  v_fmac_f32 v64, v208, v32
  v_fmac_f32 v65, v209, v33
  v_fmac_f32 v66, v210, v34
  v_fmac_f32 v67, v211, v35
  v_fmac_f32 v68, v212, v36
  v_fmac_f32 v69, v213, v37
  v_fmac_f32 v70, v214, v38
  v_fmac_f32 v71, v215, v39
  v_fmac_f32 v72, v216, v40
  v_fmac_f32 v73, v217, v41
  v_fmac_f32 v74, v218, v42
  v_fmac_f32 v75, v219, v43
  v_fmac_f32 v76, v220, v44
  v_fmac_f32 v77, v221, v45
  v_fmac_f32 v78, v222, v46
  v_fmac_f32 v79, v223, v47
  v_cvt_pk_bf16_f32 v32, v64, v65
  v_cvt_pk_bf16_f32 v33, v66, v67
  v_cvt_pk_bf16_f32 v34, v68, v69
  v_cvt_pk_bf16_f32 v35, v70, v71
  v_cvt_pk_bf16_f32 v36, v72, v73
  v_cvt_pk_bf16_f32 v37, v74, v75
  v_cvt_pk_bf16_f32 v38, v76, v77
  v_cvt_pk_bf16_f32 v39, v78, v79
  v_and_b32 v5, 31, v1
  v_mul_u32_u24 v7, 144, v5
  v_lshl_add_u32 v7, v6, 3, v7
  s_mul_i32 s34, s3, 4608
  s_add_u32 s34, s34, 82944
  v_add_u32 v7, s34, v7
  v_lshrrev_b32 v8, 3, v1
  v_mul_u32_u24 v9, 144, v8
  v_and_b32 v5, 7, v1
  v_lshl_add_u32 v9, v5, 4, v9
  v_add_u32 v9, s34, v9
  s_lshl_b32 s34, s33, 5
  v_add_u32 v8, s34, v8
  v_lshlrev_b32 v8, 11, v8
  v_lshl_add_u32 v8, v5, 4, v8
  s_lshl_b32 s35, s9, 7
  ds_write_b64 v7, v[16:17] offset:0
  ds_write_b64 v7, v[18:19] offset:16
  ds_write_b64 v7, v[20:21] offset:32
  ds_write_b64 v7, v[22:23] offset:48
  ds_write_b64 v7, v[32:33] offset:64
  ds_write_b64 v7, v[34:35] offset:80
  ds_write_b64 v7, v[36:37] offset:96
  ds_write_b64 v7, v[38:39] offset:112
  ds_read_b128 v[48:51], v9 offset:0
  ds_read_b128 v[52:55], v9 offset:1152
  ds_read_b128 v[56:59], v9 offset:2304
  ds_read_b128 v[60:63], v9 offset:3456
  s_waitcnt lgkmcnt(3)
  s_add_u32 s36, s35, 0
  buffer_store_dwordx4 v[48:51], v8, s[16:19], s36 offen sc1
  s_waitcnt lgkmcnt(2)
  s_add_u32 s36, s35, 16384
  buffer_store_dwordx4 v[52:55], v8, s[16:19], s36 offen sc1
  s_waitcnt lgkmcnt(1)
  s_add_u32 s36, s35, 32768
  buffer_store_dwordx4 v[56:59], v8, s[16:19], s36 offen sc1
  s_waitcnt lgkmcnt(0)
  s_add_u32 s36, s35, 49152
  buffer_store_dwordx4 v[60:63], v8, s[16:19], s36 offen sc1
k6_end:
  s_endpgm
.section .rodata,"a"
.p2align 6
.amdhsa_kernel k1_kernel
  .amdhsa_next_free_vgpr 128
  .amdhsa_next_free_sgpr 102
  .amdhsa_accum_offset 128
  .amdhsa_group_segment_fixed_size 0
  .amdhsa_kernarg_size 112
  .amdhsa_user_sgpr_count 2
  .amdhsa_user_sgpr_kernarg_segment_ptr 1
  .amdhsa_system_sgpr_workgroup_id_x 1
.end_amdhsa_kernel
.p2align 6
.amdhsa_kernel k2_kernel
  .amdhsa_next_free_vgpr 512
  .amdhsa_next_free_sgpr 102
  .amdhsa_accum_offset 256
  .amdhsa_group_segment_fixed_size 0
  .amdhsa_kernarg_size 112
  .amdhsa_user_sgpr_count 2
  .amdhsa_user_sgpr_kernarg_segment_ptr 1
  .amdhsa_system_sgpr_workgroup_id_x 1
.end_amdhsa_kernel
.p2align 6
.amdhsa_kernel k3_kernel
  .amdhsa_next_free_vgpr 184
  .amdhsa_next_free_sgpr 102
  .amdhsa_accum_offset 184
  .amdhsa_group_segment_fixed_size 0
  .amdhsa_kernarg_size 112
  .amdhsa_user_sgpr_count 2
  .amdhsa_user_sgpr_kernarg_segment_ptr 1
  .amdhsa_system_sgpr_workgroup_id_x 1
.end_amdhsa_kernel
.p2align 6
.amdhsa_kernel k4_kernel
  .amdhsa_next_free_vgpr 184
  .amdhsa_next_free_sgpr 102
  .amdhsa_accum_offset 184
  .amdhsa_group_segment_fixed_size 0
  .amdhsa_kernarg_size 112
  .amdhsa_user_sgpr_count 2
  .amdhsa_user_sgpr_kernarg_segment_ptr 1
  .amdhsa_system_sgpr_workgroup_id_x 1
.end_amdhsa_kernel
.p2align 6
.amdhsa_kernel k5_kernel
  .amdhsa_next_free_vgpr 512
  .amdhsa_next_free_sgpr 102
  .amdhsa_accum_offset 256
  .amdhsa_group_segment_fixed_size 0
  .amdhsa_kernarg_size 112
  .amdhsa_user_sgpr_count 2
  .amdhsa_user_sgpr_kernarg_segment_ptr 1
  .amdhsa_system_sgpr_workgroup_id_x 1
.end_amdhsa_kernel
.p2align 6
.amdhsa_kernel k6_kernel
  .amdhsa_next_free_vgpr 256
  .amdhsa_next_free_sgpr 102
  .amdhsa_accum_offset 256
  .amdhsa_group_segment_fixed_size 0
  .amdhsa_kernarg_size 112
  .amdhsa_user_sgpr_count 2
  .amdhsa_user_sgpr_kernarg_segment_ptr 1
  .amdhsa_system_sgpr_workgroup_id_x 1
.end_amdhsa_kernel
```
